```python
import torch

def _softmax(x, axis=-1):
    return torch.softmax(x, dim=axis)
def _gelu(x):
    return torch.nn.functional.gelu(x, approximate="tanh")
def _silu(x):
    return torch.nn.functional.silu(x)
def _sigmoid(x):
    return torch.sigmoid(x)
def _layernorm(x, axis=-1, eps=1e-5):
    m = x.mean(dim=axis, keepdim=True)
    v = x.var(dim=axis, keepdim=True, unbiased=False)
    return (x - m) / torch.sqrt(v + eps)
def _scatter_add(tgt, idx, src, axis=0):
    return tgt.clone().index_add_(axis, idx, src)
def _segment_sum(src, seg, n):
    out = torch.zeros((n,) + src.shape[1:], dtype=src.dtype)
    return out.index_add_(0, seg, src)
def _pad(x, pw):
    flat = tuple(v for pair in reversed(pw) for v in pair)
    return torch.nn.functional.pad(x, flat)

kernel_name = 'standalone__mha_block_cached__near_ridge'

def setup_inputs():

    _w = (lambda a: (lambda t: t.to(torch.bfloat16) if t.is_floating_point() else t)(torch.as_tensor(a)))
    B, Sq, D = 8, 304, 512
    H, Sk, Dh = 32, 1024, 128
    return {
        "x": _w((lambda *s: torch.randn(*s, dtype=torch.bfloat16) * 0.8)(B, Sq, D)),
        "k_cache": _w((lambda *s: torch.randn(*s, dtype=torch.bfloat16) * 0.8)(B, H, Sk, Dh)),
        "v_cache": _w((lambda *s: torch.randn(*s, dtype=torch.bfloat16) * 0.05)(B, H, Sk, Dh)),
        "wq": _w((lambda *s: torch.randn(*s, dtype=torch.bfloat16) * 0.8)(D, H * Dh) * (D ** -0.5)),
        "wo": _w((lambda *s: torch.randn(*s, dtype=torch.bfloat16) * 0.05)(H * Dh, D) * ((H * Dh) ** -0.5)),
    }

def reference(x, k_cache, v_cache, wq, wo):
    B, Sq, D = x.shape
    H, Dh = 32, 128
    q = (lambda x, *d: x.permute(*d))((x @ wq).reshape(B, Sq, H, Dh), 0, 2, 1, 3)
    scores = torch.einsum("bhqd,bhkd->bhqk", q, k_cache) * (Dh ** -0.5)
    p = _softmax(scores, axis=-1)
    o = torch.einsum("bhqk,bhkd->bhqd", p, v_cache)
    return (lambda x, *d: x.permute(*d))(o, 0, 2, 1, 3).reshape(B, Sq, H * Dh) @ wo
```

```asm
; @launch grid=(256,1,1) block=(256,1,1) lds=163840
.amdgcn_target "amdgcn-amd-amdhsa--gfx950"
.text
.globl standalone__mha_block_cached__near_ridge_kernel
.p2align 8
.type standalone__mha_block_cached__near_ridge_kernel,@function
standalone__mha_block_cached__near_ridge_kernel:
    s_getpc_b64 s[100:101]
    s_cmp_ge_u32 s2, 256
    s_cbranch_scc1 L_end
    s_load_dwordx16 s[4:19], s[0:1], 0
    v_lshrrev_b32 v209, 6, v0
    v_and_b32 v204, 63, v0
    v_readfirstlane_b32 s40, v209
    s_and_b32 s86, s2, 7
    s_lshr_b32 s85, s2, 3
    s_and_b32 s41, s2, 3
    s_lshl_b32 s41, s41, 1
    s_and_b32 s50, s85, 1
    s_add_u32 s41, s41, s50
    s_bfe_u32 s42, s2, 0x10002
    s_lshl_b32 s42, s42, 4
    s_lshr_b32 s50, s2, 4
    s_add_u32 s42, s42, s50
    v_and_b32 v205, 15, v204
    v_lshrrev_b32 v206, 4, v204
    v_lshlrev_b32 v209, 2, v206
    v_xor_b32 v209, v209, v205
    v_lshlrev_b32 v209, 4, v209
    v_lshl_add_u32 v209, v206, 13, v209
    s_lshl_b32 s50, s40, 16
    v_add_u32 v196, s50, v209
    v_add_u32 v197, 31744, v196
    s_lshl_b32 s44, s40, 11
    s_add_u32 s44, s44, 32768
    v_and_b32 v209, 7, v204
    v_xor_b32 v209, v209, v206
    v_lshlrev_b32 v209, 4, v209
    v_lshrrev_b32 v210, 3, v204
    v_lshl_add_u32 v209, v210, 10, v209
    s_mul_i32 s50, s40, 81920
    v_add_u32 v192, s50, v209
    v_xor_b32 v193, 64, v192
    v_add_u32 v193, 7168, v193
    v_add_u32 v194, 14336, v192
    v_add_u32 v195, 14336, v193
    s_mul_i32 s43, s40, 10240
    s_add_u32 s43, s43, 81920
    s_add_u32 s49, s42, s41
    s_lshl_b32 s49, s49, 7
    s_and_b32 s49, s49, 0x3ff
    s_mul_i32 s50, s41, 311296
    s_lshl_b32 s51, s42, 8
    s_mov_b32 s22, 311296
    s_mov_b32 s23, 0x20000
    s_sub_u32 s26, 4194304, s51
    s_mov_b32 s27, 0x20000
    s_waitcnt lgkmcnt(0)
    s_add_u32 s24, s10, s51
    s_addc_u32 s25, s11, 0
    s_add_u32 s20, s4, s50
    s_addc_u32 s21, s5, 0
    s_cmp_eq_u32 s40, 3
    s_cbranch_scc1 L_w3
    s_add_u32 s51, s49, 0
    s_bfe_u32 s51, s51, 0x0a0000
    s_add_u32 m0, s44, 0
    s_lshl_b32 s51, s51, 12
    buffer_load_dwordx4 v196, s[24:27], s51 offen offset:0 lds
    buffer_load_dwordx4 v197, s[24:27], s51 offen offset:1024 lds
    s_add_u32 s50, s49, 0
    s_bfe_u32 s50, s50, 0x0a0000
    s_add_u32 m0, s43, 0
    s_nop 0
    buffer_load_dwordx4 v192, s[20:23], s50 offen offset:0 lds
    buffer_load_dwordx4 v193, s[20:23], s50 offen offset:1024 lds
    buffer_load_dwordx4 v194, s[20:23], s50 offen offset:2048 lds
    buffer_load_dwordx4 v195, s[20:23], s50 offen offset:3072 lds
    s_add_u32 s50, s50, 0x8000
    s_add_u32 m0, s43, 4096
    s_nop 0
    buffer_load_dwordx4 v192, s[20:23], s50 offen offset:0 lds
    buffer_load_dwordx4 v193, s[20:23], s50 offen offset:1024 lds
    buffer_load_dwordx4 v194, s[20:23], s50 offen offset:2048 lds
    buffer_load_dwordx4 v195, s[20:23], s50 offen offset:3072 lds
    s_add_u32 s50, s50, 0x8000
    s_add_u32 m0, s43, 8192
    s_nop 0
    buffer_load_dwordx4 v192, s[20:23], s50 offen offset:0 lds
    buffer_load_dwordx4 v193, s[20:23], s50 offen offset:1024 lds
    s_add_u32 s51, s49, 64
    s_bfe_u32 s51, s51, 0x0a0000
    s_add_u32 m0, s44, 8192
    s_lshl_b32 s51, s51, 12
    buffer_load_dwordx4 v196, s[24:27], s51 offen offset:0 lds
    buffer_load_dwordx4 v197, s[24:27], s51 offen offset:1024 lds
    v_bfe_u32 v207, v204, 2, 2
    v_and_b32 v208, 3, v204
    v_lshrrev_b32 v209, 1, v205
    v_xor_b32 v209, v209, v206
    v_lshlrev_b32 v209, 4, v209
    v_lshl_add_u32 v209, v205, 7, v209
    v_add_u32 v198, s43, v209
    v_xor_b32 v199, 64, v198
    v_lshl_add_u32 v209, v206, 3, v207
    v_lshlrev_b32 v209, 8, v209
    v_lshl_add_u32 v209, v208, 4, v209
    v_add_u32 v209, 32768, v209
    v_xor_b32 v210, 0, v207
    v_lshl_add_u32 v200, v210, 6, v209
    v_xor_b32 v210, 1, v207
    v_lshl_add_u32 v201, v210, 6, v209
    v_xor_b32 v210, 2, v207
    v_lshl_add_u32 v202, v210, 6, v209
    v_xor_b32 v210, 3, v207
    v_lshl_add_u32 v203, v210, 6, v209
    s_add_u32 s50, s49, 128
    s_bfe_u32 s50, s50, 0x0a0000
    s_add_u32 m0, s43, 40960
    s_nop 0
    buffer_load_dwordx4 v192, s[20:23], s50 offen offset:0 lds
    buffer_load_dwordx4 v193, s[20:23], s50 offen offset:1024 lds
    buffer_load_dwordx4 v194, s[20:23], s50 offen offset:2048 lds
    buffer_load_dwordx4 v195, s[20:23], s50 offen offset:3072 lds
    s_add_u32 s50, s50, 0x8000
    s_add_u32 m0, s43, 45056
    s_nop 0
    buffer_load_dwordx4 v192, s[20:23], s50 offen offset:0 lds
    buffer_load_dwordx4 v193, s[20:23], s50 offen offset:1024 lds
    buffer_load_dwordx4 v194, s[20:23], s50 offen offset:2048 lds
    buffer_load_dwordx4 v195, s[20:23], s50 offen offset:3072 lds
    s_add_u32 s50, s50, 0x8000
    s_add_u32 m0, s43, 49152
    s_nop 0
    buffer_load_dwordx4 v192, s[20:23], s50 offen offset:0 lds
    buffer_load_dwordx4 v193, s[20:23], s50 offen offset:1024 lds
    s_add_u32 s51, s49, 128
    s_bfe_u32 s51, s51, 0x0a0000
    s_add_u32 m0, s44, 16384
    s_lshl_b32 s51, s51, 12
    buffer_load_dwordx4 v196, s[24:27], s51 offen offset:0 lds
    buffer_load_dwordx4 v197, s[24:27], s51 offen offset:1024 lds
    s_waitcnt vmcnt(14)
    s_barrier
    ds_read_b128 a[0:3], v198 offset:0
    ds_read_b128 a[4:7], v198 offset:2048
    ds_read_b128 a[8:11], v198 offset:4096
    ds_read_b128 a[12:15], v198 offset:6144
    ds_read_b128 a[16:19], v198 offset:8192
    ds_read_b64_tr_b16 a[80:81], v200 offset:0
    ds_read_b64_tr_b16 a[82:83], v200 offset:1024
    ds_read_b64_tr_b16 a[84:85], v200 offset:8
    ds_read_b64_tr_b16 a[86:87], v200 offset:1032
    ds_read_b64_tr_b16 a[88:89], v201 offset:0
    ds_read_b64_tr_b16 a[90:91], v201 offset:1024
    ds_read_b64_tr_b16 a[92:93], v201 offset:8
    ds_read_b64_tr_b16 a[94:95], v201 offset:1032
    ds_read_b64_tr_b16 a[96:97], v202 offset:0
    ds_read_b64_tr_b16 a[98:99], v202 offset:1024
    ds_read_b64_tr_b16 a[100:101], v202 offset:8
    ds_read_b64_tr_b16 a[102:103], v202 offset:1032
    ds_read_b64_tr_b16 a[104:105], v203 offset:0
    ds_read_b64_tr_b16 a[106:107], v203 offset:1024
    ds_read_b64_tr_b16 a[108:109], v203 offset:8
    ds_read_b64_tr_b16 a[110:111], v203 offset:1032
    ds_read_b128 a[20:23], v199 offset:0
    ds_read_b128 a[24:27], v199 offset:2048
    ds_read_b128 a[28:31], v199 offset:4096
    ds_read_b128 a[32:35], v199 offset:6144
    ds_read_b128 a[36:39], v199 offset:8192
    s_waitcnt vmcnt(12) lgkmcnt(0)
    s_barrier
    v_mfma_f32_16x16x32_bf16 v[32:35], a[80:83], a[0:3], 0
    s_add_u32 s51, s49, 192
    ds_read_b64_tr_b16 a[112:113], v200 offset:8192
    v_lshlrev_b32 v19, 4, v204
    v_mfma_f32_16x16x32_bf16 v[64:67], a[80:83], a[4:7], 0
    s_bfe_u32 s51, s51, 0x0a0000
    ds_read_b64_tr_b16 a[114:115], v200 offset:9216
    v_mov_b32 v250, 0
    v_mfma_f32_16x16x32_bf16 v[96:99], a[80:83], a[8:11], 0
    s_add_u32 m0, s44, 24576
    ds_read_b64_tr_b16 a[116:117], v200 offset:8200
    v_add_u32 v209, 0, v206
    v_mfma_f32_16x16x32_bf16 v[128:131], a[80:83], a[12:15], 0
    s_lshl_b32 s51, s51, 12
    ds_read_b64_tr_b16 a[118:119], v200 offset:9224
    v_xor_b32 v209, v209, v205
    v_mfma_f32_16x16x32_bf16 v[160:163], a[80:83], a[16:19], 0
    buffer_load_dwordx4 v196, s[24:27], s51 offen offset:0 lds
    v_mfma_f32_16x16x32_bf16 v[36:39], a[84:87], a[0:3], 0
    buffer_load_dwordx4 v197, s[24:27], s51 offen offset:1024 lds
    v_mfma_f32_16x16x32_bf16 v[68:71], a[84:87], a[4:7], 0
    s_add_u32 s50, s49, 256
    ds_read_b64_tr_b16 a[120:121], v201 offset:8192
    v_lshlrev_b32 v209, 4, v209
    v_mfma_f32_16x16x32_bf16 v[100:103], a[84:87], a[8:11], 0
    s_bfe_u32 s50, s50, 0x0a0000
    ds_read_b64_tr_b16 a[122:123], v201 offset:9216
    v_lshl_add_u32 v1, v205, 8, v209
    v_mfma_f32_16x16x32_bf16 v[132:135], a[84:87], a[12:15], 0
    s_add_u32 m0, s43, 0
    ds_read_b64_tr_b16 a[124:125], v201 offset:8200
    v_lshl_add_u32 v13, v206, 8, v209
    v_mfma_f32_16x16x32_bf16 v[164:167], a[84:87], a[16:19], 0
    buffer_load_dwordx4 v192, s[20:23], s50 offen offset:0 lds
    v_mfma_f32_16x16x32_bf16 v[40:43], a[88:91], a[0:3], 0
    ds_read_b64_tr_b16 a[126:127], v201 offset:9224
    v_add_u32 v209, 4, v206
    v_mfma_f32_16x16x32_bf16 v[72:75], a[88:91], a[4:7], 0
    buffer_load_dwordx4 v193, s[20:23], s50 offen offset:1024 lds
    v_mfma_f32_16x16x32_bf16 v[104:107], a[88:91], a[8:11], 0
    ds_read_b64_tr_b16 a[128:129], v202 offset:8192
    v_xor_b32 v209, v209, v205
    v_mfma_f32_16x16x32_bf16 v[136:139], a[88:91], a[12:15], 0
    ds_read_b64_tr_b16 a[130:131], v202 offset:9216
    v_lshlrev_b32 v209, 4, v209
    v_mfma_f32_16x16x32_bf16 v[168:171], a[88:91], a[16:19], 0
    ds_read_b64_tr_b16 a[132:133], v202 offset:8200
    v_lshl_add_u32 v2, v205, 8, v209
    v_mfma_f32_16x16x32_bf16 v[44:47], a[92:95], a[0:3], 0
    buffer_load_dwordx4 v194, s[20:23], s50 offen offset:2048 lds
    v_mfma_f32_16x16x32_bf16 v[76:79], a[92:95], a[4:7], 0
    ds_read_b64_tr_b16 a[134:135], v202 offset:9224
    v_lshl_add_u32 v14, v206, 8, v209
    v_mfma_f32_16x16x32_bf16 v[108:111], a[92:95], a[8:11], 0
    ds_read_b64_tr_b16 a[136:137], v203 offset:8192
    v_add_u32 v209, 8, v206
    v_mfma_f32_16x16x32_bf16 v[140:143], a[92:95], a[12:15], 0
    buffer_load_dwordx4 v195, s[20:23], s50 offen offset:3072 lds
    v_mfma_f32_16x16x32_bf16 v[172:175], a[92:95], a[16:19], 0
    s_add_u32 s50, s50, 0x8000
    ds_read_b64_tr_b16 a[138:139], v203 offset:9216
    v_xor_b32 v209, v209, v205
    v_mfma_f32_16x16x32_bf16 v[48:51], a[96:99], a[0:3], 0
    s_add_u32 m0, s43, 4096
    ds_read_b64_tr_b16 a[140:141], v203 offset:8200
    v_lshlrev_b32 v209, 4, v209
    v_mfma_f32_16x16x32_bf16 v[80:83], a[96:99], a[4:7], 0
    ds_read_b64_tr_b16 a[142:143], v203 offset:9224
    v_lshl_add_u32 v3, v205, 8, v209
    v_mfma_f32_16x16x32_bf16 v[112:115], a[96:99], a[8:11], 0
    buffer_load_dwordx4 v192, s[20:23], s50 offen offset:0 lds
    v_mfma_f32_16x16x32_bf16 v[144:147], a[96:99], a[12:15], 0
    buffer_load_dwordx4 v193, s[20:23], s50 offen offset:1024 lds
    v_mfma_f32_16x16x32_bf16 v[176:179], a[96:99], a[16:19], 0
    s_add_u32 s51, s49, 256
    v_lshl_add_u32 v15, v206, 8, v209
    v_add_u32 v209, 12, v206
    v_mfma_f32_16x16x32_bf16 v[52:55], a[100:103], a[0:3], 0
    s_bfe_u32 s51, s51, 0x0a0000
    v_xor_b32 v209, v209, v205
    v_lshlrev_b32 v209, 4, v209
    v_mfma_f32_16x16x32_bf16 v[84:87], a[100:103], a[4:7], 0
    s_add_u32 m0, s44, 0
    v_lshl_add_u32 v4, v205, 8, v209
    v_lshl_add_u32 v16, v206, 8, v209
    v_mfma_f32_16x16x32_bf16 v[116:119], a[100:103], a[8:11], 0
    s_lshl_b32 s51, s51, 12
    v_lshl_add_u32 v212, v206, 2, v207
    v_and_b32 v210, 7, v212
    v_mfma_f32_16x16x32_bf16 v[148:151], a[100:103], a[12:15], 0
    buffer_load_dwordx4 v196, s[24:27], s51 offen offset:0 lds
    v_mfma_f32_16x16x32_bf16 v[180:183], a[100:103], a[16:19], 0
    buffer_load_dwordx4 v197, s[24:27], s51 offen offset:1024 lds
    v_mfma_f32_16x16x32_bf16 v[56:59], a[104:107], a[0:3], 0
    v_lshlrev_b32 v209, 8, v212
    v_lshl_add_u32 v209, v208, 3, v209
    v_mfma_f32_16x16x32_bf16 v[88:91], a[104:107], a[4:7], 0
    v_add_u32 v209, 65536, v209
    v_xor_b32 v211, 0, v210
    v_mfma_f32_16x16x32_bf16 v[120:123], a[104:107], a[8:11], 0
    v_lshl_add_u32 v5, v211, 5, v209
    v_xor_b32 v211, 1, v210
    v_mfma_f32_16x16x32_bf16 v[152:155], a[104:107], a[12:15], 0
    v_lshl_add_u32 v6, v211, 5, v209
    v_xor_b32 v211, 2, v210
    v_mfma_f32_16x16x32_bf16 v[184:187], a[104:107], a[16:19], 0
    v_lshl_add_u32 v7, v211, 5, v209
    v_xor_b32 v211, 3, v210
    v_mfma_f32_16x16x32_bf16 v[60:63], a[108:111], a[0:3], 0
    v_lshl_add_u32 v8, v211, 5, v209
    v_xor_b32 v211, 4, v210
    v_mfma_f32_16x16x32_bf16 v[92:95], a[108:111], a[4:7], 0
    v_lshl_add_u32 v9, v211, 5, v209
    v_xor_b32 v211, 5, v210
    v_mfma_f32_16x16x32_bf16 v[124:127], a[108:111], a[8:11], 0
    v_lshl_add_u32 v10, v211, 5, v209
    v_xor_b32 v211, 6, v210
    v_mfma_f32_16x16x32_bf16 v[156:159], a[108:111], a[12:15], 0
    s_waitcnt vmcnt(10) lgkmcnt(0)
    v_mfma_f32_16x16x32_bf16 v[188:191], a[108:111], a[16:19], 0
    s_barrier
    v_mfma_f32_16x16x32_bf16 v[32:35], a[112:115], a[20:23], v[32:35]
    s_add_u32 m0, s43, 4096
    ds_read_b64_tr_b16 a[80:81], v200 offset:16384
    v_lshl_add_u32 v11, v211, 5, v209
    v_mfma_f32_16x16x32_bf16 v[64:67], a[112:115], a[24:27], v[64:67]
    buffer_load_dwordx4 v194, s[20:23], s50 offen offset:2048 lds
    v_mfma_f32_16x16x32_bf16 v[96:99], a[112:115], a[28:31], v[96:99]
    ds_read_b128 a[40:43], v198 offset:40960
    v_xor_b32 v211, 7, v210
    v_mfma_f32_16x16x32_bf16 v[128:131], a[112:115], a[32:35], v[128:131]
    ds_read_b64_tr_b16 a[82:83], v200 offset:17408
    v_lshl_add_u32 v12, v211, 5, v209
    v_mfma_f32_16x16x32_bf16 v[160:163], a[112:115], a[36:39], v[160:163]
    ds_read_b128 a[44:47], v198 offset:43008
    v_add_u32 v209, 0, v206
    v_mfma_f32_16x16x32_bf16 v[36:39], a[116:119], a[20:23], v[36:39]
    ds_read_b64_tr_b16 a[84:85], v200 offset:16392
    v_lshlrev_b32 v209, 1, v209
    v_mfma_f32_16x16x32_bf16 v[68:71], a[116:119], a[24:27], v[68:71]
    buffer_load_dwordx4 v195, s[20:23], s50 offen offset:3072 lds
    v_mfma_f32_16x16x32_bf16 v[100:103], a[116:119], a[28:31], v[100:103]
    s_add_u32 s50, s50, 0x8000
    ds_read_b128 a[48:51], v198 offset:45056
    v_xor_b32 v209, v209, v205
    v_mfma_f32_16x16x32_bf16 v[132:135], a[116:119], a[32:35], v[132:135]
    s_add_u32 m0, s43, 8192
    ds_read_b64_tr_b16 a[86:87], v200 offset:17416
    v_lshlrev_b32 v209, 4, v209
    v_mfma_f32_16x16x32_bf16 v[164:167], a[116:119], a[36:39], v[164:167]
    ds_read_b128 a[52:55], v198 offset:47104
    v_lshl_add_u32 v17, v206, 8, v209
    v_mfma_f32_16x16x32_bf16 v[40:43], a[120:123], a[20:23], v[40:43]
    ds_read_b64_tr_b16 a[88:89], v201 offset:16384
    v_add_u32 v209, 4, v206
    v_mfma_f32_16x16x32_bf16 v[72:75], a[120:123], a[24:27], v[72:75]
    ds_read_b128 a[56:59], v198 offset:49152
    v_lshlrev_b32 v209, 1, v209
    v_mfma_f32_16x16x32_bf16 v[104:107], a[120:123], a[28:31], v[104:107]
    buffer_load_dwordx4 v192, s[20:23], s50 offen offset:0 lds
    v_mfma_f32_16x16x32_bf16 v[136:139], a[120:123], a[32:35], v[136:139]
    ds_read_b64_tr_b16 a[90:91], v201 offset:17408
    v_xor_b32 v209, v209, v205
    v_mfma_f32_16x16x32_bf16 v[168:171], a[120:123], a[36:39], v[168:171]
    ds_read_b128 a[60:63], v199 offset:40960
    v_lshlrev_b32 v209, 4, v209
    v_mfma_f32_16x16x32_bf16 v[44:47], a[124:127], a[20:23], v[44:47]
    ds_read_b64_tr_b16 a[92:93], v201 offset:16392
    v_lshl_add_u32 v18, v206, 8, v209
    v_mfma_f32_16x16x32_bf16 v[76:79], a[124:127], a[24:27], v[76:79]
    s_lshl_b32 s45, s40, 12
    ds_read_b128 a[64:67], v199 offset:43008
    v_mfma_f32_16x16x32_bf16 v[108:111], a[124:127], a[28:31], v[108:111]
    s_lshl_b32 s63, s40, 13
    ds_read_b64_tr_b16 a[94:95], v201 offset:17416
    v_mfma_f32_16x16x32_bf16 v[140:143], a[124:127], a[32:35], v[140:143]
    buffer_load_dwordx4 v193, s[20:23], s50 offen offset:1024 lds
    v_mfma_f32_16x16x32_bf16 v[172:175], a[124:127], a[36:39], v[172:175]
    s_add_u32 s51, s49, 320
    ds_read_b128 a[68:71], v199 offset:45056
    v_mfma_f32_16x16x32_bf16 v[48:51], a[128:131], a[20:23], v[48:51]
    s_bfe_u32 s51, s51, 0x0a0000
    ds_read_b64_tr_b16 a[96:97], v202 offset:16384
    v_mfma_f32_16x16x32_bf16 v[80:83], a[128:131], a[24:27], v[80:83]
    s_add_u32 m0, s44, 8192
    ds_read_b128 a[72:75], v199 offset:47104
    v_mfma_f32_16x16x32_bf16 v[112:115], a[128:131], a[28:31], v[112:115]
    s_lshl_b32 s51, s51, 12
    ds_read_b64_tr_b16 a[98:99], v202 offset:17408
    v_mfma_f32_16x16x32_bf16 v[144:147], a[128:131], a[32:35], v[144:147]
    s_add_u32 s63, s63, 131072
    ds_read_b128 a[76:79], v199 offset:49152
    v_mfma_f32_16x16x32_bf16 v[176:179], a[128:131], a[36:39], v[176:179]
    buffer_load_dwordx4 v196, s[24:27], s51 offen offset:0 lds
    v_mfma_f32_16x16x32_bf16 v[52:55], a[132:135], a[20:23], v[52:55]
    s_lshl_b32 s86, s41, 5
    ds_read_b64_tr_b16 a[100:101], v202 offset:16392
    v_mfma_f32_16x16x32_bf16 v[84:87], a[132:135], a[24:27], v[84:87]
    s_add_u32 s86, s86, s42
    ds_read_b64_tr_b16 a[102:103], v202 offset:17416
    v_mfma_f32_16x16x32_bf16 v[116:119], a[132:135], a[28:31], v[116:119]
    s_lshl_b32 s86, s86, 18
    ds_read_b64_tr_b16 a[104:105], v203 offset:16384
    v_mfma_f32_16x16x32_bf16 v[148:151], a[132:135], a[32:35], v[148:151]
    s_add_u32 s28, s6, s86
    s_addc_u32 s29, s7, 0
    ds_read_b64_tr_b16 a[106:107], v203 offset:17408
    v_mfma_f32_16x16x32_bf16 v[180:183], a[132:135], a[36:39], v[180:183]
    s_mov_b32 s30, 262144
    ds_read_b64_tr_b16 a[108:109], v203 offset:16392
    v_mfma_f32_16x16x32_bf16 v[56:59], a[136:139], a[20:23], v[56:59]
    buffer_load_dwordx4 v197, s[24:27], s51 offen offset:1024 lds
    v_mfma_f32_16x16x32_bf16 v[88:91], a[136:139], a[24:27], v[88:91]
    s_mov_b32 s31, 0x20000
    ds_read_b64_tr_b16 a[110:111], v203 offset:17416
    v_mfma_f32_16x16x32_bf16 v[120:123], a[136:139], a[28:31], v[120:123]
    s_add_u32 s32, s8, s86
    s_addc_u32 s33, s9, 0
    v_mfma_f32_16x16x32_bf16 v[152:155], a[136:139], a[32:35], v[152:155]
    s_mov_b32 s34, 262144
    v_mfma_f32_16x16x32_bf16 v[184:187], a[136:139], a[36:39], v[184:187]
    s_mov_b32 s35, 0x20000
    v_mfma_f32_16x16x32_bf16 v[60:63], a[140:143], a[20:23], v[60:63]
    s_mov_b32 s86, 0
    v_mfma_f32_16x16x32_bf16 v[92:95], a[140:143], a[24:27], v[92:95]
    s_add_u32 s86, s86, s45
    v_mfma_f32_16x16x32_bf16 v[124:127], a[140:143], a[28:31], v[124:127]
    s_add_u32 s57, s86, 0
    v_mfma_f32_16x16x32_bf16 v[156:159], a[140:143], a[32:35], v[156:159]
    s_waitcnt vmcnt(14) lgkmcnt(0)
    v_mfma_f32_16x16x32_bf16 v[188:191], a[140:143], a[36:39], v[188:191]
    s_barrier
    v_mfma_f32_16x16x32_bf16 v[32:35], a[80:83], a[40:43], v[32:35]
    s_add_u32 s50, s49, 384
    ds_read_b64_tr_b16 a[112:113], v200 offset:24576
    v_mfma_f32_16x16x32_bf16 v[64:67], a[80:83], a[44:47], v[64:67]
    s_bfe_u32 s50, s50, 0x0a0000
    ds_read_b64_tr_b16 a[114:115], v200 offset:25600
    v_mfma_f32_16x16x32_bf16 v[96:99], a[80:83], a[48:51], v[96:99]
    s_add_u32 m0, s43, 40960
    ds_read_b64_tr_b16 a[116:117], v200 offset:24584
    v_mfma_f32_16x16x32_bf16 v[128:131], a[80:83], a[52:55], v[128:131]
    buffer_load_dwordx4 v192, s[20:23], s50 offen offset:0 lds
    v_mfma_f32_16x16x32_bf16 v[160:163], a[80:83], a[56:59], v[160:163]
    s_and_b32 s57, s57, 0x3ffff
    ds_read_b64_tr_b16 a[118:119], v200 offset:25608
    v_mfma_f32_16x16x32_bf16 v[36:39], a[84:87], a[40:43], v[36:39]
    buffer_load_dwordx4 v193, s[20:23], s50 offen offset:1024 lds
    v_mfma_f32_16x16x32_bf16 v[68:71], a[84:87], a[44:47], v[68:71]
    s_add_u32 s52, s86, 16384
    ds_read_b64_tr_b16 a[120:121], v201 offset:24576
    v_mfma_f32_16x16x32_bf16 v[100:103], a[84:87], a[48:51], v[100:103]
    s_and_b32 s52, s52, 0x3ffff
    ds_read_b64_tr_b16 a[122:123], v201 offset:25600
    v_mfma_f32_16x16x32_bf16 v[132:135], a[84:87], a[52:55], v[132:135]
    s_add_u32 s53, s86, 32768
    ds_read_b64_tr_b16 a[124:125], v201 offset:24584
    v_mfma_f32_16x16x32_bf16 v[164:167], a[84:87], a[56:59], v[164:167]
    buffer_load_dwordx4 v194, s[20:23], s50 offen offset:2048 lds
    v_mfma_f32_16x16x32_bf16 v[40:43], a[88:91], a[40:43], v[40:43]
    s_and_b32 s53, s53, 0x3ffff
    ds_read_b64_tr_b16 a[126:127], v201 offset:25608
    v_mfma_f32_16x16x32_bf16 v[72:75], a[88:91], a[44:47], v[72:75]
    s_add_u32 s46, s86, 49152
    ds_read_b64_tr_b16 a[128:129], v202 offset:24576
    v_mfma_f32_16x16x32_bf16 v[104:107], a[88:91], a[48:51], v[104:107]
    s_and_b32 s46, s46, 0x3ffff
    ds_read_b64_tr_b16 a[130:131], v202 offset:25600
    v_bfe_u32 v210, v212, 1, 2
    v_mfma_f32_16x16x32_bf16 v[136:139], a[88:91], a[52:55], v[136:139]
    ds_read_b64_tr_b16 a[132:133], v202 offset:24584
    v_lshlrev_b32 v209, 7, v212
    v_mfma_f32_16x16x32_bf16 v[168:171], a[88:91], a[56:59], v[168:171]
    buffer_load_dwordx4 v195, s[20:23], s50 offen offset:3072 lds
    v_mfma_f32_16x16x32_bf16 v[44:47], a[92:95], a[40:43], v[44:47]
    s_add_u32 s50, s50, 0x8000
    ds_read_b64_tr_b16 a[134:135], v202 offset:25608
    v_lshl_add_u32 v209, v208, 3, v209
    v_mfma_f32_16x16x32_bf16 v[76:79], a[92:95], a[44:47], v[76:79]
    s_add_u32 m0, s43, 45056
    ds_read_b64_tr_b16 a[136:137], v203 offset:24576
    v_mfma_f32_16x16x32_bf16 v[108:111], a[92:95], a[48:51], v[108:111]
    s_add_u32 s86, s40, 0
    ds_read_b64_tr_b16 a[138:139], v203 offset:25600
    v_mfma_f32_16x16x32_bf16 v[140:143], a[92:95], a[52:55], v[140:143]
    buffer_load_dwordx4 v192, s[20:23], s50 offen offset:0 lds
    v_mfma_f32_16x16x32_bf16 v[172:175], a[92:95], a[56:59], v[172:175]
    s_and_b32 s86, s86, 3
    ds_read_b64_tr_b16 a[140:141], v203 offset:24584
    v_xor_b32 v211, s86, v210
    v_mfma_f32_16x16x32_bf16 v[48:51], a[96:99], a[40:43], v[48:51]
    ds_read_b64_tr_b16 a[142:143], v203 offset:25608
    v_lshl_add_u32 v211, v211, 5, v209
    v_mfma_f32_16x16x32_bf16 v[80:83], a[96:99], a[44:47], v[80:83]
    buffer_load_dwordx4 v193, s[20:23], s50 offen offset:1024 lds
    v_mfma_f32_16x16x32_bf16 v[112:115], a[96:99], a[48:51], v[112:115]
    s_add_u32 s51, s49, 384
    v_add_u32 v20, s45, v211
    v_add_u32 v24, 65536, v20
    v_mfma_f32_16x16x32_bf16 v[144:147], a[96:99], a[52:55], v[144:147]
    s_bfe_u32 s51, s51, 0x0a0000
    v_add_u32 v28, s63, v211
    v_mfma_f32_16x16x32_bf16 v[176:179], a[96:99], a[56:59], v[176:179]
    s_add_u32 m0, s44, 16384
    v_mfma_f32_16x16x32_bf16 v[52:55], a[100:103], a[40:43], v[52:55]
    s_lshl_b32 s51, s51, 12
    v_mfma_f32_16x16x32_bf16 v[84:87], a[100:103], a[44:47], v[84:87]
    buffer_load_dwordx4 v196, s[24:27], s51 offen offset:0 lds
    v_mfma_f32_16x16x32_bf16 v[116:119], a[100:103], a[48:51], v[116:119]
    buffer_load_dwordx4 v197, s[24:27], s51 offen offset:1024 lds
    v_mfma_f32_16x16x32_bf16 v[148:151], a[100:103], a[52:55], v[148:151]
    s_add_u32 s86, s40, 1
    v_mfma_f32_16x16x32_bf16 v[180:183], a[100:103], a[56:59], v[180:183]
    s_and_b32 s86, s86, 3
    v_xor_b32 v211, s86, v210
    v_lshl_add_u32 v211, v211, 5, v209
    v_mfma_f32_16x16x32_bf16 v[56:59], a[104:107], a[40:43], v[56:59]
    v_add_u32 v21, s45, v211
    v_add_u32 v25, 65536, v21
    v_mfma_f32_16x16x32_bf16 v[88:91], a[104:107], a[44:47], v[88:91]
    v_add_u32 v29, s63, v211
    v_mfma_f32_16x16x32_bf16 v[120:123], a[104:107], a[48:51], v[120:123]
    s_add_u32 s86, s40, 2
    v_mfma_f32_16x16x32_bf16 v[152:155], a[104:107], a[52:55], v[152:155]
    s_and_b32 s86, s86, 3
    v_xor_b32 v211, s86, v210
    v_lshl_add_u32 v211, v211, 5, v209
    v_mfma_f32_16x16x32_bf16 v[184:187], a[104:107], a[56:59], v[184:187]
    v_add_u32 v22, s45, v211
    v_add_u32 v26, 65536, v22
    v_mfma_f32_16x16x32_bf16 v[60:63], a[108:111], a[40:43], v[60:63]
    v_add_u32 v30, s63, v211
    v_mfma_f32_16x16x32_bf16 v[92:95], a[108:111], a[44:47], v[92:95]
    s_add_u32 s86, s40, 3
    v_mfma_f32_16x16x32_bf16 v[124:127], a[108:111], a[48:51], v[124:127]
    s_and_b32 s86, s86, 3
    v_xor_b32 v211, s86, v210
    v_lshl_add_u32 v211, v211, 5, v209
    v_mfma_f32_16x16x32_bf16 v[156:159], a[108:111], a[52:55], v[156:159]
    s_waitcnt vmcnt(10) lgkmcnt(0)
    v_mfma_f32_16x16x32_bf16 v[188:191], a[108:111], a[56:59], v[188:191]
    s_barrier
    v_mfma_f32_16x16x32_bf16 v[32:35], a[112:115], a[60:63], v[32:35]
    s_add_u32 m0, s43, 45056
    ds_read_b64_tr_b16 a[80:81], v200 offset:0
    v_add_u32 v23, s45, v211
    v_mfma_f32_16x16x32_bf16 v[64:67], a[112:115], a[64:67], v[64:67]
    buffer_load_dwordx4 v194, s[20:23], s50 offen offset:2048 lds
    v_mfma_f32_16x16x32_bf16 v[96:99], a[112:115], a[68:71], v[96:99]
    ds_read_b128 a[0:3], v198 offset:0
    v_add_u32 v27, 65536, v23
    v_mfma_f32_16x16x32_bf16 v[128:131], a[112:115], a[72:75], v[128:131]
    ds_read_b64_tr_b16 a[82:83], v200 offset:1024
    v_add_u32 v31, s63, v211
    v_mfma_f32_16x16x32_bf16 v[160:163], a[112:115], a[76:79], v[160:163]
    ds_read_b128 a[4:7], v198 offset:2048
    v_and_b32 v209, 7, v204
    v_mfma_f32_16x16x32_bf16 v[36:39], a[116:119], a[60:63], v[36:39]
    ds_read_b64_tr_b16 a[84:85], v200 offset:8
    v_lshlrev_b32 v210, 1, v206
    v_mfma_f32_16x16x32_bf16 v[68:71], a[116:119], a[64:67], v[68:71]
    buffer_load_dwordx4 v195, s[20:23], s50 offen offset:3072 lds
    v_mfma_f32_16x16x32_bf16 v[100:103], a[116:119], a[68:71], v[100:103]
    s_add_u32 s50, s50, 0x8000
    ds_read_b128 a[8:11], v198 offset:4096
    v_xor_b32 v209, v209, v210
    v_mfma_f32_16x16x32_bf16 v[132:135], a[116:119], a[72:75], v[132:135]
    s_add_u32 m0, s43, 49152
    ds_read_b64_tr_b16 a[86:87], v200 offset:1032
    v_lshlrev_b32 v209, 4, v209
    v_mfma_f32_16x16x32_bf16 v[164:167], a[116:119], a[76:79], v[164:167]
    ds_read_b128 a[12:15], v198 offset:6144
    v_lshrrev_b32 v210, 3, v204
    v_mfma_f32_16x16x32_bf16 v[40:43], a[120:123], a[60:63], v[40:43]
    ds_read_b64_tr_b16 a[88:89], v201 offset:0
    v_lshl_add_u32 v241, v210, 10, v209
    v_mfma_f32_16x16x32_bf16 v[72:75], a[120:123], a[64:67], v[72:75]
    ds_read_b128 a[16:19], v198 offset:8192
    v_add_u32 v242, 7168, v241
    v_mfma_f32_16x16x32_bf16 v[104:107], a[120:123], a[68:71], v[104:107]
    buffer_load_dwordx4 v192, s[20:23], s50 offen offset:0 lds
    v_mfma_f32_16x16x32_bf16 v[136:139], a[120:123], a[72:75], v[136:139]
    ds_read_b64_tr_b16 a[90:91], v201 offset:1024
    v_add_u32 v243, 14336, v241
    v_mfma_f32_16x16x32_bf16 v[168:171], a[120:123], a[76:79], v[168:171]
    ds_read_b128 a[20:23], v199 offset:0
    v_add_u32 v244, 21504, v241
    v_mfma_f32_16x16x32_bf16 v[44:47], a[124:127], a[60:63], v[44:47]
    ds_read_b64_tr_b16 a[92:93], v201 offset:8
    v_add_u32 v245, 0, v19
    v_mfma_f32_16x16x32_bf16 v[76:79], a[124:127], a[64:67], v[76:79]
    ds_read_b128 a[24:27], v199 offset:2048
    v_add_u32 v246, 4096, v19
    v_mfma_f32_16x16x32_bf16 v[108:111], a[124:127], a[68:71], v[108:111]
    ds_read_b64_tr_b16 a[94:95], v201 offset:1032
    v_add_u32 v247, 8192, v19
    v_mfma_f32_16x16x32_bf16 v[140:143], a[124:127], a[72:75], v[140:143]
    buffer_load_dwordx4 v193, s[20:23], s50 offen offset:1024 lds
    v_mfma_f32_16x16x32_bf16 v[172:175], a[124:127], a[76:79], v[172:175]
    s_add_u32 s51, s49, 448
    ds_read_b128 a[28:31], v199 offset:4096
    v_add_u32 v248, 12288, v19
    v_mfma_f32_16x16x32_bf16 v[48:51], a[128:131], a[60:63], v[48:51]
    s_bfe_u32 s51, s51, 0x0a0000
    ds_read_b64_tr_b16 a[96:97], v202 offset:0
    v_add_u32 v249, 16384, v19
    v_mfma_f32_16x16x32_bf16 v[80:83], a[128:131], a[64:67], v[80:83]
    s_add_u32 m0, s44, 24576
    ds_read_b128 a[32:35], v199 offset:6144
    v_mfma_f32_16x16x32_bf16 v[112:115], a[128:131], a[68:71], v[112:115]
    s_lshl_b32 s51, s51, 12
    ds_read_b64_tr_b16 a[98:99], v202 offset:1024
    v_mfma_f32_16x16x32_bf16 v[144:147], a[128:131], a[72:75], v[144:147]
    s_lshl_b32 s88, s41, 2
    ds_read_b128 a[36:39], v199 offset:8192
    v_mfma_f32_16x16x32_bf16 v[176:179], a[128:131], a[76:79], v[176:179]
    buffer_load_dwordx4 v196, s[24:27], s51 offen offset:0 lds
    v_mfma_f32_16x16x32_bf16 v[52:55], a[132:135], a[60:63], v[52:55]
    s_add_u32 s86, s88, s40
    ds_read_b64_tr_b16 a[100:101], v202 offset:8
    v_mfma_f32_16x16x32_bf16 v[84:87], a[132:135], a[64:67], v[84:87]
    s_lshl_b32 s86, s86, 5
    ds_read_b64_tr_b16 a[102:103], v202 offset:1032
    v_mfma_f32_16x16x32_bf16 v[116:119], a[132:135], a[68:71], v[116:119]
    s_add_u32 s86, s86, s42
    ds_read_b64_tr_b16 a[104:105], v203 offset:0
    v_mfma_f32_16x16x32_bf16 v[148:151], a[132:135], a[72:75], v[148:151]
    s_lshl_b32 s77, s86, 15
    ds_read_b64_tr_b16 a[106:107], v203 offset:1024
    v_mfma_f32_16x16x32_bf16 v[180:183], a[132:135], a[76:79], v[180:183]
    s_add_u32 s36, s18, s77
    s_addc_u32 s37, s19, 0
    ds_read_b64_tr_b16 a[108:109], v203 offset:8
    v_mfma_f32_16x16x32_bf16 v[56:59], a[136:139], a[60:63], v[56:59]
    buffer_load_dwordx4 v197, s[24:27], s51 offen offset:1024 lds
    v_mfma_f32_16x16x32_bf16 v[88:91], a[136:139], a[64:67], v[88:91]
    s_mov_b32 s38, 32768
    ds_read_b64_tr_b16 a[110:111], v203 offset:1032
    v_mfma_f32_16x16x32_bf16 v[120:123], a[136:139], a[68:71], v[120:123]
    s_mov_b32 s39, 0x20000
    v_mfma_f32_16x16x32_bf16 v[152:155], a[136:139], a[72:75], v[152:155]
    s_and_b32 s89, s42, 3
    v_mfma_f32_16x16x32_bf16 v[184:187], a[136:139], a[76:79], v[184:187]
    s_bfe_u32 s90, s42, 0x20002
    v_mfma_f32_16x16x32_bf16 v[60:63], a[140:143], a[60:63], v[60:63]
    s_lshr_b32 s92, s42, 4
    v_mfma_f32_16x16x32_bf16 v[92:95], a[140:143], a[64:67], v[92:95]
    s_lshl_b32 s93, s92, 2
    v_mfma_f32_16x16x32_bf16 v[124:127], a[140:143], a[68:71], v[124:127]
    s_add_u32 s93, s93, s40
    v_mfma_f32_16x16x32_bf16 v[156:159], a[140:143], a[72:75], v[156:159]
    s_waitcnt vmcnt(14) lgkmcnt(0)
    v_mfma_f32_16x16x32_bf16 v[188:191], a[140:143], a[76:79], v[188:191]
    s_barrier
    v_mfma_f32_16x16x32_bf16 v[32:35], a[80:83], a[0:3], v[32:35]
    s_add_u32 s50, s49, 512
    ds_read_b64_tr_b16 a[112:113], v200 offset:8192
    v_mfma_f32_16x16x32_bf16 v[64:67], a[80:83], a[4:7], v[64:67]
    s_bfe_u32 s50, s50, 0x0a0000
    ds_read_b64_tr_b16 a[114:115], v200 offset:9216
    v_mfma_f32_16x16x32_bf16 v[96:99], a[80:83], a[8:11], v[96:99]
    s_add_u32 m0, s43, 0
    ds_read_b64_tr_b16 a[116:117], v200 offset:8200
    v_mfma_f32_16x16x32_bf16 v[128:131], a[80:83], a[12:15], v[128:131]
    buffer_load_dwordx4 v192, s[20:23], s50 offen offset:0 lds
    v_mfma_f32_16x16x32_bf16 v[160:163], a[80:83], a[16:19], v[160:163]
    s_add_u32 s86, s88, s89
    ds_read_b64_tr_b16 a[118:119], v200 offset:9224
    v_mfma_f32_16x16x32_bf16 v[36:39], a[84:87], a[0:3], v[36:39]
    buffer_load_dwordx4 v193, s[20:23], s50 offen offset:1024 lds
    v_mfma_f32_16x16x32_bf16 v[68:71], a[84:87], a[4:7], v[68:71]
    s_lshl_b32 s86, s86, 3
    ds_read_b64_tr_b16 a[120:121], v201 offset:8192
    v_mfma_f32_16x16x32_bf16 v[100:103], a[84:87], a[8:11], v[100:103]
    s_add_u32 s86, s86, s93
    ds_read_b64_tr_b16 a[122:123], v201 offset:9216
    v_mfma_f32_16x16x32_bf16 v[132:135], a[84:87], a[12:15], v[132:135]
    s_lshl_b32 s86, s86, 17
    ds_read_b64_tr_b16 a[124:125], v201 offset:8200
    v_mfma_f32_16x16x32_bf16 v[164:167], a[84:87], a[16:19], v[164:167]
    buffer_load_dwordx4 v194, s[20:23], s50 offen offset:2048 lds
    v_mfma_f32_16x16x32_bf16 v[40:43], a[88:91], a[0:3], v[40:43]
    s_add_u32 s68, s18, s86
    s_addc_u32 s69, s19, 0
    ds_read_b64_tr_b16 a[126:127], v201 offset:9224
    v_mfma_f32_16x16x32_bf16 v[72:75], a[88:91], a[4:7], v[72:75]
    s_mov_b32 s70, 131072
    ds_read_b64_tr_b16 a[128:129], v202 offset:8192
    v_mfma_f32_16x16x32_bf16 v[104:107], a[88:91], a[8:11], v[104:107]
    s_mov_b32 s71, 0x20000
    ds_read_b64_tr_b16 a[130:131], v202 offset:9216
    v_mfma_f32_16x16x32_bf16 v[136:139], a[88:91], a[12:15], v[136:139]
    s_cmp_eq_u32 s89, 3
    s_cselect_b32 s91, 4, 5
    ds_read_b64_tr_b16 a[132:133], v202 offset:8200
    v_mfma_f32_16x16x32_bf16 v[168:171], a[88:91], a[16:19], v[168:171]
    buffer_load_dwordx4 v195, s[20:23], s50 offen offset:3072 lds
    v_mfma_f32_16x16x32_bf16 v[44:47], a[92:95], a[0:3], v[44:47]
    s_add_u32 s50, s50, 0x8000
    ds_read_b64_tr_b16 a[134:135], v202 offset:9224
    v_mfma_f32_16x16x32_bf16 v[76:79], a[92:95], a[4:7], v[76:79]
    s_add_u32 m0, s43, 4096
    ds_read_b64_tr_b16 a[136:137], v203 offset:8192
    v_mfma_f32_16x16x32_bf16 v[108:111], a[92:95], a[8:11], v[108:111]
    s_lshl_b32 s60, s93, 19
    ds_read_b64_tr_b16 a[138:139], v203 offset:9216
    v_mfma_f32_16x16x32_bf16 v[140:143], a[92:95], a[12:15], v[140:143]
    buffer_load_dwordx4 v192, s[20:23], s50 offen offset:0 lds
    v_mfma_f32_16x16x32_bf16 v[172:175], a[92:95], a[16:19], v[172:175]
    s_lshl_b32 s87, s90, 8
    ds_read_b64_tr_b16 a[140:141], v203 offset:8200
    v_mfma_f32_16x16x32_bf16 v[48:51], a[96:99], a[0:3], v[48:51]
    s_add_u32 s86, s60, s87
    ds_read_b64_tr_b16 a[142:143], v203 offset:9224
    v_mfma_f32_16x16x32_bf16 v[80:83], a[96:99], a[4:7], v[80:83]
    buffer_load_dwordx4 v193, s[20:23], s50 offen offset:1024 lds
    v_mfma_f32_16x16x32_bf16 v[112:115], a[96:99], a[8:11], v[112:115]
    s_add_u32 s51, s49, 512
    v_mfma_f32_16x16x32_bf16 v[144:147], a[96:99], a[12:15], v[144:147]
    s_bfe_u32 s51, s51, 0x0a0000
    v_mfma_f32_16x16x32_bf16 v[176:179], a[96:99], a[16:19], v[176:179]
    s_add_u32 m0, s44, 0
    v_mfma_f32_16x16x32_bf16 v[52:55], a[100:103], a[0:3], v[52:55]
    s_lshl_b32 s51, s51, 12
    v_mfma_f32_16x16x32_bf16 v[84:87], a[100:103], a[4:7], v[84:87]
    buffer_load_dwordx4 v196, s[24:27], s51 offen offset:0 lds
    v_mfma_f32_16x16x32_bf16 v[116:119], a[100:103], a[8:11], v[116:119]
    buffer_load_dwordx4 v197, s[24:27], s51 offen offset:1024 lds
    v_mfma_f32_16x16x32_bf16 v[148:151], a[100:103], a[12:15], v[148:151]
    s_add_u32 s64, s12, s86
    s_addc_u32 s65, s13, 0
    v_mfma_f32_16x16x32_bf16 v[180:183], a[100:103], a[16:19], v[180:183]
    s_mov_b32 s67, 0x20000
    v_mfma_f32_16x16x32_bf16 v[56:59], a[104:107], a[0:3], v[56:59]
    s_sub_u32 s66, 4194304, s86
    v_mfma_f32_16x16x32_bf16 v[88:91], a[104:107], a[4:7], v[88:91]
    s_lshl_b32 s88, s92, 7
    v_mfma_f32_16x16x32_bf16 v[120:123], a[104:107], a[8:11], v[120:123]
    s_xor_b32 s3, s88, 128
    v_mfma_f32_16x16x32_bf16 v[152:155], a[104:107], a[12:15], v[152:155]
    s_add_u32 s87, s87, s88
    v_mfma_f32_16x16x32_bf16 v[184:187], a[104:107], a[16:19], v[184:187]
    s_mul_i32 s86, s41, 304
    v_mfma_f32_16x16x32_bf16 v[60:63], a[108:111], a[0:3], v[60:63]
    s_mul_i32 s88, s89, 80
    v_mfma_f32_16x16x32_bf16 v[92:95], a[108:111], a[4:7], v[92:95]
    s_add_u32 s86, s86, s88
    v_mfma_f32_16x16x32_bf16 v[124:127], a[108:111], a[8:11], v[124:127]
    s_lshl_b32 s86, s86, 10
    v_mfma_f32_16x16x32_bf16 v[156:159], a[108:111], a[12:15], v[156:159]
    s_waitcnt vmcnt(10) lgkmcnt(0)
    v_mfma_f32_16x16x32_bf16 v[188:191], a[108:111], a[16:19], v[188:191]
    s_barrier
    v_mfma_f32_16x16x32_bf16 v[32:35], a[112:115], a[20:23], v[32:35]
    s_add_u32 m0, s43, 4096
    ds_read_b64_tr_b16 a[80:81], v200 offset:16384
    v_mfma_f32_16x16x32_bf16 v[64:67], a[112:115], a[24:27], v[64:67]
    buffer_load_dwordx4 v194, s[20:23], s50 offen offset:2048 lds
    v_mfma_f32_16x16x32_bf16 v[96:99], a[112:115], a[28:31], v[96:99]
    s_lshl_b32 s88, s40, 5
    ds_read_b128 a[40:43], v198 offset:40960
    v_mfma_f32_16x16x32_bf16 v[128:131], a[112:115], a[32:35], v[128:131]
    s_add_u32 s87, s87, s88
    ds_read_b64_tr_b16 a[82:83], v200 offset:17408
    v_mfma_f32_16x16x32_bf16 v[160:163], a[112:115], a[36:39], v[160:163]
    buffer_load_dwordx4 v195, s[20:23], s50 offen offset:3072 lds
    v_mfma_f32_16x16x32_bf16 v[36:39], a[116:119], a[20:23], v[36:39]
    s_add_u32 s50, s50, 0x8000
    ds_read_b128 a[44:47], v198 offset:43008
    v_mfma_f32_16x16x32_bf16 v[68:71], a[116:119], a[24:27], v[68:71]
    s_add_u32 m0, s43, 8192
    ds_read_b64_tr_b16 a[84:85], v200 offset:16392
    v_mfma_f32_16x16x32_bf16 v[100:103], a[116:119], a[28:31], v[100:103]
    s_add_u32 s86, s86, s87
    ds_read_b128 a[48:51], v198 offset:45056
    v_mfma_f32_16x16x32_bf16 v[132:135], a[116:119], a[32:35], v[132:135]
    buffer_load_dwordx4 v192, s[20:23], s50 offen offset:0 lds
    v_mfma_f32_16x16x32_bf16 v[164:167], a[116:119], a[36:39], v[164:167]
    s_add_u32 s72, s14, s86
    s_addc_u32 s73, s15, 0
    ds_read_b64_tr_b16 a[86:87], v200 offset:17416
    v_mfma_f32_16x16x32_bf16 v[40:43], a[120:123], a[20:23], v[40:43]
    s_mov_b32 s75, 0x20000
    ds_read_b128 a[52:55], v198 offset:47104
    v_mfma_f32_16x16x32_bf16 v[72:75], a[120:123], a[24:27], v[72:75]
    s_lshl_b32 s74, s91, 14
    ds_read_b64_tr_b16 a[88:89], v201 offset:16384
    v_mfma_f32_16x16x32_bf16 v[104:107], a[120:123], a[28:31], v[104:107]
    buffer_load_dwordx4 v193, s[20:23], s50 offen offset:1024 lds
    v_mfma_f32_16x16x32_bf16 v[136:139], a[120:123], a[32:35], v[136:139]
    s_add_u32 s51, s49, 576
    ds_read_b128 a[56:59], v198 offset:49152
    v_mfma_f32_16x16x32_bf16 v[168:171], a[120:123], a[36:39], v[168:171]
    s_bfe_u32 s51, s51, 0x0a0000
    ds_read_b64_tr_b16 a[90:91], v201 offset:17408
    v_mfma_f32_16x16x32_bf16 v[44:47], a[124:127], a[20:23], v[44:47]
    s_add_u32 m0, s44, 8192
    ds_read_b128 a[60:63], v199 offset:40960
    v_mfma_f32_16x16x32_bf16 v[76:79], a[124:127], a[24:27], v[76:79]
    s_lshl_b32 s51, s51, 12
    ds_read_b64_tr_b16 a[92:93], v201 offset:16392
    v_mfma_f32_16x16x32_bf16 v[108:111], a[124:127], a[28:31], v[108:111]
    buffer_load_dwordx4 v196, s[24:27], s51 offen offset:0 lds
    v_mfma_f32_16x16x32_bf16 v[140:143], a[124:127], a[32:35], v[140:143]
    s_sub_u32 s74, s74, s87
    ds_read_b128 a[64:67], v199 offset:43008
    v_mfma_f32_16x16x32_bf16 v[172:175], a[124:127], a[36:39], v[172:175]
    s_lshl_b32 s86, s41, 2
    ds_read_b64_tr_b16 a[94:95], v201 offset:17416
    v_mfma_f32_16x16x32_bf16 v[48:51], a[128:131], a[20:23], v[48:51]
    buffer_load_dwordx4 v197, s[24:27], s51 offen offset:1024 lds
    v_mfma_f32_16x16x32_bf16 v[80:83], a[128:131], a[24:27], v[80:83]
    s_add_u32 m0, s45, 0
    ds_read_b128 a[68:71], v199 offset:45056
    v_mfma_f32_16x16x32_bf16 v[112:115], a[128:131], a[28:31], v[112:115]
    s_add_u32 s87, s86, s89
    ds_read_b64_tr_b16 a[96:97], v202 offset:16384
    v_mfma_f32_16x16x32_bf16 v[144:147], a[128:131], a[32:35], v[144:147]
    s_lshl_b32 s87, s87, 12
    ds_read_b128 a[72:75], v199 offset:47104
    v_mfma_f32_16x16x32_bf16 v[176:179], a[128:131], a[36:39], v[176:179]
    buffer_load_dwordx4 v13, s[28:31], s57 offen offset:0 nt lds
    v_mfma_f32_16x16x32_bf16 v[52:55], a[132:135], a[20:23], v[52:55]
    s_lshl_b32 s88, s93, 9
    ds_read_b64_tr_b16 a[98:99], v202 offset:17408
    v_mfma_f32_16x16x32_bf16 v[84:87], a[132:135], a[24:27], v[84:87]
    s_add_u32 s87, s87, s88
    ds_read_b128 a[76:79], v199 offset:49152
    v_mfma_f32_16x16x32_bf16 v[116:119], a[132:135], a[28:31], v[116:119]
    s_add_u32 s87, s87, 33554432
    ds_read_b64_tr_b16 a[100:101], v202 offset:16392
    v_mfma_f32_16x16x32_bf16 v[148:151], a[132:135], a[32:35], v[148:151]
    s_mov_b32 s76, s87
    ds_read_b64_tr_b16 a[102:103], v202 offset:17416
    v_mfma_f32_16x16x32_bf16 v[180:183], a[132:135], a[36:39], v[180:183]
    s_add_u32 s87, s86, s40
    ds_read_b64_tr_b16 a[104:105], v203 offset:16384
    v_mfma_f32_16x16x32_bf16 v[56:59], a[136:139], a[20:23], v[56:59]
    s_lshl_b32 s87, s87, 12
    ds_read_b64_tr_b16 a[106:107], v203 offset:17408
    v_mfma_f32_16x16x32_bf16 v[88:91], a[136:139], a[24:27], v[88:91]
    s_lshl_b32 s88, s42, 7
    ds_read_b64_tr_b16 a[108:109], v203 offset:16392
    v_mfma_f32_16x16x32_bf16 v[120:123], a[136:139], a[28:31], v[120:123]
    s_add_u32 s87, s87, s88
    ds_read_b64_tr_b16 a[110:111], v203 offset:17416
    v_mfma_f32_16x16x32_bf16 v[152:155], a[136:139], a[32:35], v[152:155]
    s_add_u32 s87, s87, 33554432
    v_mfma_f32_16x16x32_bf16 v[184:187], a[136:139], a[36:39], v[184:187]
    s_add_u32 s78, s18, s87
    s_addc_u32 s79, s19, 0
    v_mfma_f32_16x16x32_bf16 v[60:63], a[140:143], a[20:23], v[60:63]
    s_xor_b32 s0, s87, 0x800
    v_mfma_f32_16x16x32_bf16 v[92:95], a[140:143], a[24:27], v[92:95]
    s_and_b32 s55, s87, 0xfffff87f
    v_mfma_f32_16x16x32_bf16 v[124:127], a[140:143], a[28:31], v[124:127]
    s_lshl_b32 s88, s40, 7
    s_nop 0
    buffer_load_dwordx4 v14, s[28:31], s57 offen offset:1024 nt lds
    buffer_load_dwordx4 v15, s[28:31], s57 offen offset:2048 nt lds
    v_mfma_f32_16x16x32_bf16 v[156:159], a[140:143], a[32:35], v[156:159]
    s_waitcnt vmcnt(17) lgkmcnt(0)
    v_mfma_f32_16x16x32_bf16 v[188:191], a[140:143], a[36:39], v[188:191]
    s_barrier
    v_mfma_f32_16x16x32_bf16 v[32:35], a[80:83], a[40:43], v[32:35]
    s_add_u32 s50, s49, 640
    ds_read_b64_tr_b16 a[112:113], v200 offset:24576
    v_mfma_f32_16x16x32_bf16 v[64:67], a[80:83], a[44:47], v[64:67]
    s_bfe_u32 s50, s50, 0x0a0000
    ds_read_b64_tr_b16 a[114:115], v200 offset:25600
    v_mfma_f32_16x16x32_bf16 v[96:99], a[80:83], a[48:51], v[96:99]
    s_add_u32 m0, s43, 40960
    ds_read_b64_tr_b16 a[116:117], v200 offset:24584
    v_mfma_f32_16x16x32_bf16 v[128:131], a[80:83], a[52:55], v[128:131]
    buffer_load_dwordx4 v192, s[20:23], s50 offen offset:0 lds
    v_mfma_f32_16x16x32_bf16 v[160:163], a[80:83], a[56:59], v[160:163]
    s_add_u32 s55, s55, s88
    ds_read_b64_tr_b16 a[118:119], v200 offset:25608
    v_mfma_f32_16x16x32_bf16 v[36:39], a[84:87], a[40:43], v[36:39]
    buffer_load_dwordx4 v193, s[20:23], s50 offen offset:1024 lds
    v_mfma_f32_16x16x32_bf16 v[68:71], a[84:87], a[44:47], v[68:71]
    s_add_u32 s76, s76, 131072
    ds_read_b64_tr_b16 a[120:121], v201 offset:24576
    v_mfma_f32_16x16x32_bf16 v[100:103], a[84:87], a[48:51], v[100:103]
    s_getreg_b32 s58, hwreg(HW_REG_XCC_ID, 0, 4)
    ds_read_b64_tr_b16 a[122:123], v201 offset:25600
    v_mfma_f32_16x16x32_bf16 v[132:135], a[84:87], a[52:55], v[132:135]
    s_add_u32 s58, s58, 1
    ds_read_b64_tr_b16 a[124:125], v201 offset:24584
    v_mfma_f32_16x16x32_bf16 v[164:167], a[84:87], a[56:59], v[164:167]
    buffer_load_dwordx4 v194, s[20:23], s50 offen offset:2048 lds
    v_mfma_f32_16x16x32_bf16 v[40:43], a[88:91], a[40:43], v[40:43]
    s_lshl_b32 s1, s41, 2
    ds_read_b64_tr_b16 a[126:127], v201 offset:25608
    v_mfma_f32_16x16x32_bf16 v[72:75], a[88:91], a[44:47], v[72:75]
    s_add_u32 s80, s16, 0
    s_addc_u32 s81, s17, 0
    ds_read_b64_tr_b16 a[128:129], v202 offset:24576
    v_mfma_f32_16x16x32_bf16 v[104:107], a[88:91], a[48:51], v[104:107]
    ds_read_b64_tr_b16 a[130:131], v202 offset:25600
    v_mfma_f32_16x16x32_bf16 v[136:139], a[88:91], a[52:55], v[136:139]
    ds_read_b64_tr_b16 a[132:133], v202 offset:24584
    v_mfma_f32_16x16x32_bf16 v[168:171], a[88:91], a[56:59], v[168:171]
    buffer_load_dwordx4 v195, s[20:23], s50 offen offset:3072 lds
    v_mfma_f32_16x16x32_bf16 v[44:47], a[92:95], a[40:43], v[44:47]
    s_add_u32 s50, s50, 0x8000
    ds_read_b64_tr_b16 a[134:135], v202 offset:25608
    v_mfma_f32_16x16x32_bf16 v[76:79], a[92:95], a[44:47], v[76:79]
    s_add_u32 m0, s43, 45056
    ds_read_b64_tr_b16 a[136:137], v203 offset:24576
    v_mfma_f32_16x16x32_bf16 v[108:111], a[92:95], a[48:51], v[108:111]
    ds_read_b64_tr_b16 a[138:139], v203 offset:25600
    v_mfma_f32_16x16x32_bf16 v[140:143], a[92:95], a[52:55], v[140:143]
    buffer_load_dwordx4 v192, s[20:23], s50 offen offset:0 lds
    v_mfma_f32_16x16x32_bf16 v[172:175], a[92:95], a[56:59], v[172:175]
    ds_read_b64_tr_b16 a[140:141], v203 offset:24584
    v_mfma_f32_16x16x32_bf16 v[48:51], a[96:99], a[40:43], v[48:51]
    ds_read_b64_tr_b16 a[142:143], v203 offset:25608
    v_mfma_f32_16x16x32_bf16 v[80:83], a[96:99], a[44:47], v[80:83]
    buffer_load_dwordx4 v193, s[20:23], s50 offen offset:1024 lds
    v_mfma_f32_16x16x32_bf16 v[112:115], a[96:99], a[48:51], v[112:115]
    s_add_u32 s51, s49, 640
    v_mfma_f32_16x16x32_bf16 v[144:147], a[96:99], a[52:55], v[144:147]
    s_bfe_u32 s51, s51, 0x0a0000
    v_mfma_f32_16x16x32_bf16 v[176:179], a[96:99], a[56:59], v[176:179]
    s_add_u32 m0, s44, 16384
    v_mfma_f32_16x16x32_bf16 v[52:55], a[100:103], a[40:43], v[52:55]
    s_lshl_b32 s51, s51, 12
    v_mfma_f32_16x16x32_bf16 v[84:87], a[100:103], a[44:47], v[84:87]
    buffer_load_dwordx4 v196, s[24:27], s51 offen offset:0 lds
    v_mfma_f32_16x16x32_bf16 v[116:119], a[100:103], a[48:51], v[116:119]
    buffer_load_dwordx4 v197, s[24:27], s51 offen offset:1024 lds
    v_mfma_f32_16x16x32_bf16 v[148:151], a[100:103], a[52:55], v[148:151]
    v_mfma_f32_16x16x32_bf16 v[180:183], a[100:103], a[56:59], v[180:183]
    v_mfma_f32_16x16x32_bf16 v[56:59], a[104:107], a[40:43], v[56:59]
    v_mfma_f32_16x16x32_bf16 v[88:91], a[104:107], a[44:47], v[88:91]
    v_mfma_f32_16x16x32_bf16 v[120:123], a[104:107], a[48:51], v[120:123]
    v_mfma_f32_16x16x32_bf16 v[152:155], a[104:107], a[52:55], v[152:155]
    v_mfma_f32_16x16x32_bf16 v[184:187], a[104:107], a[56:59], v[184:187]
    v_mfma_f32_16x16x32_bf16 v[60:63], a[108:111], a[40:43], v[60:63]
    v_mfma_f32_16x16x32_bf16 v[92:95], a[108:111], a[44:47], v[92:95]
    v_mfma_f32_16x16x32_bf16 v[124:127], a[108:111], a[48:51], v[124:127]
    v_mfma_f32_16x16x32_bf16 v[156:159], a[108:111], a[52:55], v[156:159]
    s_waitcnt vmcnt(13) lgkmcnt(0)
    v_mfma_f32_16x16x32_bf16 v[188:191], a[108:111], a[56:59], v[188:191]
    s_barrier
    v_mfma_f32_16x16x32_bf16 v[32:35], a[112:115], a[60:63], v[32:35]
    s_add_u32 m0, s43, 45056
    ds_read_b64_tr_b16 a[80:81], v200 offset:0
    v_mfma_f32_16x16x32_bf16 v[64:67], a[112:115], a[64:67], v[64:67]
    buffer_load_dwordx4 v194, s[20:23], s50 offen offset:2048 lds
    v_mfma_f32_16x16x32_bf16 v[96:99], a[112:115], a[68:71], v[96:99]
    ds_read_b128 a[0:3], v198 offset:0
    v_mfma_f32_16x16x32_bf16 v[128:131], a[112:115], a[72:75], v[128:131]
    ds_read_b64_tr_b16 a[82:83], v200 offset:1024
    v_mfma_f32_16x16x32_bf16 v[160:163], a[112:115], a[76:79], v[160:163]
    buffer_load_dwordx4 v195, s[20:23], s50 offen offset:3072 lds
    v_mfma_f32_16x16x32_bf16 v[36:39], a[116:119], a[60:63], v[36:39]
    s_add_u32 s50, s50, 0x8000
    ds_read_b128 a[4:7], v198 offset:2048
    v_mfma_f32_16x16x32_bf16 v[68:71], a[116:119], a[64:67], v[68:71]
    s_add_u32 m0, s43, 49152
    ds_read_b64_tr_b16 a[84:85], v200 offset:8
    v_mfma_f32_16x16x32_bf16 v[100:103], a[116:119], a[68:71], v[100:103]
    ds_read_b128 a[8:11], v198 offset:4096
    v_mfma_f32_16x16x32_bf16 v[132:135], a[116:119], a[72:75], v[132:135]
    buffer_load_dwordx4 v192, s[20:23], s50 offen offset:0 lds
    v_mfma_f32_16x16x32_bf16 v[164:167], a[116:119], a[76:79], v[164:167]
    ds_read_b64_tr_b16 a[86:87], v200 offset:1032
    v_mfma_f32_16x16x32_bf16 v[40:43], a[120:123], a[60:63], v[40:43]
    ds_read_b128 a[12:15], v198 offset:6144
    v_mfma_f32_16x16x32_bf16 v[72:75], a[120:123], a[64:67], v[72:75]
    ds_read_b64_tr_b16 a[88:89], v201 offset:0
    v_mfma_f32_16x16x32_bf16 v[104:107], a[120:123], a[68:71], v[104:107]
    buffer_load_dwordx4 v193, s[20:23], s50 offen offset:1024 lds
    v_mfma_f32_16x16x32_bf16 v[136:139], a[120:123], a[72:75], v[136:139]
    s_add_u32 s51, s49, 704
    ds_read_b128 a[16:19], v198 offset:8192
    v_mfma_f32_16x16x32_bf16 v[168:171], a[120:123], a[76:79], v[168:171]
    s_bfe_u32 s51, s51, 0x0a0000
    ds_read_b64_tr_b16 a[90:91], v201 offset:1024
    v_mfma_f32_16x16x32_bf16 v[44:47], a[124:127], a[60:63], v[44:47]
    s_add_u32 m0, s44, 24576
    ds_read_b128 a[20:23], v199 offset:0
    v_mfma_f32_16x16x32_bf16 v[76:79], a[124:127], a[64:67], v[76:79]
    s_lshl_b32 s51, s51, 12
    ds_read_b64_tr_b16 a[92:93], v201 offset:8
    v_mfma_f32_16x16x32_bf16 v[108:111], a[124:127], a[68:71], v[108:111]
    buffer_load_dwordx4 v196, s[24:27], s51 offen offset:0 lds
    v_mfma_f32_16x16x32_bf16 v[140:143], a[124:127], a[72:75], v[140:143]
    ds_read_b128 a[24:27], v199 offset:2048
    v_mfma_f32_16x16x32_bf16 v[172:175], a[124:127], a[76:79], v[172:175]
    ds_read_b64_tr_b16 a[94:95], v201 offset:1032
    v_mfma_f32_16x16x32_bf16 v[48:51], a[128:131], a[60:63], v[48:51]
    buffer_load_dwordx4 v197, s[24:27], s51 offen offset:1024 lds
    v_mfma_f32_16x16x32_bf16 v[80:83], a[128:131], a[64:67], v[80:83]
    s_add_u32 m0, s45, 0
    ds_read_b128 a[28:31], v199 offset:4096
    v_mfma_f32_16x16x32_bf16 v[112:115], a[128:131], a[68:71], v[112:115]
    ds_read_b64_tr_b16 a[96:97], v202 offset:0
    v_mfma_f32_16x16x32_bf16 v[144:147], a[128:131], a[72:75], v[144:147]
    ds_read_b128 a[32:35], v199 offset:6144
    v_mfma_f32_16x16x32_bf16 v[176:179], a[128:131], a[76:79], v[176:179]
    buffer_load_dwordx4 v16, s[28:31], s57 offen offset:3072 nt lds
    v_mfma_f32_16x16x32_bf16 v[52:55], a[132:135], a[60:63], v[52:55]
    s_add_u32 m0, s45, 65536
    ds_read_b64_tr_b16 a[98:99], v202 offset:1024
    v_mfma_f32_16x16x32_bf16 v[84:87], a[132:135], a[64:67], v[84:87]
    ds_read_b128 a[36:39], v199 offset:8192
    v_mfma_f32_16x16x32_bf16 v[116:119], a[132:135], a[68:71], v[116:119]
    ds_read_b64_tr_b16 a[100:101], v202 offset:8
    v_mfma_f32_16x16x32_bf16 v[148:151], a[132:135], a[72:75], v[148:151]
    ds_read_b64_tr_b16 a[102:103], v202 offset:1032
    v_mfma_f32_16x16x32_bf16 v[180:183], a[132:135], a[76:79], v[180:183]
    ds_read_b64_tr_b16 a[104:105], v203 offset:0
    v_mfma_f32_16x16x32_bf16 v[56:59], a[136:139], a[60:63], v[56:59]
    ds_read_b64_tr_b16 a[106:107], v203 offset:1024
    v_mfma_f32_16x16x32_bf16 v[88:91], a[136:139], a[64:67], v[88:91]
    ds_read_b64_tr_b16 a[108:109], v203 offset:8
    v_mfma_f32_16x16x32_bf16 v[120:123], a[136:139], a[68:71], v[120:123]
    ds_read_b64_tr_b16 a[110:111], v203 offset:1032
    v_mfma_f32_16x16x32_bf16 v[152:155], a[136:139], a[72:75], v[152:155]
    v_mfma_f32_16x16x32_bf16 v[184:187], a[136:139], a[76:79], v[184:187]
    v_mfma_f32_16x16x32_bf16 v[60:63], a[140:143], a[60:63], v[60:63]
    v_mfma_f32_16x16x32_bf16 v[92:95], a[140:143], a[64:67], v[92:95]
    v_mfma_f32_16x16x32_bf16 v[124:127], a[140:143], a[68:71], v[124:127]
    s_nop 0
    buffer_load_dwordx4 v17, s[32:35], s57 offen offset:0 nt lds
    buffer_load_dwordx4 v18, s[32:35], s57 offen offset:1024 nt lds
    v_mfma_f32_16x16x32_bf16 v[156:159], a[140:143], a[72:75], v[156:159]
    s_waitcnt vmcnt(20) lgkmcnt(0)
    v_mfma_f32_16x16x32_bf16 v[188:191], a[140:143], a[76:79], v[188:191]
    s_barrier
    v_mfma_f32_16x16x32_bf16 v[32:35], a[80:83], a[0:3], v[32:35]
    s_add_u32 s50, s49, 768
    ds_read_b64_tr_b16 a[112:113], v200 offset:8192
    v_mfma_f32_16x16x32_bf16 v[64:67], a[80:83], a[4:7], v[64:67]
    s_bfe_u32 s50, s50, 0x0a0000
    ds_read_b64_tr_b16 a[114:115], v200 offset:9216
    v_mfma_f32_16x16x32_bf16 v[96:99], a[80:83], a[8:11], v[96:99]
    s_add_u32 m0, s43, 0
    ds_read_b64_tr_b16 a[116:117], v200 offset:8200
    v_mfma_f32_16x16x32_bf16 v[128:131], a[80:83], a[12:15], v[128:131]
    buffer_load_dwordx4 v192, s[20:23], s50 offen offset:0 lds
    v_mfma_f32_16x16x32_bf16 v[160:163], a[80:83], a[16:19], v[160:163]
    ds_read_b64_tr_b16 a[118:119], v200 offset:9224
    v_mfma_f32_16x16x32_bf16 v[36:39], a[84:87], a[0:3], v[36:39]
    buffer_load_dwordx4 v193, s[20:23], s50 offen offset:1024 lds
    v_mfma_f32_16x16x32_bf16 v[68:71], a[84:87], a[4:7], v[68:71]
    ds_read_b64_tr_b16 a[120:121], v201 offset:8192
    v_mfma_f32_16x16x32_bf16 v[100:103], a[84:87], a[8:11], v[100:103]
    ds_read_b64_tr_b16 a[122:123], v201 offset:9216
    v_mfma_f32_16x16x32_bf16 v[132:135], a[84:87], a[12:15], v[132:135]
    ds_read_b64_tr_b16 a[124:125], v201 offset:8200
    v_mfma_f32_16x16x32_bf16 v[164:167], a[84:87], a[16:19], v[164:167]
    buffer_load_dwordx4 v194, s[20:23], s50 offen offset:2048 lds
    v_mfma_f32_16x16x32_bf16 v[40:43], a[88:91], a[0:3], v[40:43]
    ds_read_b64_tr_b16 a[126:127], v201 offset:9224
    v_mfma_f32_16x16x32_bf16 v[72:75], a[88:91], a[4:7], v[72:75]
    ds_read_b64_tr_b16 a[128:129], v202 offset:8192
    v_mfma_f32_16x16x32_bf16 v[104:107], a[88:91], a[8:11], v[104:107]
    ds_read_b64_tr_b16 a[130:131], v202 offset:9216
    v_mfma_f32_16x16x32_bf16 v[136:139], a[88:91], a[12:15], v[136:139]
    ds_read_b64_tr_b16 a[132:133], v202 offset:8200
    v_mfma_f32_16x16x32_bf16 v[168:171], a[88:91], a[16:19], v[168:171]
    buffer_load_dwordx4 v195, s[20:23], s50 offen offset:3072 lds
    v_mfma_f32_16x16x32_bf16 v[44:47], a[92:95], a[0:3], v[44:47]
    s_add_u32 s50, s50, 0x8000
    ds_read_b64_tr_b16 a[134:135], v202 offset:9224
    v_mfma_f32_16x16x32_bf16 v[76:79], a[92:95], a[4:7], v[76:79]
    s_add_u32 m0, s43, 4096
    ds_read_b64_tr_b16 a[136:137], v203 offset:8192
    v_mfma_f32_16x16x32_bf16 v[108:111], a[92:95], a[8:11], v[108:111]
    ds_read_b64_tr_b16 a[138:139], v203 offset:9216
    v_mfma_f32_16x16x32_bf16 v[140:143], a[92:95], a[12:15], v[140:143]
    buffer_load_dwordx4 v192, s[20:23], s50 offen offset:0 lds
    v_mfma_f32_16x16x32_bf16 v[172:175], a[92:95], a[16:19], v[172:175]
    ds_read_b64_tr_b16 a[140:141], v203 offset:8200
    v_mfma_f32_16x16x32_bf16 v[48:51], a[96:99], a[0:3], v[48:51]
    ds_read_b64_tr_b16 a[142:143], v203 offset:9224
    v_mfma_f32_16x16x32_bf16 v[80:83], a[96:99], a[4:7], v[80:83]
    buffer_load_dwordx4 v193, s[20:23], s50 offen offset:1024 lds
    v_mfma_f32_16x16x32_bf16 v[112:115], a[96:99], a[8:11], v[112:115]
    s_add_u32 s51, s49, 768
    v_mfma_f32_16x16x32_bf16 v[144:147], a[96:99], a[12:15], v[144:147]
    s_bfe_u32 s51, s51, 0x0a0000
    v_mfma_f32_16x16x32_bf16 v[176:179], a[96:99], a[16:19], v[176:179]
    s_add_u32 m0, s44, 0
    v_mfma_f32_16x16x32_bf16 v[52:55], a[100:103], a[0:3], v[52:55]
    s_lshl_b32 s51, s51, 12
    v_mfma_f32_16x16x32_bf16 v[84:87], a[100:103], a[4:7], v[84:87]
    buffer_load_dwordx4 v196, s[24:27], s51 offen offset:0 lds
    v_mfma_f32_16x16x32_bf16 v[116:119], a[100:103], a[8:11], v[116:119]
    buffer_load_dwordx4 v197, s[24:27], s51 offen offset:1024 lds
    v_mfma_f32_16x16x32_bf16 v[148:151], a[100:103], a[12:15], v[148:151]
    v_mfma_f32_16x16x32_bf16 v[180:183], a[100:103], a[16:19], v[180:183]
    v_mfma_f32_16x16x32_bf16 v[56:59], a[104:107], a[0:3], v[56:59]
    v_mfma_f32_16x16x32_bf16 v[88:91], a[104:107], a[4:7], v[88:91]
    v_mfma_f32_16x16x32_bf16 v[120:123], a[104:107], a[8:11], v[120:123]
    v_mfma_f32_16x16x32_bf16 v[152:155], a[104:107], a[12:15], v[152:155]
    v_mfma_f32_16x16x32_bf16 v[184:187], a[104:107], a[16:19], v[184:187]
    v_mfma_f32_16x16x32_bf16 v[60:63], a[108:111], a[0:3], v[60:63]
    v_mfma_f32_16x16x32_bf16 v[92:95], a[108:111], a[4:7], v[92:95]
    v_mfma_f32_16x16x32_bf16 v[124:127], a[108:111], a[8:11], v[124:127]
    v_mfma_f32_16x16x32_bf16 v[156:159], a[108:111], a[12:15], v[156:159]
    s_waitcnt vmcnt(13) lgkmcnt(0)
    v_mfma_f32_16x16x32_bf16 v[188:191], a[108:111], a[16:19], v[188:191]
    s_barrier
    v_mfma_f32_16x16x32_bf16 v[32:35], a[112:115], a[20:23], v[32:35]
    s_add_u32 m0, s43, 4096
    ds_read_b64_tr_b16 a[80:81], v200 offset:16384
    v_mfma_f32_16x16x32_bf16 v[64:67], a[112:115], a[24:27], v[64:67]
    buffer_load_dwordx4 v194, s[20:23], s50 offen offset:2048 lds
    v_mfma_f32_16x16x32_bf16 v[96:99], a[112:115], a[28:31], v[96:99]
    ds_read_b128 a[40:43], v198 offset:40960
    v_mfma_f32_16x16x32_bf16 v[128:131], a[112:115], a[32:35], v[128:131]
    ds_read_b64_tr_b16 a[82:83], v200 offset:17408
    v_mfma_f32_16x16x32_bf16 v[160:163], a[112:115], a[36:39], v[160:163]
    buffer_load_dwordx4 v195, s[20:23], s50 offen offset:3072 lds
    v_mfma_f32_16x16x32_bf16 v[36:39], a[116:119], a[20:23], v[36:39]
    s_add_u32 s50, s50, 0x8000
    ds_read_b128 a[44:47], v198 offset:43008
    v_mfma_f32_16x16x32_bf16 v[68:71], a[116:119], a[24:27], v[68:71]
    s_add_u32 m0, s43, 8192
    ds_read_b64_tr_b16 a[84:85], v200 offset:16392
    v_mfma_f32_16x16x32_bf16 v[100:103], a[116:119], a[28:31], v[100:103]
    ds_read_b128 a[48:51], v198 offset:45056
    v_mfma_f32_16x16x32_bf16 v[132:135], a[116:119], a[32:35], v[132:135]
    buffer_load_dwordx4 v192, s[20:23], s50 offen offset:0 lds
    v_mfma_f32_16x16x32_bf16 v[164:167], a[116:119], a[36:39], v[164:167]
    ds_read_b64_tr_b16 a[86:87], v200 offset:17416
    v_mfma_f32_16x16x32_bf16 v[40:43], a[120:123], a[20:23], v[40:43]
    ds_read_b128 a[52:55], v198 offset:47104
    v_mfma_f32_16x16x32_bf16 v[72:75], a[120:123], a[24:27], v[72:75]
    ds_read_b64_tr_b16 a[88:89], v201 offset:16384
    v_mfma_f32_16x16x32_bf16 v[104:107], a[120:123], a[28:31], v[104:107]
    buffer_load_dwordx4 v193, s[20:23], s50 offen offset:1024 lds
    v_mfma_f32_16x16x32_bf16 v[136:139], a[120:123], a[32:35], v[136:139]
    s_add_u32 s51, s49, 832
    ds_read_b128 a[56:59], v198 offset:49152
    v_mfma_f32_16x16x32_bf16 v[168:171], a[120:123], a[36:39], v[168:171]
    s_bfe_u32 s51, s51, 0x0a0000
    ds_read_b64_tr_b16 a[90:91], v201 offset:17408
    v_mfma_f32_16x16x32_bf16 v[44:47], a[124:127], a[20:23], v[44:47]
    s_add_u32 m0, s44, 8192
    ds_read_b128 a[60:63], v199 offset:40960
    v_mfma_f32_16x16x32_bf16 v[76:79], a[124:127], a[24:27], v[76:79]
    s_lshl_b32 s51, s51, 12
    ds_read_b64_tr_b16 a[92:93], v201 offset:16392
    v_mfma_f32_16x16x32_bf16 v[108:111], a[124:127], a[28:31], v[108:111]
    buffer_load_dwordx4 v196, s[24:27], s51 offen offset:0 lds
    v_mfma_f32_16x16x32_bf16 v[140:143], a[124:127], a[32:35], v[140:143]
    ds_read_b128 a[64:67], v199 offset:43008
    v_mfma_f32_16x16x32_bf16 v[172:175], a[124:127], a[36:39], v[172:175]
    ds_read_b64_tr_b16 a[94:95], v201 offset:17416
    v_mfma_f32_16x16x32_bf16 v[48:51], a[128:131], a[20:23], v[48:51]
    buffer_load_dwordx4 v197, s[24:27], s51 offen offset:1024 lds
    v_mfma_f32_16x16x32_bf16 v[80:83], a[128:131], a[24:27], v[80:83]
    s_add_u32 m0, s45, 65536
    ds_read_b128 a[68:71], v199 offset:45056
    v_mfma_f32_16x16x32_bf16 v[112:115], a[128:131], a[28:31], v[112:115]
    ds_read_b64_tr_b16 a[96:97], v202 offset:16384
    v_mfma_f32_16x16x32_bf16 v[144:147], a[128:131], a[32:35], v[144:147]
    ds_read_b128 a[72:75], v199 offset:47104
    v_mfma_f32_16x16x32_bf16 v[176:179], a[128:131], a[36:39], v[176:179]
    buffer_load_dwordx4 v17, s[32:35], s57 offen offset:2048 nt lds
    v_mfma_f32_16x16x32_bf16 v[52:55], a[132:135], a[20:23], v[52:55]
    ds_read_b64_tr_b16 a[98:99], v202 offset:17408
    v_mfma_f32_16x16x32_bf16 v[84:87], a[132:135], a[24:27], v[84:87]
    ds_read_b128 a[76:79], v199 offset:49152
    v_mfma_f32_16x16x32_bf16 v[116:119], a[132:135], a[28:31], v[116:119]
    ds_read_b64_tr_b16 a[100:101], v202 offset:16392
    v_mfma_f32_16x16x32_bf16 v[148:151], a[132:135], a[32:35], v[148:151]
    ds_read_b64_tr_b16 a[102:103], v202 offset:17416
    v_mfma_f32_16x16x32_bf16 v[180:183], a[132:135], a[36:39], v[180:183]
    ds_read_b64_tr_b16 a[104:105], v203 offset:16384
    v_mfma_f32_16x16x32_bf16 v[56:59], a[136:139], a[20:23], v[56:59]
    ds_read_b64_tr_b16 a[106:107], v203 offset:17408
    v_mfma_f32_16x16x32_bf16 v[88:91], a[136:139], a[24:27], v[88:91]
    ds_read_b64_tr_b16 a[108:109], v203 offset:16392
    v_mfma_f32_16x16x32_bf16 v[120:123], a[136:139], a[28:31], v[120:123]
    ds_read_b64_tr_b16 a[110:111], v203 offset:17416
    v_mfma_f32_16x16x32_bf16 v[152:155], a[136:139], a[32:35], v[152:155]
    v_mfma_f32_16x16x32_bf16 v[184:187], a[136:139], a[36:39], v[184:187]
    v_mfma_f32_16x16x32_bf16 v[60:63], a[140:143], a[20:23], v[60:63]
    v_mfma_f32_16x16x32_bf16 v[92:95], a[140:143], a[24:27], v[92:95]
    v_mfma_f32_16x16x32_bf16 v[124:127], a[140:143], a[28:31], v[124:127]
    s_nop 0
    buffer_load_dwordx4 v18, s[32:35], s57 offen offset:3072 nt lds
    s_add_u32 m0, s45, 16384
    s_nop 0
    buffer_load_dwordx4 v13, s[28:31], s52 offen offset:0 nt lds
    v_mfma_f32_16x16x32_bf16 v[156:159], a[140:143], a[32:35], v[156:159]
    s_waitcnt vmcnt(20) lgkmcnt(0)
    v_mfma_f32_16x16x32_bf16 v[188:191], a[140:143], a[36:39], v[188:191]
    s_barrier
    v_mfma_f32_16x16x32_bf16 v[32:35], a[80:83], a[40:43], v[32:35]
    s_add_u32 s50, s49, 896
    ds_read_b64_tr_b16 a[112:113], v200 offset:24576
    v_mfma_f32_16x16x32_bf16 v[64:67], a[80:83], a[44:47], v[64:67]
    s_bfe_u32 s50, s50, 0x0a0000
    ds_read_b64_tr_b16 a[114:115], v200 offset:25600
    v_mfma_f32_16x16x32_bf16 v[96:99], a[80:83], a[48:51], v[96:99]
    s_add_u32 m0, s43, 40960
    ds_read_b64_tr_b16 a[116:117], v200 offset:24584
    v_mfma_f32_16x16x32_bf16 v[128:131], a[80:83], a[52:55], v[128:131]
    buffer_load_dwordx4 v192, s[20:23], s50 offen offset:0 lds
    v_mfma_f32_16x16x32_bf16 v[160:163], a[80:83], a[56:59], v[160:163]
    ds_read_b64_tr_b16 a[118:119], v200 offset:25608
    v_mfma_f32_16x16x32_bf16 v[36:39], a[84:87], a[40:43], v[36:39]
    buffer_load_dwordx4 v193, s[20:23], s50 offen offset:1024 lds
    v_mfma_f32_16x16x32_bf16 v[68:71], a[84:87], a[44:47], v[68:71]
    ds_read_b64_tr_b16 a[120:121], v201 offset:24576
    v_mfma_f32_16x16x32_bf16 v[100:103], a[84:87], a[48:51], v[100:103]
    ds_read_b64_tr_b16 a[122:123], v201 offset:25600
    v_mfma_f32_16x16x32_bf16 v[132:135], a[84:87], a[52:55], v[132:135]
    ds_read_b64_tr_b16 a[124:125], v201 offset:24584
    v_mfma_f32_16x16x32_bf16 v[164:167], a[84:87], a[56:59], v[164:167]
    buffer_load_dwordx4 v194, s[20:23], s50 offen offset:2048 lds
    v_mfma_f32_16x16x32_bf16 v[40:43], a[88:91], a[40:43], v[40:43]
    ds_read_b64_tr_b16 a[126:127], v201 offset:25608
    v_mfma_f32_16x16x32_bf16 v[72:75], a[88:91], a[44:47], v[72:75]
    ds_read_b64_tr_b16 a[128:129], v202 offset:24576
    v_mfma_f32_16x16x32_bf16 v[104:107], a[88:91], a[48:51], v[104:107]
    ds_read_b64_tr_b16 a[130:131], v202 offset:25600
    v_mfma_f32_16x16x32_bf16 v[136:139], a[88:91], a[52:55], v[136:139]
    ds_read_b64_tr_b16 a[132:133], v202 offset:24584
    v_mfma_f32_16x16x32_bf16 v[168:171], a[88:91], a[56:59], v[168:171]
    buffer_load_dwordx4 v195, s[20:23], s50 offen offset:3072 lds
    v_mfma_f32_16x16x32_bf16 v[44:47], a[92:95], a[40:43], v[44:47]
    s_add_u32 s50, s50, 0x8000
    ds_read_b64_tr_b16 a[134:135], v202 offset:25608
    v_mfma_f32_16x16x32_bf16 v[76:79], a[92:95], a[44:47], v[76:79]
    s_add_u32 m0, s43, 45056
    ds_read_b64_tr_b16 a[136:137], v203 offset:24576
    v_mfma_f32_16x16x32_bf16 v[108:111], a[92:95], a[48:51], v[108:111]
    ds_read_b64_tr_b16 a[138:139], v203 offset:25600
    v_mfma_f32_16x16x32_bf16 v[140:143], a[92:95], a[52:55], v[140:143]
    buffer_load_dwordx4 v192, s[20:23], s50 offen offset:0 lds
    v_mfma_f32_16x16x32_bf16 v[172:175], a[92:95], a[56:59], v[172:175]
    ds_read_b64_tr_b16 a[140:141], v203 offset:24584
    v_mfma_f32_16x16x32_bf16 v[48:51], a[96:99], a[40:43], v[48:51]
    ds_read_b64_tr_b16 a[142:143], v203 offset:25608
    v_mfma_f32_16x16x32_bf16 v[80:83], a[96:99], a[44:47], v[80:83]
    buffer_load_dwordx4 v193, s[20:23], s50 offen offset:1024 lds
    v_mfma_f32_16x16x32_bf16 v[112:115], a[96:99], a[48:51], v[112:115]
    s_add_u32 s51, s49, 896
    v_mfma_f32_16x16x32_bf16 v[144:147], a[96:99], a[52:55], v[144:147]
    s_bfe_u32 s51, s51, 0x0a0000
    v_mfma_f32_16x16x32_bf16 v[176:179], a[96:99], a[56:59], v[176:179]
    s_add_u32 m0, s44, 16384
    v_mfma_f32_16x16x32_bf16 v[52:55], a[100:103], a[40:43], v[52:55]
    s_lshl_b32 s51, s51, 12
    v_mfma_f32_16x16x32_bf16 v[84:87], a[100:103], a[44:47], v[84:87]
    buffer_load_dwordx4 v196, s[24:27], s51 offen offset:0 lds
    v_mfma_f32_16x16x32_bf16 v[116:119], a[100:103], a[48:51], v[116:119]
    buffer_load_dwordx4 v197, s[24:27], s51 offen offset:1024 lds
    v_mfma_f32_16x16x32_bf16 v[148:151], a[100:103], a[52:55], v[148:151]
    v_mfma_f32_16x16x32_bf16 v[180:183], a[100:103], a[56:59], v[180:183]
    v_mfma_f32_16x16x32_bf16 v[56:59], a[104:107], a[40:43], v[56:59]
    v_mfma_f32_16x16x32_bf16 v[88:91], a[104:107], a[44:47], v[88:91]
    v_mfma_f32_16x16x32_bf16 v[120:123], a[104:107], a[48:51], v[120:123]
    v_mfma_f32_16x16x32_bf16 v[152:155], a[104:107], a[52:55], v[152:155]
    v_mfma_f32_16x16x32_bf16 v[184:187], a[104:107], a[56:59], v[184:187]
    v_mfma_f32_16x16x32_bf16 v[60:63], a[108:111], a[40:43], v[60:63]
    v_mfma_f32_16x16x32_bf16 v[92:95], a[108:111], a[44:47], v[92:95]
    v_mfma_f32_16x16x32_bf16 v[124:127], a[108:111], a[48:51], v[124:127]
    v_mfma_f32_16x16x32_bf16 v[156:159], a[108:111], a[52:55], v[156:159]
    s_waitcnt vmcnt(13) lgkmcnt(0)
    v_mfma_f32_16x16x32_bf16 v[188:191], a[108:111], a[56:59], v[188:191]
    s_barrier
    v_mfma_f32_16x16x32_bf16 v[32:35], a[112:115], a[60:63], v[32:35]
    s_add_u32 m0, s43, 45056
    ds_read_b64_tr_b16 a[80:81], v200 offset:0
    v_mfma_f32_16x16x32_bf16 v[64:67], a[112:115], a[64:67], v[64:67]
    buffer_load_dwordx4 v194, s[20:23], s50 offen offset:2048 lds
    v_mfma_f32_16x16x32_bf16 v[96:99], a[112:115], a[68:71], v[96:99]
    ds_read_b128 a[0:3], v198 offset:0
    v_mfma_f32_16x16x32_bf16 v[128:131], a[112:115], a[72:75], v[128:131]
    ds_read_b64_tr_b16 a[82:83], v200 offset:1024
    v_mfma_f32_16x16x32_bf16 v[160:163], a[112:115], a[76:79], v[160:163]
    buffer_load_dwordx4 v195, s[20:23], s50 offen offset:3072 lds
    v_mfma_f32_16x16x32_bf16 v[36:39], a[116:119], a[60:63], v[36:39]
    s_add_u32 s50, s50, 0x8000
    ds_read_b128 a[4:7], v198 offset:2048
    v_mfma_f32_16x16x32_bf16 v[68:71], a[116:119], a[64:67], v[68:71]
    s_add_u32 m0, s43, 49152
    ds_read_b64_tr_b16 a[84:85], v200 offset:8
    v_mfma_f32_16x16x32_bf16 v[100:103], a[116:119], a[68:71], v[100:103]
    ds_read_b128 a[8:11], v198 offset:4096
    v_mfma_f32_16x16x32_bf16 v[132:135], a[116:119], a[72:75], v[132:135]
    buffer_load_dwordx4 v192, s[20:23], s50 offen offset:0 lds
    v_mfma_f32_16x16x32_bf16 v[164:167], a[116:119], a[76:79], v[164:167]
    ds_read_b64_tr_b16 a[86:87], v200 offset:1032
    v_mfma_f32_16x16x32_bf16 v[40:43], a[120:123], a[60:63], v[40:43]
    ds_read_b128 a[12:15], v198 offset:6144
    v_mfma_f32_16x16x32_bf16 v[72:75], a[120:123], a[64:67], v[72:75]
    ds_read_b64_tr_b16 a[88:89], v201 offset:0
    v_mfma_f32_16x16x32_bf16 v[104:107], a[120:123], a[68:71], v[104:107]
    buffer_load_dwordx4 v193, s[20:23], s50 offen offset:1024 lds
    v_mfma_f32_16x16x32_bf16 v[136:139], a[120:123], a[72:75], v[136:139]
    s_add_u32 s51, s49, 960
    ds_read_b128 a[16:19], v198 offset:8192
    v_mfma_f32_16x16x32_bf16 v[168:171], a[120:123], a[76:79], v[168:171]
    s_bfe_u32 s51, s51, 0x0a0000
    ds_read_b64_tr_b16 a[90:91], v201 offset:1024
    v_mfma_f32_16x16x32_bf16 v[44:47], a[124:127], a[60:63], v[44:47]
    s_add_u32 m0, s44, 24576
    ds_read_b128 a[20:23], v199 offset:0
    v_mfma_f32_16x16x32_bf16 v[76:79], a[124:127], a[64:67], v[76:79]
    s_lshl_b32 s51, s51, 12
    ds_read_b64_tr_b16 a[92:93], v201 offset:8
    v_mfma_f32_16x16x32_bf16 v[108:111], a[124:127], a[68:71], v[108:111]
    buffer_load_dwordx4 v196, s[24:27], s51 offen offset:0 lds
    v_mfma_f32_16x16x32_bf16 v[140:143], a[124:127], a[72:75], v[140:143]
    ds_read_b128 a[24:27], v199 offset:2048
    v_mfma_f32_16x16x32_bf16 v[172:175], a[124:127], a[76:79], v[172:175]
    ds_read_b64_tr_b16 a[94:95], v201 offset:1032
    v_mfma_f32_16x16x32_bf16 v[48:51], a[128:131], a[60:63], v[48:51]
    buffer_load_dwordx4 v197, s[24:27], s51 offen offset:1024 lds
    v_mfma_f32_16x16x32_bf16 v[80:83], a[128:131], a[64:67], v[80:83]
    s_add_u32 m0, s45, 16384
    ds_read_b128 a[28:31], v199 offset:4096
    v_mfma_f32_16x16x32_bf16 v[112:115], a[128:131], a[68:71], v[112:115]
    ds_read_b64_tr_b16 a[96:97], v202 offset:0
    v_mfma_f32_16x16x32_bf16 v[144:147], a[128:131], a[72:75], v[144:147]
    ds_read_b128 a[32:35], v199 offset:6144
    v_mfma_f32_16x16x32_bf16 v[176:179], a[128:131], a[76:79], v[176:179]
    buffer_load_dwordx4 v14, s[28:31], s52 offen offset:1024 nt lds
    v_mfma_f32_16x16x32_bf16 v[52:55], a[132:135], a[60:63], v[52:55]
    ds_read_b64_tr_b16 a[98:99], v202 offset:1024
    v_mfma_f32_16x16x32_bf16 v[84:87], a[132:135], a[64:67], v[84:87]
    ds_read_b128 a[36:39], v199 offset:8192
    v_mfma_f32_16x16x32_bf16 v[116:119], a[132:135], a[68:71], v[116:119]
    ds_read_b64_tr_b16 a[100:101], v202 offset:8
    v_mfma_f32_16x16x32_bf16 v[148:151], a[132:135], a[72:75], v[148:151]
    ds_read_b64_tr_b16 a[102:103], v202 offset:1032
    v_mfma_f32_16x16x32_bf16 v[180:183], a[132:135], a[76:79], v[180:183]
    ds_read_b64_tr_b16 a[104:105], v203 offset:0
    v_mfma_f32_16x16x32_bf16 v[56:59], a[136:139], a[60:63], v[56:59]
    ds_read_b64_tr_b16 a[106:107], v203 offset:1024
    v_mfma_f32_16x16x32_bf16 v[88:91], a[136:139], a[64:67], v[88:91]
    ds_read_b64_tr_b16 a[108:109], v203 offset:8
    v_mfma_f32_16x16x32_bf16 v[120:123], a[136:139], a[68:71], v[120:123]
    ds_read_b64_tr_b16 a[110:111], v203 offset:1032
    v_mfma_f32_16x16x32_bf16 v[152:155], a[136:139], a[72:75], v[152:155]
    v_mfma_f32_16x16x32_bf16 v[184:187], a[136:139], a[76:79], v[184:187]
    v_mfma_f32_16x16x32_bf16 v[60:63], a[140:143], a[60:63], v[60:63]
    v_mfma_f32_16x16x32_bf16 v[92:95], a[140:143], a[64:67], v[92:95]
    v_mfma_f32_16x16x32_bf16 v[124:127], a[140:143], a[68:71], v[124:127]
    s_nop 0
    buffer_load_dwordx4 v15, s[28:31], s52 offen offset:2048 nt lds
    buffer_load_dwordx4 v16, s[28:31], s52 offen offset:3072 nt lds
    v_mfma_f32_16x16x32_bf16 v[156:159], a[140:143], a[72:75], v[156:159]
    s_waitcnt vmcnt(20) lgkmcnt(0)
    v_mfma_f32_16x16x32_bf16 v[188:191], a[140:143], a[76:79], v[188:191]
    s_barrier
    v_mfma_f32_16x16x32_bf16 v[32:35], a[80:83], a[0:3], v[32:35]
    s_add_u32 m0, s45, 81920
    ds_read_b64_tr_b16 a[112:113], v200 offset:8192
    v_mfma_f32_16x16x32_bf16 v[64:67], a[80:83], a[4:7], v[64:67]
    buffer_load_dwordx4 v17, s[32:35], s52 offen offset:0 nt lds
    v_mfma_f32_16x16x32_bf16 v[96:99], a[80:83], a[8:11], v[96:99]
    ds_read_b64_tr_b16 a[114:115], v200 offset:9216
    v_mfma_f32_16x16x32_bf16 v[128:131], a[80:83], a[12:15], v[128:131]
    ds_read_b64_tr_b16 a[116:117], v200 offset:8200
    v_mfma_f32_16x16x32_bf16 v[160:163], a[80:83], a[16:19], v[160:163]
    ds_read_b64_tr_b16 a[118:119], v200 offset:9224
    v_mfma_f32_16x16x32_bf16 v[36:39], a[84:87], a[0:3], v[36:39]
    ds_read_b64_tr_b16 a[120:121], v201 offset:8192
    v_mfma_f32_16x16x32_bf16 v[68:71], a[84:87], a[4:7], v[68:71]
    ds_read_b64_tr_b16 a[122:123], v201 offset:9216
    v_mfma_f32_16x16x32_bf16 v[100:103], a[84:87], a[8:11], v[100:103]
    ds_read_b64_tr_b16 a[124:125], v201 offset:8200
    v_mfma_f32_16x16x32_bf16 v[132:135], a[84:87], a[12:15], v[132:135]
    ds_read_b64_tr_b16 a[126:127], v201 offset:9224
    v_mfma_f32_16x16x32_bf16 v[164:167], a[84:87], a[16:19], v[164:167]
    ds_read_b64_tr_b16 a[128:129], v202 offset:8192
    v_mfma_f32_16x16x32_bf16 v[40:43], a[88:91], a[0:3], v[40:43]
    ds_read_b64_tr_b16 a[130:131], v202 offset:9216
    v_mfma_f32_16x16x32_bf16 v[72:75], a[88:91], a[4:7], v[72:75]
    ds_read_b64_tr_b16 a[132:133], v202 offset:8200
    v_mfma_f32_16x16x32_bf16 v[104:107], a[88:91], a[8:11], v[104:107]
    ds_read_b64_tr_b16 a[134:135], v202 offset:9224
    v_mfma_f32_16x16x32_bf16 v[136:139], a[88:91], a[12:15], v[136:139]
    ds_read_b64_tr_b16 a[136:137], v203 offset:8192
    v_mfma_f32_16x16x32_bf16 v[168:171], a[88:91], a[16:19], v[168:171]
    ds_read_b64_tr_b16 a[138:139], v203 offset:9216
    v_mfma_f32_16x16x32_bf16 v[44:47], a[92:95], a[0:3], v[44:47]
    ds_read_b64_tr_b16 a[140:141], v203 offset:8200
    v_mfma_f32_16x16x32_bf16 v[76:79], a[92:95], a[4:7], v[76:79]
    ds_read_b64_tr_b16 a[142:143], v203 offset:9224
    v_mfma_f32_16x16x32_bf16 v[108:111], a[92:95], a[8:11], v[108:111]
    buffer_load_dwordx4 v18, s[32:35], s52 offen offset:1024 nt lds
    v_mfma_f32_16x16x32_bf16 v[140:143], a[92:95], a[12:15], v[140:143]
    v_mfma_f32_16x16x32_bf16 v[172:175], a[92:95], a[16:19], v[172:175]
    v_mfma_f32_16x16x32_bf16 v[48:51], a[96:99], a[0:3], v[48:51]
    v_mfma_f32_16x16x32_bf16 v[80:83], a[96:99], a[4:7], v[80:83]
    v_mfma_f32_16x16x32_bf16 v[112:115], a[96:99], a[8:11], v[112:115]
    v_mfma_f32_16x16x32_bf16 v[144:147], a[96:99], a[12:15], v[144:147]
    v_mfma_f32_16x16x32_bf16 v[176:179], a[96:99], a[16:19], v[176:179]
    v_mfma_f32_16x16x32_bf16 v[52:55], a[100:103], a[0:3], v[52:55]
    v_mfma_f32_16x16x32_bf16 v[84:87], a[100:103], a[4:7], v[84:87]
    v_mfma_f32_16x16x32_bf16 v[116:119], a[100:103], a[8:11], v[116:119]
    v_mfma_f32_16x16x32_bf16 v[148:151], a[100:103], a[12:15], v[148:151]
    v_mfma_f32_16x16x32_bf16 v[180:183], a[100:103], a[16:19], v[180:183]
    v_mfma_f32_16x16x32_bf16 v[56:59], a[104:107], a[0:3], v[56:59]
    v_mfma_f32_16x16x32_bf16 v[88:91], a[104:107], a[4:7], v[88:91]
    v_mfma_f32_16x16x32_bf16 v[120:123], a[104:107], a[8:11], v[120:123]
    v_mfma_f32_16x16x32_bf16 v[152:155], a[104:107], a[12:15], v[152:155]
    v_mfma_f32_16x16x32_bf16 v[184:187], a[104:107], a[16:19], v[184:187]
    v_mfma_f32_16x16x32_bf16 v[60:63], a[108:111], a[0:3], v[60:63]
    v_mfma_f32_16x16x32_bf16 v[92:95], a[108:111], a[4:7], v[92:95]
    v_mfma_f32_16x16x32_bf16 v[124:127], a[108:111], a[8:11], v[124:127]
    v_mfma_f32_16x16x32_bf16 v[156:159], a[108:111], a[12:15], v[156:159]
    s_waitcnt vmcnt(7) lgkmcnt(0)
    v_mfma_f32_16x16x32_bf16 v[188:191], a[108:111], a[16:19], v[188:191]
    s_barrier
    v_mfma_f32_16x16x32_bf16 v[32:35], a[112:115], a[20:23], v[32:35]
    s_add_u32 m0, s45, 81920
    ds_read_b64_tr_b16 a[80:81], v200 offset:16384
    v_mfma_f32_16x16x32_bf16 v[64:67], a[112:115], a[24:27], v[64:67]
    buffer_load_dwordx4 v17, s[32:35], s52 offen offset:2048 nt lds
    v_mfma_f32_16x16x32_bf16 v[96:99], a[112:115], a[28:31], v[96:99]
    ds_read_b128 a[40:43], v198 offset:40960
    v_mfma_f32_16x16x32_bf16 v[128:131], a[112:115], a[32:35], v[128:131]
    ds_read_b64_tr_b16 a[82:83], v200 offset:17408
    v_mfma_f32_16x16x32_bf16 v[160:163], a[112:115], a[36:39], v[160:163]
    ds_read_b128 a[44:47], v198 offset:43008
    v_mfma_f32_16x16x32_bf16 v[36:39], a[116:119], a[20:23], v[36:39]
    ds_read_b64_tr_b16 a[84:85], v200 offset:16392
    v_mfma_f32_16x16x32_bf16 v[68:71], a[116:119], a[24:27], v[68:71]
    ds_read_b128 a[48:51], v198 offset:45056
    v_mfma_f32_16x16x32_bf16 v[100:103], a[116:119], a[28:31], v[100:103]
    ds_read_b64_tr_b16 a[86:87], v200 offset:17416
    v_mfma_f32_16x16x32_bf16 v[132:135], a[116:119], a[32:35], v[132:135]
    ds_read_b128 a[52:55], v198 offset:47104
    v_mfma_f32_16x16x32_bf16 v[164:167], a[116:119], a[36:39], v[164:167]
    ds_read_b64_tr_b16 a[88:89], v201 offset:16384
    v_mfma_f32_16x16x32_bf16 v[40:43], a[120:123], a[20:23], v[40:43]
    ds_read_b128 a[56:59], v198 offset:49152
    v_mfma_f32_16x16x32_bf16 v[72:75], a[120:123], a[24:27], v[72:75]
    ds_read_b64_tr_b16 a[90:91], v201 offset:17408
    v_mfma_f32_16x16x32_bf16 v[104:107], a[120:123], a[28:31], v[104:107]
    ds_read_b128 a[60:63], v199 offset:40960
    v_mfma_f32_16x16x32_bf16 v[136:139], a[120:123], a[32:35], v[136:139]
    ds_read_b64_tr_b16 a[92:93], v201 offset:16392
    v_mfma_f32_16x16x32_bf16 v[168:171], a[120:123], a[36:39], v[168:171]
    ds_read_b128 a[64:67], v199 offset:43008
    v_mfma_f32_16x16x32_bf16 v[44:47], a[124:127], a[20:23], v[44:47]
    ds_read_b64_tr_b16 a[94:95], v201 offset:17416
    v_mfma_f32_16x16x32_bf16 v[76:79], a[124:127], a[24:27], v[76:79]
    ds_read_b128 a[68:71], v199 offset:45056
    v_mfma_f32_16x16x32_bf16 v[108:111], a[124:127], a[28:31], v[108:111]
    ds_read_b64_tr_b16 a[96:97], v202 offset:16384
    v_mfma_f32_16x16x32_bf16 v[140:143], a[124:127], a[32:35], v[140:143]
    buffer_load_dwordx4 v18, s[32:35], s52 offen offset:3072 nt lds
    v_mfma_f32_16x16x32_bf16 v[172:175], a[124:127], a[36:39], v[172:175]
    ds_read_b128 a[72:75], v199 offset:47104
    v_mfma_f32_16x16x32_bf16 v[48:51], a[128:131], a[20:23], v[48:51]
    ds_read_b64_tr_b16 a[98:99], v202 offset:17408
    v_mfma_f32_16x16x32_bf16 v[80:83], a[128:131], a[24:27], v[80:83]
    ds_read_b128 a[76:79], v199 offset:49152
    v_mfma_f32_16x16x32_bf16 v[112:115], a[128:131], a[28:31], v[112:115]
    ds_read_b64_tr_b16 a[100:101], v202 offset:16392
    v_mfma_f32_16x16x32_bf16 v[144:147], a[128:131], a[32:35], v[144:147]
    ds_read_b64_tr_b16 a[102:103], v202 offset:17416
    v_mfma_f32_16x16x32_bf16 v[176:179], a[128:131], a[36:39], v[176:179]
    ds_read_b64_tr_b16 a[104:105], v203 offset:16384
    v_mfma_f32_16x16x32_bf16 v[52:55], a[132:135], a[20:23], v[52:55]
    ds_read_b64_tr_b16 a[106:107], v203 offset:17408
    v_mfma_f32_16x16x32_bf16 v[84:87], a[132:135], a[24:27], v[84:87]
    ds_read_b64_tr_b16 a[108:109], v203 offset:16392
    v_mfma_f32_16x16x32_bf16 v[116:119], a[132:135], a[28:31], v[116:119]
    ds_read_b64_tr_b16 a[110:111], v203 offset:17416
    v_mfma_f32_16x16x32_bf16 v[148:151], a[132:135], a[32:35], v[148:151]
    v_mfma_f32_16x16x32_bf16 v[180:183], a[132:135], a[36:39], v[180:183]
    v_mfma_f32_16x16x32_bf16 v[56:59], a[136:139], a[20:23], v[56:59]
    v_mfma_f32_16x16x32_bf16 v[88:91], a[136:139], a[24:27], v[88:91]
    v_mfma_f32_16x16x32_bf16 v[120:123], a[136:139], a[28:31], v[120:123]
    v_mfma_f32_16x16x32_bf16 v[152:155], a[136:139], a[32:35], v[152:155]
    v_mfma_f32_16x16x32_bf16 v[184:187], a[136:139], a[36:39], v[184:187]
    v_mfma_f32_16x16x32_bf16 v[60:63], a[140:143], a[20:23], v[60:63]
    v_mfma_f32_16x16x32_bf16 v[92:95], a[140:143], a[24:27], v[92:95]
    v_mfma_f32_16x16x32_bf16 v[124:127], a[140:143], a[28:31], v[124:127]
    v_mfma_f32_16x16x32_bf16 v[156:159], a[140:143], a[32:35], v[156:159]
    s_waitcnt vmcnt(7) lgkmcnt(0)
    v_mfma_f32_16x16x32_bf16 v[188:191], a[140:143], a[36:39], v[188:191]
    s_barrier
    v_mfma_f32_16x16x32_bf16 v[32:35], a[80:83], a[40:43], v[32:35]
    s_add_u32 m0, s45, 32768
    ds_read_b64_tr_b16 a[112:113], v200 offset:24576
    v_mfma_f32_16x16x32_bf16 v[64:67], a[80:83], a[44:47], v[64:67]
    buffer_load_dwordx4 v13, s[28:31], s53 offen offset:0 nt lds
    v_mfma_f32_16x16x32_bf16 v[96:99], a[80:83], a[48:51], v[96:99]
    ds_read_b64_tr_b16 a[114:115], v200 offset:25600
    v_mfma_f32_16x16x32_bf16 v[128:131], a[80:83], a[52:55], v[128:131]
    ds_read_b64_tr_b16 a[116:117], v200 offset:24584
    v_mfma_f32_16x16x32_bf16 v[160:163], a[80:83], a[56:59], v[160:163]
    ds_read_b64_tr_b16 a[118:119], v200 offset:25608
    v_mfma_f32_16x16x32_bf16 v[36:39], a[84:87], a[40:43], v[36:39]
    ds_read_b64_tr_b16 a[120:121], v201 offset:24576
    v_mfma_f32_16x16x32_bf16 v[68:71], a[84:87], a[44:47], v[68:71]
    ds_read_b64_tr_b16 a[122:123], v201 offset:25600
    v_mfma_f32_16x16x32_bf16 v[100:103], a[84:87], a[48:51], v[100:103]
    ds_read_b64_tr_b16 a[124:125], v201 offset:24584
    v_mfma_f32_16x16x32_bf16 v[132:135], a[84:87], a[52:55], v[132:135]
    ds_read_b64_tr_b16 a[126:127], v201 offset:25608
    v_mfma_f32_16x16x32_bf16 v[164:167], a[84:87], a[56:59], v[164:167]
    ds_read_b64_tr_b16 a[128:129], v202 offset:24576
    v_mfma_f32_16x16x32_bf16 v[40:43], a[88:91], a[40:43], v[40:43]
    ds_read_b64_tr_b16 a[130:131], v202 offset:25600
    v_mfma_f32_16x16x32_bf16 v[72:75], a[88:91], a[44:47], v[72:75]
    ds_read_b64_tr_b16 a[132:133], v202 offset:24584
    v_mfma_f32_16x16x32_bf16 v[104:107], a[88:91], a[48:51], v[104:107]
    ds_read_b64_tr_b16 a[134:135], v202 offset:25608
    v_mfma_f32_16x16x32_bf16 v[136:139], a[88:91], a[52:55], v[136:139]
    ds_read_b64_tr_b16 a[136:137], v203 offset:24576
    v_mfma_f32_16x16x32_bf16 v[168:171], a[88:91], a[56:59], v[168:171]
    ds_read_b64_tr_b16 a[138:139], v203 offset:25600
    v_mfma_f32_16x16x32_bf16 v[44:47], a[92:95], a[40:43], v[44:47]
    ds_read_b64_tr_b16 a[140:141], v203 offset:24584
    v_mfma_f32_16x16x32_bf16 v[76:79], a[92:95], a[44:47], v[76:79]
    ds_read_b64_tr_b16 a[142:143], v203 offset:25608
    v_mfma_f32_16x16x32_bf16 v[108:111], a[92:95], a[48:51], v[108:111]
    buffer_load_dwordx4 v14, s[28:31], s53 offen offset:1024 nt lds
    v_mfma_f32_16x16x32_bf16 v[140:143], a[92:95], a[52:55], v[140:143]
    v_mfma_f32_16x16x32_bf16 v[172:175], a[92:95], a[56:59], v[172:175]
    v_mfma_f32_16x16x32_bf16 v[48:51], a[96:99], a[40:43], v[48:51]
    v_mfma_f32_16x16x32_bf16 v[80:83], a[96:99], a[44:47], v[80:83]
    v_mfma_f32_16x16x32_bf16 v[112:115], a[96:99], a[48:51], v[112:115]
    v_mfma_f32_16x16x32_bf16 v[144:147], a[96:99], a[52:55], v[144:147]
    v_mfma_f32_16x16x32_bf16 v[176:179], a[96:99], a[56:59], v[176:179]
    v_mfma_f32_16x16x32_bf16 v[52:55], a[100:103], a[40:43], v[52:55]
    v_mfma_f32_16x16x32_bf16 v[84:87], a[100:103], a[44:47], v[84:87]
    v_mfma_f32_16x16x32_bf16 v[116:119], a[100:103], a[48:51], v[116:119]
    v_mfma_f32_16x16x32_bf16 v[148:151], a[100:103], a[52:55], v[148:151]
    v_mfma_f32_16x16x32_bf16 v[180:183], a[100:103], a[56:59], v[180:183]
    v_mfma_f32_16x16x32_bf16 v[56:59], a[104:107], a[40:43], v[56:59]
    v_mfma_f32_16x16x32_bf16 v[88:91], a[104:107], a[44:47], v[88:91]
    v_mfma_f32_16x16x32_bf16 v[120:123], a[104:107], a[48:51], v[120:123]
    v_mfma_f32_16x16x32_bf16 v[152:155], a[104:107], a[52:55], v[152:155]
    v_mfma_f32_16x16x32_bf16 v[184:187], a[104:107], a[56:59], v[184:187]
    v_mfma_f32_16x16x32_bf16 v[60:63], a[108:111], a[40:43], v[60:63]
    v_mfma_f32_16x16x32_bf16 v[92:95], a[108:111], a[44:47], v[92:95]
    v_mfma_f32_16x16x32_bf16 v[124:127], a[108:111], a[48:51], v[124:127]
    v_mfma_f32_16x16x32_bf16 v[156:159], a[108:111], a[52:55], v[156:159]
    s_waitcnt vmcnt(24) lgkmcnt(0)
    v_mfma_f32_16x16x32_bf16 v[188:191], a[108:111], a[56:59], v[188:191]
    s_barrier
    v_mfma_f32_16x16x32_bf16 v[32:35], a[112:115], a[60:63], v[32:35]
    s_add_u32 m0, s45, 32768
    ds_read_b128 a[80:83], v1 offset:0
    v_mfma_f32_16x16x32_bf16 v[64:67], a[112:115], a[64:67], v[64:67]
    buffer_load_dwordx4 v15, s[28:31], s53 offen offset:2048 nt lds
    v_mfma_f32_16x16x32_bf16 v[96:99], a[112:115], a[68:71], v[96:99]
    ds_read_b128 a[84:87], v2 offset:0
    v_mfma_f32_16x16x32_bf16 v[128:131], a[112:115], a[72:75], v[128:131]
    ds_read_b128 a[88:91], v3 offset:0
    v_mfma_f32_16x16x32_bf16 v[160:163], a[112:115], a[76:79], v[160:163]
    ds_read_b128 a[92:95], v4 offset:0
    v_mfma_f32_16x16x32_bf16 v[36:39], a[116:119], a[60:63], v[36:39]
    ds_read_b128 a[96:99], v1 offset:4096
    v_mfma_f32_16x16x32_bf16 v[68:71], a[116:119], a[64:67], v[68:71]
    ds_read_b128 a[100:103], v2 offset:4096
    v_mfma_f32_16x16x32_bf16 v[100:103], a[116:119], a[68:71], v[100:103]
    ds_read_b128 a[104:107], v3 offset:4096
    v_mfma_f32_16x16x32_bf16 v[132:135], a[116:119], a[72:75], v[132:135]
    ds_read_b128 a[108:111], v4 offset:4096
    v_mfma_f32_16x16x32_bf16 v[164:167], a[116:119], a[76:79], v[164:167]
    ds_read_b64_tr_b16 a[144:145], v5 offset:0
    v_mfma_f32_16x16x32_bf16 v[40:43], a[120:123], a[60:63], v[40:43]
    ds_read_b64_tr_b16 a[146:147], v5 offset:4096
    v_mfma_f32_16x16x32_bf16 v[72:75], a[120:123], a[64:67], v[72:75]
    ds_read_b64_tr_b16 a[148:149], v6 offset:0
    v_mfma_f32_16x16x32_bf16 v[104:107], a[120:123], a[68:71], v[104:107]
    ds_read_b64_tr_b16 a[150:151], v6 offset:4096
    v_mfma_f32_16x16x32_bf16 v[136:139], a[120:123], a[72:75], v[136:139]
    ds_read_b64_tr_b16 a[152:153], v7 offset:0
    v_mfma_f32_16x16x32_bf16 v[168:171], a[120:123], a[76:79], v[168:171]
    ds_read_b64_tr_b16 a[154:155], v7 offset:4096
    v_mfma_f32_16x16x32_bf16 v[44:47], a[124:127], a[60:63], v[44:47]
    ds_read_b64_tr_b16 a[156:157], v8 offset:0
    v_mfma_f32_16x16x32_bf16 v[76:79], a[124:127], a[64:67], v[76:79]
    ds_read_b64_tr_b16 a[158:159], v8 offset:4096
    v_mfma_f32_16x16x32_bf16 v[108:111], a[124:127], a[68:71], v[108:111]
    ds_read_b64_tr_b16 a[160:161], v9 offset:0
    v_mfma_f32_16x16x32_bf16 v[140:143], a[124:127], a[72:75], v[140:143]
    buffer_load_dwordx4 v16, s[28:31], s53 offen offset:3072 nt lds
    v_mfma_f32_16x16x32_bf16 v[172:175], a[124:127], a[76:79], v[172:175]
    ds_read_b64_tr_b16 a[162:163], v9 offset:4096
    v_mfma_f32_16x16x32_bf16 v[48:51], a[128:131], a[60:63], v[48:51]
    ds_read_b64_tr_b16 a[164:165], v10 offset:0
    v_mfma_f32_16x16x32_bf16 v[80:83], a[128:131], a[64:67], v[80:83]
    ds_read_b64_tr_b16 a[166:167], v10 offset:4096
    v_mfma_f32_16x16x32_bf16 v[112:115], a[128:131], a[68:71], v[112:115]
    ds_read_b64_tr_b16 a[168:169], v11 offset:0
    v_mfma_f32_16x16x32_bf16 v[144:147], a[128:131], a[72:75], v[144:147]
    ds_read_b64_tr_b16 a[170:171], v11 offset:4096
    v_mfma_f32_16x16x32_bf16 v[176:179], a[128:131], a[76:79], v[176:179]
    ds_read_b64_tr_b16 a[172:173], v12 offset:0
    v_mfma_f32_16x16x32_bf16 v[52:55], a[132:135], a[60:63], v[52:55]
    ds_read_b64_tr_b16 a[174:175], v12 offset:4096
    v_mfma_f32_16x16x32_bf16 v[84:87], a[132:135], a[64:67], v[84:87]
    v_mfma_f32_16x16x32_bf16 v[116:119], a[132:135], a[68:71], v[116:119]
    v_mfma_f32_16x16x32_bf16 v[148:151], a[132:135], a[72:75], v[148:151]
    v_mfma_f32_16x16x32_bf16 v[180:183], a[132:135], a[76:79], v[180:183]
    v_mfma_f32_16x16x32_bf16 v[56:59], a[136:139], a[60:63], v[56:59]
    v_mfma_f32_16x16x32_bf16 v[88:91], a[136:139], a[64:67], v[88:91]
    v_mfma_f32_16x16x32_bf16 v[120:123], a[136:139], a[68:71], v[120:123]
    v_mfma_f32_16x16x32_bf16 v[152:155], a[136:139], a[72:75], v[152:155]
    v_mfma_f32_16x16x32_bf16 v[184:187], a[136:139], a[76:79], v[184:187]
    v_mfma_f32_16x16x32_bf16 v[60:63], a[140:143], a[60:63], v[60:63]
    v_mfma_f32_16x16x32_bf16 v[92:95], a[140:143], a[64:67], v[92:95]
    v_mfma_f32_16x16x32_bf16 v[124:127], a[140:143], a[68:71], v[124:127]
    v_mfma_f32_16x16x32_bf16 v[156:159], a[140:143], a[72:75], v[156:159]
    v_mfma_f32_16x16x32_bf16 v[188:191], a[140:143], a[76:79], v[188:191]
    v_mov_b32 v252, 0x3e0293ee
    v_mov_b32 v253, 0x3e0293ee
    s_nop 4
.p2align 3
    v_pk_mul_f32 v[32:33], v[32:33], v[252:253]
    v_pk_mul_f32 v[34:35], v[34:35], v[252:253]
    v_pk_mul_f32 v[36:37], v[36:37], v[252:253]
    v_pk_mul_f32 v[38:39], v[38:39], v[252:253]
    v_pk_mul_f32 v[40:41], v[40:41], v[252:253]
    v_pk_mul_f32 v[42:43], v[42:43], v[252:253]
    v_pk_mul_f32 v[44:45], v[44:45], v[252:253]
    v_pk_mul_f32 v[46:47], v[46:47], v[252:253]
    v_pk_mul_f32 v[48:49], v[48:49], v[252:253]
    v_pk_mul_f32 v[50:51], v[50:51], v[252:253]
    v_pk_mul_f32 v[52:53], v[52:53], v[252:253]
    v_pk_mul_f32 v[54:55], v[54:55], v[252:253]
    v_pk_mul_f32 v[56:57], v[56:57], v[252:253]
    v_pk_mul_f32 v[58:59], v[58:59], v[252:253]
    v_pk_mul_f32 v[60:61], v[60:61], v[252:253]
    v_pk_mul_f32 v[62:63], v[62:63], v[252:253]
    v_pk_mul_f32 v[64:65], v[64:65], v[252:253]
    v_pk_mul_f32 v[66:67], v[66:67], v[252:253]
    v_pk_mul_f32 v[68:69], v[68:69], v[252:253]
    v_pk_mul_f32 v[70:71], v[70:71], v[252:253]
    v_pk_mul_f32 v[72:73], v[72:73], v[252:253]
    v_pk_mul_f32 v[74:75], v[74:75], v[252:253]
    v_pk_mul_f32 v[76:77], v[76:77], v[252:253]
    v_pk_mul_f32 v[78:79], v[78:79], v[252:253]
    v_pk_mul_f32 v[80:81], v[80:81], v[252:253]
    v_pk_mul_f32 v[82:83], v[82:83], v[252:253]
    v_pk_mul_f32 v[84:85], v[84:85], v[252:253]
    v_pk_mul_f32 v[86:87], v[86:87], v[252:253]
    v_pk_mul_f32 v[88:89], v[88:89], v[252:253]
    v_pk_mul_f32 v[90:91], v[90:91], v[252:253]
    v_pk_mul_f32 v[92:93], v[92:93], v[252:253]
    v_pk_mul_f32 v[94:95], v[94:95], v[252:253]
    v_pk_mul_f32 v[96:97], v[96:97], v[252:253]
    v_pk_mul_f32 v[98:99], v[98:99], v[252:253]
    v_pk_mul_f32 v[100:101], v[100:101], v[252:253]
    v_pk_mul_f32 v[102:103], v[102:103], v[252:253]
    v_pk_mul_f32 v[104:105], v[104:105], v[252:253]
    v_pk_mul_f32 v[106:107], v[106:107], v[252:253]
    v_pk_mul_f32 v[108:109], v[108:109], v[252:253]
    v_pk_mul_f32 v[110:111], v[110:111], v[252:253]
    v_pk_mul_f32 v[112:113], v[112:113], v[252:253]
    v_pk_mul_f32 v[114:115], v[114:115], v[252:253]
    v_pk_mul_f32 v[116:117], v[116:117], v[252:253]
    v_pk_mul_f32 v[118:119], v[118:119], v[252:253]
    v_pk_mul_f32 v[120:121], v[120:121], v[252:253]
    v_pk_mul_f32 v[122:123], v[122:123], v[252:253]
    v_pk_mul_f32 v[124:125], v[124:125], v[252:253]
    v_pk_mul_f32 v[126:127], v[126:127], v[252:253]
    v_pk_mul_f32 v[128:129], v[128:129], v[252:253]
    v_pk_mul_f32 v[130:131], v[130:131], v[252:253]
    v_pk_mul_f32 v[132:133], v[132:133], v[252:253]
    v_pk_mul_f32 v[134:135], v[134:135], v[252:253]
    v_pk_mul_f32 v[136:137], v[136:137], v[252:253]
    v_pk_mul_f32 v[138:139], v[138:139], v[252:253]
    v_pk_mul_f32 v[140:141], v[140:141], v[252:253]
    v_pk_mul_f32 v[142:143], v[142:143], v[252:253]
    v_pk_mul_f32 v[144:145], v[144:145], v[252:253]
    v_pk_mul_f32 v[146:147], v[146:147], v[252:253]
    v_pk_mul_f32 v[148:149], v[148:149], v[252:253]
    v_pk_mul_f32 v[150:151], v[150:151], v[252:253]
    v_pk_mul_f32 v[152:153], v[152:153], v[252:253]
    v_pk_mul_f32 v[154:155], v[154:155], v[252:253]
    v_pk_mul_f32 v[156:157], v[156:157], v[252:253]
    v_pk_mul_f32 v[158:159], v[158:159], v[252:253]
    v_pk_mul_f32 v[160:161], v[160:161], v[252:253]
    v_pk_mul_f32 v[162:163], v[162:163], v[252:253]
    v_pk_mul_f32 v[164:165], v[164:165], v[252:253]
    v_pk_mul_f32 v[166:167], v[166:167], v[252:253]
    v_pk_mul_f32 v[168:169], v[168:169], v[252:253]
    v_pk_mul_f32 v[170:171], v[170:171], v[252:253]
    v_pk_mul_f32 v[172:173], v[172:173], v[252:253]
    v_pk_mul_f32 v[174:175], v[174:175], v[252:253]
    v_pk_mul_f32 v[176:177], v[176:177], v[252:253]
    v_pk_mul_f32 v[178:179], v[178:179], v[252:253]
    v_pk_mul_f32 v[180:181], v[180:181], v[252:253]
    v_pk_mul_f32 v[182:183], v[182:183], v[252:253]
    v_pk_mul_f32 v[184:185], v[184:185], v[252:253]
    v_pk_mul_f32 v[186:187], v[186:187], v[252:253]
    v_pk_mul_f32 v[188:189], v[188:189], v[252:253]
    v_pk_mul_f32 v[190:191], v[190:191], v[252:253]
    s_add_u32 m0, s45, 98304
    s_nop 0
    buffer_load_dwordx4 v17, s[32:35], s53 offen offset:0 nt lds
    buffer_load_dwordx4 v18, s[32:35], s53 offen offset:1024 nt lds
    buffer_load_dwordx4 v17, s[32:35], s53 offen offset:2048 nt lds
    buffer_load_dwordx4 v18, s[32:35], s53 offen offset:3072 nt lds
    v_cvt_pk_bf16_f32 v32, v32, v33
    v_cvt_pk_bf16_f32 v33, v34, v35
    v_cvt_pk_bf16_f32 v34, v36, v37
    v_cvt_pk_bf16_f32 v35, v38, v39
    v_accvgpr_write_b32 a0, v32
    v_accvgpr_write_b32 a1, v33
    v_accvgpr_write_b32 a2, v34
    v_accvgpr_write_b32 a3, v35
    v_cvt_pk_bf16_f32 v40, v40, v41
    v_cvt_pk_bf16_f32 v41, v42, v43
    v_cvt_pk_bf16_f32 v42, v44, v45
    v_cvt_pk_bf16_f32 v43, v46, v47
    v_accvgpr_write_b32 a4, v40
    v_accvgpr_write_b32 a5, v41
    v_accvgpr_write_b32 a6, v42
    v_accvgpr_write_b32 a7, v43
    v_cvt_pk_bf16_f32 v48, v48, v49
    v_cvt_pk_bf16_f32 v49, v50, v51
    v_cvt_pk_bf16_f32 v50, v52, v53
    v_cvt_pk_bf16_f32 v51, v54, v55
    v_accvgpr_write_b32 a8, v48
    v_accvgpr_write_b32 a9, v49
    v_accvgpr_write_b32 a10, v50
    v_accvgpr_write_b32 a11, v51
    v_cvt_pk_bf16_f32 v56, v56, v57
    v_cvt_pk_bf16_f32 v57, v58, v59
    v_cvt_pk_bf16_f32 v58, v60, v61
    v_cvt_pk_bf16_f32 v59, v62, v63
    v_accvgpr_write_b32 a12, v56
    v_accvgpr_write_b32 a13, v57
    v_accvgpr_write_b32 a14, v58
    v_accvgpr_write_b32 a15, v59
    s_waitcnt lgkmcnt(0)
    s_nop 0
    v_mfma_f32_16x16x32_bf16 v[32:35], a[80:83], a[0:3], 0
    v_cvt_pk_bf16_f32 v64, v64, v65
    v_cvt_pk_bf16_f32 v65, v66, v67
    v_cvt_pk_bf16_f32 v66, v68, v69
    v_cvt_pk_bf16_f32 v67, v70, v71
    v_mfma_f32_16x16x32_bf16 v[32:35], a[84:87], a[4:7], v[32:35]
    v_accvgpr_write_b32 a16, v64
    v_accvgpr_write_b32 a17, v65
    v_accvgpr_write_b32 a18, v66
    v_accvgpr_write_b32 a19, v67
    v_mfma_f32_16x16x32_bf16 v[32:35], a[88:91], a[8:11], v[32:35]
    v_cvt_pk_bf16_f32 v72, v72, v73
    v_cvt_pk_bf16_f32 v73, v74, v75
    v_cvt_pk_bf16_f32 v74, v76, v77
    v_cvt_pk_bf16_f32 v75, v78, v79
    v_mfma_f32_16x16x32_bf16 v[32:35], a[92:95], a[12:15], v[32:35]
    v_accvgpr_write_b32 a20, v72
    v_accvgpr_write_b32 a21, v73
    v_accvgpr_write_b32 a22, v74
    v_accvgpr_write_b32 a23, v75
    v_mfma_f32_16x16x32_bf16 v[36:39], a[96:99], a[0:3], 0
    v_cvt_pk_bf16_f32 v80, v80, v81
    v_cvt_pk_bf16_f32 v81, v82, v83
    v_cvt_pk_bf16_f32 v82, v84, v85
    v_cvt_pk_bf16_f32 v83, v86, v87
    v_mfma_f32_16x16x32_bf16 v[36:39], a[100:103], a[4:7], v[36:39]
    v_accvgpr_write_b32 a24, v80
    v_accvgpr_write_b32 a25, v81
    v_accvgpr_write_b32 a26, v82
    v_accvgpr_write_b32 a27, v83
    v_mfma_f32_16x16x32_bf16 v[36:39], a[104:107], a[8:11], v[36:39]
    v_cvt_pk_bf16_f32 v88, v88, v89
    v_cvt_pk_bf16_f32 v89, v90, v91
    v_cvt_pk_bf16_f32 v90, v92, v93
    v_cvt_pk_bf16_f32 v91, v94, v95
    v_mfma_f32_16x16x32_bf16 v[36:39], a[108:111], a[12:15], v[36:39]
    v_accvgpr_write_b32 a28, v88
    v_accvgpr_write_b32 a29, v89
    v_accvgpr_write_b32 a30, v90
    v_accvgpr_write_b32 a31, v91
    s_nop 1
    v_mfma_f32_16x16x32_bf16 v[64:67], a[80:83], a[16:19], 0
    v_cvt_pk_bf16_f32 v96, v96, v97
    v_cvt_pk_bf16_f32 v97, v98, v99
    v_cvt_pk_bf16_f32 v98, v100, v101
    v_cvt_pk_bf16_f32 v99, v102, v103
    v_mfma_f32_16x16x32_bf16 v[64:67], a[84:87], a[20:23], v[64:67]
    v_accvgpr_write_b32 a32, v96
    v_accvgpr_write_b32 a33, v97
    v_accvgpr_write_b32 a34, v98
    v_accvgpr_write_b32 a35, v99
    v_mfma_f32_16x16x32_bf16 v[64:67], a[88:91], a[24:27], v[64:67]
    v_cvt_pk_bf16_f32 v104, v104, v105
    v_cvt_pk_bf16_f32 v105, v106, v107
    v_cvt_pk_bf16_f32 v106, v108, v109
    v_cvt_pk_bf16_f32 v107, v110, v111
    v_mfma_f32_16x16x32_bf16 v[64:67], a[92:95], a[28:31], v[64:67]
    v_accvgpr_write_b32 a36, v104
    v_accvgpr_write_b32 a37, v105
    v_accvgpr_write_b32 a38, v106
    v_accvgpr_write_b32 a39, v107
    v_mfma_f32_16x16x32_bf16 v[68:71], a[96:99], a[16:19], 0
    v_cvt_pk_bf16_f32 v112, v112, v113
    v_cvt_pk_bf16_f32 v113, v114, v115
    v_cvt_pk_bf16_f32 v114, v116, v117
    v_cvt_pk_bf16_f32 v115, v118, v119
    v_mfma_f32_16x16x32_bf16 v[68:71], a[100:103], a[20:23], v[68:71]
    v_accvgpr_write_b32 a40, v112
    v_accvgpr_write_b32 a41, v113
    v_accvgpr_write_b32 a42, v114
    v_accvgpr_write_b32 a43, v115
    v_mfma_f32_16x16x32_bf16 v[68:71], a[104:107], a[24:27], v[68:71]
    v_cvt_pk_bf16_f32 v120, v120, v121
    v_cvt_pk_bf16_f32 v121, v122, v123
    v_cvt_pk_bf16_f32 v122, v124, v125
    v_cvt_pk_bf16_f32 v123, v126, v127
    v_mfma_f32_16x16x32_bf16 v[68:71], a[108:111], a[28:31], v[68:71]
    v_accvgpr_write_b32 a44, v120
    v_accvgpr_write_b32 a45, v121
    v_accvgpr_write_b32 a46, v122
    v_accvgpr_write_b32 a47, v123
    s_nop 1
    v_mfma_f32_16x16x32_bf16 v[96:99], a[80:83], a[32:35], 0
    v_cvt_pk_bf16_f32 v128, v128, v129
    v_cvt_pk_bf16_f32 v129, v130, v131
    v_cvt_pk_bf16_f32 v130, v132, v133
    v_cvt_pk_bf16_f32 v131, v134, v135
    v_mfma_f32_16x16x32_bf16 v[96:99], a[84:87], a[36:39], v[96:99]
    v_accvgpr_write_b32 a48, v128
    v_accvgpr_write_b32 a49, v129
    v_accvgpr_write_b32 a50, v130
    v_accvgpr_write_b32 a51, v131
    v_mfma_f32_16x16x32_bf16 v[96:99], a[88:91], a[40:43], v[96:99]
    v_cvt_pk_bf16_f32 v136, v136, v137
    v_cvt_pk_bf16_f32 v137, v138, v139
    v_cvt_pk_bf16_f32 v138, v140, v141
    v_cvt_pk_bf16_f32 v139, v142, v143
    v_mfma_f32_16x16x32_bf16 v[96:99], a[92:95], a[44:47], v[96:99]
    v_accvgpr_write_b32 a52, v136
    v_accvgpr_write_b32 a53, v137
    v_accvgpr_write_b32 a54, v138
    v_accvgpr_write_b32 a55, v139
    v_mfma_f32_16x16x32_bf16 v[100:103], a[96:99], a[32:35], 0
    v_cvt_pk_bf16_f32 v144, v144, v145
    v_cvt_pk_bf16_f32 v145, v146, v147
    v_cvt_pk_bf16_f32 v146, v148, v149
    v_cvt_pk_bf16_f32 v147, v150, v151
    v_mfma_f32_16x16x32_bf16 v[100:103], a[100:103], a[36:39], v[100:103]
    v_accvgpr_write_b32 a56, v144
    v_accvgpr_write_b32 a57, v145
    v_accvgpr_write_b32 a58, v146
    v_accvgpr_write_b32 a59, v147
    v_mfma_f32_16x16x32_bf16 v[100:103], a[104:107], a[40:43], v[100:103]
    v_cvt_pk_bf16_f32 v152, v152, v153
    v_cvt_pk_bf16_f32 v153, v154, v155
    v_cvt_pk_bf16_f32 v154, v156, v157
    v_cvt_pk_bf16_f32 v155, v158, v159
    v_mfma_f32_16x16x32_bf16 v[100:103], a[108:111], a[44:47], v[100:103]
    v_accvgpr_write_b32 a60, v152
    v_accvgpr_write_b32 a61, v153
    v_accvgpr_write_b32 a62, v154
    v_accvgpr_write_b32 a63, v155
    s_nop 1
    v_mfma_f32_16x16x32_bf16 v[128:131], a[80:83], a[48:51], 0
    v_cvt_pk_bf16_f32 v160, v160, v161
    v_cvt_pk_bf16_f32 v161, v162, v163
    v_cvt_pk_bf16_f32 v162, v164, v165
    v_cvt_pk_bf16_f32 v163, v166, v167
    v_mfma_f32_16x16x32_bf16 v[128:131], a[84:87], a[52:55], v[128:131]
    v_accvgpr_write_b32 a64, v160
    v_accvgpr_write_b32 a65, v161
    v_accvgpr_write_b32 a66, v162
    v_accvgpr_write_b32 a67, v163
    v_mfma_f32_16x16x32_bf16 v[128:131], a[88:91], a[56:59], v[128:131]
    v_cvt_pk_bf16_f32 v168, v168, v169
    v_cvt_pk_bf16_f32 v169, v170, v171
    v_cvt_pk_bf16_f32 v170, v172, v173
    v_cvt_pk_bf16_f32 v171, v174, v175
    v_mfma_f32_16x16x32_bf16 v[128:131], a[92:95], a[60:63], v[128:131]
    v_accvgpr_write_b32 a68, v168
    v_accvgpr_write_b32 a69, v169
    v_accvgpr_write_b32 a70, v170
    v_accvgpr_write_b32 a71, v171
    v_mfma_f32_16x16x32_bf16 v[132:135], a[96:99], a[48:51], 0
    v_cvt_pk_bf16_f32 v176, v176, v177
    v_cvt_pk_bf16_f32 v177, v178, v179
    v_cvt_pk_bf16_f32 v178, v180, v181
    v_cvt_pk_bf16_f32 v179, v182, v183
    v_mfma_f32_16x16x32_bf16 v[132:135], a[100:103], a[52:55], v[132:135]
    v_accvgpr_write_b32 a72, v176
    v_accvgpr_write_b32 a73, v177
    v_accvgpr_write_b32 a74, v178
    v_accvgpr_write_b32 a75, v179
    v_mfma_f32_16x16x32_bf16 v[132:135], a[104:107], a[56:59], v[132:135]
    v_cvt_pk_bf16_f32 v184, v184, v185
    v_cvt_pk_bf16_f32 v185, v186, v187
    v_cvt_pk_bf16_f32 v186, v188, v189
    v_cvt_pk_bf16_f32 v187, v190, v191
    v_mfma_f32_16x16x32_bf16 v[132:135], a[108:111], a[60:63], v[132:135]
    v_accvgpr_write_b32 a76, v184
    v_accvgpr_write_b32 a77, v185
    v_accvgpr_write_b32 a78, v186
    v_accvgpr_write_b32 a79, v187
    s_nop 1
    v_mfma_f32_16x16x32_bf16 v[160:163], a[80:83], a[64:67], 0
    ds_read_b128 a[112:115], v1 offset:8192
    v_max3_f32 v216, v32, v33, v34
    v_max3_f32 v217, v35, v36, v37
    v_mfma_f32_16x16x32_bf16 v[160:163], a[84:87], a[68:71], v[160:163]
    v_max3_f32 v216, v216, v38, v39
    v_max_f32_e64 v216, v216, v217
    v_mfma_f32_16x16x32_bf16 v[160:163], a[88:91], a[72:75], v[160:163]
    ds_read_b128 a[116:119], v2 offset:8192
    v_max3_f32 v220, v64, v65, v66
    v_max3_f32 v221, v67, v68, v69
    v_mfma_f32_16x16x32_bf16 v[160:163], a[92:95], a[76:79], v[160:163]
    v_max3_f32 v220, v220, v70, v71
    v_max_f32_e64 v220, v220, v221
    v_mfma_f32_16x16x32_bf16 v[164:167], a[96:99], a[64:67], 0
    ds_read_b128 a[120:123], v3 offset:8192
    v_max3_f32 v224, v96, v97, v98
    v_max3_f32 v225, v99, v100, v101
    v_mfma_f32_16x16x32_bf16 v[164:167], a[100:103], a[68:71], v[164:167]
    v_max3_f32 v224, v224, v102, v103
    v_max_f32_e64 v224, v224, v225
    v_mfma_f32_16x16x32_bf16 v[164:167], a[104:107], a[72:75], v[164:167]
    ds_read_b128 a[124:127], v4 offset:8192
    v_max3_f32 v228, v128, v129, v130
    v_max3_f32 v229, v131, v132, v133
    v_mfma_f32_16x16x32_bf16 v[164:167], a[108:111], a[76:79], v[164:167]
    v_max3_f32 v228, v228, v134, v135
    v_max_f32_e64 v228, v228, v229
    s_nop 5
    v_max3_f32 v232, v160, v161, v162
    v_max3_f32 v233, v163, v164, v165
    v_max3_f32 v232, v232, v166, v167
    v_max_f32_e64 v232, v232, v233
    v_mov_b32 v217, v216
    v_mov_b32 v221, v220
    v_mov_b32 v225, v224
    v_mov_b32 v229, v228
    v_mov_b32 v233, v232
    s_nop 1
    v_permlane32_swap_b32 v216, v217
    v_permlane32_swap_b32 v220, v221
    v_permlane32_swap_b32 v224, v225
    v_permlane32_swap_b32 v228, v229
    v_permlane32_swap_b32 v232, v233
    v_max_f32 v216, v216, v217
    v_max_f32 v220, v220, v221
    v_max_f32 v224, v224, v225
    v_max_f32 v228, v228, v229
    v_max_f32 v232, v232, v233
    v_mov_b32 v217, v216
    v_mov_b32 v221, v220
    v_mov_b32 v225, v224
    v_mov_b32 v229, v228
    v_mov_b32 v233, v232
    s_nop 1
    v_permlane16_swap_b32 v216, v217
    v_permlane16_swap_b32 v220, v221
    v_permlane16_swap_b32 v224, v225
    v_permlane16_swap_b32 v228, v229
    v_permlane16_swap_b32 v232, v233
    v_max_f32 v216, v216, v217
    v_max_f32 v220, v220, v221
    v_max_f32 v224, v224, v225
    v_max_f32 v228, v228, v229
    v_max_f32 v232, v232, v233
    v_sub_f32 v219, 0, v216
    v_sub_f32 v218, 0, v216
    v_sub_f32 v217, 0, v216
    v_sub_f32 v216, 0, v216
    v_mov_b32 v236, 0
    v_sub_f32 v223, 0, v220
    v_sub_f32 v222, 0, v220
    v_sub_f32 v221, 0, v220
    v_sub_f32 v220, 0, v220
    v_mov_b32 v237, 0
    v_sub_f32 v227, 0, v224
    v_sub_f32 v226, 0, v224
    v_sub_f32 v225, 0, v224
    v_sub_f32 v224, 0, v224
    v_mov_b32 v238, 0
    v_sub_f32 v231, 0, v228
    v_sub_f32 v230, 0, v228
    v_sub_f32 v229, 0, v228
    v_sub_f32 v228, 0, v228
    v_mov_b32 v239, 0
    v_sub_f32 v235, 0, v232
    v_sub_f32 v234, 0, v232
    v_sub_f32 v233, 0, v232
    v_sub_f32 v232, 0, v232
    v_mov_b32 v240, 0
    s_mov_b32 s59, 0
    v_accvgpr_write_b32 a208, -1
    v_accvgpr_write_b32 a209, -1
    v_accvgpr_write_b32 a210, -1
    v_accvgpr_write_b32 a211, -1
    s_mov_b32 s47, 3
    s_nop 0
    ds_read_b128 a[128:131], v1 offset:12288
    ds_read_b128 a[132:135], v2 offset:12288
    ds_read_b128 a[136:139], v3 offset:12288
    ds_read_b128 a[140:143], v4 offset:12288
    v_add_f32 v32, v216, v32
    v_exp_f32 v32, v32
    v_add_f32 v33, v216, v33
    v_exp_f32 v33, v33
    v_add_f32 v236, v236, v32
    v_add_f32 v236, v236, v33
    v_add_f32 v34, v216, v34
    v_exp_f32 v34, v34
    v_add_f32 v35, v216, v35
    v_exp_f32 v35, v35
    v_cvt_pk_bf16_f32 v208, v32, v33
    v_add_f32 v236, v236, v34
    v_add_f32 v36, v216, v36
    v_exp_f32 v36, v36
    v_add_f32 v236, v236, v35
    v_cvt_pk_bf16_f32 v209, v34, v35
    v_add_f32 v37, v216, v37
    v_exp_f32 v37, v37
    v_add_f32 v38, v216, v38
    v_exp_f32 v38, v38
    v_add_f32 v236, v236, v36
    v_add_f32 v236, v236, v37
    v_add_f32 v39, v216, v39
    v_exp_f32 v39, v39
    v_cvt_pk_bf16_f32 v210, v36, v37
    v_add_f32 v236, v236, v38
    v_add_f32 v236, v236, v39
    v_cvt_pk_bf16_f32 v211, v38, v39
    s_nop 1
    v_mfma_f32_16x16x32_bf16 v[32:35], a[144:147], v[208:211], 0
    s_add_u32 m0, s45, 49152
    ds_read_b64_tr_b16 a[176:177], v5 offset:8192
    v_add_f32 v64, v220, v64
    v_exp_f32 v64, v64
    v_add_f32 v65, v220, v65
    v_exp_f32 v65, v65
    v_mfma_f32_16x16x32_bf16 v[36:39], a[148:151], v[208:211], 0
    buffer_load_dwordx4 v13, s[28:31], s46 offen offset:0 nt lds
    ds_read_b64_tr_b16 a[178:179], v5 offset:12288
    v_add_f32 v237, v237, v64
    v_add_f32 v237, v237, v65
    v_add_f32 v66, v220, v66
    v_mfma_f32_16x16x32_bf16 v[40:43], a[152:155], v[208:211], 0
    buffer_load_dwordx4 v14, s[28:31], s46 offen offset:1024 nt lds
    ds_read_b64_tr_b16 a[180:181], v6 offset:8192
    v_exp_f32 v66, v66
    v_add_f32 v67, v220, v67
    v_exp_f32 v67, v67
    v_cvt_pk_bf16_f32 v212, v64, v65
    v_mfma_f32_16x16x32_bf16 v[44:47], a[156:159], v[208:211], 0
    buffer_load_dwordx4 v15, s[28:31], s46 offen offset:2048 nt lds
    v_add_f32 v237, v237, v66
    v_add_f32 v68, v220, v68
    v_exp_f32 v68, v68
    v_mfma_f32_16x16x32_bf16 v[48:51], a[160:163], v[208:211], 0
    buffer_load_dwordx4 v16, s[28:31], s46 offen offset:3072 nt lds
    ds_read_b64_tr_b16 a[182:183], v6 offset:12288
    v_add_f32 v237, v237, v67
    v_cvt_pk_bf16_f32 v213, v66, v67
    v_add_f32 v69, v220, v69
    v_exp_f32 v69, v69
    v_mfma_f32_16x16x32_bf16 v[52:55], a[164:167], v[208:211], 0
    ds_read_b64_tr_b16 a[184:185], v7 offset:8192
    v_add_f32 v70, v220, v70
    v_exp_f32 v70, v70
    v_add_f32 v237, v237, v68
    v_mfma_f32_16x16x32_bf16 v[56:59], a[168:171], v[208:211], 0
    ds_read_b64_tr_b16 a[186:187], v7 offset:12288
    v_add_f32 v237, v237, v69
    v_add_f32 v71, v220, v71
    v_exp_f32 v71, v71
    v_cvt_pk_bf16_f32 v214, v68, v69
    v_mfma_f32_16x16x32_bf16 v[60:63], a[172:175], v[208:211], 0
    v_add_f32 v237, v237, v70
    v_add_f32 v237, v237, v71
    v_cvt_pk_bf16_f32 v215, v70, v71
    s_nop 1
    v_mfma_f32_16x16x32_bf16 v[64:67], a[144:147], v[212:215], 0
    s_add_u32 m0, s45, 114688
    ds_read_b64_tr_b16 a[188:189], v8 offset:8192
    v_add_f32 v96, v224, v96
    v_exp_f32 v96, v96
    v_add_f32 v97, v224, v97
    v_exp_f32 v97, v97
    v_mfma_f32_16x16x32_bf16 v[68:71], a[148:151], v[212:215], 0
    buffer_load_dwordx4 v17, s[32:35], s46 offen offset:0 nt lds
    ds_read_b64_tr_b16 a[190:191], v8 offset:12288
    v_add_f32 v238, v238, v96
    v_add_f32 v238, v238, v97
    v_add_f32 v98, v224, v98
    v_mfma_f32_16x16x32_bf16 v[72:75], a[152:155], v[212:215], 0
    buffer_load_dwordx4 v18, s[32:35], s46 offen offset:1024 nt lds
    ds_read_b64_tr_b16 a[192:193], v9 offset:8192
    v_exp_f32 v98, v98
    v_add_f32 v99, v224, v99
    v_exp_f32 v99, v99
    v_cvt_pk_bf16_f32 v208, v96, v97
    v_mfma_f32_16x16x32_bf16 v[76:79], a[156:159], v[212:215], 0
    buffer_load_dwordx4 v17, s[32:35], s46 offen offset:2048 nt lds
    v_add_f32 v238, v238, v98
    v_add_f32 v100, v224, v100
    v_exp_f32 v100, v100
    v_mfma_f32_16x16x32_bf16 v[80:83], a[160:163], v[212:215], 0
    buffer_load_dwordx4 v18, s[32:35], s46 offen offset:3072 nt lds
    ds_read_b64_tr_b16 a[194:195], v9 offset:12288
    v_add_f32 v238, v238, v99
    v_cvt_pk_bf16_f32 v209, v98, v99
    v_add_f32 v101, v224, v101
    v_exp_f32 v101, v101
    v_mfma_f32_16x16x32_bf16 v[84:87], a[164:167], v[212:215], 0
    ds_read_b64_tr_b16 a[196:197], v10 offset:8192
    v_add_f32 v102, v224, v102
    v_exp_f32 v102, v102
    v_add_f32 v238, v238, v100
    v_mfma_f32_16x16x32_bf16 v[88:91], a[168:171], v[212:215], 0
    ds_read_b64_tr_b16 a[198:199], v10 offset:12288
    v_add_f32 v238, v238, v101
    v_add_f32 v103, v224, v103
    v_exp_f32 v103, v103
    v_cvt_pk_bf16_f32 v210, v100, v101
    v_mfma_f32_16x16x32_bf16 v[92:95], a[172:175], v[212:215], 0
    v_add_f32 v238, v238, v102
    v_add_f32 v238, v238, v103
    v_cvt_pk_bf16_f32 v211, v102, v103
    s_nop 1
    v_mfma_f32_16x16x32_bf16 v[96:99], a[144:147], v[208:211], 0
    ds_read_b64_tr_b16 a[200:201], v11 offset:8192
    v_add_f32 v128, v228, v128
    v_exp_f32 v128, v128
    v_add_f32 v129, v228, v129
    v_exp_f32 v129, v129
    v_mfma_f32_16x16x32_bf16 v[100:103], a[148:151], v[208:211], 0
    ds_read_b64_tr_b16 a[202:203], v11 offset:12288
    v_add_f32 v239, v239, v128
    v_add_f32 v130, v228, v130
    v_exp_f32 v130, v130
    v_mfma_f32_16x16x32_bf16 v[104:107], a[152:155], v[208:211], 0
    ds_read_b64_tr_b16 a[204:205], v12 offset:8192
    v_add_f32 v239, v239, v129
    v_add_f32 v131, v228, v131
    v_exp_f32 v131, v131
    v_cvt_pk_bf16_f32 v212, v128, v129
    v_mfma_f32_16x16x32_bf16 v[108:111], a[156:159], v[208:211], 0
    ds_read_b64_tr_b16 a[206:207], v12 offset:12288
    v_add_f32 v132, v228, v132
    v_exp_f32 v132, v132
    v_add_f32 v239, v239, v130
    v_mfma_f32_16x16x32_bf16 v[112:115], a[160:163], v[208:211], 0
    v_add_f32 v133, v228, v133
    v_exp_f32 v133, v133
    v_add_f32 v239, v239, v131
    v_cvt_pk_bf16_f32 v213, v130, v131
    v_mfma_f32_16x16x32_bf16 v[116:119], a[164:167], v[208:211], 0
    v_add_f32 v134, v228, v134
    v_exp_f32 v134, v134
    v_add_f32 v239, v239, v132
    v_mfma_f32_16x16x32_bf16 v[120:123], a[168:171], v[208:211], 0
    v_add_f32 v239, v239, v133
    v_add_f32 v135, v228, v135
    v_exp_f32 v135, v135
    v_cvt_pk_bf16_f32 v214, v132, v133
    v_mfma_f32_16x16x32_bf16 v[124:127], a[172:175], v[208:211], 0
    v_add_f32 v239, v239, v134
    v_add_f32 v239, v239, v135
    v_cvt_pk_bf16_f32 v215, v134, v135
    s_waitcnt vmcnt(16) lgkmcnt(0)
    s_barrier
    s_nop 1
    v_mfma_f32_16x16x32_bf16 v[200:203], a[112:115], a[0:3], v[216:219]
    v_add_f32 v160, v232, v160
    v_exp_f32 v160, v160
    v_mfma_f32_16x16x32_bf16 v[200:203], a[116:119], a[4:7], v[200:203]
    v_add_f32 v161, v232, v161
    v_exp_f32 v161, v161
    v_mfma_f32_16x16x32_bf16 v[200:203], a[120:123], a[8:11], v[200:203]
    v_add_f32 v240, v240, v160
    v_add_f32 v240, v240, v161
    v_mfma_f32_16x16x32_bf16 v[200:203], a[124:127], a[12:15], v[200:203]
    v_add_f32 v162, v232, v162
    v_exp_f32 v162, v162
    v_mfma_f32_16x16x32_bf16 v[204:207], a[128:131], a[0:3], v[216:219]
    v_add_f32 v163, v232, v163
    v_exp_f32 v163, v163
    v_mfma_f32_16x16x32_bf16 v[204:207], a[132:135], a[4:7], v[204:207]
    ds_read_b128 a[80:83], v1 offset:16384
    v_cvt_pk_bf16_f32 v208, v160, v161
    v_mfma_f32_16x16x32_bf16 v[204:207], a[136:139], a[8:11], v[204:207]
    ds_read_b128 a[84:87], v2 offset:16384
    v_add_f32 v240, v240, v162
    v_mfma_f32_16x16x32_bf16 v[204:207], a[140:143], a[12:15], v[204:207]
    v_add_f32 v164, v232, v164
    v_exp_f32 v164, v164
    v_mfma_f32_16x16x32_bf16 v[128:131], a[144:147], v[212:215], 0
    v_add_f32 v240, v240, v163
    v_cvt_pk_bf16_f32 v209, v162, v163
    v_mfma_f32_16x16x32_bf16 v[132:135], a[148:151], v[212:215], 0
    v_add_f32 v165, v232, v165
    v_exp_f32 v165, v165
    v_mfma_f32_16x16x32_bf16 v[136:139], a[152:155], v[212:215], 0
    v_add_f32 v166, v232, v166
    v_exp_f32 v166, v166
    v_mfma_f32_16x16x32_bf16 v[140:143], a[156:159], v[212:215], 0
    v_add_f32 v240, v240, v164
    v_add_f32 v240, v240, v165
    v_mfma_f32_16x16x32_bf16 v[144:147], a[160:163], v[212:215], 0
    v_add_f32 v167, v232, v167
    v_exp_f32 v167, v167
    v_mfma_f32_16x16x32_bf16 v[148:151], a[164:167], v[212:215], 0
    ds_read_b128 a[88:91], v3 offset:16384
    v_cvt_pk_bf16_f32 v210, v164, v165
    v_mfma_f32_16x16x32_bf16 v[152:155], a[168:171], v[212:215], 0
    ds_read_b128 a[92:95], v4 offset:16384
    v_add_f32 v240, v240, v166
    v_mfma_f32_16x16x32_bf16 v[156:159], a[172:175], v[212:215], 0
    v_add_f32 v240, v240, v167
    v_cvt_pk_bf16_f32 v211, v166, v167
    v_mfma_f32_16x16x32_bf16 v[192:195], a[112:115], a[16:19], v[220:223]
    v_exp_f32 v200, v200
    v_mfma_f32_16x16x32_bf16 v[192:195], a[116:119], a[20:23], v[192:195]
    v_exp_f32 v201, v201
    v_mfma_f32_16x16x32_bf16 v[192:195], a[120:123], a[24:27], v[192:195]
    v_add_f32 v236, v236, v200
    v_add_f32 v236, v236, v201
    v_mfma_f32_16x16x32_bf16 v[192:195], a[124:127], a[28:31], v[192:195]
    v_exp_f32 v202, v202
    v_mfma_f32_16x16x32_bf16 v[196:199], a[128:131], a[16:19], v[220:223]
    v_exp_f32 v203, v203
    v_mfma_f32_16x16x32_bf16 v[196:199], a[132:135], a[20:23], v[196:199]
    ds_read_b128 a[96:99], v1 offset:20480
    v_cvt_pk_bf16_f32 v212, v200, v201
    v_mfma_f32_16x16x32_bf16 v[196:199], a[136:139], a[24:27], v[196:199]
    ds_read_b128 a[100:103], v2 offset:20480
    v_add_f32 v236, v236, v202
    v_mfma_f32_16x16x32_bf16 v[196:199], a[140:143], a[28:31], v[196:199]
    v_exp_f32 v204, v204
    v_mfma_f32_16x16x32_bf16 v[160:163], a[144:147], v[208:211], 0
    v_add_f32 v236, v236, v203
    v_cvt_pk_bf16_f32 v213, v202, v203
    v_mfma_f32_16x16x32_bf16 v[164:167], a[148:151], v[208:211], 0
    v_exp_f32 v205, v205
    v_mfma_f32_16x16x32_bf16 v[168:171], a[152:155], v[208:211], 0
    v_exp_f32 v206, v206
    v_mfma_f32_16x16x32_bf16 v[172:175], a[156:159], v[208:211], 0
    v_add_f32 v236, v236, v204
    v_add_f32 v236, v236, v205
    v_mfma_f32_16x16x32_bf16 v[176:179], a[160:163], v[208:211], 0
    v_exp_f32 v207, v207
    v_mfma_f32_16x16x32_bf16 v[180:183], a[164:167], v[208:211], 0
    ds_read_b128 a[104:107], v3 offset:20480
    v_cvt_pk_bf16_f32 v214, v204, v205
    v_mfma_f32_16x16x32_bf16 v[184:187], a[168:171], v[208:211], 0
    ds_read_b128 a[108:111], v4 offset:20480
    v_add_f32 v236, v236, v206
    v_mfma_f32_16x16x32_bf16 v[188:191], a[172:175], v[208:211], 0
    v_add_f32 v236, v236, v207
    v_cvt_pk_bf16_f32 v215, v206, v207
    s_branch L_mid_a
.p2align 6
L_loop_a:
    v_mfma_f32_16x16x32_bf16 v[200:203], a[80:83], a[16:19], v[220:223]
    v_exp_f32 v192, v192
    v_mfma_f32_16x16x32_bf16 v[200:203], a[84:87], a[20:23], v[200:203]
    v_exp_f32 v193, v193
    v_mfma_f32_16x16x32_bf16 v[200:203], a[88:91], a[24:27], v[200:203]
    v_add_f32 v236, v236, v192
    v_add_f32 v236, v236, v193
    v_mfma_f32_16x16x32_bf16 v[200:203], a[92:95], a[28:31], v[200:203]
    v_exp_f32 v194, v194
    v_mfma_f32_16x16x32_bf16 v[204:207], a[96:99], a[16:19], v[220:223]
    v_exp_f32 v195, v195
    v_mfma_f32_16x16x32_bf16 v[204:207], a[100:103], a[20:23], v[204:207]
    ds_read_b128 a[128:131], v1 offset:12288
    v_cvt_pk_bf16_f32 v208, v192, v193
    v_mfma_f32_16x16x32_bf16 v[204:207], a[104:107], a[24:27], v[204:207]
    ds_read_b128 a[132:135], v2 offset:12288
    v_add_f32 v236, v236, v194
    v_mfma_f32_16x16x32_bf16 v[204:207], a[108:111], a[28:31], v[204:207]
    v_exp_f32 v196, v196
    v_mfma_f32_16x16x32_bf16 v[160:163], a[176:179], v[212:215], v[160:163]
    v_add_f32 v236, v236, v195
    v_cvt_pk_bf16_f32 v209, v194, v195
    v_mfma_f32_16x16x32_bf16 v[164:167], a[180:183], v[212:215], v[164:167]
    v_exp_f32 v197, v197
    v_mfma_f32_16x16x32_bf16 v[168:171], a[184:187], v[212:215], v[168:171]
    v_exp_f32 v198, v198
    v_mfma_f32_16x16x32_bf16 v[172:175], a[188:191], v[212:215], v[172:175]
    v_add_f32 v236, v236, v196
    v_add_f32 v236, v236, v197
    v_mfma_f32_16x16x32_bf16 v[176:179], a[192:195], v[212:215], v[176:179]
    v_exp_f32 v199, v199
    v_mfma_f32_16x16x32_bf16 v[180:183], a[196:199], v[212:215], v[180:183]
    ds_read_b128 a[136:139], v3 offset:12288
    v_cvt_pk_bf16_f32 v210, v196, v197
    v_mfma_f32_16x16x32_bf16 v[184:187], a[200:203], v[212:215], v[184:187]
    ds_read_b128 a[140:143], v4 offset:12288
    v_add_f32 v236, v236, v198
    v_mfma_f32_16x16x32_bf16 v[188:191], a[204:207], v[212:215], v[188:191]
    v_add_f32 v236, v236, v199
    v_cvt_pk_bf16_f32 v211, v198, v199
    v_mfma_f32_16x16x32_bf16 v[192:195], a[80:83], a[32:35], v[224:227]
    v_exp_f32 v200, v200
    v_mfma_f32_16x16x32_bf16 v[192:195], a[84:87], a[36:39], v[192:195]
    v_exp_f32 v201, v201
    v_mfma_f32_16x16x32_bf16 v[192:195], a[88:91], a[40:43], v[192:195]
    ds_read_b64_tr_b16 a[176:177], v5 offset:8192
    v_add_f32 v237, v237, v200
    v_add_f32 v237, v237, v201
    v_mfma_f32_16x16x32_bf16 v[192:195], a[92:95], a[44:47], v[192:195]
    v_exp_f32 v202, v202
    v_mfma_f32_16x16x32_bf16 v[196:199], a[96:99], a[32:35], v[224:227]
    v_exp_f32 v203, v203
    v_mfma_f32_16x16x32_bf16 v[196:199], a[100:103], a[36:39], v[196:199]
    ds_read_b64_tr_b16 a[178:179], v5 offset:12288
    v_cvt_pk_bf16_f32 v212, v200, v201
    v_mfma_f32_16x16x32_bf16 v[196:199], a[104:107], a[40:43], v[196:199]
    ds_read_b64_tr_b16 a[180:181], v6 offset:8192
    v_add_f32 v237, v237, v202
    v_mfma_f32_16x16x32_bf16 v[196:199], a[108:111], a[44:47], v[196:199]
    v_exp_f32 v204, v204
    v_mfma_f32_16x16x32_bf16 v[32:35], a[144:147], v[208:211], v[32:35]
    ds_read_b64_tr_b16 a[182:183], v6 offset:12288
    v_add_f32 v237, v237, v203
    v_cvt_pk_bf16_f32 v213, v202, v203
    v_mfma_f32_16x16x32_bf16 v[36:39], a[148:151], v[208:211], v[36:39]
    v_exp_f32 v205, v205
    v_mfma_f32_16x16x32_bf16 v[40:43], a[152:155], v[208:211], v[40:43]
    v_exp_f32 v206, v206
    v_mfma_f32_16x16x32_bf16 v[44:47], a[156:159], v[208:211], v[44:47]
    v_add_f32 v237, v237, v204
    v_add_f32 v237, v237, v205
    v_mfma_f32_16x16x32_bf16 v[48:51], a[160:163], v[208:211], v[48:51]
    v_exp_f32 v207, v207
    v_mfma_f32_16x16x32_bf16 v[52:55], a[164:167], v[208:211], v[52:55]
    ds_read_b64_tr_b16 a[184:185], v7 offset:8192
    v_cvt_pk_bf16_f32 v214, v204, v205
    v_mfma_f32_16x16x32_bf16 v[56:59], a[168:171], v[208:211], v[56:59]
    ds_read_b64_tr_b16 a[186:187], v7 offset:12288
    v_add_f32 v237, v237, v206
    v_mfma_f32_16x16x32_bf16 v[60:63], a[172:175], v[208:211], v[60:63]
    v_add_f32 v237, v237, v207
    v_cvt_pk_bf16_f32 v215, v206, v207
    v_mfma_f32_16x16x32_bf16 v[200:203], a[80:83], a[48:51], v[228:231]
    v_exp_f32 v192, v192
    v_mfma_f32_16x16x32_bf16 v[200:203], a[84:87], a[52:55], v[200:203]
    v_exp_f32 v193, v193
    v_mfma_f32_16x16x32_bf16 v[200:203], a[88:91], a[56:59], v[200:203]
    ds_read_b64_tr_b16 a[188:189], v8 offset:8192
    v_add_f32 v238, v238, v192
    v_add_f32 v238, v238, v193
    v_mfma_f32_16x16x32_bf16 v[200:203], a[92:95], a[60:63], v[200:203]
    v_exp_f32 v194, v194
    v_mfma_f32_16x16x32_bf16 v[204:207], a[96:99], a[48:51], v[228:231]
    v_exp_f32 v195, v195
    v_mfma_f32_16x16x32_bf16 v[204:207], a[100:103], a[52:55], v[204:207]
    ds_read_b64_tr_b16 a[190:191], v8 offset:12288
    v_cvt_pk_bf16_f32 v208, v192, v193
    v_mfma_f32_16x16x32_bf16 v[204:207], a[104:107], a[56:59], v[204:207]
    ds_read_b64_tr_b16 a[192:193], v9 offset:8192
    v_add_f32 v238, v238, v194
    v_mfma_f32_16x16x32_bf16 v[204:207], a[108:111], a[60:63], v[204:207]
    v_exp_f32 v196, v196
    v_mfma_f32_16x16x32_bf16 v[64:67], a[144:147], v[212:215], v[64:67]
    ds_read_b64_tr_b16 a[194:195], v9 offset:12288
    v_add_f32 v238, v238, v195
    v_cvt_pk_bf16_f32 v209, v194, v195
    v_mfma_f32_16x16x32_bf16 v[68:71], a[148:151], v[212:215], v[68:71]
    v_exp_f32 v197, v197
    v_mfma_f32_16x16x32_bf16 v[72:75], a[152:155], v[212:215], v[72:75]
    v_exp_f32 v198, v198
    v_mfma_f32_16x16x32_bf16 v[76:79], a[156:159], v[212:215], v[76:79]
    v_add_f32 v238, v238, v196
    v_add_f32 v238, v238, v197
    v_mfma_f32_16x16x32_bf16 v[80:83], a[160:163], v[212:215], v[80:83]
    v_exp_f32 v199, v199
    v_mfma_f32_16x16x32_bf16 v[84:87], a[164:167], v[212:215], v[84:87]
    ds_read_b64_tr_b16 a[196:197], v10 offset:8192
    v_cvt_pk_bf16_f32 v210, v196, v197
    v_mfma_f32_16x16x32_bf16 v[88:91], a[168:171], v[212:215], v[88:91]
    ds_read_b64_tr_b16 a[198:199], v10 offset:12288
    v_add_f32 v238, v238, v198
    v_mfma_f32_16x16x32_bf16 v[92:95], a[172:175], v[212:215], v[92:95]
    v_add_f32 v238, v238, v199
    v_cvt_pk_bf16_f32 v211, v198, v199
    v_mfma_f32_16x16x32_bf16 v[192:195], a[80:83], a[64:67], v[232:235]
    v_exp_f32 v200, v200
    v_mfma_f32_16x16x32_bf16 v[192:195], a[84:87], a[68:71], v[192:195]
    v_exp_f32 v201, v201
    v_mfma_f32_16x16x32_bf16 v[192:195], a[88:91], a[72:75], v[192:195]
    ds_read_b64_tr_b16 a[200:201], v11 offset:8192
    v_add_f32 v239, v239, v200
    v_mfma_f32_16x16x32_bf16 v[192:195], a[92:95], a[76:79], v[192:195]
    v_exp_f32 v202, v202
    v_mfma_f32_16x16x32_bf16 v[196:199], a[96:99], a[64:67], v[232:235]
    ds_read_b64_tr_b16 a[202:203], v11 offset:12288
    v_add_f32 v239, v239, v201
    v_mfma_f32_16x16x32_bf16 v[196:199], a[100:103], a[68:71], v[196:199]
    v_exp_f32 v203, v203
    v_mfma_f32_16x16x32_bf16 v[196:199], a[104:107], a[72:75], v[196:199]
    ds_read_b64_tr_b16 a[204:205], v12 offset:8192
    v_cvt_pk_bf16_f32 v212, v200, v201
    v_mfma_f32_16x16x32_bf16 v[196:199], a[108:111], a[76:79], v[196:199]
    v_exp_f32 v204, v204
    v_mfma_f32_16x16x32_bf16 v[96:99], a[144:147], v[208:211], v[96:99]
    ds_read_b64_tr_b16 a[206:207], v12 offset:12288
    v_add_f32 v239, v239, v202
    v_mfma_f32_16x16x32_bf16 v[100:103], a[148:151], v[208:211], v[100:103]
    v_exp_f32 v205, v205
    v_mfma_f32_16x16x32_bf16 v[104:107], a[152:155], v[208:211], v[104:107]
    v_add_f32 v239, v239, v203
    v_cvt_pk_bf16_f32 v213, v202, v203
    v_mfma_f32_16x16x32_bf16 v[108:111], a[156:159], v[208:211], v[108:111]
    v_exp_f32 v206, v206
    v_mfma_f32_16x16x32_bf16 v[112:115], a[160:163], v[208:211], v[112:115]
    v_add_f32 v239, v239, v204
    v_add_f32 v239, v239, v205
    v_mfma_f32_16x16x32_bf16 v[116:119], a[164:167], v[208:211], v[116:119]
    v_exp_f32 v207, v207
    v_mfma_f32_16x16x32_bf16 v[120:123], a[168:171], v[208:211], v[120:123]
    s_waitcnt vmcnt(16) lgkmcnt(0)
    v_cvt_pk_bf16_f32 v214, v204, v205
    v_add_f32 v239, v239, v206
    v_mfma_f32_16x16x32_bf16 v[124:127], a[172:175], v[208:211], v[124:127]
    s_barrier
    v_add_f32 v239, v239, v207
    v_cvt_pk_bf16_f32 v215, v206, v207
    v_mfma_f32_16x16x32_bf16 v[200:203], a[112:115], a[0:3], v[216:219]
    v_exp_f32 v192, v192
    v_mfma_f32_16x16x32_bf16 v[200:203], a[116:119], a[4:7], v[200:203]
    v_exp_f32 v193, v193
    v_mfma_f32_16x16x32_bf16 v[200:203], a[120:123], a[8:11], v[200:203]
    v_add_f32 v240, v240, v192
    v_add_f32 v240, v240, v193
    v_mfma_f32_16x16x32_bf16 v[200:203], a[124:127], a[12:15], v[200:203]
    v_exp_f32 v194, v194
    v_mfma_f32_16x16x32_bf16 v[204:207], a[128:131], a[0:3], v[216:219]
    v_exp_f32 v195, v195
    v_mfma_f32_16x16x32_bf16 v[204:207], a[132:135], a[4:7], v[204:207]
    ds_read_b128 a[80:83], v1 offset:16384
    v_cvt_pk_bf16_f32 v208, v192, v193
    v_mfma_f32_16x16x32_bf16 v[204:207], a[136:139], a[8:11], v[204:207]
    ds_read_b128 a[84:87], v2 offset:16384
    v_add_f32 v240, v240, v194
    v_mfma_f32_16x16x32_bf16 v[204:207], a[140:143], a[12:15], v[204:207]
    v_exp_f32 v196, v196
    v_mfma_f32_16x16x32_bf16 v[128:131], a[144:147], v[212:215], v[128:131]
    v_add_f32 v240, v240, v195
    v_cvt_pk_bf16_f32 v209, v194, v195
    v_mfma_f32_16x16x32_bf16 v[132:135], a[148:151], v[212:215], v[132:135]
    v_exp_f32 v197, v197
    v_mfma_f32_16x16x32_bf16 v[136:139], a[152:155], v[212:215], v[136:139]
    v_exp_f32 v198, v198
    v_mfma_f32_16x16x32_bf16 v[140:143], a[156:159], v[212:215], v[140:143]
    v_add_f32 v240, v240, v196
    v_add_f32 v240, v240, v197
    v_mfma_f32_16x16x32_bf16 v[144:147], a[160:163], v[212:215], v[144:147]
    v_exp_f32 v199, v199
    v_mfma_f32_16x16x32_bf16 v[148:151], a[164:167], v[212:215], v[148:151]
    ds_read_b128 a[88:91], v3 offset:16384
    v_cvt_pk_bf16_f32 v210, v196, v197
    v_mfma_f32_16x16x32_bf16 v[152:155], a[168:171], v[212:215], v[152:155]
    ds_read_b128 a[92:95], v4 offset:16384
    v_add_f32 v240, v240, v198
    v_mfma_f32_16x16x32_bf16 v[156:159], a[172:175], v[212:215], v[156:159]
    v_add_f32 v240, v240, v199
    v_cvt_pk_bf16_f32 v211, v198, v199
    v_mfma_f32_16x16x32_bf16 v[192:195], a[112:115], a[16:19], v[220:223]
    v_exp_f32 v200, v200
    v_mfma_f32_16x16x32_bf16 v[192:195], a[116:119], a[20:23], v[192:195]
    v_exp_f32 v201, v201
    v_mfma_f32_16x16x32_bf16 v[192:195], a[120:123], a[24:27], v[192:195]
    v_add_f32 v236, v236, v200
    v_add_f32 v236, v236, v201
    v_mfma_f32_16x16x32_bf16 v[192:195], a[124:127], a[28:31], v[192:195]
    v_exp_f32 v202, v202
    v_mfma_f32_16x16x32_bf16 v[196:199], a[128:131], a[16:19], v[220:223]
    v_exp_f32 v203, v203
    v_mfma_f32_16x16x32_bf16 v[196:199], a[132:135], a[20:23], v[196:199]
    ds_read_b128 a[96:99], v1 offset:20480
    v_cvt_pk_bf16_f32 v212, v200, v201
    v_mfma_f32_16x16x32_bf16 v[196:199], a[136:139], a[24:27], v[196:199]
    ds_read_b128 a[100:103], v2 offset:20480
    v_add_f32 v236, v236, v202
    v_mfma_f32_16x16x32_bf16 v[196:199], a[140:143], a[28:31], v[196:199]
    v_exp_f32 v204, v204
    v_mfma_f32_16x16x32_bf16 v[160:163], a[144:147], v[208:211], v[160:163]
    v_add_f32 v236, v236, v203
    v_cvt_pk_bf16_f32 v213, v202, v203
    v_mfma_f32_16x16x32_bf16 v[164:167], a[148:151], v[208:211], v[164:167]
    v_exp_f32 v205, v205
    v_mfma_f32_16x16x32_bf16 v[168:171], a[152:155], v[208:211], v[168:171]
    v_exp_f32 v206, v206
    v_mfma_f32_16x16x32_bf16 v[172:175], a[156:159], v[208:211], v[172:175]
    v_add_f32 v236, v236, v204
    v_add_f32 v236, v236, v205
    v_mfma_f32_16x16x32_bf16 v[176:179], a[160:163], v[208:211], v[176:179]
    v_exp_f32 v207, v207
    v_mfma_f32_16x16x32_bf16 v[180:183], a[164:167], v[208:211], v[180:183]
    ds_read_b128 a[104:107], v3 offset:20480
    v_cvt_pk_bf16_f32 v214, v204, v205
    v_mfma_f32_16x16x32_bf16 v[184:187], a[168:171], v[208:211], v[184:187]
    ds_read_b128 a[108:111], v4 offset:20480
    v_add_f32 v236, v236, v206
    v_mfma_f32_16x16x32_bf16 v[188:191], a[172:175], v[208:211], v[188:191]
    v_add_f32 v236, v236, v207
    v_cvt_pk_bf16_f32 v215, v206, v207
L_mid_a:
    v_mfma_f32_16x16x32_bf16 v[200:203], a[112:115], a[32:35], v[224:227]
    v_exp_f32 v192, v192
    v_mfma_f32_16x16x32_bf16 v[200:203], a[116:119], a[36:39], v[200:203]
    v_exp_f32 v193, v193
    v_mfma_f32_16x16x32_bf16 v[200:203], a[120:123], a[40:43], v[200:203]
    ds_read_b64_tr_b16 a[144:145], v5 offset:16384
    v_add_f32 v237, v237, v192
    v_add_f32 v237, v237, v193
    v_mfma_f32_16x16x32_bf16 v[200:203], a[124:127], a[44:47], v[200:203]
    v_exp_f32 v194, v194
    v_mfma_f32_16x16x32_bf16 v[204:207], a[128:131], a[32:35], v[224:227]
    v_exp_f32 v195, v195
    v_mfma_f32_16x16x32_bf16 v[204:207], a[132:135], a[36:39], v[204:207]
    ds_read_b64_tr_b16 a[146:147], v5 offset:20480
    v_cvt_pk_bf16_f32 v208, v192, v193
    v_mfma_f32_16x16x32_bf16 v[204:207], a[136:139], a[40:43], v[204:207]
    ds_read_b64_tr_b16 a[148:149], v6 offset:16384
    v_add_f32 v237, v237, v194
    v_mfma_f32_16x16x32_bf16 v[204:207], a[140:143], a[44:47], v[204:207]
    v_exp_f32 v196, v196
    v_mfma_f32_16x16x32_bf16 v[32:35], a[176:179], v[212:215], v[32:35]
    ds_read_b64_tr_b16 a[150:151], v6 offset:20480
    v_add_f32 v237, v237, v195
    v_cvt_pk_bf16_f32 v209, v194, v195
    v_mfma_f32_16x16x32_bf16 v[36:39], a[180:183], v[212:215], v[36:39]
    v_exp_f32 v197, v197
    v_mfma_f32_16x16x32_bf16 v[40:43], a[184:187], v[212:215], v[40:43]
    v_exp_f32 v198, v198
    v_mfma_f32_16x16x32_bf16 v[44:47], a[188:191], v[212:215], v[44:47]
    v_add_f32 v237, v237, v196
    v_add_f32 v237, v237, v197
    v_mfma_f32_16x16x32_bf16 v[48:51], a[192:195], v[212:215], v[48:51]
    v_exp_f32 v199, v199
    v_mfma_f32_16x16x32_bf16 v[52:55], a[196:199], v[212:215], v[52:55]
    ds_read_b64_tr_b16 a[152:153], v7 offset:16384
    v_cvt_pk_bf16_f32 v210, v196, v197
    v_mfma_f32_16x16x32_bf16 v[56:59], a[200:203], v[212:215], v[56:59]
    ds_read_b64_tr_b16 a[154:155], v7 offset:20480
    v_add_f32 v237, v237, v198
    v_mfma_f32_16x16x32_bf16 v[60:63], a[204:207], v[212:215], v[60:63]
    v_add_f32 v237, v237, v199
    v_cvt_pk_bf16_f32 v211, v198, v199
    v_mfma_f32_16x16x32_bf16 v[192:195], a[112:115], a[48:51], v[228:231]
    v_exp_f32 v200, v200
    v_mfma_f32_16x16x32_bf16 v[192:195], a[116:119], a[52:55], v[192:195]
    v_exp_f32 v201, v201
    v_mfma_f32_16x16x32_bf16 v[192:195], a[120:123], a[56:59], v[192:195]
    ds_read_b64_tr_b16 a[156:157], v8 offset:16384
    v_add_f32 v238, v238, v200
    v_add_f32 v238, v238, v201
    v_mfma_f32_16x16x32_bf16 v[192:195], a[124:127], a[60:63], v[192:195]
    v_exp_f32 v202, v202
    v_mfma_f32_16x16x32_bf16 v[196:199], a[128:131], a[48:51], v[228:231]
    v_exp_f32 v203, v203
    v_mfma_f32_16x16x32_bf16 v[196:199], a[132:135], a[52:55], v[196:199]
    ds_read_b64_tr_b16 a[158:159], v8 offset:20480
    v_cvt_pk_bf16_f32 v212, v200, v201
    v_mfma_f32_16x16x32_bf16 v[196:199], a[136:139], a[56:59], v[196:199]
    ds_read_b64_tr_b16 a[160:161], v9 offset:16384
    v_add_f32 v238, v238, v202
    v_mfma_f32_16x16x32_bf16 v[196:199], a[140:143], a[60:63], v[196:199]
    v_exp_f32 v204, v204
    v_mfma_f32_16x16x32_bf16 v[64:67], a[176:179], v[208:211], v[64:67]
    ds_read_b64_tr_b16 a[162:163], v9 offset:20480
    v_add_f32 v238, v238, v203
    v_cvt_pk_bf16_f32 v213, v202, v203
    v_mfma_f32_16x16x32_bf16 v[68:71], a[180:183], v[208:211], v[68:71]
    v_exp_f32 v205, v205
    v_mfma_f32_16x16x32_bf16 v[72:75], a[184:187], v[208:211], v[72:75]
    v_exp_f32 v206, v206
    v_mfma_f32_16x16x32_bf16 v[76:79], a[188:191], v[208:211], v[76:79]
    v_add_f32 v238, v238, v204
    v_add_f32 v238, v238, v205
    v_mfma_f32_16x16x32_bf16 v[80:83], a[192:195], v[208:211], v[80:83]
    v_exp_f32 v207, v207
    v_mfma_f32_16x16x32_bf16 v[84:87], a[196:199], v[208:211], v[84:87]
    ds_read_b64_tr_b16 a[164:165], v10 offset:16384
    v_cvt_pk_bf16_f32 v214, v204, v205
    v_mfma_f32_16x16x32_bf16 v[88:91], a[200:203], v[208:211], v[88:91]
    ds_read_b64_tr_b16 a[166:167], v10 offset:20480
    v_add_f32 v238, v238, v206
    v_mfma_f32_16x16x32_bf16 v[92:95], a[204:207], v[208:211], v[92:95]
    v_add_f32 v238, v238, v207
    v_cvt_pk_bf16_f32 v215, v206, v207
    v_mfma_f32_16x16x32_bf16 v[200:203], a[112:115], a[64:67], v[232:235]
    v_exp_f32 v192, v192
    v_mfma_f32_16x16x32_bf16 v[200:203], a[116:119], a[68:71], v[200:203]
    v_exp_f32 v193, v193
    v_mfma_f32_16x16x32_bf16 v[200:203], a[120:123], a[72:75], v[200:203]
    ds_read_b64_tr_b16 a[168:169], v11 offset:16384
    v_add_f32 v239, v239, v192
    v_mfma_f32_16x16x32_bf16 v[200:203], a[124:127], a[76:79], v[200:203]
    v_exp_f32 v194, v194
    v_mfma_f32_16x16x32_bf16 v[204:207], a[128:131], a[64:67], v[232:235]
    ds_read_b64_tr_b16 a[170:171], v11 offset:20480
    v_add_f32 v239, v239, v193
    v_mfma_f32_16x16x32_bf16 v[204:207], a[132:135], a[68:71], v[204:207]
    v_exp_f32 v195, v195
    v_mfma_f32_16x16x32_bf16 v[204:207], a[136:139], a[72:75], v[204:207]
    ds_read_b64_tr_b16 a[172:173], v12 offset:16384
    v_cvt_pk_bf16_f32 v208, v192, v193
    v_mfma_f32_16x16x32_bf16 v[204:207], a[140:143], a[76:79], v[204:207]
    v_exp_f32 v196, v196
    v_mfma_f32_16x16x32_bf16 v[96:99], a[176:179], v[212:215], v[96:99]
    ds_read_b64_tr_b16 a[174:175], v12 offset:20480
    v_add_f32 v239, v239, v194
    v_mfma_f32_16x16x32_bf16 v[100:103], a[180:183], v[212:215], v[100:103]
    v_exp_f32 v197, v197
    v_mfma_f32_16x16x32_bf16 v[104:107], a[184:187], v[212:215], v[104:107]
    v_add_f32 v239, v239, v195
    v_cvt_pk_bf16_f32 v209, v194, v195
    v_mfma_f32_16x16x32_bf16 v[108:111], a[188:191], v[212:215], v[108:111]
    v_exp_f32 v198, v198
    v_mfma_f32_16x16x32_bf16 v[112:115], a[192:195], v[212:215], v[112:115]
    v_add_f32 v239, v239, v196
    v_add_f32 v239, v239, v197
    v_mfma_f32_16x16x32_bf16 v[116:119], a[196:199], v[212:215], v[116:119]
    v_exp_f32 v199, v199
    v_mfma_f32_16x16x32_bf16 v[120:123], a[200:203], v[212:215], v[120:123]
    v_cvt_pk_bf16_f32 v210, v196, v197
    v_add_f32 v239, v239, v198
    v_mfma_f32_16x16x32_bf16 v[124:127], a[204:207], v[212:215], v[124:127]
    s_waitcnt lgkmcnt(0)
    v_add_f32 v239, v239, v199
    v_cvt_pk_bf16_f32 v211, v198, v199
    v_mfma_f32_16x16x32_bf16 v[192:195], a[80:83], a[0:3], v[216:219]
    v_exp_f32 v200, v200
    v_mfma_f32_16x16x32_bf16 v[192:195], a[84:87], a[4:7], v[192:195]
    v_exp_f32 v201, v201
    v_mfma_f32_16x16x32_bf16 v[192:195], a[88:91], a[8:11], v[192:195]
    v_add_f32 v240, v240, v200
    v_add_f32 v240, v240, v201
    v_mfma_f32_16x16x32_bf16 v[192:195], a[92:95], a[12:15], v[192:195]
    v_exp_f32 v202, v202
    v_mfma_f32_16x16x32_bf16 v[196:199], a[96:99], a[0:3], v[216:219]
    v_exp_f32 v203, v203
    v_mfma_f32_16x16x32_bf16 v[196:199], a[100:103], a[4:7], v[196:199]
    ds_read_b128 a[112:115], v1 offset:24576
    v_cvt_pk_bf16_f32 v212, v200, v201
    v_mfma_f32_16x16x32_bf16 v[196:199], a[104:107], a[8:11], v[196:199]
    ds_read_b128 a[116:119], v2 offset:24576
    v_add_f32 v240, v240, v202
    v_mfma_f32_16x16x32_bf16 v[196:199], a[108:111], a[12:15], v[196:199]
    v_exp_f32 v204, v204
    v_mfma_f32_16x16x32_bf16 v[128:131], a[176:179], v[208:211], v[128:131]
    v_add_f32 v240, v240, v203
    v_cvt_pk_bf16_f32 v213, v202, v203
    v_mfma_f32_16x16x32_bf16 v[132:135], a[180:183], v[208:211], v[132:135]
    v_exp_f32 v205, v205
    v_mfma_f32_16x16x32_bf16 v[136:139], a[184:187], v[208:211], v[136:139]
    v_exp_f32 v206, v206
    v_mfma_f32_16x16x32_bf16 v[140:143], a[188:191], v[208:211], v[140:143]
    v_add_f32 v240, v240, v204
    v_add_f32 v240, v240, v205
    v_mfma_f32_16x16x32_bf16 v[144:147], a[192:195], v[208:211], v[144:147]
    v_exp_f32 v207, v207
    v_mfma_f32_16x16x32_bf16 v[148:151], a[196:199], v[208:211], v[148:151]
    ds_read_b128 a[120:123], v3 offset:24576
    v_cvt_pk_bf16_f32 v214, v204, v205
    v_mfma_f32_16x16x32_bf16 v[152:155], a[200:203], v[208:211], v[152:155]
    ds_read_b128 a[124:127], v4 offset:24576
    v_add_f32 v240, v240, v206
    v_mfma_f32_16x16x32_bf16 v[156:159], a[204:207], v[208:211], v[156:159]
    v_add_f32 v240, v240, v207
    v_cvt_pk_bf16_f32 v215, v206, v207
    v_mfma_f32_16x16x32_bf16 v[200:203], a[80:83], a[16:19], v[220:223]
    v_exp_f32 v192, v192
    v_mfma_f32_16x16x32_bf16 v[200:203], a[84:87], a[20:23], v[200:203]
    v_exp_f32 v193, v193
    v_mfma_f32_16x16x32_bf16 v[200:203], a[88:91], a[24:27], v[200:203]
    v_add_f32 v236, v236, v192
    v_add_f32 v236, v236, v193
    v_mfma_f32_16x16x32_bf16 v[200:203], a[92:95], a[28:31], v[200:203]
    v_exp_f32 v194, v194
    v_mfma_f32_16x16x32_bf16 v[204:207], a[96:99], a[16:19], v[220:223]
    v_exp_f32 v195, v195
    v_mfma_f32_16x16x32_bf16 v[204:207], a[100:103], a[20:23], v[204:207]
    ds_read_b128 a[128:131], v1 offset:28672
    v_cvt_pk_bf16_f32 v208, v192, v193
    v_mfma_f32_16x16x32_bf16 v[204:207], a[104:107], a[24:27], v[204:207]
    ds_read_b128 a[132:135], v2 offset:28672
    v_add_f32 v236, v236, v194
    v_mfma_f32_16x16x32_bf16 v[204:207], a[108:111], a[28:31], v[204:207]
    v_exp_f32 v196, v196
    v_mfma_f32_16x16x32_bf16 v[160:163], a[176:179], v[212:215], v[160:163]
    v_add_f32 v236, v236, v195
    v_cvt_pk_bf16_f32 v209, v194, v195
    v_mfma_f32_16x16x32_bf16 v[164:167], a[180:183], v[212:215], v[164:167]
    v_exp_f32 v197, v197
    v_mfma_f32_16x16x32_bf16 v[168:171], a[184:187], v[212:215], v[168:171]
    v_exp_f32 v198, v198
    v_mfma_f32_16x16x32_bf16 v[172:175], a[188:191], v[212:215], v[172:175]
    v_add_f32 v236, v236, v196
    v_add_f32 v236, v236, v197
    v_mfma_f32_16x16x32_bf16 v[176:179], a[192:195], v[212:215], v[176:179]
    v_exp_f32 v199, v199
    v_mfma_f32_16x16x32_bf16 v[180:183], a[196:199], v[212:215], v[180:183]
    ds_read_b128 a[136:139], v3 offset:28672
    v_cvt_pk_bf16_f32 v210, v196, v197
    v_mfma_f32_16x16x32_bf16 v[184:187], a[200:203], v[212:215], v[184:187]
    ds_read_b128 a[140:143], v4 offset:28672
    v_add_f32 v236, v236, v198
    v_mfma_f32_16x16x32_bf16 v[188:191], a[204:207], v[212:215], v[188:191]
    v_add_f32 v236, v236, v199
    v_cvt_pk_bf16_f32 v211, v198, v199
    v_mfma_f32_16x16x32_bf16 v[192:195], a[80:83], a[32:35], v[224:227]
    v_exp_f32 v200, v200
    v_mfma_f32_16x16x32_bf16 v[192:195], a[84:87], a[36:39], v[192:195]
    v_exp_f32 v201, v201
    v_mfma_f32_16x16x32_bf16 v[192:195], a[88:91], a[40:43], v[192:195]
    ds_read_b64_tr_b16 a[176:177], v5 offset:24576
    v_add_f32 v237, v237, v200
    v_add_f32 v237, v237, v201
    v_mfma_f32_16x16x32_bf16 v[192:195], a[92:95], a[44:47], v[192:195]
    v_exp_f32 v202, v202
    v_mfma_f32_16x16x32_bf16 v[196:199], a[96:99], a[32:35], v[224:227]
    v_exp_f32 v203, v203
    v_mfma_f32_16x16x32_bf16 v[196:199], a[100:103], a[36:39], v[196:199]
    ds_read_b64_tr_b16 a[178:179], v5 offset:28672
    v_cvt_pk_bf16_f32 v212, v200, v201
    v_mfma_f32_16x16x32_bf16 v[196:199], a[104:107], a[40:43], v[196:199]
    ds_read_b64_tr_b16 a[180:181], v6 offset:24576
    v_add_f32 v237, v237, v202
    v_mfma_f32_16x16x32_bf16 v[196:199], a[108:111], a[44:47], v[196:199]
    v_exp_f32 v204, v204
    v_mfma_f32_16x16x32_bf16 v[32:35], a[144:147], v[208:211], v[32:35]
    ds_read_b64_tr_b16 a[182:183], v6 offset:28672
    v_add_f32 v237, v237, v203
    v_cvt_pk_bf16_f32 v213, v202, v203
    v_mfma_f32_16x16x32_bf16 v[36:39], a[148:151], v[208:211], v[36:39]
    v_exp_f32 v205, v205
    v_mfma_f32_16x16x32_bf16 v[40:43], a[152:155], v[208:211], v[40:43]
    v_exp_f32 v206, v206
    v_mfma_f32_16x16x32_bf16 v[44:47], a[156:159], v[208:211], v[44:47]
    v_add_f32 v237, v237, v204
    v_add_f32 v237, v237, v205
    v_mfma_f32_16x16x32_bf16 v[48:51], a[160:163], v[208:211], v[48:51]
    v_exp_f32 v207, v207
    v_mfma_f32_16x16x32_bf16 v[52:55], a[164:167], v[208:211], v[52:55]
    ds_read_b64_tr_b16 a[184:185], v7 offset:24576
    v_cvt_pk_bf16_f32 v214, v204, v205
    v_mfma_f32_16x16x32_bf16 v[56:59], a[168:171], v[208:211], v[56:59]
    ds_read_b64_tr_b16 a[186:187], v7 offset:28672
    v_add_f32 v237, v237, v206
    v_mfma_f32_16x16x32_bf16 v[60:63], a[172:175], v[208:211], v[60:63]
    v_add_f32 v237, v237, v207
    v_cvt_pk_bf16_f32 v215, v206, v207
    v_mfma_f32_16x16x32_bf16 v[200:203], a[80:83], a[48:51], v[228:231]
    v_exp_f32 v192, v192
    v_mfma_f32_16x16x32_bf16 v[200:203], a[84:87], a[52:55], v[200:203]
    v_exp_f32 v193, v193
    v_mfma_f32_16x16x32_bf16 v[200:203], a[88:91], a[56:59], v[200:203]
    ds_read_b64_tr_b16 a[188:189], v8 offset:24576
    v_add_f32 v238, v238, v192
    v_add_f32 v238, v238, v193
    v_mfma_f32_16x16x32_bf16 v[200:203], a[92:95], a[60:63], v[200:203]
    v_exp_f32 v194, v194
    v_mfma_f32_16x16x32_bf16 v[204:207], a[96:99], a[48:51], v[228:231]
    v_exp_f32 v195, v195
    v_mfma_f32_16x16x32_bf16 v[204:207], a[100:103], a[52:55], v[204:207]
    ds_read_b64_tr_b16 a[190:191], v8 offset:28672
    v_cvt_pk_bf16_f32 v208, v192, v193
    v_mfma_f32_16x16x32_bf16 v[204:207], a[104:107], a[56:59], v[204:207]
    ds_read_b64_tr_b16 a[192:193], v9 offset:24576
    v_add_f32 v238, v238, v194
    v_mfma_f32_16x16x32_bf16 v[204:207], a[108:111], a[60:63], v[204:207]
    v_exp_f32 v196, v196
    v_mfma_f32_16x16x32_bf16 v[64:67], a[144:147], v[212:215], v[64:67]
    ds_read_b64_tr_b16 a[194:195], v9 offset:28672
    v_add_f32 v238, v238, v195
    v_cvt_pk_bf16_f32 v209, v194, v195
    v_mfma_f32_16x16x32_bf16 v[68:71], a[148:151], v[212:215], v[68:71]
    v_exp_f32 v197, v197
    v_mfma_f32_16x16x32_bf16 v[72:75], a[152:155], v[212:215], v[72:75]
    v_exp_f32 v198, v198
    v_mfma_f32_16x16x32_bf16 v[76:79], a[156:159], v[212:215], v[76:79]
    v_add_f32 v238, v238, v196
    v_add_f32 v238, v238, v197
    v_mfma_f32_16x16x32_bf16 v[80:83], a[160:163], v[212:215], v[80:83]
    v_exp_f32 v199, v199
    v_mfma_f32_16x16x32_bf16 v[84:87], a[164:167], v[212:215], v[84:87]
    ds_read_b64_tr_b16 a[196:197], v10 offset:24576
    v_cvt_pk_bf16_f32 v210, v196, v197
    v_mfma_f32_16x16x32_bf16 v[88:91], a[168:171], v[212:215], v[88:91]
    ds_read_b64_tr_b16 a[198:199], v10 offset:28672
    v_add_f32 v238, v238, v198
    v_mfma_f32_16x16x32_bf16 v[92:95], a[172:175], v[212:215], v[92:95]
    v_add_f32 v238, v238, v199
    v_cvt_pk_bf16_f32 v211, v198, v199
    v_mfma_f32_16x16x32_bf16 v[192:195], a[80:83], a[64:67], v[232:235]
    v_exp_f32 v200, v200
    v_mfma_f32_16x16x32_bf16 v[192:195], a[84:87], a[68:71], v[192:195]
    v_exp_f32 v201, v201
    v_mfma_f32_16x16x32_bf16 v[192:195], a[88:91], a[72:75], v[192:195]
    ds_read_b64_tr_b16 a[200:201], v11 offset:24576
    v_add_f32 v239, v239, v200
    v_mfma_f32_16x16x32_bf16 v[192:195], a[92:95], a[76:79], v[192:195]
    v_exp_f32 v202, v202
    v_mfma_f32_16x16x32_bf16 v[196:199], a[96:99], a[64:67], v[232:235]
    ds_read_b64_tr_b16 a[202:203], v11 offset:28672
    v_add_f32 v239, v239, v201
    v_mfma_f32_16x16x32_bf16 v[196:199], a[100:103], a[68:71], v[196:199]
    v_exp_f32 v203, v203
    v_mfma_f32_16x16x32_bf16 v[196:199], a[104:107], a[72:75], v[196:199]
    ds_read_b64_tr_b16 a[204:205], v12 offset:24576
    v_cvt_pk_bf16_f32 v212, v200, v201
    v_mfma_f32_16x16x32_bf16 v[196:199], a[108:111], a[76:79], v[196:199]
    v_exp_f32 v204, v204
    v_mfma_f32_16x16x32_bf16 v[96:99], a[144:147], v[208:211], v[96:99]
    ds_read_b64_tr_b16 a[206:207], v12 offset:28672
    v_add_f32 v239, v239, v202
    v_mfma_f32_16x16x32_bf16 v[100:103], a[148:151], v[208:211], v[100:103]
    v_exp_f32 v205, v205
    v_mfma_f32_16x16x32_bf16 v[104:107], a[152:155], v[208:211], v[104:107]
    v_add_f32 v239, v239, v203
    v_cvt_pk_bf16_f32 v213, v202, v203
    v_mfma_f32_16x16x32_bf16 v[108:111], a[156:159], v[208:211], v[108:111]
    v_exp_f32 v206, v206
    v_mfma_f32_16x16x32_bf16 v[112:115], a[160:163], v[208:211], v[112:115]
    v_add_f32 v239, v239, v204
    v_add_f32 v239, v239, v205
    v_mfma_f32_16x16x32_bf16 v[116:119], a[164:167], v[208:211], v[116:119]
    v_exp_f32 v207, v207
    v_mfma_f32_16x16x32_bf16 v[120:123], a[168:171], v[208:211], v[120:123]
    s_waitcnt vmcnt(8) lgkmcnt(0)
    v_cvt_pk_bf16_f32 v214, v204, v205
    v_add_f32 v239, v239, v206
    v_mfma_f32_16x16x32_bf16 v[124:127], a[172:175], v[208:211], v[124:127]
    s_barrier
    v_add_f32 v239, v239, v207
    v_cvt_pk_bf16_f32 v215, v206, v207
    v_mfma_f32_16x16x32_bf16 v[200:203], a[112:115], a[0:3], v[216:219]
    v_exp_f32 v192, v192
    v_mfma_f32_16x16x32_bf16 v[200:203], a[116:119], a[4:7], v[200:203]
    v_exp_f32 v193, v193
    v_mfma_f32_16x16x32_bf16 v[200:203], a[120:123], a[8:11], v[200:203]
    v_add_f32 v240, v240, v192
    v_add_f32 v240, v240, v193
    v_mfma_f32_16x16x32_bf16 v[200:203], a[124:127], a[12:15], v[200:203]
    v_exp_f32 v194, v194
    v_mfma_f32_16x16x32_bf16 v[204:207], a[128:131], a[0:3], v[216:219]
    v_exp_f32 v195, v195
    v_mfma_f32_16x16x32_bf16 v[204:207], a[132:135], a[4:7], v[204:207]
    ds_read_b128 a[80:83], v1 offset:32768
    v_cvt_pk_bf16_f32 v208, v192, v193
    v_mfma_f32_16x16x32_bf16 v[204:207], a[136:139], a[8:11], v[204:207]
    ds_read_b128 a[84:87], v2 offset:32768
    v_add_f32 v240, v240, v194
    v_mfma_f32_16x16x32_bf16 v[204:207], a[140:143], a[12:15], v[204:207]
    v_exp_f32 v196, v196
    v_mfma_f32_16x16x32_bf16 v[128:131], a[144:147], v[212:215], v[128:131]
    v_add_f32 v240, v240, v195
    v_cvt_pk_bf16_f32 v209, v194, v195
    v_mfma_f32_16x16x32_bf16 v[132:135], a[148:151], v[212:215], v[132:135]
    v_exp_f32 v197, v197
    v_mfma_f32_16x16x32_bf16 v[136:139], a[152:155], v[212:215], v[136:139]
    v_exp_f32 v198, v198
    v_mfma_f32_16x16x32_bf16 v[140:143], a[156:159], v[212:215], v[140:143]
    v_add_f32 v240, v240, v196
    v_add_f32 v240, v240, v197
    v_mfma_f32_16x16x32_bf16 v[144:147], a[160:163], v[212:215], v[144:147]
    v_exp_f32 v199, v199
    v_mfma_f32_16x16x32_bf16 v[148:151], a[164:167], v[212:215], v[148:151]
    ds_read_b128 a[88:91], v3 offset:32768
    v_cvt_pk_bf16_f32 v210, v196, v197
    v_mfma_f32_16x16x32_bf16 v[152:155], a[168:171], v[212:215], v[152:155]
    ds_read_b128 a[92:95], v4 offset:32768
    v_add_f32 v240, v240, v198
    v_mfma_f32_16x16x32_bf16 v[156:159], a[172:175], v[212:215], v[156:159]
    v_add_f32 v240, v240, v199
    v_cvt_pk_bf16_f32 v211, v198, v199
    v_mfma_f32_16x16x32_bf16 v[192:195], a[112:115], a[16:19], v[220:223]
    v_exp_f32 v200, v200
    v_mfma_f32_16x16x32_bf16 v[192:195], a[116:119], a[20:23], v[192:195]
    v_exp_f32 v201, v201
    v_mfma_f32_16x16x32_bf16 v[192:195], a[120:123], a[24:27], v[192:195]
    v_add_f32 v236, v236, v200
    v_add_f32 v236, v236, v201
    v_mfma_f32_16x16x32_bf16 v[192:195], a[124:127], a[28:31], v[192:195]
    v_exp_f32 v202, v202
    v_mfma_f32_16x16x32_bf16 v[196:199], a[128:131], a[16:19], v[220:223]
    v_exp_f32 v203, v203
    v_mfma_f32_16x16x32_bf16 v[196:199], a[132:135], a[20:23], v[196:199]
    ds_read_b128 a[96:99], v1 offset:36864
    v_cvt_pk_bf16_f32 v212, v200, v201
    v_mfma_f32_16x16x32_bf16 v[196:199], a[136:139], a[24:27], v[196:199]
    ds_read_b128 a[100:103], v2 offset:36864
    v_add_f32 v236, v236, v202
    v_mfma_f32_16x16x32_bf16 v[196:199], a[140:143], a[28:31], v[196:199]
    v_exp_f32 v204, v204
    v_mfma_f32_16x16x32_bf16 v[160:163], a[144:147], v[208:211], v[160:163]
    v_add_f32 v236, v236, v203
    v_cvt_pk_bf16_f32 v213, v202, v203
    v_mfma_f32_16x16x32_bf16 v[164:167], a[148:151], v[208:211], v[164:167]
    v_exp_f32 v205, v205
    v_mfma_f32_16x16x32_bf16 v[168:171], a[152:155], v[208:211], v[168:171]
    v_exp_f32 v206, v206
    v_mfma_f32_16x16x32_bf16 v[172:175], a[156:159], v[208:211], v[172:175]
    v_add_f32 v236, v236, v204
    v_add_f32 v236, v236, v205
    v_mfma_f32_16x16x32_bf16 v[176:179], a[160:163], v[208:211], v[176:179]
    v_exp_f32 v207, v207
    v_mfma_f32_16x16x32_bf16 v[180:183], a[164:167], v[208:211], v[180:183]
    ds_read_b128 a[104:107], v3 offset:36864
    v_cvt_pk_bf16_f32 v214, v204, v205
    v_mfma_f32_16x16x32_bf16 v[184:187], a[168:171], v[208:211], v[184:187]
    ds_read_b128 a[108:111], v4 offset:36864
    v_add_f32 v236, v236, v206
    v_mfma_f32_16x16x32_bf16 v[188:191], a[172:175], v[208:211], v[188:191]
    v_add_f32 v236, v236, v207
    v_cvt_pk_bf16_f32 v215, v206, v207
    v_mfma_f32_16x16x32_bf16 v[200:203], a[112:115], a[32:35], v[224:227]
    v_exp_f32 v192, v192
    v_mfma_f32_16x16x32_bf16 v[200:203], a[116:119], a[36:39], v[200:203]
    v_exp_f32 v193, v193
    v_mfma_f32_16x16x32_bf16 v[200:203], a[120:123], a[40:43], v[200:203]
    ds_read_b64_tr_b16 a[144:145], v5 offset:32768
    v_add_f32 v237, v237, v192
    v_add_f32 v237, v237, v193
    v_mfma_f32_16x16x32_bf16 v[200:203], a[124:127], a[44:47], v[200:203]
    v_exp_f32 v194, v194
    v_mfma_f32_16x16x32_bf16 v[204:207], a[128:131], a[32:35], v[224:227]
    v_exp_f32 v195, v195
    v_mfma_f32_16x16x32_bf16 v[204:207], a[132:135], a[36:39], v[204:207]
    ds_read_b64_tr_b16 a[146:147], v5 offset:36864
    v_cvt_pk_bf16_f32 v208, v192, v193
    v_mfma_f32_16x16x32_bf16 v[204:207], a[136:139], a[40:43], v[204:207]
    ds_read_b64_tr_b16 a[148:149], v6 offset:32768
    v_add_f32 v237, v237, v194
    v_mfma_f32_16x16x32_bf16 v[204:207], a[140:143], a[44:47], v[204:207]
    v_exp_f32 v196, v196
    v_mfma_f32_16x16x32_bf16 v[32:35], a[176:179], v[212:215], v[32:35]
    ds_read_b64_tr_b16 a[150:151], v6 offset:36864
    v_add_f32 v237, v237, v195
    v_cvt_pk_bf16_f32 v209, v194, v195
    v_mfma_f32_16x16x32_bf16 v[36:39], a[180:183], v[212:215], v[36:39]
    v_exp_f32 v197, v197
    v_mfma_f32_16x16x32_bf16 v[40:43], a[184:187], v[212:215], v[40:43]
    v_exp_f32 v198, v198
    v_mfma_f32_16x16x32_bf16 v[44:47], a[188:191], v[212:215], v[44:47]
    v_add_f32 v237, v237, v196
    v_add_f32 v237, v237, v197
    v_mfma_f32_16x16x32_bf16 v[48:51], a[192:195], v[212:215], v[48:51]
    v_exp_f32 v199, v199
    v_mfma_f32_16x16x32_bf16 v[52:55], a[196:199], v[212:215], v[52:55]
    ds_read_b64_tr_b16 a[152:153], v7 offset:32768
    v_cvt_pk_bf16_f32 v210, v196, v197
    v_mfma_f32_16x16x32_bf16 v[56:59], a[200:203], v[212:215], v[56:59]
    ds_read_b64_tr_b16 a[154:155], v7 offset:36864
    v_add_f32 v237, v237, v198
    v_mfma_f32_16x16x32_bf16 v[60:63], a[204:207], v[212:215], v[60:63]
    v_add_f32 v237, v237, v199
    v_cvt_pk_bf16_f32 v211, v198, v199
    v_mfma_f32_16x16x32_bf16 v[192:195], a[112:115], a[48:51], v[228:231]
    v_exp_f32 v200, v200
    v_mfma_f32_16x16x32_bf16 v[192:195], a[116:119], a[52:55], v[192:195]
    v_exp_f32 v201, v201
    v_mfma_f32_16x16x32_bf16 v[192:195], a[120:123], a[56:59], v[192:195]
    ds_read_b64_tr_b16 a[156:157], v8 offset:32768
    v_add_f32 v238, v238, v200
    v_add_f32 v238, v238, v201
    v_mfma_f32_16x16x32_bf16 v[192:195], a[124:127], a[60:63], v[192:195]
    v_exp_f32 v202, v202
    v_mfma_f32_16x16x32_bf16 v[196:199], a[128:131], a[48:51], v[228:231]
    v_exp_f32 v203, v203
    v_mfma_f32_16x16x32_bf16 v[196:199], a[132:135], a[52:55], v[196:199]
    ds_read_b64_tr_b16 a[158:159], v8 offset:36864
    v_cvt_pk_bf16_f32 v212, v200, v201
    v_mfma_f32_16x16x32_bf16 v[196:199], a[136:139], a[56:59], v[196:199]
    ds_read_b64_tr_b16 a[160:161], v9 offset:32768
    v_add_f32 v238, v238, v202
    v_mfma_f32_16x16x32_bf16 v[196:199], a[140:143], a[60:63], v[196:199]
    v_exp_f32 v204, v204
    v_mfma_f32_16x16x32_bf16 v[64:67], a[176:179], v[208:211], v[64:67]
    ds_read_b64_tr_b16 a[162:163], v9 offset:36864
    v_add_f32 v238, v238, v203
    v_cvt_pk_bf16_f32 v213, v202, v203
    v_mfma_f32_16x16x32_bf16 v[68:71], a[180:183], v[208:211], v[68:71]
    v_exp_f32 v205, v205
    v_mfma_f32_16x16x32_bf16 v[72:75], a[184:187], v[208:211], v[72:75]
    v_exp_f32 v206, v206
    v_mfma_f32_16x16x32_bf16 v[76:79], a[188:191], v[208:211], v[76:79]
    v_add_f32 v238, v238, v204
    v_add_f32 v238, v238, v205
    v_mfma_f32_16x16x32_bf16 v[80:83], a[192:195], v[208:211], v[80:83]
    v_exp_f32 v207, v207
    v_mfma_f32_16x16x32_bf16 v[84:87], a[196:199], v[208:211], v[84:87]
    ds_read_b64_tr_b16 a[164:165], v10 offset:32768
    v_cvt_pk_bf16_f32 v214, v204, v205
    v_mfma_f32_16x16x32_bf16 v[88:91], a[200:203], v[208:211], v[88:91]
    ds_read_b64_tr_b16 a[166:167], v10 offset:36864
    v_add_f32 v238, v238, v206
    v_mfma_f32_16x16x32_bf16 v[92:95], a[204:207], v[208:211], v[92:95]
    v_add_f32 v238, v238, v207
    v_cvt_pk_bf16_f32 v215, v206, v207
    v_mfma_f32_16x16x32_bf16 v[200:203], a[112:115], a[64:67], v[232:235]
    v_exp_f32 v192, v192
    v_mfma_f32_16x16x32_bf16 v[200:203], a[116:119], a[68:71], v[200:203]
    v_exp_f32 v193, v193
    v_mfma_f32_16x16x32_bf16 v[200:203], a[120:123], a[72:75], v[200:203]
    ds_read_b64_tr_b16 a[168:169], v11 offset:32768
    v_add_f32 v239, v239, v192
    v_mfma_f32_16x16x32_bf16 v[200:203], a[124:127], a[76:79], v[200:203]
    v_exp_f32 v194, v194
    v_mfma_f32_16x16x32_bf16 v[204:207], a[128:131], a[64:67], v[232:235]
    ds_read_b64_tr_b16 a[170:171], v11 offset:36864
    v_add_f32 v239, v239, v193
    v_mfma_f32_16x16x32_bf16 v[204:207], a[132:135], a[68:71], v[204:207]
    v_exp_f32 v195, v195
    v_mfma_f32_16x16x32_bf16 v[204:207], a[136:139], a[72:75], v[204:207]
    ds_read_b64_tr_b16 a[172:173], v12 offset:32768
    v_cvt_pk_bf16_f32 v208, v192, v193
    v_mfma_f32_16x16x32_bf16 v[204:207], a[140:143], a[76:79], v[204:207]
    v_exp_f32 v196, v196
    v_mfma_f32_16x16x32_bf16 v[96:99], a[176:179], v[212:215], v[96:99]
    ds_read_b64_tr_b16 a[174:175], v12 offset:36864
    v_add_f32 v239, v239, v194
    v_mfma_f32_16x16x32_bf16 v[100:103], a[180:183], v[212:215], v[100:103]
    v_exp_f32 v197, v197
    v_mfma_f32_16x16x32_bf16 v[104:107], a[184:187], v[212:215], v[104:107]
    v_add_f32 v239, v239, v195
    v_cvt_pk_bf16_f32 v209, v194, v195
    v_mfma_f32_16x16x32_bf16 v[108:111], a[188:191], v[212:215], v[108:111]
    v_exp_f32 v198, v198
    v_mfma_f32_16x16x32_bf16 v[112:115], a[192:195], v[212:215], v[112:115]
    v_add_f32 v239, v239, v196
    v_add_f32 v239, v239, v197
    v_mfma_f32_16x16x32_bf16 v[116:119], a[196:199], v[212:215], v[116:119]
    v_exp_f32 v199, v199
    v_mfma_f32_16x16x32_bf16 v[120:123], a[200:203], v[212:215], v[120:123]
    v_cvt_pk_bf16_f32 v210, v196, v197
    v_add_f32 v239, v239, v198
    v_mfma_f32_16x16x32_bf16 v[124:127], a[204:207], v[212:215], v[124:127]
    s_waitcnt lgkmcnt(0)
    v_add_f32 v239, v239, v199
    v_cvt_pk_bf16_f32 v211, v198, v199
    v_mfma_f32_16x16x32_bf16 v[192:195], a[80:83], a[0:3], v[216:219]
    v_exp_f32 v200, v200
    v_mfma_f32_16x16x32_bf16 v[192:195], a[84:87], a[4:7], v[192:195]
    v_exp_f32 v201, v201
    v_mfma_f32_16x16x32_bf16 v[192:195], a[88:91], a[8:11], v[192:195]
    v_add_f32 v240, v240, v200
    v_add_f32 v240, v240, v201
    v_mfma_f32_16x16x32_bf16 v[192:195], a[92:95], a[12:15], v[192:195]
    v_exp_f32 v202, v202
    v_mfma_f32_16x16x32_bf16 v[196:199], a[96:99], a[0:3], v[216:219]
    v_exp_f32 v203, v203
    v_mfma_f32_16x16x32_bf16 v[196:199], a[100:103], a[4:7], v[196:199]
    ds_read_b128 a[112:115], v1 offset:40960
    v_cvt_pk_bf16_f32 v212, v200, v201
    v_mfma_f32_16x16x32_bf16 v[196:199], a[104:107], a[8:11], v[196:199]
    ds_read_b128 a[116:119], v2 offset:40960
    v_add_f32 v240, v240, v202
    v_mfma_f32_16x16x32_bf16 v[196:199], a[108:111], a[12:15], v[196:199]
    v_exp_f32 v204, v204
    v_mfma_f32_16x16x32_bf16 v[128:131], a[176:179], v[208:211], v[128:131]
    v_add_f32 v240, v240, v203
    v_cvt_pk_bf16_f32 v213, v202, v203
    v_mfma_f32_16x16x32_bf16 v[132:135], a[180:183], v[208:211], v[132:135]
    v_exp_f32 v205, v205
    v_mfma_f32_16x16x32_bf16 v[136:139], a[184:187], v[208:211], v[136:139]
    v_exp_f32 v206, v206
    v_mfma_f32_16x16x32_bf16 v[140:143], a[188:191], v[208:211], v[140:143]
    v_add_f32 v240, v240, v204
    v_add_f32 v240, v240, v205
    v_mfma_f32_16x16x32_bf16 v[144:147], a[192:195], v[208:211], v[144:147]
    v_exp_f32 v207, v207
    v_mfma_f32_16x16x32_bf16 v[148:151], a[196:199], v[208:211], v[148:151]
    ds_read_b128 a[120:123], v3 offset:40960
    v_cvt_pk_bf16_f32 v214, v204, v205
    v_mfma_f32_16x16x32_bf16 v[152:155], a[200:203], v[208:211], v[152:155]
    ds_read_b128 a[124:127], v4 offset:40960
    v_add_f32 v240, v240, v206
    v_mfma_f32_16x16x32_bf16 v[156:159], a[204:207], v[208:211], v[156:159]
    v_add_f32 v240, v240, v207
    v_cvt_pk_bf16_f32 v215, v206, v207
    v_mfma_f32_16x16x32_bf16 v[200:203], a[80:83], a[16:19], v[220:223]
    v_exp_f32 v192, v192
    v_mfma_f32_16x16x32_bf16 v[200:203], a[84:87], a[20:23], v[200:203]
    v_exp_f32 v193, v193
    v_mfma_f32_16x16x32_bf16 v[200:203], a[88:91], a[24:27], v[200:203]
    v_add_f32 v236, v236, v192
    v_add_f32 v236, v236, v193
    v_mfma_f32_16x16x32_bf16 v[200:203], a[92:95], a[28:31], v[200:203]
    v_exp_f32 v194, v194
    v_mfma_f32_16x16x32_bf16 v[204:207], a[96:99], a[16:19], v[220:223]
    v_exp_f32 v195, v195
    v_mfma_f32_16x16x32_bf16 v[204:207], a[100:103], a[20:23], v[204:207]
    ds_read_b128 a[128:131], v1 offset:45056
    v_cvt_pk_bf16_f32 v208, v192, v193
    v_mfma_f32_16x16x32_bf16 v[204:207], a[104:107], a[24:27], v[204:207]
    ds_read_b128 a[132:135], v2 offset:45056
    v_add_f32 v236, v236, v194
    v_mfma_f32_16x16x32_bf16 v[204:207], a[108:111], a[28:31], v[204:207]
    v_exp_f32 v196, v196
    v_mfma_f32_16x16x32_bf16 v[160:163], a[176:179], v[212:215], v[160:163]
    v_add_f32 v236, v236, v195
    v_cvt_pk_bf16_f32 v209, v194, v195
    v_mfma_f32_16x16x32_bf16 v[164:167], a[180:183], v[212:215], v[164:167]
    v_exp_f32 v197, v197
    v_mfma_f32_16x16x32_bf16 v[168:171], a[184:187], v[212:215], v[168:171]
    v_exp_f32 v198, v198
    v_mfma_f32_16x16x32_bf16 v[172:175], a[188:191], v[212:215], v[172:175]
    v_add_f32 v236, v236, v196
    v_add_f32 v236, v236, v197
    v_mfma_f32_16x16x32_bf16 v[176:179], a[192:195], v[212:215], v[176:179]
    v_exp_f32 v199, v199
    v_mfma_f32_16x16x32_bf16 v[180:183], a[196:199], v[212:215], v[180:183]
    ds_read_b128 a[136:139], v3 offset:45056
    v_cvt_pk_bf16_f32 v210, v196, v197
    v_mfma_f32_16x16x32_bf16 v[184:187], a[200:203], v[212:215], v[184:187]
    ds_read_b128 a[140:143], v4 offset:45056
    v_add_f32 v236, v236, v198
    v_mfma_f32_16x16x32_bf16 v[188:191], a[204:207], v[212:215], v[188:191]
    v_add_f32 v236, v236, v199
    v_cvt_pk_bf16_f32 v211, v198, v199
    v_mfma_f32_16x16x32_bf16 v[192:195], a[80:83], a[32:35], v[224:227]
    v_exp_f32 v200, v200
    v_mfma_f32_16x16x32_bf16 v[192:195], a[84:87], a[36:39], v[192:195]
    v_exp_f32 v201, v201
    v_mfma_f32_16x16x32_bf16 v[192:195], a[88:91], a[40:43], v[192:195]
    ds_read_b64_tr_b16 a[176:177], v5 offset:40960
    v_add_f32 v237, v237, v200
    v_add_f32 v237, v237, v201
    v_mfma_f32_16x16x32_bf16 v[192:195], a[92:95], a[44:47], v[192:195]
    v_exp_f32 v202, v202
    v_mfma_f32_16x16x32_bf16 v[196:199], a[96:99], a[32:35], v[224:227]
    v_exp_f32 v203, v203
    v_mfma_f32_16x16x32_bf16 v[196:199], a[100:103], a[36:39], v[196:199]
    ds_read_b64_tr_b16 a[178:179], v5 offset:45056
    v_cvt_pk_bf16_f32 v212, v200, v201
    v_mfma_f32_16x16x32_bf16 v[196:199], a[104:107], a[40:43], v[196:199]
    ds_read_b64_tr_b16 a[180:181], v6 offset:40960
    v_add_f32 v237, v237, v202
    v_mfma_f32_16x16x32_bf16 v[196:199], a[108:111], a[44:47], v[196:199]
    v_exp_f32 v204, v204
    v_mfma_f32_16x16x32_bf16 v[32:35], a[144:147], v[208:211], v[32:35]
    ds_read_b64_tr_b16 a[182:183], v6 offset:45056
    v_add_f32 v237, v237, v203
    v_cvt_pk_bf16_f32 v213, v202, v203
    v_mfma_f32_16x16x32_bf16 v[36:39], a[148:151], v[208:211], v[36:39]
    v_exp_f32 v205, v205
    v_mfma_f32_16x16x32_bf16 v[40:43], a[152:155], v[208:211], v[40:43]
    v_exp_f32 v206, v206
    v_mfma_f32_16x16x32_bf16 v[44:47], a[156:159], v[208:211], v[44:47]
    v_add_f32 v237, v237, v204
    v_add_f32 v237, v237, v205
    v_mfma_f32_16x16x32_bf16 v[48:51], a[160:163], v[208:211], v[48:51]
    v_exp_f32 v207, v207
    v_mfma_f32_16x16x32_bf16 v[52:55], a[164:167], v[208:211], v[52:55]
    ds_read_b64_tr_b16 a[184:185], v7 offset:40960
    v_cvt_pk_bf16_f32 v214, v204, v205
    v_mfma_f32_16x16x32_bf16 v[56:59], a[168:171], v[208:211], v[56:59]
    ds_read_b64_tr_b16 a[186:187], v7 offset:45056
    v_add_f32 v237, v237, v206
    v_mfma_f32_16x16x32_bf16 v[60:63], a[172:175], v[208:211], v[60:63]
    v_add_f32 v237, v237, v207
    v_cvt_pk_bf16_f32 v215, v206, v207
    v_mfma_f32_16x16x32_bf16 v[200:203], a[80:83], a[48:51], v[228:231]
    v_exp_f32 v192, v192
    v_mfma_f32_16x16x32_bf16 v[200:203], a[84:87], a[52:55], v[200:203]
    v_exp_f32 v193, v193
    v_mfma_f32_16x16x32_bf16 v[200:203], a[88:91], a[56:59], v[200:203]
    ds_read_b64_tr_b16 a[188:189], v8 offset:40960
    v_add_f32 v238, v238, v192
    v_add_f32 v238, v238, v193
    v_mfma_f32_16x16x32_bf16 v[200:203], a[92:95], a[60:63], v[200:203]
    v_exp_f32 v194, v194
    v_mfma_f32_16x16x32_bf16 v[204:207], a[96:99], a[48:51], v[228:231]
    v_exp_f32 v195, v195
    v_mfma_f32_16x16x32_bf16 v[204:207], a[100:103], a[52:55], v[204:207]
    ds_read_b64_tr_b16 a[190:191], v8 offset:45056
    v_cvt_pk_bf16_f32 v208, v192, v193
    v_mfma_f32_16x16x32_bf16 v[204:207], a[104:107], a[56:59], v[204:207]
    ds_read_b64_tr_b16 a[192:193], v9 offset:40960
    v_add_f32 v238, v238, v194
    v_mfma_f32_16x16x32_bf16 v[204:207], a[108:111], a[60:63], v[204:207]
    v_exp_f32 v196, v196
    v_mfma_f32_16x16x32_bf16 v[64:67], a[144:147], v[212:215], v[64:67]
    ds_read_b64_tr_b16 a[194:195], v9 offset:45056
    v_add_f32 v238, v238, v195
    v_cvt_pk_bf16_f32 v209, v194, v195
    v_mfma_f32_16x16x32_bf16 v[68:71], a[148:151], v[212:215], v[68:71]
    v_exp_f32 v197, v197
    v_mfma_f32_16x16x32_bf16 v[72:75], a[152:155], v[212:215], v[72:75]
    v_exp_f32 v198, v198
    v_mfma_f32_16x16x32_bf16 v[76:79], a[156:159], v[212:215], v[76:79]
    v_add_f32 v238, v238, v196
    v_add_f32 v238, v238, v197
    v_mfma_f32_16x16x32_bf16 v[80:83], a[160:163], v[212:215], v[80:83]
    v_exp_f32 v199, v199
    v_mfma_f32_16x16x32_bf16 v[84:87], a[164:167], v[212:215], v[84:87]
    ds_read_b64_tr_b16 a[196:197], v10 offset:40960
    v_cvt_pk_bf16_f32 v210, v196, v197
    v_mfma_f32_16x16x32_bf16 v[88:91], a[168:171], v[212:215], v[88:91]
    ds_read_b64_tr_b16 a[198:199], v10 offset:45056
    v_add_f32 v238, v238, v198
    v_mfma_f32_16x16x32_bf16 v[92:95], a[172:175], v[212:215], v[92:95]
    v_add_f32 v238, v238, v199
    v_cvt_pk_bf16_f32 v211, v198, v199
    v_mfma_f32_16x16x32_bf16 v[192:195], a[80:83], a[64:67], v[232:235]
    v_exp_f32 v200, v200
    v_mfma_f32_16x16x32_bf16 v[192:195], a[84:87], a[68:71], v[192:195]
    v_exp_f32 v201, v201
    v_mfma_f32_16x16x32_bf16 v[192:195], a[88:91], a[72:75], v[192:195]
    ds_read_b64_tr_b16 a[200:201], v11 offset:40960
    v_add_f32 v239, v239, v200
    v_mfma_f32_16x16x32_bf16 v[192:195], a[92:95], a[76:79], v[192:195]
    v_exp_f32 v202, v202
    v_mfma_f32_16x16x32_bf16 v[196:199], a[96:99], a[64:67], v[232:235]
    ds_read_b64_tr_b16 a[202:203], v11 offset:45056
    v_add_f32 v239, v239, v201
    v_mfma_f32_16x16x32_bf16 v[196:199], a[100:103], a[68:71], v[196:199]
    v_exp_f32 v203, v203
    v_mfma_f32_16x16x32_bf16 v[196:199], a[104:107], a[72:75], v[196:199]
    ds_read_b64_tr_b16 a[204:205], v12 offset:40960
    v_cvt_pk_bf16_f32 v212, v200, v201
    v_mfma_f32_16x16x32_bf16 v[196:199], a[108:111], a[76:79], v[196:199]
    v_exp_f32 v204, v204
    v_mfma_f32_16x16x32_bf16 v[96:99], a[144:147], v[208:211], v[96:99]
    ds_read_b64_tr_b16 a[206:207], v12 offset:45056
    v_add_f32 v239, v239, v202
    v_mfma_f32_16x16x32_bf16 v[100:103], a[148:151], v[208:211], v[100:103]
    v_exp_f32 v205, v205
    v_mfma_f32_16x16x32_bf16 v[104:107], a[152:155], v[208:211], v[104:107]
    v_add_f32 v239, v239, v203
    v_cvt_pk_bf16_f32 v213, v202, v203
    v_mfma_f32_16x16x32_bf16 v[108:111], a[156:159], v[208:211], v[108:111]
    v_exp_f32 v206, v206
    v_mfma_f32_16x16x32_bf16 v[112:115], a[160:163], v[208:211], v[112:115]
    v_add_f32 v239, v239, v204
    v_add_f32 v239, v239, v205
    v_mfma_f32_16x16x32_bf16 v[116:119], a[164:167], v[208:211], v[116:119]
    v_exp_f32 v207, v207
    v_mfma_f32_16x16x32_bf16 v[120:123], a[168:171], v[208:211], v[120:123]
    s_waitcnt vmcnt(0) lgkmcnt(0)
    v_cvt_pk_bf16_f32 v214, v204, v205
    v_add_f32 v239, v239, v206
    v_mfma_f32_16x16x32_bf16 v[124:127], a[172:175], v[208:211], v[124:127]
    s_barrier
    v_add_f32 v239, v239, v207
    v_cvt_pk_bf16_f32 v215, v206, v207
    v_mfma_f32_16x16x32_bf16 v[200:203], a[112:115], a[0:3], v[216:219]
    v_exp_f32 v192, v192
    v_mfma_f32_16x16x32_bf16 v[200:203], a[116:119], a[4:7], v[200:203]
    v_exp_f32 v193, v193
    v_mfma_f32_16x16x32_bf16 v[200:203], a[120:123], a[8:11], v[200:203]
    v_add_f32 v240, v240, v192
    v_add_f32 v240, v240, v193
    v_mfma_f32_16x16x32_bf16 v[200:203], a[124:127], a[12:15], v[200:203]
    v_exp_f32 v194, v194
    v_mfma_f32_16x16x32_bf16 v[204:207], a[128:131], a[0:3], v[216:219]
    v_exp_f32 v195, v195
    v_mfma_f32_16x16x32_bf16 v[204:207], a[132:135], a[4:7], v[204:207]
    ds_read_b128 a[80:83], v1 offset:49152
    v_cvt_pk_bf16_f32 v208, v192, v193
    v_mfma_f32_16x16x32_bf16 v[204:207], a[136:139], a[8:11], v[204:207]
    ds_read_b128 a[84:87], v2 offset:49152
    v_add_f32 v240, v240, v194
    v_mfma_f32_16x16x32_bf16 v[204:207], a[140:143], a[12:15], v[204:207]
    v_exp_f32 v196, v196
    v_mfma_f32_16x16x32_bf16 v[128:131], a[144:147], v[212:215], v[128:131]
    v_add_f32 v240, v240, v195
    v_cvt_pk_bf16_f32 v209, v194, v195
    v_mfma_f32_16x16x32_bf16 v[132:135], a[148:151], v[212:215], v[132:135]
    v_exp_f32 v197, v197
    v_mfma_f32_16x16x32_bf16 v[136:139], a[152:155], v[212:215], v[136:139]
    v_exp_f32 v198, v198
    v_mfma_f32_16x16x32_bf16 v[140:143], a[156:159], v[212:215], v[140:143]
    v_add_f32 v240, v240, v196
    v_add_f32 v240, v240, v197
    v_mfma_f32_16x16x32_bf16 v[144:147], a[160:163], v[212:215], v[144:147]
    v_exp_f32 v199, v199
    v_mfma_f32_16x16x32_bf16 v[148:151], a[164:167], v[212:215], v[148:151]
    ds_read_b128 a[88:91], v3 offset:49152
    v_cvt_pk_bf16_f32 v210, v196, v197
    v_mfma_f32_16x16x32_bf16 v[152:155], a[168:171], v[212:215], v[152:155]
    ds_read_b128 a[92:95], v4 offset:49152
    v_add_f32 v240, v240, v198
    v_mfma_f32_16x16x32_bf16 v[156:159], a[172:175], v[212:215], v[156:159]
    v_add_f32 v240, v240, v199
    v_cvt_pk_bf16_f32 v211, v198, v199
    v_mfma_f32_16x16x32_bf16 v[192:195], a[112:115], a[16:19], v[220:223]
    v_exp_f32 v200, v200
    v_mfma_f32_16x16x32_bf16 v[192:195], a[116:119], a[20:23], v[192:195]
    v_exp_f32 v201, v201
    v_mfma_f32_16x16x32_bf16 v[192:195], a[120:123], a[24:27], v[192:195]
    v_add_f32 v236, v236, v200
    v_add_f32 v236, v236, v201
    v_mfma_f32_16x16x32_bf16 v[192:195], a[124:127], a[28:31], v[192:195]
    v_exp_f32 v202, v202
    v_mfma_f32_16x16x32_bf16 v[196:199], a[128:131], a[16:19], v[220:223]
    v_exp_f32 v203, v203
    v_mfma_f32_16x16x32_bf16 v[196:199], a[132:135], a[20:23], v[196:199]
    ds_read_b128 a[96:99], v1 offset:53248
    v_cvt_pk_bf16_f32 v212, v200, v201
    v_mfma_f32_16x16x32_bf16 v[196:199], a[136:139], a[24:27], v[196:199]
    ds_read_b128 a[100:103], v2 offset:53248
    v_add_f32 v236, v236, v202
    v_mfma_f32_16x16x32_bf16 v[196:199], a[140:143], a[28:31], v[196:199]
    v_exp_f32 v204, v204
    v_mfma_f32_16x16x32_bf16 v[160:163], a[144:147], v[208:211], v[160:163]
    v_add_f32 v236, v236, v203
    v_cvt_pk_bf16_f32 v213, v202, v203
    v_mfma_f32_16x16x32_bf16 v[164:167], a[148:151], v[208:211], v[164:167]
    v_exp_f32 v205, v205
    v_mfma_f32_16x16x32_bf16 v[168:171], a[152:155], v[208:211], v[168:171]
    v_exp_f32 v206, v206
    v_mfma_f32_16x16x32_bf16 v[172:175], a[156:159], v[208:211], v[172:175]
    v_add_f32 v236, v236, v204
    v_add_f32 v236, v236, v205
    v_mfma_f32_16x16x32_bf16 v[176:179], a[160:163], v[208:211], v[176:179]
    v_exp_f32 v207, v207
    v_mfma_f32_16x16x32_bf16 v[180:183], a[164:167], v[208:211], v[180:183]
    ds_read_b128 a[104:107], v3 offset:53248
    v_cvt_pk_bf16_f32 v214, v204, v205
    v_mfma_f32_16x16x32_bf16 v[184:187], a[168:171], v[208:211], v[184:187]
    ds_read_b128 a[108:111], v4 offset:53248
    v_add_f32 v236, v236, v206
    v_mfma_f32_16x16x32_bf16 v[188:191], a[172:175], v[208:211], v[188:191]
    v_add_f32 v236, v236, v207
    v_cvt_pk_bf16_f32 v215, v206, v207
    v_mfma_f32_16x16x32_bf16 v[200:203], a[112:115], a[32:35], v[224:227]
    v_exp_f32 v192, v192
    v_mfma_f32_16x16x32_bf16 v[200:203], a[116:119], a[36:39], v[200:203]
    v_exp_f32 v193, v193
    v_mfma_f32_16x16x32_bf16 v[200:203], a[120:123], a[40:43], v[200:203]
    ds_read_b64_tr_b16 a[144:145], v5 offset:49152
    v_add_f32 v237, v237, v192
    v_add_f32 v237, v237, v193
    v_mfma_f32_16x16x32_bf16 v[200:203], a[124:127], a[44:47], v[200:203]
    v_exp_f32 v194, v194
    v_mfma_f32_16x16x32_bf16 v[204:207], a[128:131], a[32:35], v[224:227]
    v_exp_f32 v195, v195
    v_mfma_f32_16x16x32_bf16 v[204:207], a[132:135], a[36:39], v[204:207]
    ds_read_b64_tr_b16 a[146:147], v5 offset:53248
    v_cvt_pk_bf16_f32 v208, v192, v193
    v_mfma_f32_16x16x32_bf16 v[204:207], a[136:139], a[40:43], v[204:207]
    ds_read_b64_tr_b16 a[148:149], v6 offset:49152
    v_add_f32 v237, v237, v194
    v_mfma_f32_16x16x32_bf16 v[204:207], a[140:143], a[44:47], v[204:207]
    v_exp_f32 v196, v196
    v_mfma_f32_16x16x32_bf16 v[32:35], a[176:179], v[212:215], v[32:35]
    ds_read_b64_tr_b16 a[150:151], v6 offset:53248
    v_add_f32 v237, v237, v195
    v_cvt_pk_bf16_f32 v209, v194, v195
    v_mfma_f32_16x16x32_bf16 v[36:39], a[180:183], v[212:215], v[36:39]
    v_exp_f32 v197, v197
    v_mfma_f32_16x16x32_bf16 v[40:43], a[184:187], v[212:215], v[40:43]
    v_exp_f32 v198, v198
    v_mfma_f32_16x16x32_bf16 v[44:47], a[188:191], v[212:215], v[44:47]
    v_add_f32 v237, v237, v196
    v_add_f32 v237, v237, v197
    v_mfma_f32_16x16x32_bf16 v[48:51], a[192:195], v[212:215], v[48:51]
    v_exp_f32 v199, v199
    v_mfma_f32_16x16x32_bf16 v[52:55], a[196:199], v[212:215], v[52:55]
    ds_read_b64_tr_b16 a[152:153], v7 offset:49152
    v_cvt_pk_bf16_f32 v210, v196, v197
    v_mfma_f32_16x16x32_bf16 v[56:59], a[200:203], v[212:215], v[56:59]
    ds_read_b64_tr_b16 a[154:155], v7 offset:53248
    v_add_f32 v237, v237, v198
    v_mfma_f32_16x16x32_bf16 v[60:63], a[204:207], v[212:215], v[60:63]
    v_add_f32 v237, v237, v199
    v_cvt_pk_bf16_f32 v211, v198, v199
    v_mfma_f32_16x16x32_bf16 v[192:195], a[112:115], a[48:51], v[228:231]
    v_exp_f32 v200, v200
    v_mfma_f32_16x16x32_bf16 v[192:195], a[116:119], a[52:55], v[192:195]
    v_exp_f32 v201, v201
    v_mfma_f32_16x16x32_bf16 v[192:195], a[120:123], a[56:59], v[192:195]
    ds_read_b64_tr_b16 a[156:157], v8 offset:49152
    v_add_f32 v238, v238, v200
    v_add_f32 v238, v238, v201
    v_mfma_f32_16x16x32_bf16 v[192:195], a[124:127], a[60:63], v[192:195]
    v_exp_f32 v202, v202
    v_mfma_f32_16x16x32_bf16 v[196:199], a[128:131], a[48:51], v[228:231]
    v_exp_f32 v203, v203
    v_mfma_f32_16x16x32_bf16 v[196:199], a[132:135], a[52:55], v[196:199]
    ds_read_b64_tr_b16 a[158:159], v8 offset:53248
    v_cvt_pk_bf16_f32 v212, v200, v201
    v_mfma_f32_16x16x32_bf16 v[196:199], a[136:139], a[56:59], v[196:199]
    ds_read_b64_tr_b16 a[160:161], v9 offset:49152
    v_add_f32 v238, v238, v202
    v_mfma_f32_16x16x32_bf16 v[196:199], a[140:143], a[60:63], v[196:199]
    v_exp_f32 v204, v204
    v_mfma_f32_16x16x32_bf16 v[64:67], a[176:179], v[208:211], v[64:67]
    ds_read_b64_tr_b16 a[162:163], v9 offset:53248
    v_add_f32 v238, v238, v203
    v_cvt_pk_bf16_f32 v213, v202, v203
    v_mfma_f32_16x16x32_bf16 v[68:71], a[180:183], v[208:211], v[68:71]
    v_exp_f32 v205, v205
    v_mfma_f32_16x16x32_bf16 v[72:75], a[184:187], v[208:211], v[72:75]
    v_exp_f32 v206, v206
    v_mfma_f32_16x16x32_bf16 v[76:79], a[188:191], v[208:211], v[76:79]
    v_add_f32 v238, v238, v204
    v_add_f32 v238, v238, v205
    v_mfma_f32_16x16x32_bf16 v[80:83], a[192:195], v[208:211], v[80:83]
    v_exp_f32 v207, v207
    v_mfma_f32_16x16x32_bf16 v[84:87], a[196:199], v[208:211], v[84:87]
    ds_read_b64_tr_b16 a[164:165], v10 offset:49152
    v_cvt_pk_bf16_f32 v214, v204, v205
    v_mfma_f32_16x16x32_bf16 v[88:91], a[200:203], v[208:211], v[88:91]
    ds_read_b64_tr_b16 a[166:167], v10 offset:53248
    v_add_f32 v238, v238, v206
    v_mfma_f32_16x16x32_bf16 v[92:95], a[204:207], v[208:211], v[92:95]
    v_add_f32 v238, v238, v207
    v_cvt_pk_bf16_f32 v215, v206, v207
    v_mfma_f32_16x16x32_bf16 v[200:203], a[112:115], a[64:67], v[232:235]
    v_exp_f32 v192, v192
    v_mfma_f32_16x16x32_bf16 v[200:203], a[116:119], a[68:71], v[200:203]
    v_exp_f32 v193, v193
    v_mfma_f32_16x16x32_bf16 v[200:203], a[120:123], a[72:75], v[200:203]
    ds_read_b64_tr_b16 a[168:169], v11 offset:49152
    v_add_f32 v239, v239, v192
    v_mfma_f32_16x16x32_bf16 v[200:203], a[124:127], a[76:79], v[200:203]
    v_exp_f32 v194, v194
    v_mfma_f32_16x16x32_bf16 v[204:207], a[128:131], a[64:67], v[232:235]
    ds_read_b64_tr_b16 a[170:171], v11 offset:53248
    v_add_f32 v239, v239, v193
    v_mfma_f32_16x16x32_bf16 v[204:207], a[132:135], a[68:71], v[204:207]
    v_exp_f32 v195, v195
    v_mfma_f32_16x16x32_bf16 v[204:207], a[136:139], a[72:75], v[204:207]
    ds_read_b64_tr_b16 a[172:173], v12 offset:49152
    v_cvt_pk_bf16_f32 v208, v192, v193
    v_mfma_f32_16x16x32_bf16 v[204:207], a[140:143], a[76:79], v[204:207]
    v_exp_f32 v196, v196
    v_mfma_f32_16x16x32_bf16 v[96:99], a[176:179], v[212:215], v[96:99]
    ds_read_b64_tr_b16 a[174:175], v12 offset:53248
    v_add_f32 v239, v239, v194
    v_mfma_f32_16x16x32_bf16 v[100:103], a[180:183], v[212:215], v[100:103]
    v_exp_f32 v197, v197
    v_mfma_f32_16x16x32_bf16 v[104:107], a[184:187], v[212:215], v[104:107]
    v_add_f32 v239, v239, v195
    v_cvt_pk_bf16_f32 v209, v194, v195
    v_mfma_f32_16x16x32_bf16 v[108:111], a[188:191], v[212:215], v[108:111]
    v_exp_f32 v198, v198
    v_mfma_f32_16x16x32_bf16 v[112:115], a[192:195], v[212:215], v[112:115]
    v_add_f32 v239, v239, v196
    v_add_f32 v239, v239, v197
    v_mfma_f32_16x16x32_bf16 v[116:119], a[196:199], v[212:215], v[116:119]
    v_exp_f32 v199, v199
    v_mfma_f32_16x16x32_bf16 v[120:123], a[200:203], v[212:215], v[120:123]
    v_cvt_pk_bf16_f32 v210, v196, v197
    v_add_f32 v239, v239, v198
    v_mfma_f32_16x16x32_bf16 v[124:127], a[204:207], v[212:215], v[124:127]
    s_waitcnt lgkmcnt(0)
    v_add_f32 v239, v239, v199
    v_cvt_pk_bf16_f32 v211, v198, v199
    v_mfma_f32_16x16x32_bf16 v[192:195], a[80:83], a[0:3], v[216:219]
    v_exp_f32 v200, v200
    v_mfma_f32_16x16x32_bf16 v[192:195], a[84:87], a[4:7], v[192:195]
    v_exp_f32 v201, v201
    v_mfma_f32_16x16x32_bf16 v[192:195], a[88:91], a[8:11], v[192:195]
    v_add_f32 v240, v240, v200
    v_add_f32 v240, v240, v201
    v_mfma_f32_16x16x32_bf16 v[192:195], a[92:95], a[12:15], v[192:195]
    v_exp_f32 v202, v202
    v_mfma_f32_16x16x32_bf16 v[196:199], a[96:99], a[0:3], v[216:219]
    v_exp_f32 v203, v203
    v_mfma_f32_16x16x32_bf16 v[196:199], a[100:103], a[4:7], v[196:199]
    ds_read_b128 a[112:115], v1 offset:57344
    v_cvt_pk_bf16_f32 v212, v200, v201
    v_mfma_f32_16x16x32_bf16 v[196:199], a[104:107], a[8:11], v[196:199]
    ds_read_b128 a[116:119], v2 offset:57344
    v_add_f32 v240, v240, v202
    v_mfma_f32_16x16x32_bf16 v[196:199], a[108:111], a[12:15], v[196:199]
    v_exp_f32 v204, v204
    v_mfma_f32_16x16x32_bf16 v[128:131], a[176:179], v[208:211], v[128:131]
    v_add_f32 v240, v240, v203
    v_cvt_pk_bf16_f32 v213, v202, v203
    v_mfma_f32_16x16x32_bf16 v[132:135], a[180:183], v[208:211], v[132:135]
    v_exp_f32 v205, v205
    v_mfma_f32_16x16x32_bf16 v[136:139], a[184:187], v[208:211], v[136:139]
    v_exp_f32 v206, v206
    v_mfma_f32_16x16x32_bf16 v[140:143], a[188:191], v[208:211], v[140:143]
    v_add_f32 v240, v240, v204
    v_add_f32 v240, v240, v205
    v_mfma_f32_16x16x32_bf16 v[144:147], a[192:195], v[208:211], v[144:147]
    v_exp_f32 v207, v207
    v_mfma_f32_16x16x32_bf16 v[148:151], a[196:199], v[208:211], v[148:151]
    ds_read_b128 a[120:123], v3 offset:57344
    v_cvt_pk_bf16_f32 v214, v204, v205
    v_mfma_f32_16x16x32_bf16 v[152:155], a[200:203], v[208:211], v[152:155]
    ds_read_b128 a[124:127], v4 offset:57344
    v_add_f32 v240, v240, v206
    v_mfma_f32_16x16x32_bf16 v[156:159], a[204:207], v[208:211], v[156:159]
    v_add_f32 v240, v240, v207
    v_cvt_pk_bf16_f32 v215, v206, v207
    v_mfma_f32_16x16x32_bf16 v[200:203], a[80:83], a[16:19], v[220:223]
    v_exp_f32 v192, v192
    v_mfma_f32_16x16x32_bf16 v[200:203], a[84:87], a[20:23], v[200:203]
    v_exp_f32 v193, v193
    v_mfma_f32_16x16x32_bf16 v[200:203], a[88:91], a[24:27], v[200:203]
    v_add_f32 v236, v236, v192
    v_add_f32 v236, v236, v193
    v_mfma_f32_16x16x32_bf16 v[200:203], a[92:95], a[28:31], v[200:203]
    v_exp_f32 v194, v194
    v_mfma_f32_16x16x32_bf16 v[204:207], a[96:99], a[16:19], v[220:223]
    v_exp_f32 v195, v195
    v_mfma_f32_16x16x32_bf16 v[204:207], a[100:103], a[20:23], v[204:207]
    ds_read_b128 a[128:131], v1 offset:61440
    v_cvt_pk_bf16_f32 v208, v192, v193
    v_mfma_f32_16x16x32_bf16 v[204:207], a[104:107], a[24:27], v[204:207]
    ds_read_b128 a[132:135], v2 offset:61440
    v_add_f32 v236, v236, v194
    v_mfma_f32_16x16x32_bf16 v[204:207], a[108:111], a[28:31], v[204:207]
    v_exp_f32 v196, v196
    v_mfma_f32_16x16x32_bf16 v[160:163], a[176:179], v[212:215], v[160:163]
    v_add_f32 v236, v236, v195
    v_cvt_pk_bf16_f32 v209, v194, v195
    v_mfma_f32_16x16x32_bf16 v[164:167], a[180:183], v[212:215], v[164:167]
    v_exp_f32 v197, v197
    v_mfma_f32_16x16x32_bf16 v[168:171], a[184:187], v[212:215], v[168:171]
    v_exp_f32 v198, v198
    v_mfma_f32_16x16x32_bf16 v[172:175], a[188:191], v[212:215], v[172:175]
    v_add_f32 v236, v236, v196
    v_add_f32 v236, v236, v197
    v_mfma_f32_16x16x32_bf16 v[176:179], a[192:195], v[212:215], v[176:179]
    v_exp_f32 v199, v199
    v_mfma_f32_16x16x32_bf16 v[180:183], a[196:199], v[212:215], v[180:183]
    ds_read_b128 a[136:139], v3 offset:61440
    v_cvt_pk_bf16_f32 v210, v196, v197
    v_mfma_f32_16x16x32_bf16 v[184:187], a[200:203], v[212:215], v[184:187]
    ds_read_b128 a[140:143], v4 offset:61440
    v_add_f32 v236, v236, v198
    v_mfma_f32_16x16x32_bf16 v[188:191], a[204:207], v[212:215], v[188:191]
    v_add_f32 v236, v236, v199
    v_cvt_pk_bf16_f32 v211, v198, v199
    v_mfma_f32_16x16x32_bf16 v[192:195], a[80:83], a[32:35], v[224:227]
    v_exp_f32 v200, v200
    v_mfma_f32_16x16x32_bf16 v[192:195], a[84:87], a[36:39], v[192:195]
    v_exp_f32 v201, v201
    v_mfma_f32_16x16x32_bf16 v[192:195], a[88:91], a[40:43], v[192:195]
    ds_read_b64_tr_b16 a[176:177], v5 offset:57344
    v_add_f32 v237, v237, v200
    v_add_f32 v237, v237, v201
    v_mfma_f32_16x16x32_bf16 v[192:195], a[92:95], a[44:47], v[192:195]
    v_exp_f32 v202, v202
    v_mfma_f32_16x16x32_bf16 v[196:199], a[96:99], a[32:35], v[224:227]
    v_exp_f32 v203, v203
    v_mfma_f32_16x16x32_bf16 v[196:199], a[100:103], a[36:39], v[196:199]
    ds_read_b64_tr_b16 a[178:179], v5 offset:61440
    v_cvt_pk_bf16_f32 v212, v200, v201
    v_mfma_f32_16x16x32_bf16 v[196:199], a[104:107], a[40:43], v[196:199]
    ds_read_b64_tr_b16 a[180:181], v6 offset:57344
    v_add_f32 v237, v237, v202
    v_mfma_f32_16x16x32_bf16 v[196:199], a[108:111], a[44:47], v[196:199]
    v_exp_f32 v204, v204
    v_mfma_f32_16x16x32_bf16 v[32:35], a[144:147], v[208:211], v[32:35]
    ds_read_b64_tr_b16 a[182:183], v6 offset:61440
    v_add_f32 v237, v237, v203
    v_cvt_pk_bf16_f32 v213, v202, v203
    v_mfma_f32_16x16x32_bf16 v[36:39], a[148:151], v[208:211], v[36:39]
    v_exp_f32 v205, v205
    v_mfma_f32_16x16x32_bf16 v[40:43], a[152:155], v[208:211], v[40:43]
    v_exp_f32 v206, v206
    v_mfma_f32_16x16x32_bf16 v[44:47], a[156:159], v[208:211], v[44:47]
    v_add_f32 v237, v237, v204
    v_add_f32 v237, v237, v205
    v_mfma_f32_16x16x32_bf16 v[48:51], a[160:163], v[208:211], v[48:51]
    v_exp_f32 v207, v207
    v_mfma_f32_16x16x32_bf16 v[52:55], a[164:167], v[208:211], v[52:55]
    ds_read_b64_tr_b16 a[184:185], v7 offset:57344
    v_cvt_pk_bf16_f32 v214, v204, v205
    v_mfma_f32_16x16x32_bf16 v[56:59], a[168:171], v[208:211], v[56:59]
    ds_read_b64_tr_b16 a[186:187], v7 offset:61440
    v_add_f32 v237, v237, v206
    v_mfma_f32_16x16x32_bf16 v[60:63], a[172:175], v[208:211], v[60:63]
    v_add_f32 v237, v237, v207
    v_cvt_pk_bf16_f32 v215, v206, v207
    v_mfma_f32_16x16x32_bf16 v[200:203], a[80:83], a[48:51], v[228:231]
    v_exp_f32 v192, v192
    v_mfma_f32_16x16x32_bf16 v[200:203], a[84:87], a[52:55], v[200:203]
    v_exp_f32 v193, v193
    v_mfma_f32_16x16x32_bf16 v[200:203], a[88:91], a[56:59], v[200:203]
    ds_read_b64_tr_b16 a[188:189], v8 offset:57344
    v_add_f32 v238, v238, v192
    v_add_f32 v238, v238, v193
    v_mfma_f32_16x16x32_bf16 v[200:203], a[92:95], a[60:63], v[200:203]
    v_exp_f32 v194, v194
    v_mfma_f32_16x16x32_bf16 v[204:207], a[96:99], a[48:51], v[228:231]
    v_exp_f32 v195, v195
    v_mfma_f32_16x16x32_bf16 v[204:207], a[100:103], a[52:55], v[204:207]
    ds_read_b64_tr_b16 a[190:191], v8 offset:61440
    v_cvt_pk_bf16_f32 v208, v192, v193
    v_mfma_f32_16x16x32_bf16 v[204:207], a[104:107], a[56:59], v[204:207]
    ds_read_b64_tr_b16 a[192:193], v9 offset:57344
    v_add_f32 v238, v238, v194
    v_mfma_f32_16x16x32_bf16 v[204:207], a[108:111], a[60:63], v[204:207]
    v_exp_f32 v196, v196
    v_mfma_f32_16x16x32_bf16 v[64:67], a[144:147], v[212:215], v[64:67]
    ds_read_b64_tr_b16 a[194:195], v9 offset:61440
    v_add_f32 v238, v238, v195
    v_cvt_pk_bf16_f32 v209, v194, v195
    v_mfma_f32_16x16x32_bf16 v[68:71], a[148:151], v[212:215], v[68:71]
    v_exp_f32 v197, v197
    v_mfma_f32_16x16x32_bf16 v[72:75], a[152:155], v[212:215], v[72:75]
    v_exp_f32 v198, v198
    v_mfma_f32_16x16x32_bf16 v[76:79], a[156:159], v[212:215], v[76:79]
    v_add_f32 v238, v238, v196
    v_add_f32 v238, v238, v197
    v_mfma_f32_16x16x32_bf16 v[80:83], a[160:163], v[212:215], v[80:83]
    v_exp_f32 v199, v199
    v_mfma_f32_16x16x32_bf16 v[84:87], a[164:167], v[212:215], v[84:87]
    ds_read_b64_tr_b16 a[196:197], v10 offset:57344
    v_cvt_pk_bf16_f32 v210, v196, v197
    v_mfma_f32_16x16x32_bf16 v[88:91], a[168:171], v[212:215], v[88:91]
    ds_read_b64_tr_b16 a[198:199], v10 offset:61440
    v_add_f32 v238, v238, v198
    v_mfma_f32_16x16x32_bf16 v[92:95], a[172:175], v[212:215], v[92:95]
    v_add_f32 v238, v238, v199
    v_cvt_pk_bf16_f32 v211, v198, v199
    v_mfma_f32_16x16x32_bf16 v[192:195], a[80:83], a[64:67], v[232:235]
    v_exp_f32 v200, v200
    v_mfma_f32_16x16x32_bf16 v[192:195], a[84:87], a[68:71], v[192:195]
    v_exp_f32 v201, v201
    v_mfma_f32_16x16x32_bf16 v[192:195], a[88:91], a[72:75], v[192:195]
    ds_read_b64_tr_b16 a[200:201], v11 offset:57344
    v_add_f32 v239, v239, v200
    v_mfma_f32_16x16x32_bf16 v[192:195], a[92:95], a[76:79], v[192:195]
    v_exp_f32 v202, v202
    v_mfma_f32_16x16x32_bf16 v[196:199], a[96:99], a[64:67], v[232:235]
    ds_read_b64_tr_b16 a[202:203], v11 offset:61440
    v_add_f32 v239, v239, v201
    v_mfma_f32_16x16x32_bf16 v[196:199], a[100:103], a[68:71], v[196:199]
    v_exp_f32 v203, v203
    v_mfma_f32_16x16x32_bf16 v[196:199], a[104:107], a[72:75], v[196:199]
    ds_read_b64_tr_b16 a[204:205], v12 offset:57344
    v_cvt_pk_bf16_f32 v212, v200, v201
    v_mfma_f32_16x16x32_bf16 v[196:199], a[108:111], a[76:79], v[196:199]
    v_exp_f32 v204, v204
    v_mfma_f32_16x16x32_bf16 v[96:99], a[144:147], v[208:211], v[96:99]
    ds_read_b64_tr_b16 a[206:207], v12 offset:61440
    v_add_f32 v239, v239, v202
    v_mfma_f32_16x16x32_bf16 v[100:103], a[148:151], v[208:211], v[100:103]
    v_exp_f32 v205, v205
    v_mfma_f32_16x16x32_bf16 v[104:107], a[152:155], v[208:211], v[104:107]
    v_add_f32 v239, v239, v203
    v_cvt_pk_bf16_f32 v213, v202, v203
    v_mfma_f32_16x16x32_bf16 v[108:111], a[156:159], v[208:211], v[108:111]
    v_exp_f32 v206, v206
    v_mfma_f32_16x16x32_bf16 v[112:115], a[160:163], v[208:211], v[112:115]
    v_add_f32 v239, v239, v204
    v_add_f32 v239, v239, v205
    v_mfma_f32_16x16x32_bf16 v[116:119], a[164:167], v[208:211], v[116:119]
    v_exp_f32 v207, v207
    v_mfma_f32_16x16x32_bf16 v[120:123], a[168:171], v[208:211], v[120:123]
    s_waitcnt vmcnt(38) lgkmcnt(0)
    v_cvt_pk_bf16_f32 v214, v204, v205
    v_add_f32 v239, v239, v206
    v_mfma_f32_16x16x32_bf16 v[124:127], a[172:175], v[208:211], v[124:127]
    s_barrier
    v_add_f32 v239, v239, v207
    v_cvt_pk_bf16_f32 v215, v206, v207
    v_mfma_f32_16x16x32_bf16 v[200:203], a[112:115], a[0:3], v[216:219]
    v_exp_f32 v192, v192
    v_mfma_f32_16x16x32_bf16 v[200:203], a[116:119], a[4:7], v[200:203]
    v_exp_f32 v193, v193
    v_mfma_f32_16x16x32_bf16 v[200:203], a[120:123], a[8:11], v[200:203]
    v_add_f32 v240, v240, v192
    v_add_f32 v240, v240, v193
    v_mfma_f32_16x16x32_bf16 v[200:203], a[124:127], a[12:15], v[200:203]
    v_exp_f32 v194, v194
    v_mfma_f32_16x16x32_bf16 v[204:207], a[128:131], a[0:3], v[216:219]
    v_exp_f32 v195, v195
    v_mfma_f32_16x16x32_bf16 v[204:207], a[132:135], a[4:7], v[204:207]
    ds_read_b128 a[80:83], v1 offset:0
    v_cvt_pk_bf16_f32 v208, v192, v193
    v_mfma_f32_16x16x32_bf16 v[204:207], a[136:139], a[8:11], v[204:207]
    ds_read_b128 a[84:87], v2 offset:0
    v_add_f32 v240, v240, v194
    v_mfma_f32_16x16x32_bf16 v[204:207], a[140:143], a[12:15], v[204:207]
    v_exp_f32 v196, v196
    v_mfma_f32_16x16x32_bf16 v[128:131], a[144:147], v[212:215], v[128:131]
    v_add_f32 v240, v240, v195
    v_cvt_pk_bf16_f32 v209, v194, v195
    v_mfma_f32_16x16x32_bf16 v[132:135], a[148:151], v[212:215], v[132:135]
    v_exp_f32 v197, v197
    v_mfma_f32_16x16x32_bf16 v[136:139], a[152:155], v[212:215], v[136:139]
    v_exp_f32 v198, v198
    v_mfma_f32_16x16x32_bf16 v[140:143], a[156:159], v[212:215], v[140:143]
    v_add_f32 v240, v240, v196
    v_add_f32 v240, v240, v197
    v_mfma_f32_16x16x32_bf16 v[144:147], a[160:163], v[212:215], v[144:147]
    v_exp_f32 v199, v199
    v_mfma_f32_16x16x32_bf16 v[148:151], a[164:167], v[212:215], v[148:151]
    ds_read_b128 a[88:91], v3 offset:0
    v_cvt_pk_bf16_f32 v210, v196, v197
    v_mfma_f32_16x16x32_bf16 v[152:155], a[168:171], v[212:215], v[152:155]
    ds_read_b128 a[92:95], v4 offset:0
    v_add_f32 v240, v240, v198
    v_mfma_f32_16x16x32_bf16 v[156:159], a[172:175], v[212:215], v[156:159]
    v_add_f32 v240, v240, v199
    v_cvt_pk_bf16_f32 v211, v198, v199
    v_mfma_f32_16x16x32_bf16 v[192:195], a[112:115], a[16:19], v[220:223]
    v_exp_f32 v200, v200
    v_mfma_f32_16x16x32_bf16 v[192:195], a[116:119], a[20:23], v[192:195]
    v_exp_f32 v201, v201
    v_mfma_f32_16x16x32_bf16 v[192:195], a[120:123], a[24:27], v[192:195]
    v_add_f32 v236, v236, v200
    v_add_f32 v236, v236, v201
    v_mfma_f32_16x16x32_bf16 v[192:195], a[124:127], a[28:31], v[192:195]
    v_exp_f32 v202, v202
    v_mfma_f32_16x16x32_bf16 v[196:199], a[128:131], a[16:19], v[220:223]
    v_exp_f32 v203, v203
    v_mfma_f32_16x16x32_bf16 v[196:199], a[132:135], a[20:23], v[196:199]
    ds_read_b128 a[96:99], v1 offset:4096
    v_cvt_pk_bf16_f32 v212, v200, v201
    v_mfma_f32_16x16x32_bf16 v[196:199], a[136:139], a[24:27], v[196:199]
    ds_read_b128 a[100:103], v2 offset:4096
    v_add_f32 v236, v236, v202
    v_mfma_f32_16x16x32_bf16 v[196:199], a[140:143], a[28:31], v[196:199]
    v_exp_f32 v204, v204
    v_mfma_f32_16x16x32_bf16 v[160:163], a[144:147], v[208:211], v[160:163]
    v_add_f32 v236, v236, v203
    v_cvt_pk_bf16_f32 v213, v202, v203
    v_mfma_f32_16x16x32_bf16 v[164:167], a[148:151], v[208:211], v[164:167]
    v_exp_f32 v205, v205
    v_mfma_f32_16x16x32_bf16 v[168:171], a[152:155], v[208:211], v[168:171]
    v_exp_f32 v206, v206
    v_mfma_f32_16x16x32_bf16 v[172:175], a[156:159], v[208:211], v[172:175]
    v_add_f32 v236, v236, v204
    v_add_f32 v236, v236, v205
    v_mfma_f32_16x16x32_bf16 v[176:179], a[160:163], v[208:211], v[176:179]
    v_exp_f32 v207, v207
    v_mfma_f32_16x16x32_bf16 v[180:183], a[164:167], v[208:211], v[180:183]
    ds_read_b128 a[104:107], v3 offset:4096
    v_cvt_pk_bf16_f32 v214, v204, v205
    v_mfma_f32_16x16x32_bf16 v[184:187], a[168:171], v[208:211], v[184:187]
    ds_read_b128 a[108:111], v4 offset:4096
    v_add_f32 v236, v236, v206
    v_mfma_f32_16x16x32_bf16 v[188:191], a[172:175], v[208:211], v[188:191]
    v_add_f32 v236, v236, v207
    v_cvt_pk_bf16_f32 v215, v206, v207
    v_mfma_f32_16x16x32_bf16 v[200:203], a[112:115], a[32:35], v[224:227]
    v_exp_f32 v192, v192
    v_mfma_f32_16x16x32_bf16 v[200:203], a[116:119], a[36:39], v[200:203]
    v_exp_f32 v193, v193
    v_mfma_f32_16x16x32_bf16 v[200:203], a[120:123], a[40:43], v[200:203]
    ds_read_b64_tr_b16 a[144:145], v5 offset:0
    v_add_f32 v237, v237, v192
    v_add_f32 v237, v237, v193
    v_mfma_f32_16x16x32_bf16 v[200:203], a[124:127], a[44:47], v[200:203]
    v_exp_f32 v194, v194
    v_mfma_f32_16x16x32_bf16 v[204:207], a[128:131], a[32:35], v[224:227]
    v_exp_f32 v195, v195
    v_mfma_f32_16x16x32_bf16 v[204:207], a[132:135], a[36:39], v[204:207]
    ds_read_b64_tr_b16 a[146:147], v5 offset:4096
    v_cvt_pk_bf16_f32 v208, v192, v193
    v_mfma_f32_16x16x32_bf16 v[204:207], a[136:139], a[40:43], v[204:207]
    ds_read_b64_tr_b16 a[148:149], v6 offset:0
    v_add_f32 v237, v237, v194
    v_mfma_f32_16x16x32_bf16 v[204:207], a[140:143], a[44:47], v[204:207]
    v_exp_f32 v196, v196
    v_mfma_f32_16x16x32_bf16 v[32:35], a[176:179], v[212:215], v[32:35]
    ds_read_b64_tr_b16 a[150:151], v6 offset:4096
    v_add_f32 v237, v237, v195
    v_cvt_pk_bf16_f32 v209, v194, v195
    v_mfma_f32_16x16x32_bf16 v[36:39], a[180:183], v[212:215], v[36:39]
    v_exp_f32 v197, v197
    v_mfma_f32_16x16x32_bf16 v[40:43], a[184:187], v[212:215], v[40:43]
    v_exp_f32 v198, v198
    v_mfma_f32_16x16x32_bf16 v[44:47], a[188:191], v[212:215], v[44:47]
    v_add_f32 v237, v237, v196
    v_add_f32 v237, v237, v197
    v_mfma_f32_16x16x32_bf16 v[48:51], a[192:195], v[212:215], v[48:51]
    v_exp_f32 v199, v199
    v_mfma_f32_16x16x32_bf16 v[52:55], a[196:199], v[212:215], v[52:55]
    ds_read_b64_tr_b16 a[152:153], v7 offset:0
    v_cvt_pk_bf16_f32 v210, v196, v197
    v_mfma_f32_16x16x32_bf16 v[56:59], a[200:203], v[212:215], v[56:59]
    ds_read_b64_tr_b16 a[154:155], v7 offset:4096
    v_add_f32 v237, v237, v198
    v_mfma_f32_16x16x32_bf16 v[60:63], a[204:207], v[212:215], v[60:63]
    v_add_f32 v237, v237, v199
    v_cvt_pk_bf16_f32 v211, v198, v199
    v_mfma_f32_16x16x32_bf16 v[192:195], a[112:115], a[48:51], v[228:231]
    v_exp_f32 v200, v200
    v_mfma_f32_16x16x32_bf16 v[192:195], a[116:119], a[52:55], v[192:195]
    v_exp_f32 v201, v201
    v_mfma_f32_16x16x32_bf16 v[192:195], a[120:123], a[56:59], v[192:195]
    ds_read_b64_tr_b16 a[156:157], v8 offset:0
    v_add_f32 v238, v238, v200
    v_add_f32 v238, v238, v201
    v_mfma_f32_16x16x32_bf16 v[192:195], a[124:127], a[60:63], v[192:195]
    v_exp_f32 v202, v202
    v_mfma_f32_16x16x32_bf16 v[196:199], a[128:131], a[48:51], v[228:231]
    v_exp_f32 v203, v203
    v_mfma_f32_16x16x32_bf16 v[196:199], a[132:135], a[52:55], v[196:199]
    ds_read_b64_tr_b16 a[158:159], v8 offset:4096
    v_cvt_pk_bf16_f32 v212, v200, v201
    v_mfma_f32_16x16x32_bf16 v[196:199], a[136:139], a[56:59], v[196:199]
    ds_read_b64_tr_b16 a[160:161], v9 offset:0
    v_add_f32 v238, v238, v202
    v_mfma_f32_16x16x32_bf16 v[196:199], a[140:143], a[60:63], v[196:199]
    v_exp_f32 v204, v204
    v_mfma_f32_16x16x32_bf16 v[64:67], a[176:179], v[208:211], v[64:67]
    ds_read_b64_tr_b16 a[162:163], v9 offset:4096
    v_add_f32 v238, v238, v203
    v_cvt_pk_bf16_f32 v213, v202, v203
    v_mfma_f32_16x16x32_bf16 v[68:71], a[180:183], v[208:211], v[68:71]
    v_exp_f32 v205, v205
    v_mfma_f32_16x16x32_bf16 v[72:75], a[184:187], v[208:211], v[72:75]
    v_exp_f32 v206, v206
    v_mfma_f32_16x16x32_bf16 v[76:79], a[188:191], v[208:211], v[76:79]
    v_add_f32 v238, v238, v204
    v_add_f32 v238, v238, v205
    v_mfma_f32_16x16x32_bf16 v[80:83], a[192:195], v[208:211], v[80:83]
    v_exp_f32 v207, v207
    v_mfma_f32_16x16x32_bf16 v[84:87], a[196:199], v[208:211], v[84:87]
    ds_read_b64_tr_b16 a[164:165], v10 offset:0
    v_cvt_pk_bf16_f32 v214, v204, v205
    v_mfma_f32_16x16x32_bf16 v[88:91], a[200:203], v[208:211], v[88:91]
    ds_read_b64_tr_b16 a[166:167], v10 offset:4096
    v_add_f32 v238, v238, v206
    v_mfma_f32_16x16x32_bf16 v[92:95], a[204:207], v[208:211], v[92:95]
    v_add_f32 v238, v238, v207
    v_cvt_pk_bf16_f32 v215, v206, v207
    v_mfma_f32_16x16x32_bf16 v[200:203], a[112:115], a[64:67], v[232:235]
    v_exp_f32 v192, v192
    v_mfma_f32_16x16x32_bf16 v[200:203], a[116:119], a[68:71], v[200:203]
    v_exp_f32 v193, v193
    v_mfma_f32_16x16x32_bf16 v[200:203], a[120:123], a[72:75], v[200:203]
    ds_read_b64_tr_b16 a[168:169], v11 offset:0
    v_add_f32 v239, v239, v192
    v_mfma_f32_16x16x32_bf16 v[200:203], a[124:127], a[76:79], v[200:203]
    v_exp_f32 v194, v194
    v_mfma_f32_16x16x32_bf16 v[204:207], a[128:131], a[64:67], v[232:235]
    ds_read_b64_tr_b16 a[170:171], v11 offset:4096
    v_add_f32 v239, v239, v193
    v_mfma_f32_16x16x32_bf16 v[204:207], a[132:135], a[68:71], v[204:207]
    v_exp_f32 v195, v195
    v_mfma_f32_16x16x32_bf16 v[204:207], a[136:139], a[72:75], v[204:207]
    ds_read_b64_tr_b16 a[172:173], v12 offset:0
    v_cvt_pk_bf16_f32 v208, v192, v193
    v_mfma_f32_16x16x32_bf16 v[204:207], a[140:143], a[76:79], v[204:207]
    v_exp_f32 v196, v196
    v_mfma_f32_16x16x32_bf16 v[96:99], a[176:179], v[212:215], v[96:99]
    ds_read_b64_tr_b16 a[174:175], v12 offset:4096
    v_add_f32 v239, v239, v194
    v_mfma_f32_16x16x32_bf16 v[100:103], a[180:183], v[212:215], v[100:103]
    v_exp_f32 v197, v197
    v_mfma_f32_16x16x32_bf16 v[104:107], a[184:187], v[212:215], v[104:107]
    v_add_f32 v239, v239, v195
    v_cvt_pk_bf16_f32 v209, v194, v195
    v_mfma_f32_16x16x32_bf16 v[108:111], a[188:191], v[212:215], v[108:111]
    v_exp_f32 v198, v198
    v_mfma_f32_16x16x32_bf16 v[112:115], a[192:195], v[212:215], v[112:115]
    v_add_f32 v239, v239, v196
    v_add_f32 v239, v239, v197
    v_mfma_f32_16x16x32_bf16 v[116:119], a[196:199], v[212:215], v[116:119]
    v_exp_f32 v199, v199
    v_mfma_f32_16x16x32_bf16 v[120:123], a[200:203], v[212:215], v[120:123]
    v_cvt_pk_bf16_f32 v210, v196, v197
    v_add_f32 v239, v239, v198
    v_mfma_f32_16x16x32_bf16 v[124:127], a[204:207], v[212:215], v[124:127]
    s_waitcnt lgkmcnt(0)
    v_add_f32 v239, v239, v199
    v_cvt_pk_bf16_f32 v211, v198, v199
    v_mfma_f32_16x16x32_bf16 v[192:195], a[80:83], a[0:3], v[216:219]
    v_exp_f32 v200, v200
    v_mfma_f32_16x16x32_bf16 v[192:195], a[84:87], a[4:7], v[192:195]
    v_exp_f32 v201, v201
    v_mfma_f32_16x16x32_bf16 v[192:195], a[88:91], a[8:11], v[192:195]
    v_add_f32 v240, v240, v200
    v_add_f32 v240, v240, v201
    v_mfma_f32_16x16x32_bf16 v[192:195], a[92:95], a[12:15], v[192:195]
    v_exp_f32 v202, v202
    v_mfma_f32_16x16x32_bf16 v[196:199], a[96:99], a[0:3], v[216:219]
    v_exp_f32 v203, v203
    v_mfma_f32_16x16x32_bf16 v[196:199], a[100:103], a[4:7], v[196:199]
    ds_read_b128 a[112:115], v1 offset:8192
    v_cvt_pk_bf16_f32 v212, v200, v201
    v_mfma_f32_16x16x32_bf16 v[196:199], a[104:107], a[8:11], v[196:199]
    ds_read_b128 a[116:119], v2 offset:8192
    v_add_f32 v240, v240, v202
    v_mfma_f32_16x16x32_bf16 v[196:199], a[108:111], a[12:15], v[196:199]
    v_exp_f32 v204, v204
    v_mfma_f32_16x16x32_bf16 v[128:131], a[176:179], v[208:211], v[128:131]
    v_add_f32 v240, v240, v203
    v_cvt_pk_bf16_f32 v213, v202, v203
    v_mfma_f32_16x16x32_bf16 v[132:135], a[180:183], v[208:211], v[132:135]
    v_exp_f32 v205, v205
    v_mfma_f32_16x16x32_bf16 v[136:139], a[184:187], v[208:211], v[136:139]
    v_exp_f32 v206, v206
    v_mfma_f32_16x16x32_bf16 v[140:143], a[188:191], v[208:211], v[140:143]
    v_add_f32 v240, v240, v204
    v_add_f32 v240, v240, v205
    v_mfma_f32_16x16x32_bf16 v[144:147], a[192:195], v[208:211], v[144:147]
    v_exp_f32 v207, v207
    v_mfma_f32_16x16x32_bf16 v[148:151], a[196:199], v[208:211], v[148:151]
    ds_read_b128 a[120:123], v3 offset:8192
    v_cvt_pk_bf16_f32 v214, v204, v205
    v_mfma_f32_16x16x32_bf16 v[152:155], a[200:203], v[208:211], v[152:155]
    ds_read_b128 a[124:127], v4 offset:8192
    v_add_f32 v240, v240, v206
    v_mfma_f32_16x16x32_bf16 v[156:159], a[204:207], v[208:211], v[156:159]
    v_add_f32 v240, v240, v207
    v_cvt_pk_bf16_f32 v215, v206, v207
    s_sub_u32 s47, s47, 1
    s_cmp_lg_u32 s47, 0
    s_cbranch_scc1 L_loop_a
    s_load_dword s54, s[80:81], s1
    s_mov_b32 s56, 0x40000
    v_mfma_f32_16x16x32_bf16 v[200:203], a[80:83], a[16:19], v[220:223]
    v_exp_f32 v192, v192
    v_mfma_f32_16x16x32_bf16 v[200:203], a[84:87], a[20:23], v[200:203]
    v_exp_f32 v193, v193
    v_mfma_f32_16x16x32_bf16 v[200:203], a[88:91], a[24:27], v[200:203]
    v_add_f32 v236, v236, v192
    v_add_f32 v236, v236, v193
    v_mfma_f32_16x16x32_bf16 v[200:203], a[92:95], a[28:31], v[200:203]
    v_exp_f32 v194, v194
    v_mfma_f32_16x16x32_bf16 v[204:207], a[96:99], a[16:19], v[220:223]
    v_exp_f32 v195, v195
    v_mfma_f32_16x16x32_bf16 v[204:207], a[100:103], a[20:23], v[204:207]
    ds_read_b128 a[128:131], v1 offset:12288
    v_cvt_pk_bf16_f32 v208, v192, v193
    v_mfma_f32_16x16x32_bf16 v[204:207], a[104:107], a[24:27], v[204:207]
    ds_read_b128 a[132:135], v2 offset:12288
    v_add_f32 v236, v236, v194
    v_mfma_f32_16x16x32_bf16 v[204:207], a[108:111], a[28:31], v[204:207]
    v_exp_f32 v196, v196
    v_mfma_f32_16x16x32_bf16 v[160:163], a[176:179], v[212:215], v[160:163]
    v_add_f32 v236, v236, v195
    v_cvt_pk_bf16_f32 v209, v194, v195
    v_mfma_f32_16x16x32_bf16 v[164:167], a[180:183], v[212:215], v[164:167]
    v_exp_f32 v197, v197
    v_mfma_f32_16x16x32_bf16 v[168:171], a[184:187], v[212:215], v[168:171]
    v_exp_f32 v198, v198
    v_mfma_f32_16x16x32_bf16 v[172:175], a[188:191], v[212:215], v[172:175]
    v_add_f32 v236, v236, v196
    v_add_f32 v236, v236, v197
    v_mfma_f32_16x16x32_bf16 v[176:179], a[192:195], v[212:215], v[176:179]
    v_exp_f32 v199, v199
    v_mfma_f32_16x16x32_bf16 v[180:183], a[196:199], v[212:215], v[180:183]
    ds_read_b128 a[136:139], v3 offset:12288
    v_cvt_pk_bf16_f32 v210, v196, v197
    v_mfma_f32_16x16x32_bf16 v[184:187], a[200:203], v[212:215], v[184:187]
    ds_read_b128 a[140:143], v4 offset:12288
    v_add_f32 v236, v236, v198
    v_mfma_f32_16x16x32_bf16 v[188:191], a[204:207], v[212:215], v[188:191]
    v_add_f32 v236, v236, v199
    v_cvt_pk_bf16_f32 v211, v198, v199
    s_movk_i32 s50, 20480
    v_mfma_f32_16x16x32_bf16 v[192:195], a[80:83], a[32:35], v[224:227]
    buffer_store_dwordx4 a[208:211], v19, s[36:39], s50 offen sc1
    v_exp_f32 v200, v200
    v_mfma_f32_16x16x32_bf16 v[192:195], a[84:87], a[36:39], v[192:195]
    v_exp_f32 v201, v201
    v_mfma_f32_16x16x32_bf16 v[192:195], a[88:91], a[40:43], v[192:195]
    ds_read_b64_tr_b16 a[176:177], v5 offset:8192
    v_add_f32 v237, v237, v200
    v_add_f32 v237, v237, v201
    v_mfma_f32_16x16x32_bf16 v[192:195], a[92:95], a[44:47], v[192:195]
    v_exp_f32 v202, v202
    v_mfma_f32_16x16x32_bf16 v[196:199], a[96:99], a[32:35], v[224:227]
    v_exp_f32 v203, v203
    v_mfma_f32_16x16x32_bf16 v[196:199], a[100:103], a[36:39], v[196:199]
    ds_read_b64_tr_b16 a[178:179], v5 offset:12288
    v_cvt_pk_bf16_f32 v212, v200, v201
    v_mfma_f32_16x16x32_bf16 v[196:199], a[104:107], a[40:43], v[196:199]
    ds_read_b64_tr_b16 a[180:181], v6 offset:8192
    v_add_f32 v237, v237, v202
    v_mfma_f32_16x16x32_bf16 v[196:199], a[108:111], a[44:47], v[196:199]
    v_exp_f32 v204, v204
    v_mfma_f32_16x16x32_bf16 v[32:35], a[144:147], v[208:211], v[32:35]
    ds_read_b64_tr_b16 a[182:183], v6 offset:12288
    v_add_f32 v237, v237, v203
    v_cvt_pk_bf16_f32 v213, v202, v203
    v_mfma_f32_16x16x32_bf16 v[36:39], a[148:151], v[208:211], v[36:39]
    v_exp_f32 v205, v205
    v_mfma_f32_16x16x32_bf16 v[40:43], a[152:155], v[208:211], v[40:43]
    v_exp_f32 v206, v206
    v_mfma_f32_16x16x32_bf16 v[44:47], a[156:159], v[208:211], v[44:47]
    v_add_f32 v237, v237, v204
    v_add_f32 v237, v237, v205
    v_mfma_f32_16x16x32_bf16 v[48:51], a[160:163], v[208:211], v[48:51]
    v_exp_f32 v207, v207
    v_mfma_f32_16x16x32_bf16 v[52:55], a[164:167], v[208:211], v[52:55]
    ds_read_b64_tr_b16 a[184:185], v7 offset:8192
    v_cvt_pk_bf16_f32 v214, v204, v205
    v_mfma_f32_16x16x32_bf16 v[56:59], a[168:171], v[208:211], v[56:59]
    ds_read_b64_tr_b16 a[186:187], v7 offset:12288
    v_add_f32 v237, v237, v206
    v_mfma_f32_16x16x32_bf16 v[60:63], a[172:175], v[208:211], v[60:63]
    v_add_f32 v237, v237, v207
    v_cvt_pk_bf16_f32 v215, v206, v207
    s_lshl_b32 s87, s85, 12
    s_add_u32 s86, s60, s87
    v_lshlrev_b32 v254, 2, v19
    v_add_u32 v254, s86, v254
    v_mfma_f32_16x16x32_bf16 v[200:203], a[80:83], a[48:51], v[228:231]
    global_load_dword v251, v254, s[12:13]
    v_exp_f32 v192, v192
    v_mfma_f32_16x16x32_bf16 v[200:203], a[84:87], a[52:55], v[200:203]
    v_exp_f32 v193, v193
    v_mfma_f32_16x16x32_bf16 v[200:203], a[88:91], a[56:59], v[200:203]
    ds_read_b64_tr_b16 a[188:189], v8 offset:8192
    v_add_f32 v238, v238, v192
    v_add_f32 v238, v238, v193
    v_mfma_f32_16x16x32_bf16 v[200:203], a[92:95], a[60:63], v[200:203]
    v_exp_f32 v194, v194
    v_mfma_f32_16x16x32_bf16 v[204:207], a[96:99], a[48:51], v[228:231]
    v_exp_f32 v195, v195
    v_mfma_f32_16x16x32_bf16 v[204:207], a[100:103], a[52:55], v[204:207]
    ds_read_b64_tr_b16 a[190:191], v8 offset:12288
    v_cvt_pk_bf16_f32 v208, v192, v193
    v_mfma_f32_16x16x32_bf16 v[204:207], a[104:107], a[56:59], v[204:207]
    ds_read_b64_tr_b16 a[192:193], v9 offset:8192
    v_add_f32 v238, v238, v194
    v_mfma_f32_16x16x32_bf16 v[204:207], a[108:111], a[60:63], v[204:207]
    v_exp_f32 v196, v196
    v_mfma_f32_16x16x32_bf16 v[64:67], a[144:147], v[212:215], v[64:67]
    ds_read_b64_tr_b16 a[194:195], v9 offset:12288
    v_add_f32 v238, v238, v195
    v_cvt_pk_bf16_f32 v209, v194, v195
    v_mfma_f32_16x16x32_bf16 v[68:71], a[148:151], v[212:215], v[68:71]
    v_exp_f32 v197, v197
    v_mfma_f32_16x16x32_bf16 v[72:75], a[152:155], v[212:215], v[72:75]
    v_exp_f32 v198, v198
    v_mfma_f32_16x16x32_bf16 v[76:79], a[156:159], v[212:215], v[76:79]
    v_add_f32 v238, v238, v196
    v_add_f32 v238, v238, v197
    v_mfma_f32_16x16x32_bf16 v[80:83], a[160:163], v[212:215], v[80:83]
    v_exp_f32 v199, v199
    v_mfma_f32_16x16x32_bf16 v[84:87], a[164:167], v[212:215], v[84:87]
    ds_read_b64_tr_b16 a[196:197], v10 offset:8192
    v_cvt_pk_bf16_f32 v210, v196, v197
    v_mfma_f32_16x16x32_bf16 v[88:91], a[168:171], v[212:215], v[88:91]
    ds_read_b64_tr_b16 a[198:199], v10 offset:12288
    v_add_f32 v238, v238, v198
    v_mfma_f32_16x16x32_bf16 v[92:95], a[172:175], v[212:215], v[92:95]
    v_add_f32 v238, v238, v199
    v_cvt_pk_bf16_f32 v211, v198, v199
    s_movk_i32 s51, 21504
    v_mfma_f32_16x16x32_bf16 v[192:195], a[80:83], a[64:67], v[232:235]
    buffer_store_dwordx4 a[208:211], v19, s[36:39], s51 offen sc1
    v_exp_f32 v200, v200
    v_mfma_f32_16x16x32_bf16 v[192:195], a[84:87], a[68:71], v[192:195]
    v_exp_f32 v201, v201
    v_mfma_f32_16x16x32_bf16 v[192:195], a[88:91], a[72:75], v[192:195]
    ds_read_b64_tr_b16 a[200:201], v11 offset:8192
    v_add_f32 v239, v239, v200
    v_mfma_f32_16x16x32_bf16 v[192:195], a[92:95], a[76:79], v[192:195]
    v_exp_f32 v202, v202
    v_mfma_f32_16x16x32_bf16 v[196:199], a[96:99], a[64:67], v[232:235]
    ds_read_b64_tr_b16 a[202:203], v11 offset:12288
    v_add_f32 v239, v239, v201
    v_mfma_f32_16x16x32_bf16 v[196:199], a[100:103], a[68:71], v[196:199]
    v_exp_f32 v203, v203
    v_mfma_f32_16x16x32_bf16 v[196:199], a[104:107], a[72:75], v[196:199]
    ds_read_b64_tr_b16 a[204:205], v12 offset:8192
    v_cvt_pk_bf16_f32 v212, v200, v201
    v_mfma_f32_16x16x32_bf16 v[196:199], a[108:111], a[76:79], v[196:199]
    v_exp_f32 v204, v204
    v_mfma_f32_16x16x32_bf16 v[96:99], a[144:147], v[208:211], v[96:99]
    ds_read_b64_tr_b16 a[206:207], v12 offset:12288
    v_add_f32 v239, v239, v202
    v_mfma_f32_16x16x32_bf16 v[100:103], a[148:151], v[208:211], v[100:103]
    v_exp_f32 v205, v205
    v_mfma_f32_16x16x32_bf16 v[104:107], a[152:155], v[208:211], v[104:107]
    v_add_f32 v239, v239, v203
    v_cvt_pk_bf16_f32 v213, v202, v203
    v_mfma_f32_16x16x32_bf16 v[108:111], a[156:159], v[208:211], v[108:111]
    v_exp_f32 v206, v206
    v_mfma_f32_16x16x32_bf16 v[112:115], a[160:163], v[208:211], v[112:115]
    v_add_f32 v239, v239, v204
    v_add_f32 v239, v239, v205
    v_mfma_f32_16x16x32_bf16 v[116:119], a[164:167], v[208:211], v[116:119]
    v_exp_f32 v207, v207
    v_mfma_f32_16x16x32_bf16 v[120:123], a[168:171], v[208:211], v[120:123]
    s_waitcnt vmcnt(19) lgkmcnt(0)
    v_cvt_pk_bf16_f32 v214, v204, v205
    v_add_f32 v239, v239, v206
    v_mfma_f32_16x16x32_bf16 v[124:127], a[172:175], v[208:211], v[124:127]
    s_barrier
    v_add_f32 v239, v239, v207
    v_cvt_pk_bf16_f32 v215, v206, v207
    v_mfma_f32_16x16x32_bf16 v[200:203], a[112:115], a[0:3], v[216:219]
    v_exp_f32 v192, v192
    v_mfma_f32_16x16x32_bf16 v[200:203], a[116:119], a[4:7], v[200:203]
    v_exp_f32 v193, v193
    v_mfma_f32_16x16x32_bf16 v[200:203], a[120:123], a[8:11], v[200:203]
    v_add_f32 v240, v240, v192
    v_add_f32 v240, v240, v193
    v_mfma_f32_16x16x32_bf16 v[200:203], a[124:127], a[12:15], v[200:203]
    v_exp_f32 v194, v194
    v_mfma_f32_16x16x32_bf16 v[204:207], a[128:131], a[0:3], v[216:219]
    v_exp_f32 v195, v195
    v_mfma_f32_16x16x32_bf16 v[204:207], a[132:135], a[4:7], v[204:207]
    ds_read_b128 a[80:83], v1 offset:16384
    v_cvt_pk_bf16_f32 v208, v192, v193
    v_mfma_f32_16x16x32_bf16 v[204:207], a[136:139], a[8:11], v[204:207]
    ds_read_b128 a[84:87], v2 offset:16384
    v_add_f32 v240, v240, v194
    v_mfma_f32_16x16x32_bf16 v[204:207], a[140:143], a[12:15], v[204:207]
    v_exp_f32 v196, v196
    v_mfma_f32_16x16x32_bf16 v[128:131], a[144:147], v[212:215], v[128:131]
    v_add_f32 v240, v240, v195
    v_cvt_pk_bf16_f32 v209, v194, v195
    v_mfma_f32_16x16x32_bf16 v[132:135], a[148:151], v[212:215], v[132:135]
    v_exp_f32 v197, v197
    v_mfma_f32_16x16x32_bf16 v[136:139], a[152:155], v[212:215], v[136:139]
    v_exp_f32 v198, v198
    v_mfma_f32_16x16x32_bf16 v[140:143], a[156:159], v[212:215], v[140:143]
    v_add_f32 v240, v240, v196
    v_add_f32 v240, v240, v197
    v_mfma_f32_16x16x32_bf16 v[144:147], a[160:163], v[212:215], v[144:147]
    v_exp_f32 v199, v199
    v_mfma_f32_16x16x32_bf16 v[148:151], a[164:167], v[212:215], v[148:151]
    ds_read_b128 a[88:91], v3 offset:16384
    v_cvt_pk_bf16_f32 v210, v196, v197
    v_mfma_f32_16x16x32_bf16 v[152:155], a[168:171], v[212:215], v[152:155]
    ds_read_b128 a[92:95], v4 offset:16384
    v_add_f32 v240, v240, v198
    v_mfma_f32_16x16x32_bf16 v[156:159], a[172:175], v[212:215], v[156:159]
    v_add_f32 v240, v240, v199
    v_cvt_pk_bf16_f32 v211, v198, v199
    s_movk_i32 s50, 22528
    v_mfma_f32_16x16x32_bf16 v[192:195], a[112:115], a[16:19], v[220:223]
    buffer_store_dwordx4 a[208:211], v19, s[36:39], s50 offen sc1
    v_exp_f32 v200, v200
    v_mfma_f32_16x16x32_bf16 v[192:195], a[116:119], a[20:23], v[192:195]
    v_exp_f32 v201, v201
    v_mfma_f32_16x16x32_bf16 v[192:195], a[120:123], a[24:27], v[192:195]
    v_add_f32 v236, v236, v200
    v_add_f32 v236, v236, v201
    v_mfma_f32_16x16x32_bf16 v[192:195], a[124:127], a[28:31], v[192:195]
    v_exp_f32 v202, v202
    v_mfma_f32_16x16x32_bf16 v[196:199], a[128:131], a[16:19], v[220:223]
    v_exp_f32 v203, v203
    v_mfma_f32_16x16x32_bf16 v[196:199], a[132:135], a[20:23], v[196:199]
    ds_read_b128 a[96:99], v1 offset:20480
    v_cvt_pk_bf16_f32 v212, v200, v201
    v_mfma_f32_16x16x32_bf16 v[196:199], a[136:139], a[24:27], v[196:199]
    ds_read_b128 a[100:103], v2 offset:20480
    v_add_f32 v236, v236, v202
    v_mfma_f32_16x16x32_bf16 v[196:199], a[140:143], a[28:31], v[196:199]
    v_exp_f32 v204, v204
    v_mfma_f32_16x16x32_bf16 v[160:163], a[144:147], v[208:211], v[160:163]
    v_add_f32 v236, v236, v203
    v_cvt_pk_bf16_f32 v213, v202, v203
    v_mfma_f32_16x16x32_bf16 v[164:167], a[148:151], v[208:211], v[164:167]
    v_exp_f32 v205, v205
    v_mfma_f32_16x16x32_bf16 v[168:171], a[152:155], v[208:211], v[168:171]
    v_exp_f32 v206, v206
    v_mfma_f32_16x16x32_bf16 v[172:175], a[156:159], v[208:211], v[172:175]
    v_add_f32 v236, v236, v204
    v_add_f32 v236, v236, v205
    v_mfma_f32_16x16x32_bf16 v[176:179], a[160:163], v[208:211], v[176:179]
    v_exp_f32 v207, v207
    v_mfma_f32_16x16x32_bf16 v[180:183], a[164:167], v[208:211], v[180:183]
    ds_read_b128 a[104:107], v3 offset:20480
    v_cvt_pk_bf16_f32 v214, v204, v205
    v_mfma_f32_16x16x32_bf16 v[184:187], a[168:171], v[208:211], v[184:187]
    ds_read_b128 a[108:111], v4 offset:20480
    v_add_f32 v236, v236, v206
    v_mfma_f32_16x16x32_bf16 v[188:191], a[172:175], v[208:211], v[188:191]
    v_add_f32 v236, v236, v207
    v_cvt_pk_bf16_f32 v215, v206, v207
    v_mfma_f32_16x16x32_bf16 v[200:203], a[112:115], a[32:35], v[224:227]
    v_exp_f32 v192, v192
    v_mfma_f32_16x16x32_bf16 v[200:203], a[116:119], a[36:39], v[200:203]
    v_exp_f32 v193, v193
    v_mfma_f32_16x16x32_bf16 v[200:203], a[120:123], a[40:43], v[200:203]
    ds_read_b64_tr_b16 a[144:145], v5 offset:16384
    v_add_f32 v237, v237, v192
    v_add_f32 v237, v237, v193
    v_mfma_f32_16x16x32_bf16 v[200:203], a[124:127], a[44:47], v[200:203]
    v_exp_f32 v194, v194
    v_mfma_f32_16x16x32_bf16 v[204:207], a[128:131], a[32:35], v[224:227]
    v_exp_f32 v195, v195
    v_mfma_f32_16x16x32_bf16 v[204:207], a[132:135], a[36:39], v[204:207]
    ds_read_b64_tr_b16 a[146:147], v5 offset:20480
    v_cvt_pk_bf16_f32 v208, v192, v193
    v_mfma_f32_16x16x32_bf16 v[204:207], a[136:139], a[40:43], v[204:207]
    ds_read_b64_tr_b16 a[148:149], v6 offset:16384
    v_add_f32 v237, v237, v194
    v_mfma_f32_16x16x32_bf16 v[204:207], a[140:143], a[44:47], v[204:207]
    v_exp_f32 v196, v196
    v_mfma_f32_16x16x32_bf16 v[32:35], a[176:179], v[212:215], v[32:35]
    ds_read_b64_tr_b16 a[150:151], v6 offset:20480
    v_add_f32 v237, v237, v195
    v_cvt_pk_bf16_f32 v209, v194, v195
    v_mfma_f32_16x16x32_bf16 v[36:39], a[180:183], v[212:215], v[36:39]
    v_exp_f32 v197, v197
    v_mfma_f32_16x16x32_bf16 v[40:43], a[184:187], v[212:215], v[40:43]
    v_exp_f32 v198, v198
    v_mfma_f32_16x16x32_bf16 v[44:47], a[188:191], v[212:215], v[44:47]
    v_add_f32 v237, v237, v196
    v_add_f32 v237, v237, v197
    v_mfma_f32_16x16x32_bf16 v[48:51], a[192:195], v[212:215], v[48:51]
    v_exp_f32 v199, v199
    v_mfma_f32_16x16x32_bf16 v[52:55], a[196:199], v[212:215], v[52:55]
    ds_read_b64_tr_b16 a[152:153], v7 offset:16384
    v_cvt_pk_bf16_f32 v210, v196, v197
    v_mfma_f32_16x16x32_bf16 v[56:59], a[200:203], v[212:215], v[56:59]
    ds_read_b64_tr_b16 a[154:155], v7 offset:20480
    v_add_f32 v237, v237, v198
    v_mfma_f32_16x16x32_bf16 v[60:63], a[204:207], v[212:215], v[60:63]
    v_add_f32 v237, v237, v199
    v_cvt_pk_bf16_f32 v211, v198, v199
    s_movk_i32 s51, 23552
    v_mfma_f32_16x16x32_bf16 v[192:195], a[112:115], a[48:51], v[228:231]
    buffer_store_dwordx4 a[208:211], v19, s[36:39], s51 offen sc1
    v_exp_f32 v200, v200
    v_mfma_f32_16x16x32_bf16 v[192:195], a[116:119], a[52:55], v[192:195]
    v_exp_f32 v201, v201
    v_mfma_f32_16x16x32_bf16 v[192:195], a[120:123], a[56:59], v[192:195]
    ds_read_b64_tr_b16 a[156:157], v8 offset:16384
    v_add_f32 v238, v238, v200
    v_add_f32 v238, v238, v201
    v_mfma_f32_16x16x32_bf16 v[192:195], a[124:127], a[60:63], v[192:195]
    v_exp_f32 v202, v202
    v_mfma_f32_16x16x32_bf16 v[196:199], a[128:131], a[48:51], v[228:231]
    v_exp_f32 v203, v203
    v_mfma_f32_16x16x32_bf16 v[196:199], a[132:135], a[52:55], v[196:199]
    ds_read_b64_tr_b16 a[158:159], v8 offset:20480
    v_cvt_pk_bf16_f32 v212, v200, v201
    v_mfma_f32_16x16x32_bf16 v[196:199], a[136:139], a[56:59], v[196:199]
    ds_read_b64_tr_b16 a[160:161], v9 offset:16384
    v_add_f32 v238, v238, v202
    v_mfma_f32_16x16x32_bf16 v[196:199], a[140:143], a[60:63], v[196:199]
    v_exp_f32 v204, v204
    v_mfma_f32_16x16x32_bf16 v[64:67], a[176:179], v[208:211], v[64:67]
    ds_read_b64_tr_b16 a[162:163], v9 offset:20480
    v_add_f32 v238, v238, v203
    v_cvt_pk_bf16_f32 v213, v202, v203
    v_mfma_f32_16x16x32_bf16 v[68:71], a[180:183], v[208:211], v[68:71]
    v_exp_f32 v205, v205
    v_mfma_f32_16x16x32_bf16 v[72:75], a[184:187], v[208:211], v[72:75]
    v_exp_f32 v206, v206
    v_mfma_f32_16x16x32_bf16 v[76:79], a[188:191], v[208:211], v[76:79]
    v_add_f32 v238, v238, v204
    v_add_f32 v238, v238, v205
    v_mfma_f32_16x16x32_bf16 v[80:83], a[192:195], v[208:211], v[80:83]
    v_exp_f32 v207, v207
    v_mfma_f32_16x16x32_bf16 v[84:87], a[196:199], v[208:211], v[84:87]
    ds_read_b64_tr_b16 a[164:165], v10 offset:16384
    v_cvt_pk_bf16_f32 v214, v204, v205
    v_mfma_f32_16x16x32_bf16 v[88:91], a[200:203], v[208:211], v[88:91]
    ds_read_b64_tr_b16 a[166:167], v10 offset:20480
    v_add_f32 v238, v238, v206
    v_mfma_f32_16x16x32_bf16 v[92:95], a[204:207], v[208:211], v[92:95]
    v_add_f32 v238, v238, v207
    v_cvt_pk_bf16_f32 v215, v206, v207
    v_mfma_f32_16x16x32_bf16 v[200:203], a[112:115], a[64:67], v[232:235]
    s_add_u32 m0, s63, 0
    v_exp_f32 v192, v192
    v_mfma_f32_16x16x32_bf16 v[200:203], a[116:119], a[68:71], v[200:203]
    s_xor_b32 s61, s3, 0
    v_exp_f32 v193, v193
    v_mfma_f32_16x16x32_bf16 v[200:203], a[120:123], a[72:75], v[200:203]
    ds_read_b64_tr_b16 a[168:169], v11 offset:16384
    v_add_f32 v239, v239, v192
    v_mfma_f32_16x16x32_bf16 v[200:203], a[124:127], a[76:79], v[200:203]
    buffer_load_dwordx4 v241, s[64:67], s61 offen offset:0 lds
    v_exp_f32 v194, v194
    v_mfma_f32_16x16x32_bf16 v[204:207], a[128:131], a[64:67], v[232:235]
    ds_read_b64_tr_b16 a[170:171], v11 offset:20480
    v_add_f32 v239, v239, v193
    v_mfma_f32_16x16x32_bf16 v[204:207], a[132:135], a[68:71], v[204:207]
    buffer_load_dwordx4 v242, s[64:67], s61 offen offset:1024 lds
    v_exp_f32 v195, v195
    v_mfma_f32_16x16x32_bf16 v[204:207], a[136:139], a[72:75], v[204:207]
    ds_read_b64_tr_b16 a[172:173], v12 offset:16384
    v_cvt_pk_bf16_f32 v208, v192, v193
    v_mfma_f32_16x16x32_bf16 v[204:207], a[140:143], a[76:79], v[204:207]
    v_exp_f32 v196, v196
    v_mfma_f32_16x16x32_bf16 v[96:99], a[176:179], v[212:215], v[96:99]
    ds_read_b64_tr_b16 a[174:175], v12 offset:20480
    v_add_f32 v239, v239, v194
    v_mfma_f32_16x16x32_bf16 v[100:103], a[180:183], v[212:215], v[100:103]
    v_exp_f32 v197, v197
    v_mfma_f32_16x16x32_bf16 v[104:107], a[184:187], v[212:215], v[104:107]
    v_add_f32 v239, v239, v195
    v_cvt_pk_bf16_f32 v209, v194, v195
    v_mfma_f32_16x16x32_bf16 v[108:111], a[188:191], v[212:215], v[108:111]
    v_exp_f32 v198, v198
    v_mfma_f32_16x16x32_bf16 v[112:115], a[192:195], v[212:215], v[112:115]
    v_add_f32 v239, v239, v196
    v_add_f32 v239, v239, v197
    v_mfma_f32_16x16x32_bf16 v[116:119], a[196:199], v[212:215], v[116:119]
    v_exp_f32 v199, v199
    v_mfma_f32_16x16x32_bf16 v[120:123], a[200:203], v[212:215], v[120:123]
    v_cvt_pk_bf16_f32 v210, v196, v197
    v_add_f32 v239, v239, v198
    v_mfma_f32_16x16x32_bf16 v[124:127], a[204:207], v[212:215], v[124:127]
    s_waitcnt lgkmcnt(0)
    v_add_f32 v239, v239, v199
    v_cvt_pk_bf16_f32 v211, v198, v199
    s_movk_i32 s50, 24576
    v_add_u32 v254, 0x20000, v254
    v_mfma_f32_16x16x32_bf16 v[192:195], a[80:83], a[0:3], v[216:219]
    buffer_load_dwordx4 v243, s[64:67], s61 offen offset:2048 lds
    v_exp_f32 v200, v200
    v_mfma_f32_16x16x32_bf16 v[192:195], a[84:87], a[4:7], v[192:195]
    buffer_load_dwordx4 v244, s[64:67], s61 offen offset:3072 lds
    v_exp_f32 v201, v201
    v_mfma_f32_16x16x32_bf16 v[192:195], a[88:91], a[8:11], v[192:195]
    buffer_store_dwordx4 a[208:211], v19, s[36:39], s50 offen sc1
    v_add_f32 v240, v240, v200
    v_add_f32 v240, v240, v201
    v_mfma_f32_16x16x32_bf16 v[192:195], a[92:95], a[12:15], v[192:195]
    global_load_dword v251, v254, s[12:13]
    v_exp_f32 v202, v202
    v_mfma_f32_16x16x32_bf16 v[196:199], a[96:99], a[0:3], v[216:219]
    v_exp_f32 v203, v203
    v_mfma_f32_16x16x32_bf16 v[196:199], a[100:103], a[4:7], v[196:199]
    ds_read_b128 a[112:115], v1 offset:24576
    v_cvt_pk_bf16_f32 v212, v200, v201
    v_mfma_f32_16x16x32_bf16 v[196:199], a[104:107], a[8:11], v[196:199]
    ds_read_b128 a[116:119], v2 offset:24576
    v_add_f32 v240, v240, v202
    v_mfma_f32_16x16x32_bf16 v[196:199], a[108:111], a[12:15], v[196:199]
    v_exp_f32 v204, v204
    v_mfma_f32_16x16x32_bf16 v[128:131], a[176:179], v[208:211], v[128:131]
    v_add_f32 v240, v240, v203
    v_cvt_pk_bf16_f32 v213, v202, v203
    v_mfma_f32_16x16x32_bf16 v[132:135], a[180:183], v[208:211], v[132:135]
    v_exp_f32 v205, v205
    v_mfma_f32_16x16x32_bf16 v[136:139], a[184:187], v[208:211], v[136:139]
    v_exp_f32 v206, v206
    v_mfma_f32_16x16x32_bf16 v[140:143], a[188:191], v[208:211], v[140:143]
    v_add_f32 v240, v240, v204
    v_add_f32 v240, v240, v205
    v_mfma_f32_16x16x32_bf16 v[144:147], a[192:195], v[208:211], v[144:147]
    v_exp_f32 v207, v207
    v_mfma_f32_16x16x32_bf16 v[148:151], a[196:199], v[208:211], v[148:151]
    ds_read_b128 a[120:123], v3 offset:24576
    v_cvt_pk_bf16_f32 v214, v204, v205
    v_mfma_f32_16x16x32_bf16 v[152:155], a[200:203], v[208:211], v[152:155]
    ds_read_b128 a[124:127], v4 offset:24576
    v_add_f32 v240, v240, v206
    v_mfma_f32_16x16x32_bf16 v[156:159], a[204:207], v[208:211], v[156:159]
    v_add_f32 v240, v240, v207
    v_cvt_pk_bf16_f32 v215, v206, v207
    v_mfma_f32_16x16x32_bf16 v[200:203], a[80:83], a[16:19], v[220:223]
    s_add_u32 m0, s63, 4096
    v_exp_f32 v192, v192
    v_mfma_f32_16x16x32_bf16 v[200:203], a[84:87], a[20:23], v[200:203]
    s_xor_b32 s61, s3, 128
    v_exp_f32 v193, v193
    v_mfma_f32_16x16x32_bf16 v[200:203], a[88:91], a[24:27], v[200:203]
    buffer_load_dwordx4 v241, s[64:67], s61 offen offset:0 lds
    v_add_f32 v236, v236, v192
    v_add_f32 v236, v236, v193
    v_mfma_f32_16x16x32_bf16 v[200:203], a[92:95], a[28:31], v[200:203]
    buffer_load_dwordx4 v242, s[64:67], s61 offen offset:1024 lds
    v_exp_f32 v194, v194
    v_mfma_f32_16x16x32_bf16 v[204:207], a[96:99], a[16:19], v[220:223]
    v_exp_f32 v195, v195
    v_mfma_f32_16x16x32_bf16 v[204:207], a[100:103], a[20:23], v[204:207]
    ds_read_b128 a[128:131], v1 offset:28672
    v_cvt_pk_bf16_f32 v208, v192, v193
    v_mfma_f32_16x16x32_bf16 v[204:207], a[104:107], a[24:27], v[204:207]
    ds_read_b128 a[132:135], v2 offset:28672
    v_add_f32 v236, v236, v194
    v_mfma_f32_16x16x32_bf16 v[204:207], a[108:111], a[28:31], v[204:207]
    v_exp_f32 v196, v196
    v_mfma_f32_16x16x32_bf16 v[160:163], a[176:179], v[212:215], v[160:163]
    v_add_f32 v236, v236, v195
    v_cvt_pk_bf16_f32 v209, v194, v195
    v_mfma_f32_16x16x32_bf16 v[164:167], a[180:183], v[212:215], v[164:167]
    v_exp_f32 v197, v197
    v_mfma_f32_16x16x32_bf16 v[168:171], a[184:187], v[212:215], v[168:171]
    v_exp_f32 v198, v198
    v_mfma_f32_16x16x32_bf16 v[172:175], a[188:191], v[212:215], v[172:175]
    v_add_f32 v236, v236, v196
    v_add_f32 v236, v236, v197
    v_mfma_f32_16x16x32_bf16 v[176:179], a[192:195], v[212:215], v[176:179]
    v_exp_f32 v199, v199
    v_mfma_f32_16x16x32_bf16 v[180:183], a[196:199], v[212:215], v[180:183]
    ds_read_b128 a[136:139], v3 offset:28672
    v_cvt_pk_bf16_f32 v210, v196, v197
    v_mfma_f32_16x16x32_bf16 v[184:187], a[200:203], v[212:215], v[184:187]
    ds_read_b128 a[140:143], v4 offset:28672
    v_add_f32 v236, v236, v198
    v_mfma_f32_16x16x32_bf16 v[188:191], a[204:207], v[212:215], v[188:191]
    v_add_f32 v236, v236, v199
    v_cvt_pk_bf16_f32 v211, v198, v199
    v_mfma_f32_16x16x32_bf16 v[192:195], a[80:83], a[32:35], v[224:227]
    buffer_load_dwordx4 v243, s[64:67], s61 offen offset:2048 lds
    v_exp_f32 v200, v200
    v_mfma_f32_16x16x32_bf16 v[192:195], a[84:87], a[36:39], v[192:195]
    buffer_load_dwordx4 v244, s[64:67], s61 offen offset:3072 lds
    v_exp_f32 v201, v201
    v_mfma_f32_16x16x32_bf16 v[192:195], a[88:91], a[40:43], v[192:195]
    ds_read_b64_tr_b16 a[176:177], v5 offset:24576
    v_add_f32 v237, v237, v200
    v_add_f32 v237, v237, v201
    v_mfma_f32_16x16x32_bf16 v[192:195], a[92:95], a[44:47], v[192:195]
    v_exp_f32 v202, v202
    v_mfma_f32_16x16x32_bf16 v[196:199], a[96:99], a[32:35], v[224:227]
    v_exp_f32 v203, v203
    v_mfma_f32_16x16x32_bf16 v[196:199], a[100:103], a[36:39], v[196:199]
    ds_read_b64_tr_b16 a[178:179], v5 offset:28672
    v_cvt_pk_bf16_f32 v212, v200, v201
    v_mfma_f32_16x16x32_bf16 v[196:199], a[104:107], a[40:43], v[196:199]
    ds_read_b64_tr_b16 a[180:181], v6 offset:24576
    v_add_f32 v237, v237, v202
    v_mfma_f32_16x16x32_bf16 v[196:199], a[108:111], a[44:47], v[196:199]
    v_exp_f32 v204, v204
    v_mfma_f32_16x16x32_bf16 v[32:35], a[144:147], v[208:211], v[32:35]
    ds_read_b64_tr_b16 a[182:183], v6 offset:28672
    v_add_f32 v237, v237, v203
    v_cvt_pk_bf16_f32 v213, v202, v203
    v_mfma_f32_16x16x32_bf16 v[36:39], a[148:151], v[208:211], v[36:39]
    v_exp_f32 v205, v205
    v_mfma_f32_16x16x32_bf16 v[40:43], a[152:155], v[208:211], v[40:43]
    v_exp_f32 v206, v206
    v_mfma_f32_16x16x32_bf16 v[44:47], a[156:159], v[208:211], v[44:47]
    v_add_f32 v237, v237, v204
    v_add_f32 v237, v237, v205
    v_mfma_f32_16x16x32_bf16 v[48:51], a[160:163], v[208:211], v[48:51]
    v_exp_f32 v207, v207
    v_mfma_f32_16x16x32_bf16 v[52:55], a[164:167], v[208:211], v[52:55]
    ds_read_b64_tr_b16 a[184:185], v7 offset:24576
    v_cvt_pk_bf16_f32 v214, v204, v205
    v_mfma_f32_16x16x32_bf16 v[56:59], a[168:171], v[208:211], v[56:59]
    ds_read_b64_tr_b16 a[186:187], v7 offset:28672
    v_add_f32 v237, v237, v206
    v_mfma_f32_16x16x32_bf16 v[60:63], a[172:175], v[208:211], v[60:63]
    v_add_f32 v237, v237, v207
    v_cvt_pk_bf16_f32 v215, v206, v207
    s_waitcnt vmcnt(6)
    v_mfma_f32_16x16x32_bf16 v[200:203], a[80:83], a[48:51], v[228:231]
    s_add_u32 m0, s45, 0
    v_exp_f32 v192, v192
    v_mfma_f32_16x16x32_bf16 v[200:203], a[84:87], a[52:55], v[200:203]
    s_xor_b32 s61, s3, 32768
    v_exp_f32 v193, v193
    v_mfma_f32_16x16x32_bf16 v[200:203], a[88:91], a[56:59], v[200:203]
    ds_read_b64_tr_b16 a[188:189], v8 offset:24576
    v_add_f32 v238, v238, v192
    v_add_f32 v238, v238, v193
    v_mfma_f32_16x16x32_bf16 v[200:203], a[92:95], a[60:63], v[200:203]
    buffer_load_dwordx4 v241, s[64:67], s61 offen offset:0 lds
    v_exp_f32 v194, v194
    v_mfma_f32_16x16x32_bf16 v[204:207], a[96:99], a[48:51], v[228:231]
    buffer_load_dwordx4 v242, s[64:67], s61 offen offset:1024 lds
    v_exp_f32 v195, v195
    v_mfma_f32_16x16x32_bf16 v[204:207], a[100:103], a[52:55], v[204:207]
    ds_read_b64_tr_b16 a[190:191], v8 offset:28672
    ds_read_b64_tr_b16 a[192:193], v9 offset:24576
    v_cvt_pk_bf16_f32 v208, v192, v193
    v_mfma_f32_16x16x32_bf16 v[204:207], a[104:107], a[56:59], v[204:207]
    ds_read_b64_tr_b16 a[194:195], v9 offset:28672
    ds_read_b64_tr_b16 a[196:197], v10 offset:24576
    v_add_f32 v238, v238, v194
    v_mfma_f32_16x16x32_bf16 v[204:207], a[108:111], a[60:63], v[204:207]
    v_exp_f32 v196, v196
    v_mfma_f32_16x16x32_bf16 v[64:67], a[144:147], v[212:215], v[64:67]
    ds_read_b64_tr_b16 a[198:199], v10 offset:28672
    v_add_f32 v238, v238, v195
    v_cvt_pk_bf16_f32 v209, v194, v195
    v_mfma_f32_16x16x32_bf16 v[68:71], a[148:151], v[212:215], v[68:71]
    v_exp_f32 v197, v197
    v_mfma_f32_16x16x32_bf16 v[72:75], a[152:155], v[212:215], v[72:75]
    v_exp_f32 v198, v198
    v_mfma_f32_16x16x32_bf16 v[76:79], a[156:159], v[212:215], v[76:79]
    ds_read_b64_tr_b16 a[208:209], v28 offset:0
    v_add_f32 v238, v238, v196
    v_add_f32 v238, v238, v197
    v_mfma_f32_16x16x32_bf16 v[80:83], a[160:163], v[212:215], v[80:83]
    v_exp_f32 v199, v199
    v_mfma_f32_16x16x32_bf16 v[84:87], a[164:167], v[212:215], v[84:87]
    ds_read_b64_tr_b16 a[210:211], v28 offset:2048
    v_cvt_pk_bf16_f32 v210, v196, v197
    v_mfma_f32_16x16x32_bf16 v[88:91], a[168:171], v[212:215], v[88:91]
    ds_read_b64_tr_b16 a[212:213], v29 offset:0
    v_add_f32 v238, v238, v198
    v_mfma_f32_16x16x32_bf16 v[92:95], a[172:175], v[212:215], v[92:95]
    ds_read_b64_tr_b16 a[214:215], v29 offset:2048
    v_add_f32 v238, v238, v199
    v_cvt_pk_bf16_f32 v211, v198, v199
    v_mfma_f32_16x16x32_bf16 v[192:195], a[80:83], a[64:67], v[232:235]
    buffer_load_dwordx4 v243, s[64:67], s61 offen offset:2048 lds
    v_exp_f32 v200, v200
    v_mfma_f32_16x16x32_bf16 v[192:195], a[84:87], a[68:71], v[192:195]
    buffer_load_dwordx4 v244, s[64:67], s61 offen offset:3072 lds
    v_exp_f32 v201, v201
    v_mfma_f32_16x16x32_bf16 v[192:195], a[88:91], a[72:75], v[192:195]
    ds_read_b64_tr_b16 a[200:201], v11 offset:24576
    ds_read_b64_tr_b16 a[202:203], v11 offset:28672
    v_add_f32 v239, v239, v200
    v_mfma_f32_16x16x32_bf16 v[192:195], a[92:95], a[76:79], v[192:195]
    v_exp_f32 v202, v202
    v_mfma_f32_16x16x32_bf16 v[196:199], a[96:99], a[64:67], v[232:235]
    ds_read_b64_tr_b16 a[204:205], v12 offset:24576
    ds_read_b64_tr_b16 a[206:207], v12 offset:28672
    v_add_f32 v239, v239, v201
    v_mfma_f32_16x16x32_bf16 v[196:199], a[100:103], a[68:71], v[196:199]
    v_exp_f32 v203, v203
    v_mfma_f32_16x16x32_bf16 v[196:199], a[104:107], a[72:75], v[196:199]
    ds_read_b64_tr_b16 a[216:217], v30 offset:0
    ds_read_b64_tr_b16 a[218:219], v30 offset:2048
    v_cvt_pk_bf16_f32 v212, v200, v201
    v_mfma_f32_16x16x32_bf16 v[196:199], a[108:111], a[76:79], v[196:199]
    v_exp_f32 v204, v204
    v_mfma_f32_16x16x32_bf16 v[96:99], a[144:147], v[208:211], v[96:99]
    ds_read_b64_tr_b16 a[220:221], v31 offset:0
    ds_read_b64_tr_b16 a[222:223], v31 offset:2048
    v_add_f32 v239, v239, v202
    v_mfma_f32_16x16x32_bf16 v[100:103], a[148:151], v[208:211], v[100:103]
    v_exp_f32 v205, v205
    v_mfma_f32_16x16x32_bf16 v[104:107], a[152:155], v[208:211], v[104:107]
    v_add_f32 v239, v239, v203
    v_cvt_pk_bf16_f32 v213, v202, v203
    v_mfma_f32_16x16x32_bf16 v[108:111], a[156:159], v[208:211], v[108:111]
    v_exp_f32 v206, v206
    v_mfma_f32_16x16x32_bf16 v[112:115], a[160:163], v[208:211], v[112:115]
    v_add_f32 v239, v239, v204
    v_add_f32 v239, v239, v205
    v_mfma_f32_16x16x32_bf16 v[116:119], a[164:167], v[208:211], v[116:119]
    v_exp_f32 v207, v207
    v_mfma_f32_16x16x32_bf16 v[120:123], a[168:171], v[208:211], v[120:123]
    s_waitcnt vmcnt(27) lgkmcnt(0)
    v_cvt_pk_bf16_f32 v214, v204, v205
    v_add_f32 v239, v239, v206
    v_mfma_f32_16x16x32_bf16 v[124:127], a[172:175], v[208:211], v[124:127]
    s_barrier
    v_add_f32 v239, v239, v207
    v_cvt_pk_bf16_f32 v215, v206, v207
    s_waitcnt vmcnt(4)
    v_mfma_f32_16x16x32_bf16 v[200:203], a[112:115], a[0:3], v[216:219]
    s_add_u32 m0, s45, 65536
    v_exp_f32 v192, v192
    v_mfma_f32_16x16x32_bf16 v[200:203], a[116:119], a[4:7], v[200:203]
    s_xor_b32 s61, s3, 32896
    v_exp_f32 v193, v193
    v_mfma_f32_16x16x32_bf16 v[200:203], a[120:123], a[8:11], v[200:203]
    ds_read_b128 a[80:83], v1 offset:32768
    v_add_f32 v240, v240, v192
    v_add_f32 v240, v240, v193
    v_mfma_f32_16x16x32_bf16 v[200:203], a[124:127], a[12:15], v[200:203]
    buffer_load_dwordx4 v241, s[64:67], s61 offen offset:0 lds
    v_exp_f32 v194, v194
    v_mfma_f32_16x16x32_bf16 v[204:207], a[128:131], a[0:3], v[216:219]
    buffer_load_dwordx4 v242, s[64:67], s61 offen offset:1024 lds
    v_exp_f32 v195, v195
    v_mfma_f32_16x16x32_bf16 v[204:207], a[132:135], a[4:7], v[204:207]
    ds_read_b128 a[84:87], v2 offset:32768
    v_cvt_pk_bf16_f32 v208, v192, v193
    v_mfma_f32_16x16x32_bf16 v[204:207], a[136:139], a[8:11], v[204:207]
    ds_read_b128 a[88:91], v3 offset:32768
    v_add_f32 v240, v240, v194
    v_mfma_f32_16x16x32_bf16 v[204:207], a[140:143], a[12:15], v[204:207]
    v_exp_f32 v196, v196
    v_mfma_f32_16x16x32_bf16 v[128:131], a[144:147], v[212:215], v[128:131]
    ds_read_b128 a[92:95], v4 offset:32768
    v_add_f32 v240, v240, v195
    v_cvt_pk_bf16_f32 v209, v194, v195
    v_mfma_f32_16x16x32_bf16 v[132:135], a[148:151], v[212:215], v[132:135]
    v_exp_f32 v197, v197
    v_mfma_f32_16x16x32_bf16 v[136:139], a[152:155], v[212:215], v[136:139]
    v_exp_f32 v198, v198
    v_mfma_f32_16x16x32_bf16 v[140:143], a[156:159], v[212:215], v[140:143]
    ds_read_b64_tr_b16 a[224:225], v28 offset:4096
    v_add_f32 v240, v240, v196
    v_add_f32 v240, v240, v197
    v_mfma_f32_16x16x32_bf16 v[144:147], a[160:163], v[212:215], v[144:147]
    v_exp_f32 v199, v199
    v_mfma_f32_16x16x32_bf16 v[148:151], a[164:167], v[212:215], v[148:151]
    ds_read_b64_tr_b16 a[226:227], v28 offset:6144
    v_cvt_pk_bf16_f32 v210, v196, v197
    v_mfma_f32_16x16x32_bf16 v[152:155], a[168:171], v[212:215], v[152:155]
    ds_read_b64_tr_b16 a[228:229], v29 offset:4096
    v_add_f32 v240, v240, v198
    v_mfma_f32_16x16x32_bf16 v[156:159], a[172:175], v[212:215], v[156:159]
    ds_read_b64_tr_b16 a[230:231], v29 offset:6144
    v_add_f32 v240, v240, v199
    v_cvt_pk_bf16_f32 v211, v198, v199
    v_mfma_f32_16x16x32_bf16 v[192:195], a[112:115], a[16:19], v[220:223]
    buffer_load_dwordx4 v243, s[64:67], s61 offen offset:2048 lds
    v_exp_f32 v200, v200
    v_mfma_f32_16x16x32_bf16 v[192:195], a[116:119], a[20:23], v[192:195]
    buffer_load_dwordx4 v244, s[64:67], s61 offen offset:3072 lds
    v_exp_f32 v201, v201
    v_mfma_f32_16x16x32_bf16 v[192:195], a[120:123], a[24:27], v[192:195]
    ds_read_b128 a[96:99], v1 offset:36864
    v_add_f32 v236, v236, v200
    v_add_f32 v236, v236, v201
    v_mfma_f32_16x16x32_bf16 v[192:195], a[124:127], a[28:31], v[192:195]
    v_exp_f32 v202, v202
    v_mfma_f32_16x16x32_bf16 v[196:199], a[128:131], a[16:19], v[220:223]
    v_exp_f32 v203, v203
    v_mfma_f32_16x16x32_bf16 v[196:199], a[132:135], a[20:23], v[196:199]
    ds_read_b128 a[100:103], v2 offset:36864
    v_cvt_pk_bf16_f32 v212, v200, v201
    v_mfma_f32_16x16x32_bf16 v[196:199], a[136:139], a[24:27], v[196:199]
    ds_read_b128 a[104:107], v3 offset:36864
    v_add_f32 v236, v236, v202
    v_mfma_f32_16x16x32_bf16 v[196:199], a[140:143], a[28:31], v[196:199]
    v_exp_f32 v204, v204
    v_mfma_f32_16x16x32_bf16 v[160:163], a[144:147], v[208:211], v[160:163]
    ds_read_b128 a[108:111], v4 offset:36864
    v_add_f32 v236, v236, v203
    v_cvt_pk_bf16_f32 v213, v202, v203
    v_mfma_f32_16x16x32_bf16 v[164:167], a[148:151], v[208:211], v[164:167]
    v_exp_f32 v205, v205
    v_mfma_f32_16x16x32_bf16 v[168:171], a[152:155], v[208:211], v[168:171]
    v_exp_f32 v206, v206
    v_mfma_f32_16x16x32_bf16 v[172:175], a[156:159], v[208:211], v[172:175]
    ds_read_b64_tr_b16 a[232:233], v30 offset:4096
    v_add_f32 v236, v236, v204
    v_add_f32 v236, v236, v205
    v_mfma_f32_16x16x32_bf16 v[176:179], a[160:163], v[208:211], v[176:179]
    v_exp_f32 v207, v207
    v_mfma_f32_16x16x32_bf16 v[180:183], a[164:167], v[208:211], v[180:183]
    ds_read_b64_tr_b16 a[234:235], v30 offset:6144
    v_cvt_pk_bf16_f32 v214, v204, v205
    v_mfma_f32_16x16x32_bf16 v[184:187], a[168:171], v[208:211], v[184:187]
    ds_read_b64_tr_b16 a[236:237], v31 offset:4096
    v_add_f32 v236, v236, v206
    v_mfma_f32_16x16x32_bf16 v[188:191], a[172:175], v[208:211], v[188:191]
    ds_read_b64_tr_b16 a[238:239], v31 offset:6144
    v_add_f32 v236, v236, v207
    v_cvt_pk_bf16_f32 v215, v206, v207
    s_waitcnt vmcnt(4)
    v_add_u32 v254, 0x20000, v254
    v_mfma_f32_16x16x32_bf16 v[200:203], a[112:115], a[32:35], v[224:227]
    s_add_u32 m0, s45, 16384
    v_exp_f32 v192, v192
    v_mfma_f32_16x16x32_bf16 v[200:203], a[116:119], a[36:39], v[200:203]
    s_xor_b32 s61, s3, 65536
    v_exp_f32 v193, v193
    v_mfma_f32_16x16x32_bf16 v[200:203], a[120:123], a[40:43], v[200:203]
    ds_read_b64_tr_b16 a[144:145], v5 offset:32768
    v_add_f32 v237, v237, v192
    v_add_f32 v237, v237, v193
    v_mfma_f32_16x16x32_bf16 v[200:203], a[124:127], a[44:47], v[200:203]
    buffer_load_dwordx4 v241, s[64:67], s61 offen offset:0 lds
    v_exp_f32 v194, v194
    v_mfma_f32_16x16x32_bf16 v[204:207], a[128:131], a[32:35], v[224:227]
    buffer_load_dwordx4 v242, s[64:67], s61 offen offset:1024 lds
    v_exp_f32 v195, v195
    v_mfma_f32_16x16x32_bf16 v[204:207], a[132:135], a[36:39], v[204:207]
    ds_read_b64_tr_b16 a[146:147], v5 offset:36864
    ds_read_b64_tr_b16 a[148:149], v6 offset:32768
    v_cvt_pk_bf16_f32 v208, v192, v193
    v_mfma_f32_16x16x32_bf16 v[204:207], a[136:139], a[40:43], v[204:207]
    ds_read_b64_tr_b16 a[150:151], v6 offset:36864
    ds_read_b64_tr_b16 a[152:153], v7 offset:32768
    v_add_f32 v237, v237, v194
    v_mfma_f32_16x16x32_bf16 v[204:207], a[140:143], a[44:47], v[204:207]
    global_load_dword v251, v254, s[12:13]
    v_exp_f32 v196, v196
    v_mfma_f32_16x16x32_bf16 v[32:35], a[176:179], v[212:215], v[32:35]
    ds_read_b64_tr_b16 a[154:155], v7 offset:36864
    v_add_f32 v237, v237, v195
    v_cvt_pk_bf16_f32 v209, v194, v195
    v_mfma_f32_16x16x32_bf16 v[36:39], a[180:183], v[212:215], v[36:39]
    v_exp_f32 v197, v197
    v_mfma_f32_16x16x32_bf16 v[40:43], a[184:187], v[212:215], v[40:43]
    v_exp_f32 v198, v198
    v_mfma_f32_16x16x32_bf16 v[44:47], a[188:191], v[212:215], v[44:47]
    ds_read_b64_tr_b16 a[240:241], v20 offset:0
    v_add_f32 v237, v237, v196
    v_add_f32 v237, v237, v197
    v_mfma_f32_16x16x32_bf16 v[48:51], a[192:195], v[212:215], v[48:51]
    v_exp_f32 v199, v199
    v_mfma_f32_16x16x32_bf16 v[52:55], a[196:199], v[212:215], v[52:55]
    ds_read_b64_tr_b16 a[242:243], v20 offset:2048
    v_cvt_pk_bf16_f32 v210, v196, v197
    v_mfma_f32_16x16x32_bf16 v[56:59], a[200:203], v[212:215], v[56:59]
    ds_read_b64_tr_b16 a[244:245], v21 offset:0
    v_add_f32 v237, v237, v198
    v_mfma_f32_16x16x32_bf16 v[60:63], a[204:207], v[212:215], v[60:63]
    ds_read_b64_tr_b16 a[246:247], v21 offset:2048
    v_add_f32 v237, v237, v199
    v_cvt_pk_bf16_f32 v211, v198, v199
    v_mfma_f32_16x16x32_bf16 v[192:195], a[112:115], a[48:51], v[228:231]
    buffer_load_dwordx4 v243, s[64:67], s61 offen offset:2048 lds
    v_exp_f32 v200, v200
    v_mfma_f32_16x16x32_bf16 v[192:195], a[116:119], a[52:55], v[192:195]
    buffer_load_dwordx4 v244, s[64:67], s61 offen offset:3072 lds
    v_exp_f32 v201, v201
    v_mfma_f32_16x16x32_bf16 v[192:195], a[120:123], a[56:59], v[192:195]
    ds_read_b64_tr_b16 a[156:157], v8 offset:32768
    v_add_f32 v238, v238, v200
    v_add_f32 v238, v238, v201
    v_mfma_f32_16x16x32_bf16 v[192:195], a[124:127], a[60:63], v[192:195]
    v_exp_f32 v202, v202
    v_mfma_f32_16x16x32_bf16 v[196:199], a[128:131], a[48:51], v[228:231]
    v_exp_f32 v203, v203
    v_mfma_f32_16x16x32_bf16 v[196:199], a[132:135], a[52:55], v[196:199]
    ds_read_b64_tr_b16 a[158:159], v8 offset:36864
    ds_read_b64_tr_b16 a[160:161], v9 offset:32768
    v_cvt_pk_bf16_f32 v212, v200, v201
    v_mfma_f32_16x16x32_bf16 v[196:199], a[136:139], a[56:59], v[196:199]
    ds_read_b64_tr_b16 a[162:163], v9 offset:36864
    ds_read_b64_tr_b16 a[164:165], v10 offset:32768
    v_add_f32 v238, v238, v202
    v_mfma_f32_16x16x32_bf16 v[196:199], a[140:143], a[60:63], v[196:199]
    v_exp_f32 v204, v204
    v_mfma_f32_16x16x32_bf16 v[64:67], a[176:179], v[208:211], v[64:67]
    ds_read_b64_tr_b16 a[166:167], v10 offset:36864
    v_add_f32 v238, v238, v203
    v_cvt_pk_bf16_f32 v213, v202, v203
    v_mfma_f32_16x16x32_bf16 v[68:71], a[180:183], v[208:211], v[68:71]
    v_exp_f32 v205, v205
    v_mfma_f32_16x16x32_bf16 v[72:75], a[184:187], v[208:211], v[72:75]
    v_exp_f32 v206, v206
    v_mfma_f32_16x16x32_bf16 v[76:79], a[188:191], v[208:211], v[76:79]
    ds_read_b64_tr_b16 a[248:249], v22 offset:0
    v_add_f32 v238, v238, v204
    v_add_f32 v238, v238, v205
    v_mfma_f32_16x16x32_bf16 v[80:83], a[192:195], v[208:211], v[80:83]
    v_exp_f32 v207, v207
    v_mfma_f32_16x16x32_bf16 v[84:87], a[196:199], v[208:211], v[84:87]
    ds_read_b64_tr_b16 a[250:251], v22 offset:2048
    v_cvt_pk_bf16_f32 v214, v204, v205
    v_mfma_f32_16x16x32_bf16 v[88:91], a[200:203], v[208:211], v[88:91]
    ds_read_b64_tr_b16 a[252:253], v23 offset:0
    v_add_f32 v238, v238, v206
    v_mfma_f32_16x16x32_bf16 v[92:95], a[204:207], v[208:211], v[92:95]
    ds_read_b64_tr_b16 a[254:255], v23 offset:2048
    v_add_f32 v238, v238, v207
    v_cvt_pk_bf16_f32 v215, v206, v207
    v_mfma_f32_16x16x32_bf16 v[200:203], a[112:115], a[64:67], v[232:235]
    s_add_u32 m0, s45, 81920
    v_exp_f32 v192, v192
    v_mfma_f32_16x16x32_bf16 v[200:203], a[116:119], a[68:71], v[200:203]
    s_xor_b32 s61, s3, 65664
    v_exp_f32 v193, v193
    v_mfma_f32_16x16x32_bf16 v[200:203], a[120:123], a[72:75], v[200:203]
    ds_read_b64_tr_b16 a[168:169], v11 offset:32768
    v_add_f32 v239, v239, v192
    v_mfma_f32_16x16x32_bf16 v[200:203], a[124:127], a[76:79], v[200:203]
    buffer_load_dwordx4 v241, s[64:67], s61 offen offset:0 lds
    v_exp_f32 v194, v194
    v_mfma_f32_16x16x32_bf16 v[204:207], a[128:131], a[64:67], v[232:235]
    ds_read_b64_tr_b16 a[170:171], v11 offset:36864
    v_add_f32 v239, v239, v193
    v_mfma_f32_16x16x32_bf16 v[204:207], a[132:135], a[68:71], v[204:207]
    buffer_load_dwordx4 v242, s[64:67], s61 offen offset:1024 lds
    v_exp_f32 v195, v195
    v_mfma_f32_16x16x32_bf16 v[204:207], a[136:139], a[72:75], v[204:207]
    ds_read_b64_tr_b16 a[172:173], v12 offset:32768
    v_cvt_pk_bf16_f32 v208, v192, v193
    v_mfma_f32_16x16x32_bf16 v[204:207], a[140:143], a[76:79], v[204:207]
    v_exp_f32 v196, v196
    v_mfma_f32_16x16x32_bf16 v[96:99], a[176:179], v[212:215], v[96:99]
    ds_read_b64_tr_b16 a[174:175], v12 offset:36864
    v_add_f32 v239, v239, v194
    v_mfma_f32_16x16x32_bf16 v[100:103], a[180:183], v[212:215], v[100:103]
    v_exp_f32 v197, v197
    v_mfma_f32_16x16x32_bf16 v[104:107], a[184:187], v[212:215], v[104:107]
    v_add_f32 v239, v239, v195
    v_cvt_pk_bf16_f32 v209, v194, v195
    v_mfma_f32_16x16x32_bf16 v[108:111], a[188:191], v[212:215], v[108:111]
    v_exp_f32 v198, v198
    v_mfma_f32_16x16x32_bf16 v[112:115], a[192:195], v[212:215], v[112:115]
    v_add_f32 v239, v239, v196
    v_add_f32 v239, v239, v197
    v_mfma_f32_16x16x32_bf16 v[116:119], a[196:199], v[212:215], v[116:119]
    v_exp_f32 v199, v199
    v_mfma_f32_16x16x32_bf16 v[120:123], a[200:203], v[212:215], v[120:123]
    v_cvt_pk_bf16_f32 v210, v196, v197
    v_add_f32 v239, v239, v198
    v_mfma_f32_16x16x32_bf16 v[124:127], a[204:207], v[212:215], v[124:127]
    s_waitcnt lgkmcnt(0)
    v_add_f32 v239, v239, v199
    v_cvt_pk_bf16_f32 v211, v198, v199
    s_cmp_eq_u32 s54, 0
    s_cbranch_scc1 L_regw_a
L_rdy_a:
    v_mov_b32 v252, s58
    s_waitcnt vmcnt(20)
    global_store_dword v250, v252, s[78:79] sc1
    v_mfma_f32_16x16x32_bf16 v[192:195], a[80:83], a[0:3], v[216:219]
    buffer_load_dwordx4 v243, s[64:67], s61 offen offset:2048 lds
    v_exp_f32 v200, v200
    v_mfma_f32_16x16x32_bf16 v[192:195], a[84:87], a[4:7], v[192:195]
    buffer_load_dwordx4 v244, s[64:67], s61 offen offset:3072 lds
    v_exp_f32 v201, v201
    v_mfma_f32_16x16x32_bf16 v[192:195], a[88:91], a[8:11], v[192:195]
    v_add_f32 v240, v240, v200
    v_add_f32 v240, v240, v201
    v_mfma_f32_16x16x32_bf16 v[192:195], a[92:95], a[12:15], v[192:195]
    v_exp_f32 v202, v202
    v_mfma_f32_16x16x32_bf16 v[196:199], a[96:99], a[0:3], v[216:219]
    v_exp_f32 v203, v203
    v_mfma_f32_16x16x32_bf16 v[196:199], a[100:103], a[4:7], v[196:199]
    ds_read_b128 a[112:115], v1 offset:40960
    v_cvt_pk_bf16_f32 v212, v200, v201
    v_mfma_f32_16x16x32_bf16 v[196:199], a[104:107], a[8:11], v[196:199]
    ds_read_b128 a[116:119], v2 offset:40960
    v_add_f32 v240, v240, v202
    v_mfma_f32_16x16x32_bf16 v[196:199], a[108:111], a[12:15], v[196:199]
    v_exp_f32 v204, v204
    v_mfma_f32_16x16x32_bf16 v[128:131], a[176:179], v[208:211], v[128:131]
    v_add_f32 v240, v240, v203
    v_cvt_pk_bf16_f32 v213, v202, v203
    v_mfma_f32_16x16x32_bf16 v[132:135], a[180:183], v[208:211], v[132:135]
    v_exp_f32 v205, v205
    v_mfma_f32_16x16x32_bf16 v[136:139], a[184:187], v[208:211], v[136:139]
    v_exp_f32 v206, v206
    v_mfma_f32_16x16x32_bf16 v[140:143], a[188:191], v[208:211], v[140:143]
    v_add_f32 v240, v240, v204
    v_add_f32 v240, v240, v205
    v_mfma_f32_16x16x32_bf16 v[144:147], a[192:195], v[208:211], v[144:147]
    v_exp_f32 v207, v207
    v_mfma_f32_16x16x32_bf16 v[148:151], a[196:199], v[208:211], v[148:151]
    ds_read_b128 a[120:123], v3 offset:40960
    v_cvt_pk_bf16_f32 v214, v204, v205
    v_mfma_f32_16x16x32_bf16 v[152:155], a[200:203], v[208:211], v[152:155]
    ds_read_b128 a[124:127], v4 offset:40960
    v_add_f32 v240, v240, v206
    v_mfma_f32_16x16x32_bf16 v[156:159], a[204:207], v[208:211], v[156:159]
    v_add_f32 v240, v240, v207
    v_cvt_pk_bf16_f32 v215, v206, v207
    v_mfma_f32_16x16x32_bf16 v[200:203], a[80:83], a[16:19], v[220:223]
    s_add_u32 m0, s63, 0
    v_exp_f32 v192, v192
    v_mfma_f32_16x16x32_bf16 v[200:203], a[84:87], a[20:23], v[200:203]
    s_xor_b32 s61, s3, 98304
    v_exp_f32 v193, v193
    v_mfma_f32_16x16x32_bf16 v[200:203], a[88:91], a[24:27], v[200:203]
    buffer_load_dwordx4 v241, s[64:67], s61 offen offset:0 lds
    v_add_f32 v236, v236, v192
    v_add_f32 v236, v236, v193
    v_mfma_f32_16x16x32_bf16 v[200:203], a[92:95], a[28:31], v[200:203]
    buffer_load_dwordx4 v242, s[64:67], s61 offen offset:1024 lds
    v_exp_f32 v194, v194
    v_mfma_f32_16x16x32_bf16 v[204:207], a[96:99], a[16:19], v[220:223]
    v_exp_f32 v195, v195
    v_mfma_f32_16x16x32_bf16 v[204:207], a[100:103], a[20:23], v[204:207]
    ds_read_b128 a[128:131], v1 offset:45056
    v_cvt_pk_bf16_f32 v208, v192, v193
    v_mfma_f32_16x16x32_bf16 v[204:207], a[104:107], a[24:27], v[204:207]
    ds_read_b128 a[132:135], v2 offset:45056
    v_add_f32 v236, v236, v194
    v_mfma_f32_16x16x32_bf16 v[204:207], a[108:111], a[28:31], v[204:207]
    v_exp_f32 v196, v196
    v_mfma_f32_16x16x32_bf16 v[160:163], a[176:179], v[212:215], v[160:163]
    v_add_f32 v236, v236, v195
    v_cvt_pk_bf16_f32 v209, v194, v195
    v_mfma_f32_16x16x32_bf16 v[164:167], a[180:183], v[212:215], v[164:167]
    v_exp_f32 v197, v197
    v_mfma_f32_16x16x32_bf16 v[168:171], a[184:187], v[212:215], v[168:171]
    v_exp_f32 v198, v198
    v_mfma_f32_16x16x32_bf16 v[172:175], a[188:191], v[212:215], v[172:175]
    v_add_f32 v236, v236, v196
    v_add_f32 v236, v236, v197
    v_mfma_f32_16x16x32_bf16 v[176:179], a[192:195], v[212:215], v[176:179]
    v_exp_f32 v199, v199
    v_mfma_f32_16x16x32_bf16 v[180:183], a[196:199], v[212:215], v[180:183]
    ds_read_b128 a[136:139], v3 offset:45056
    v_cvt_pk_bf16_f32 v210, v196, v197
    v_mfma_f32_16x16x32_bf16 v[184:187], a[200:203], v[212:215], v[184:187]
    ds_read_b128 a[140:143], v4 offset:45056
    v_add_f32 v236, v236, v198
    v_mfma_f32_16x16x32_bf16 v[188:191], a[204:207], v[212:215], v[188:191]
    v_add_f32 v236, v236, v199
    v_cvt_pk_bf16_f32 v211, v198, v199
    v_mfma_f32_16x16x32_bf16 v[192:195], a[80:83], a[32:35], v[224:227]
    buffer_load_dwordx4 v243, s[64:67], s61 offen offset:2048 lds
    v_exp_f32 v200, v200
    v_mfma_f32_16x16x32_bf16 v[192:195], a[84:87], a[36:39], v[192:195]
    buffer_load_dwordx4 v244, s[64:67], s61 offen offset:3072 lds
    v_exp_f32 v201, v201
    v_mfma_f32_16x16x32_bf16 v[192:195], a[88:91], a[40:43], v[192:195]
    ds_read_b64_tr_b16 a[176:177], v5 offset:40960
    v_add_f32 v237, v237, v200
    v_add_f32 v237, v237, v201
    v_mfma_f32_16x16x32_bf16 v[192:195], a[92:95], a[44:47], v[192:195]
    v_exp_f32 v202, v202
    v_mfma_f32_16x16x32_bf16 v[196:199], a[96:99], a[32:35], v[224:227]
    v_exp_f32 v203, v203
    v_mfma_f32_16x16x32_bf16 v[196:199], a[100:103], a[36:39], v[196:199]
    ds_read_b64_tr_b16 a[178:179], v5 offset:45056
    v_cvt_pk_bf16_f32 v212, v200, v201
    v_mfma_f32_16x16x32_bf16 v[196:199], a[104:107], a[40:43], v[196:199]
    ds_read_b64_tr_b16 a[180:181], v6 offset:40960
    v_add_f32 v237, v237, v202
    v_mfma_f32_16x16x32_bf16 v[196:199], a[108:111], a[44:47], v[196:199]
    v_exp_f32 v204, v204
    v_mfma_f32_16x16x32_bf16 v[32:35], a[144:147], v[208:211], v[32:35]
    ds_read_b64_tr_b16 a[182:183], v6 offset:45056
    v_add_f32 v237, v237, v203
    v_cvt_pk_bf16_f32 v213, v202, v203
    v_mfma_f32_16x16x32_bf16 v[36:39], a[148:151], v[208:211], v[36:39]
    v_exp_f32 v205, v205
    v_mfma_f32_16x16x32_bf16 v[40:43], a[152:155], v[208:211], v[40:43]
    v_exp_f32 v206, v206
    v_mfma_f32_16x16x32_bf16 v[44:47], a[156:159], v[208:211], v[44:47]
    v_add_f32 v237, v237, v204
    v_add_f32 v237, v237, v205
    v_mfma_f32_16x16x32_bf16 v[48:51], a[160:163], v[208:211], v[48:51]
    v_exp_f32 v207, v207
    v_mfma_f32_16x16x32_bf16 v[52:55], a[164:167], v[208:211], v[52:55]
    ds_read_b64_tr_b16 a[184:185], v7 offset:40960
    v_cvt_pk_bf16_f32 v214, v204, v205
    v_mfma_f32_16x16x32_bf16 v[56:59], a[168:171], v[208:211], v[56:59]
    ds_read_b64_tr_b16 a[186:187], v7 offset:45056
    v_add_f32 v237, v237, v206
    v_mfma_f32_16x16x32_bf16 v[60:63], a[172:175], v[208:211], v[60:63]
    v_add_f32 v237, v237, v207
    v_cvt_pk_bf16_f32 v215, v206, v207
    v_mfma_f32_16x16x32_bf16 v[200:203], a[80:83], a[48:51], v[228:231]
    s_add_u32 m0, s63, 4096
    v_exp_f32 v192, v192
    v_mfma_f32_16x16x32_bf16 v[200:203], a[84:87], a[52:55], v[200:203]
    s_xor_b32 s61, s3, 98432
    v_exp_f32 v193, v193
    v_mfma_f32_16x16x32_bf16 v[200:203], a[88:91], a[56:59], v[200:203]
    ds_read_b64_tr_b16 a[188:189], v8 offset:40960
    v_add_f32 v238, v238, v192
    v_add_f32 v238, v238, v193
    v_mfma_f32_16x16x32_bf16 v[200:203], a[92:95], a[60:63], v[200:203]
    buffer_load_dwordx4 v241, s[64:67], s61 offen offset:0 lds
    v_exp_f32 v194, v194
    v_mfma_f32_16x16x32_bf16 v[204:207], a[96:99], a[48:51], v[228:231]
    buffer_load_dwordx4 v242, s[64:67], s61 offen offset:1024 lds
    v_exp_f32 v195, v195
    v_mfma_f32_16x16x32_bf16 v[204:207], a[100:103], a[52:55], v[204:207]
    ds_read_b64_tr_b16 a[190:191], v8 offset:45056
    v_cvt_pk_bf16_f32 v208, v192, v193
    v_mfma_f32_16x16x32_bf16 v[204:207], a[104:107], a[56:59], v[204:207]
    ds_read_b64_tr_b16 a[192:193], v9 offset:40960
    v_add_f32 v238, v238, v194
    v_mfma_f32_16x16x32_bf16 v[204:207], a[108:111], a[60:63], v[204:207]
    v_exp_f32 v196, v196
    v_mfma_f32_16x16x32_bf16 v[64:67], a[144:147], v[212:215], v[64:67]
    ds_read_b64_tr_b16 a[194:195], v9 offset:45056
    v_add_f32 v238, v238, v195
    v_cvt_pk_bf16_f32 v209, v194, v195
    v_mfma_f32_16x16x32_bf16 v[68:71], a[148:151], v[212:215], v[68:71]
    v_exp_f32 v197, v197
    v_mfma_f32_16x16x32_bf16 v[72:75], a[152:155], v[212:215], v[72:75]
    v_exp_f32 v198, v198
    v_mfma_f32_16x16x32_bf16 v[76:79], a[156:159], v[212:215], v[76:79]
    v_add_f32 v238, v238, v196
    v_add_f32 v238, v238, v197
    v_mfma_f32_16x16x32_bf16 v[80:83], a[160:163], v[212:215], v[80:83]
    v_exp_f32 v199, v199
    v_mfma_f32_16x16x32_bf16 v[84:87], a[164:167], v[212:215], v[84:87]
    ds_read_b64_tr_b16 a[196:197], v10 offset:40960
    v_cvt_pk_bf16_f32 v210, v196, v197
    v_mfma_f32_16x16x32_bf16 v[88:91], a[168:171], v[212:215], v[88:91]
    ds_read_b64_tr_b16 a[198:199], v10 offset:45056
    v_add_f32 v238, v238, v198
    v_mfma_f32_16x16x32_bf16 v[92:95], a[172:175], v[212:215], v[92:95]
    v_add_f32 v238, v238, v199
    v_cvt_pk_bf16_f32 v211, v198, v199
    v_add_u32 v254, 0x20000, v254
    v_mfma_f32_16x16x32_bf16 v[192:195], a[80:83], a[64:67], v[232:235]
    buffer_load_dwordx4 v243, s[64:67], s61 offen offset:2048 lds
    v_exp_f32 v200, v200
    v_mfma_f32_16x16x32_bf16 v[192:195], a[84:87], a[68:71], v[192:195]
    buffer_load_dwordx4 v244, s[64:67], s61 offen offset:3072 lds
    v_exp_f32 v201, v201
    v_mfma_f32_16x16x32_bf16 v[192:195], a[88:91], a[72:75], v[192:195]
    ds_read_b64_tr_b16 a[200:201], v11 offset:40960
    v_add_f32 v239, v239, v200
    v_mfma_f32_16x16x32_bf16 v[192:195], a[92:95], a[76:79], v[192:195]
    global_load_dword v251, v254, s[12:13]
    v_exp_f32 v202, v202
    v_mfma_f32_16x16x32_bf16 v[196:199], a[96:99], a[64:67], v[232:235]
    ds_read_b64_tr_b16 a[202:203], v11 offset:45056
    v_add_f32 v239, v239, v201
    v_mfma_f32_16x16x32_bf16 v[196:199], a[100:103], a[68:71], v[196:199]
    v_exp_f32 v203, v203
    v_mfma_f32_16x16x32_bf16 v[196:199], a[104:107], a[72:75], v[196:199]
    ds_read_b64_tr_b16 a[204:205], v12 offset:40960
    v_cvt_pk_bf16_f32 v212, v200, v201
    v_mfma_f32_16x16x32_bf16 v[196:199], a[108:111], a[76:79], v[196:199]
    v_exp_f32 v204, v204
    v_mfma_f32_16x16x32_bf16 v[96:99], a[144:147], v[208:211], v[96:99]
    ds_read_b64_tr_b16 a[206:207], v12 offset:45056
    v_add_f32 v239, v239, v202
    v_mfma_f32_16x16x32_bf16 v[100:103], a[148:151], v[208:211], v[100:103]
    v_exp_f32 v205, v205
    v_mfma_f32_16x16x32_bf16 v[104:107], a[152:155], v[208:211], v[104:107]
    v_add_f32 v239, v239, v203
    v_cvt_pk_bf16_f32 v213, v202, v203
    v_mfma_f32_16x16x32_bf16 v[108:111], a[156:159], v[208:211], v[108:111]
    v_exp_f32 v206, v206
    v_mfma_f32_16x16x32_bf16 v[112:115], a[160:163], v[208:211], v[112:115]
    v_add_f32 v239, v239, v204
    v_add_f32 v239, v239, v205
    v_mfma_f32_16x16x32_bf16 v[116:119], a[164:167], v[208:211], v[116:119]
    v_exp_f32 v207, v207
    v_mfma_f32_16x16x32_bf16 v[120:123], a[168:171], v[208:211], v[120:123]
    s_waitcnt vmcnt(42) lgkmcnt(0)
    v_cvt_pk_bf16_f32 v214, v204, v205
    v_add_f32 v239, v239, v206
    v_mfma_f32_16x16x32_bf16 v[124:127], a[172:175], v[208:211], v[124:127]
    s_barrier
    v_add_f32 v239, v239, v207
    v_cvt_pk_bf16_f32 v215, v206, v207
    v_mfma_f32_16x16x32_bf16 v[200:203], a[112:115], a[0:3], v[216:219]
    s_add_u32 m0, s45, 0
    v_exp_f32 v192, v192
    v_mfma_f32_16x16x32_bf16 v[200:203], a[116:119], a[4:7], v[200:203]
    s_xor_b32 s61, s3, 131072
    v_exp_f32 v193, v193
    v_mfma_f32_16x16x32_bf16 v[200:203], a[120:123], a[8:11], v[200:203]
    buffer_load_dwordx4 v241, s[64:67], s61 offen offset:0 lds
    v_add_f32 v240, v240, v192
    v_add_f32 v240, v240, v193
    v_mfma_f32_16x16x32_bf16 v[200:203], a[124:127], a[12:15], v[200:203]
    buffer_load_dwordx4 v242, s[64:67], s61 offen offset:1024 lds
    v_exp_f32 v194, v194
    v_mfma_f32_16x16x32_bf16 v[204:207], a[128:131], a[0:3], v[216:219]
    v_exp_f32 v195, v195
    v_mfma_f32_16x16x32_bf16 v[204:207], a[132:135], a[4:7], v[204:207]
    ds_read_b128 a[80:83], v1 offset:49152
    v_cvt_pk_bf16_f32 v208, v192, v193
    v_mfma_f32_16x16x32_bf16 v[204:207], a[136:139], a[8:11], v[204:207]
    ds_read_b128 a[84:87], v2 offset:49152
    v_add_f32 v240, v240, v194
    v_mfma_f32_16x16x32_bf16 v[204:207], a[140:143], a[12:15], v[204:207]
    v_exp_f32 v196, v196
    v_mfma_f32_16x16x32_bf16 v[128:131], a[144:147], v[212:215], v[128:131]
    v_add_f32 v240, v240, v195
    v_cvt_pk_bf16_f32 v209, v194, v195
    v_mfma_f32_16x16x32_bf16 v[132:135], a[148:151], v[212:215], v[132:135]
    v_exp_f32 v197, v197
    v_mfma_f32_16x16x32_bf16 v[136:139], a[152:155], v[212:215], v[136:139]
    v_exp_f32 v198, v198
    v_mfma_f32_16x16x32_bf16 v[140:143], a[156:159], v[212:215], v[140:143]
    v_add_f32 v240, v240, v196
    v_add_f32 v240, v240, v197
    v_mfma_f32_16x16x32_bf16 v[144:147], a[160:163], v[212:215], v[144:147]
    v_exp_f32 v199, v199
    v_mfma_f32_16x16x32_bf16 v[148:151], a[164:167], v[212:215], v[148:151]
    ds_read_b128 a[88:91], v3 offset:49152
    v_cvt_pk_bf16_f32 v210, v196, v197
    v_mfma_f32_16x16x32_bf16 v[152:155], a[168:171], v[212:215], v[152:155]
    ds_read_b128 a[92:95], v4 offset:49152
    v_add_f32 v240, v240, v198
    v_mfma_f32_16x16x32_bf16 v[156:159], a[172:175], v[212:215], v[156:159]
    v_add_f32 v240, v240, v199
    v_cvt_pk_bf16_f32 v211, v198, v199
    v_mfma_f32_16x16x32_bf16 v[192:195], a[112:115], a[16:19], v[220:223]
    buffer_load_dwordx4 v243, s[64:67], s61 offen offset:2048 lds
    v_exp_f32 v200, v200
    v_mfma_f32_16x16x32_bf16 v[192:195], a[116:119], a[20:23], v[192:195]
    buffer_load_dwordx4 v244, s[64:67], s61 offen offset:3072 lds
    v_exp_f32 v201, v201
    v_mfma_f32_16x16x32_bf16 v[192:195], a[120:123], a[24:27], v[192:195]
    v_add_f32 v236, v236, v200
    v_add_f32 v236, v236, v201
    v_mfma_f32_16x16x32_bf16 v[192:195], a[124:127], a[28:31], v[192:195]
    v_exp_f32 v202, v202
    v_mfma_f32_16x16x32_bf16 v[196:199], a[128:131], a[16:19], v[220:223]
    v_exp_f32 v203, v203
    v_mfma_f32_16x16x32_bf16 v[196:199], a[132:135], a[20:23], v[196:199]
    ds_read_b128 a[96:99], v1 offset:53248
    v_cvt_pk_bf16_f32 v212, v200, v201
    v_mfma_f32_16x16x32_bf16 v[196:199], a[136:139], a[24:27], v[196:199]
    ds_read_b128 a[100:103], v2 offset:53248
    v_add_f32 v236, v236, v202
    v_mfma_f32_16x16x32_bf16 v[196:199], a[140:143], a[28:31], v[196:199]
    v_exp_f32 v204, v204
    v_mfma_f32_16x16x32_bf16 v[160:163], a[144:147], v[208:211], v[160:163]
    v_add_f32 v236, v236, v203
    v_cvt_pk_bf16_f32 v213, v202, v203
    v_mfma_f32_16x16x32_bf16 v[164:167], a[148:151], v[208:211], v[164:167]
    v_exp_f32 v205, v205
    v_mfma_f32_16x16x32_bf16 v[168:171], a[152:155], v[208:211], v[168:171]
    v_exp_f32 v206, v206
    v_mfma_f32_16x16x32_bf16 v[172:175], a[156:159], v[208:211], v[172:175]
    v_add_f32 v236, v236, v204
    v_add_f32 v236, v236, v205
    v_mfma_f32_16x16x32_bf16 v[176:179], a[160:163], v[208:211], v[176:179]
    v_exp_f32 v207, v207
    v_mfma_f32_16x16x32_bf16 v[180:183], a[164:167], v[208:211], v[180:183]
    ds_read_b128 a[104:107], v3 offset:53248
    v_cvt_pk_bf16_f32 v214, v204, v205
    v_mfma_f32_16x16x32_bf16 v[184:187], a[168:171], v[208:211], v[184:187]
    ds_read_b128 a[108:111], v4 offset:53248
    v_add_f32 v236, v236, v206
    v_mfma_f32_16x16x32_bf16 v[188:191], a[172:175], v[208:211], v[188:191]
    v_add_f32 v236, v236, v207
    v_cvt_pk_bf16_f32 v215, v206, v207
    v_mfma_f32_16x16x32_bf16 v[200:203], a[112:115], a[32:35], v[224:227]
    s_add_u32 m0, s45, 32768
    v_exp_f32 v192, v192
    v_mfma_f32_16x16x32_bf16 v[200:203], a[116:119], a[36:39], v[200:203]
    s_xor_b32 s61, s3, 131200
    v_exp_f32 v193, v193
    v_mfma_f32_16x16x32_bf16 v[200:203], a[120:123], a[40:43], v[200:203]
    ds_read_b64_tr_b16 a[144:145], v5 offset:49152
    v_add_f32 v237, v237, v192
    v_add_f32 v237, v237, v193
    v_mfma_f32_16x16x32_bf16 v[200:203], a[124:127], a[44:47], v[200:203]
    buffer_load_dwordx4 v241, s[64:67], s61 offen offset:0 lds
    v_exp_f32 v194, v194
    v_mfma_f32_16x16x32_bf16 v[204:207], a[128:131], a[32:35], v[224:227]
    buffer_load_dwordx4 v242, s[64:67], s61 offen offset:1024 lds
    v_exp_f32 v195, v195
    v_mfma_f32_16x16x32_bf16 v[204:207], a[132:135], a[36:39], v[204:207]
    ds_read_b64_tr_b16 a[146:147], v5 offset:53248
    v_cvt_pk_bf16_f32 v208, v192, v193
    v_mfma_f32_16x16x32_bf16 v[204:207], a[136:139], a[40:43], v[204:207]
    ds_read_b64_tr_b16 a[148:149], v6 offset:49152
    v_add_f32 v237, v237, v194
    v_mfma_f32_16x16x32_bf16 v[204:207], a[140:143], a[44:47], v[204:207]
    v_exp_f32 v196, v196
    v_mfma_f32_16x16x32_bf16 v[32:35], a[176:179], v[212:215], v[32:35]
    ds_read_b64_tr_b16 a[150:151], v6 offset:53248
    v_add_f32 v237, v237, v195
    v_cvt_pk_bf16_f32 v209, v194, v195
    v_mfma_f32_16x16x32_bf16 v[36:39], a[180:183], v[212:215], v[36:39]
    v_exp_f32 v197, v197
    v_mfma_f32_16x16x32_bf16 v[40:43], a[184:187], v[212:215], v[40:43]
    v_exp_f32 v198, v198
    v_mfma_f32_16x16x32_bf16 v[44:47], a[188:191], v[212:215], v[44:47]
    v_add_f32 v237, v237, v196
    v_add_f32 v237, v237, v197
    v_mfma_f32_16x16x32_bf16 v[48:51], a[192:195], v[212:215], v[48:51]
    v_exp_f32 v199, v199
    v_mfma_f32_16x16x32_bf16 v[52:55], a[196:199], v[212:215], v[52:55]
    ds_read_b64_tr_b16 a[152:153], v7 offset:49152
    v_cvt_pk_bf16_f32 v210, v196, v197
    v_mfma_f32_16x16x32_bf16 v[56:59], a[200:203], v[212:215], v[56:59]
    ds_read_b64_tr_b16 a[154:155], v7 offset:53248
    v_add_f32 v237, v237, v198
    v_mfma_f32_16x16x32_bf16 v[60:63], a[204:207], v[212:215], v[60:63]
    v_add_f32 v237, v237, v199
    v_cvt_pk_bf16_f32 v211, v198, v199
    v_mfma_f32_16x16x32_bf16 v[192:195], a[112:115], a[48:51], v[228:231]
    buffer_load_dwordx4 v243, s[64:67], s61 offen offset:2048 lds
    v_exp_f32 v200, v200
    v_mfma_f32_16x16x32_bf16 v[192:195], a[116:119], a[52:55], v[192:195]
    buffer_load_dwordx4 v244, s[64:67], s61 offen offset:3072 lds
    v_exp_f32 v201, v201
    v_mfma_f32_16x16x32_bf16 v[192:195], a[120:123], a[56:59], v[192:195]
    ds_read_b64_tr_b16 a[156:157], v8 offset:49152
    v_add_f32 v238, v238, v200
    v_add_f32 v238, v238, v201
    v_mfma_f32_16x16x32_bf16 v[192:195], a[124:127], a[60:63], v[192:195]
    v_exp_f32 v202, v202
    v_mfma_f32_16x16x32_bf16 v[196:199], a[128:131], a[48:51], v[228:231]
    v_exp_f32 v203, v203
    v_mfma_f32_16x16x32_bf16 v[196:199], a[132:135], a[52:55], v[196:199]
    ds_read_b64_tr_b16 a[158:159], v8 offset:53248
    v_cvt_pk_bf16_f32 v212, v200, v201
    v_mfma_f32_16x16x32_bf16 v[196:199], a[136:139], a[56:59], v[196:199]
    ds_read_b64_tr_b16 a[160:161], v9 offset:49152
    v_add_f32 v238, v238, v202
    v_mfma_f32_16x16x32_bf16 v[196:199], a[140:143], a[60:63], v[196:199]
    v_exp_f32 v204, v204
    v_mfma_f32_16x16x32_bf16 v[64:67], a[176:179], v[208:211], v[64:67]
    ds_read_b64_tr_b16 a[162:163], v9 offset:53248
    v_add_f32 v238, v238, v203
    v_cvt_pk_bf16_f32 v213, v202, v203
    v_mfma_f32_16x16x32_bf16 v[68:71], a[180:183], v[208:211], v[68:71]
    v_exp_f32 v205, v205
    v_mfma_f32_16x16x32_bf16 v[72:75], a[184:187], v[208:211], v[72:75]
    v_exp_f32 v206, v206
    v_mfma_f32_16x16x32_bf16 v[76:79], a[188:191], v[208:211], v[76:79]
    v_add_f32 v238, v238, v204
    v_add_f32 v238, v238, v205
    v_mfma_f32_16x16x32_bf16 v[80:83], a[192:195], v[208:211], v[80:83]
    v_exp_f32 v207, v207
    v_mfma_f32_16x16x32_bf16 v[84:87], a[196:199], v[208:211], v[84:87]
    ds_read_b64_tr_b16 a[164:165], v10 offset:49152
    v_cvt_pk_bf16_f32 v214, v204, v205
    v_mfma_f32_16x16x32_bf16 v[88:91], a[200:203], v[208:211], v[88:91]
    ds_read_b64_tr_b16 a[166:167], v10 offset:53248
    v_add_f32 v238, v238, v206
    v_mfma_f32_16x16x32_bf16 v[92:95], a[204:207], v[208:211], v[92:95]
    v_add_f32 v238, v238, v207
    v_cvt_pk_bf16_f32 v215, v206, v207
    v_and_b32 v254, 0x30, v19
    v_lshlrev_b32 v254, 5, v254
    v_add_u32 v254, s55, v254
    s_mov_b32 exec_lo, 0
    v_mov_b32 v254, s0
    s_mov_b32 exec_lo, -1
    v_mfma_f32_16x16x32_bf16 v[200:203], a[112:115], a[64:67], v[232:235]
    s_add_u32 m0, s45, 98304
    v_exp_f32 v192, v192
    v_mfma_f32_16x16x32_bf16 v[200:203], a[116:119], a[68:71], v[200:203]
    s_xor_b32 s61, s3, 163840
    v_exp_f32 v193, v193
    v_mfma_f32_16x16x32_bf16 v[200:203], a[120:123], a[72:75], v[200:203]
    ds_read_b64_tr_b16 a[168:169], v11 offset:49152
    v_add_f32 v239, v239, v192
    v_mfma_f32_16x16x32_bf16 v[200:203], a[124:127], a[76:79], v[200:203]
    buffer_load_dwordx4 v241, s[64:67], s61 offen offset:0 lds
    v_exp_f32 v194, v194
    v_mfma_f32_16x16x32_bf16 v[204:207], a[128:131], a[64:67], v[232:235]
    ds_read_b64_tr_b16 a[170:171], v11 offset:53248
    v_add_f32 v239, v239, v193
    v_mfma_f32_16x16x32_bf16 v[204:207], a[132:135], a[68:71], v[204:207]
    buffer_load_dwordx4 v242, s[64:67], s61 offen offset:1024 lds
    v_exp_f32 v195, v195
    v_mfma_f32_16x16x32_bf16 v[204:207], a[136:139], a[72:75], v[204:207]
    ds_read_b64_tr_b16 a[172:173], v12 offset:49152
    v_cvt_pk_bf16_f32 v208, v192, v193
    v_mfma_f32_16x16x32_bf16 v[204:207], a[140:143], a[76:79], v[204:207]
    global_load_dword v253, v254, s[18:19] sc1
    v_exp_f32 v196, v196
    v_mfma_f32_16x16x32_bf16 v[96:99], a[176:179], v[212:215], v[96:99]
    ds_read_b64_tr_b16 a[174:175], v12 offset:53248
    v_add_f32 v239, v239, v194
    v_mfma_f32_16x16x32_bf16 v[100:103], a[180:183], v[212:215], v[100:103]
    v_exp_f32 v197, v197
    v_mfma_f32_16x16x32_bf16 v[104:107], a[184:187], v[212:215], v[104:107]
    v_add_f32 v239, v239, v195
    v_cvt_pk_bf16_f32 v209, v194, v195
    v_mfma_f32_16x16x32_bf16 v[108:111], a[188:191], v[212:215], v[108:111]
    v_exp_f32 v198, v198
    v_mfma_f32_16x16x32_bf16 v[112:115], a[192:195], v[212:215], v[112:115]
    v_add_f32 v239, v239, v196
    v_add_f32 v239, v239, v197
    v_mfma_f32_16x16x32_bf16 v[116:119], a[196:199], v[212:215], v[116:119]
    v_exp_f32 v199, v199
    v_mfma_f32_16x16x32_bf16 v[120:123], a[200:203], v[212:215], v[120:123]
    v_cvt_pk_bf16_f32 v210, v196, v197
    v_add_f32 v239, v239, v198
    v_mfma_f32_16x16x32_bf16 v[124:127], a[204:207], v[212:215], v[124:127]
    s_waitcnt lgkmcnt(0)
    v_add_f32 v239, v239, v199
    v_cvt_pk_bf16_f32 v211, v198, v199
    v_mfma_f32_16x16x32_bf16 v[192:195], a[80:83], a[0:3], v[216:219]
    buffer_load_dwordx4 v243, s[64:67], s61 offen offset:2048 lds
    v_exp_f32 v200, v200
    v_mfma_f32_16x16x32_bf16 v[192:195], a[84:87], a[4:7], v[192:195]
    buffer_load_dwordx4 v244, s[64:67], s61 offen offset:3072 lds
    v_exp_f32 v201, v201
    v_mfma_f32_16x16x32_bf16 v[192:195], a[88:91], a[8:11], v[192:195]
    ds_read_b128 a[112:115], v1 offset:57344
    ds_read_b128 a[116:119], v2 offset:57344
    v_add_f32 v240, v240, v200
    v_mfma_f32_16x16x32_bf16 v[192:195], a[92:95], a[12:15], v[192:195]
    v_exp_f32 v202, v202
    v_mfma_f32_16x16x32_bf16 v[196:199], a[96:99], a[0:3], v[216:219]
    ds_read_b128 a[120:123], v3 offset:57344
    ds_read_b128 a[124:127], v4 offset:57344
    v_add_f32 v240, v240, v201
    v_mfma_f32_16x16x32_bf16 v[196:199], a[100:103], a[4:7], v[196:199]
    v_exp_f32 v203, v203
    v_mfma_f32_16x16x32_bf16 v[196:199], a[104:107], a[8:11], v[196:199]
    ds_read_b128 a[128:131], v1 offset:61440
    ds_read_b128 a[132:135], v2 offset:61440
    v_cvt_pk_bf16_f32 v212, v200, v201
    v_mfma_f32_16x16x32_bf16 v[196:199], a[108:111], a[12:15], v[196:199]
    v_exp_f32 v204, v204
    v_mfma_f32_16x16x32_bf16 v[128:131], a[176:179], v[208:211], v[128:131]
    ds_read_b128 a[136:139], v3 offset:61440
    ds_read_b128 a[140:143], v4 offset:61440
    v_add_f32 v240, v240, v202
    v_mfma_f32_16x16x32_bf16 v[132:135], a[180:183], v[208:211], v[132:135]
    v_exp_f32 v205, v205
    v_mfma_f32_16x16x32_bf16 v[136:139], a[184:187], v[208:211], v[136:139]
    v_add_f32 v240, v240, v203
    v_cvt_pk_bf16_f32 v213, v202, v203
    v_mfma_f32_16x16x32_bf16 v[140:143], a[188:191], v[208:211], v[140:143]
    v_exp_f32 v206, v206
    v_mfma_f32_16x16x32_bf16 v[144:147], a[192:195], v[208:211], v[144:147]
    v_add_f32 v240, v240, v204
    v_add_f32 v240, v240, v205
    v_mfma_f32_16x16x32_bf16 v[148:151], a[196:199], v[208:211], v[148:151]
    v_exp_f32 v207, v207
    v_mfma_f32_16x16x32_bf16 v[152:155], a[200:203], v[208:211], v[152:155]
    v_cvt_pk_bf16_f32 v214, v204, v205
    v_add_f32 v240, v240, v206
    v_mfma_f32_16x16x32_bf16 v[156:159], a[204:207], v[208:211], v[156:159]
    s_waitcnt lgkmcnt(0)
    v_add_f32 v240, v240, v207
    v_cvt_pk_bf16_f32 v215, v206, v207
    v_mfma_f32_16x16x32_bf16 v[200:203], a[112:115], a[0:3], v[216:219]
    v_exp_f32 v192, v192
    v_mfma_f32_16x16x32_bf16 v[200:203], a[116:119], a[4:7], v[200:203]
    v_exp_f32 v193, v193
    v_mfma_f32_16x16x32_bf16 v[200:203], a[120:123], a[8:11], v[200:203]
    v_add_f32 v236, v236, v192
    v_add_f32 v236, v236, v193
    v_mfma_f32_16x16x32_bf16 v[200:203], a[124:127], a[12:15], v[200:203]
    v_exp_f32 v194, v194
    v_mfma_f32_16x16x32_bf16 v[204:207], a[128:131], a[0:3], v[216:219]
    v_exp_f32 v195, v195
    v_mfma_f32_16x16x32_bf16 v[204:207], a[132:135], a[4:7], v[204:207]
    v_cvt_pk_bf16_f32 v208, v192, v193
    v_mfma_f32_16x16x32_bf16 v[204:207], a[136:139], a[8:11], v[204:207]
    v_add_f32 v236, v236, v194
    v_mfma_f32_16x16x32_bf16 v[204:207], a[140:143], a[12:15], v[204:207]
    v_exp_f32 v196, v196
    v_mfma_f32_16x16x32_bf16 v[160:163], a[176:179], v[212:215], v[160:163]
    v_add_f32 v236, v236, v195
    v_cvt_pk_bf16_f32 v209, v194, v195
    v_mfma_f32_16x16x32_bf16 v[164:167], a[180:183], v[212:215], v[164:167]
    v_exp_f32 v197, v197
    v_mfma_f32_16x16x32_bf16 v[168:171], a[184:187], v[212:215], v[168:171]
    v_exp_f32 v198, v198
    v_mfma_f32_16x16x32_bf16 v[172:175], a[188:191], v[212:215], v[172:175]
    v_add_f32 v236, v236, v196
    v_add_f32 v236, v236, v197
    v_mfma_f32_16x16x32_bf16 v[176:179], a[192:195], v[212:215], v[176:179]
    v_exp_f32 v199, v199
    v_mfma_f32_16x16x32_bf16 v[180:183], a[196:199], v[212:215], v[180:183]
    v_cvt_pk_bf16_f32 v210, v196, v197
    v_mfma_f32_16x16x32_bf16 v[184:187], a[200:203], v[212:215], v[184:187]
    v_add_f32 v236, v236, v198
    v_mfma_f32_16x16x32_bf16 v[188:191], a[204:207], v[212:215], v[188:191]
    v_add_f32 v236, v236, v199
    v_cvt_pk_bf16_f32 v211, v198, v199
    v_mfma_f32_16x16x32_bf16 v[192:195], a[80:83], a[16:19], v[220:223]
    v_exp_f32 v200, v200
    v_mfma_f32_16x16x32_bf16 v[192:195], a[84:87], a[20:23], v[192:195]
    v_exp_f32 v201, v201
    v_mfma_f32_16x16x32_bf16 v[192:195], a[88:91], a[24:27], v[192:195]
    ds_read_b64_tr_b16 a[176:177], v5 offset:57344
    v_add_f32 v236, v236, v200
    v_add_f32 v236, v236, v201
    v_mfma_f32_16x16x32_bf16 v[192:195], a[92:95], a[28:31], v[192:195]
    v_exp_f32 v202, v202
    v_mfma_f32_16x16x32_bf16 v[196:199], a[96:99], a[16:19], v[220:223]
    v_exp_f32 v203, v203
    v_mfma_f32_16x16x32_bf16 v[196:199], a[100:103], a[20:23], v[196:199]
    ds_read_b64_tr_b16 a[178:179], v5 offset:61440
    ds_read_b64_tr_b16 a[180:181], v6 offset:57344
    v_cvt_pk_bf16_f32 v212, v200, v201
    v_mfma_f32_16x16x32_bf16 v[196:199], a[104:107], a[24:27], v[196:199]
    ds_read_b64_tr_b16 a[182:183], v6 offset:61440
    ds_read_b64_tr_b16 a[184:185], v7 offset:57344
    v_add_f32 v236, v236, v202
    v_mfma_f32_16x16x32_bf16 v[196:199], a[108:111], a[28:31], v[196:199]
    v_exp_f32 v204, v204
    v_mfma_f32_16x16x32_bf16 v[32:35], a[144:147], v[208:211], v[32:35]
    ds_read_b64_tr_b16 a[186:187], v7 offset:61440
    v_add_f32 v236, v236, v203
    v_cvt_pk_bf16_f32 v213, v202, v203
    v_mfma_f32_16x16x32_bf16 v[36:39], a[148:151], v[208:211], v[36:39]
    v_exp_f32 v205, v205
    v_mfma_f32_16x16x32_bf16 v[40:43], a[152:155], v[208:211], v[40:43]
    v_exp_f32 v206, v206
    v_mfma_f32_16x16x32_bf16 v[44:47], a[156:159], v[208:211], v[44:47]
    ds_read_b64_tr_b16 a[188:189], v8 offset:57344
    v_add_f32 v236, v236, v204
    v_add_f32 v236, v236, v205
    v_mfma_f32_16x16x32_bf16 v[48:51], a[160:163], v[208:211], v[48:51]
    v_exp_f32 v207, v207
    v_mfma_f32_16x16x32_bf16 v[52:55], a[164:167], v[208:211], v[52:55]
    ds_read_b64_tr_b16 a[190:191], v8 offset:61440
    ds_read_b64_tr_b16 a[192:193], v9 offset:57344
    v_cvt_pk_bf16_f32 v214, v204, v205
    v_mfma_f32_16x16x32_bf16 v[56:59], a[168:171], v[208:211], v[56:59]
    ds_read_b64_tr_b16 a[194:195], v9 offset:61440
    ds_read_b64_tr_b16 a[196:197], v10 offset:57344
    v_add_f32 v236, v236, v206
    v_mfma_f32_16x16x32_bf16 v[60:63], a[172:175], v[208:211], v[60:63]
    ds_read_b64_tr_b16 a[198:199], v10 offset:61440
    v_add_f32 v236, v236, v207
    v_cvt_pk_bf16_f32 v215, v206, v207
    v_mfma_f32_16x16x32_bf16 v[200:203], a[112:115], a[16:19], v[220:223]
    ds_read_b64_tr_b16 a[200:201], v11 offset:57344
    v_exp_f32 v192, v192
    v_mov_b32 v216, v236
    v_mfma_f32_16x16x32_bf16 v[200:203], a[116:119], a[20:23], v[200:203]
    ds_read_b64_tr_b16 a[202:203], v11 offset:61440
    v_exp_f32 v193, v193
    s_nop 1
    v_permlane32_swap_b32 v236, v216
    v_mfma_f32_16x16x32_bf16 v[200:203], a[120:123], a[24:27], v[200:203]
    ds_read_b64_tr_b16 a[204:205], v12 offset:57344
    ds_read_b64_tr_b16 a[206:207], v12 offset:61440
    v_add_f32 v237, v237, v192
    v_add_f32 v237, v237, v193
    v_mfma_f32_16x16x32_bf16 v[200:203], a[124:127], a[28:31], v[200:203]
    v_exp_f32 v194, v194
    v_add_f32 v236, v236, v216
    v_mfma_f32_16x16x32_bf16 v[204:207], a[128:131], a[16:19], v[220:223]
    v_exp_f32 v195, v195
    v_mfma_f32_16x16x32_bf16 v[204:207], a[132:135], a[20:23], v[204:207]
    v_cvt_pk_bf16_f32 v208, v192, v193
    v_mov_b32 v216, v236
    v_mfma_f32_16x16x32_bf16 v[204:207], a[136:139], a[24:27], v[204:207]
    v_add_f32 v237, v237, v194
    v_mfma_f32_16x16x32_bf16 v[204:207], a[140:143], a[28:31], v[204:207]
    v_exp_f32 v196, v196
    s_waitcnt lgkmcnt(0)
    s_barrier
    s_nop 1
    v_permlane16_swap_b32 v236, v216
    v_mfma_f32_16x16x32_bf16 v[32:35], a[176:179], v[212:215], v[32:35]
    v_add_f32 v237, v237, v195
    v_cvt_pk_bf16_f32 v209, v194, v195
    v_add_f32 v236, v236, v216
    v_mfma_f32_16x16x32_bf16 v[36:39], a[180:183], v[212:215], v[36:39]
    v_exp_f32 v197, v197
    v_mfma_f32_16x16x32_bf16 v[40:43], a[184:187], v[212:215], v[40:43]
    v_exp_f32 v198, v198
    v_cmp_nge_f32 vcc, 0x53800000, v236
    v_mfma_f32_16x16x32_bf16 v[44:47], a[188:191], v[212:215], v[44:47]
    v_add_f32 v237, v237, v196
    v_add_f32 v237, v237, v197
    v_mfma_f32_16x16x32_bf16 v[48:51], a[192:195], v[212:215], v[48:51]
    v_exp_f32 v199, v199
    v_rcp_f32 v216, v236
    v_mfma_f32_16x16x32_bf16 v[52:55], a[196:199], v[212:215], v[52:55]
    v_cvt_pk_bf16_f32 v210, v196, v197
    v_mfma_f32_16x16x32_bf16 v[56:59], a[200:203], v[212:215], v[56:59]
    v_add_f32 v237, v237, v198
    s_cmp_lg_u64 vcc, 0
    s_cselect_b32 s88, 1, 0
    s_or_b32 s59, s59, s88
    v_mfma_f32_16x16x32_bf16 v[60:63], a[204:207], v[212:215], v[60:63]
    v_add_f32 v237, v237, v199
    v_cvt_pk_bf16_f32 v211, v198, v199
    v_mov_b32 v217, v216
.p2align 3
    v_pk_mul_f32 v[32:33], v[32:33], v[216:217]
    v_pk_mul_f32 v[34:35], v[34:35], v[216:217]
    v_pk_mul_f32 v[36:37], v[36:37], v[216:217]
    v_pk_mul_f32 v[38:39], v[38:39], v[216:217]
    v_cvt_pk_bf16_f32 v32, v32, v33
    v_cvt_pk_bf16_f32 v33, v34, v35
    v_cvt_pk_bf16_f32 v34, v36, v37
    v_cvt_pk_bf16_f32 v35, v38, v39
    buffer_store_dwordx4 v[32:35], v245, s[36:39], 0 offen offset:0 sc1
    v_pk_mul_f32 v[40:41], v[40:41], v[216:217]
    v_pk_mul_f32 v[42:43], v[42:43], v[216:217]
    v_pk_mul_f32 v[44:45], v[44:45], v[216:217]
    v_pk_mul_f32 v[46:47], v[46:47], v[216:217]
    v_cvt_pk_bf16_f32 v40, v40, v41
    v_cvt_pk_bf16_f32 v41, v42, v43
    v_cvt_pk_bf16_f32 v42, v44, v45
    v_cvt_pk_bf16_f32 v43, v46, v47
    buffer_store_dwordx4 v[40:43], v245, s[36:39], 0 offen offset:1024 sc1
    v_pk_mul_f32 v[48:49], v[48:49], v[216:217]
    v_pk_mul_f32 v[50:51], v[50:51], v[216:217]
    v_pk_mul_f32 v[52:53], v[52:53], v[216:217]
    v_pk_mul_f32 v[54:55], v[54:55], v[216:217]
    v_cvt_pk_bf16_f32 v48, v48, v49
    v_cvt_pk_bf16_f32 v49, v50, v51
    v_cvt_pk_bf16_f32 v50, v52, v53
    v_cvt_pk_bf16_f32 v51, v54, v55
    buffer_store_dwordx4 v[48:51], v245, s[36:39], 0 offen offset:2048 sc1
    v_pk_mul_f32 v[56:57], v[56:57], v[216:217]
    v_pk_mul_f32 v[58:59], v[58:59], v[216:217]
    v_pk_mul_f32 v[60:61], v[60:61], v[216:217]
    v_pk_mul_f32 v[62:63], v[62:63], v[216:217]
    v_cvt_pk_bf16_f32 v56, v56, v57
    v_cvt_pk_bf16_f32 v57, v58, v59
    v_cvt_pk_bf16_f32 v58, v60, v61
    v_cvt_pk_bf16_f32 v59, v62, v63
    buffer_store_dwordx4 v[56:59], v245, s[36:39], 0 offen offset:3072 sc1
    s_waitcnt vmcnt(36)
    v_mfma_f32_16x16x32_bf16 v[192:195], a[80:83], a[32:35], v[224:227]
    s_add_u32 m0, s45, 49152
    v_exp_f32 v200, v200
    v_mfma_f32_16x16x32_bf16 v[192:195], a[84:87], a[36:39], v[192:195]
    s_xor_b32 s61, s3, 163968
    v_exp_f32 v201, v201
    v_mfma_f32_16x16x32_bf16 v[192:195], a[88:91], a[40:43], v[192:195]
    ds_read_b64_tr_b16 v[32:33], v24 offset:0
    v_add_f32 v237, v237, v200
    v_add_f32 v237, v237, v201
    v_mfma_f32_16x16x32_bf16 v[192:195], a[92:95], a[44:47], v[192:195]
    buffer_load_dwordx4 v241, s[64:67], s61 offen offset:0 lds
    v_exp_f32 v202, v202
    v_mfma_f32_16x16x32_bf16 v[196:199], a[96:99], a[32:35], v[224:227]
    buffer_load_dwordx4 v242, s[64:67], s61 offen offset:1024 lds
    v_exp_f32 v203, v203
    v_mfma_f32_16x16x32_bf16 v[196:199], a[100:103], a[36:39], v[196:199]
    ds_read_b64_tr_b16 v[34:35], v24 offset:2048
    v_cvt_pk_bf16_f32 v212, v200, v201
    v_mfma_f32_16x16x32_bf16 v[196:199], a[104:107], a[40:43], v[196:199]
    ds_read_b64_tr_b16 v[36:37], v25 offset:0
    v_add_f32 v237, v237, v202
    v_mfma_f32_16x16x32_bf16 v[196:199], a[108:111], a[44:47], v[196:199]
    buffer_load_dwordx4 v243, s[64:67], s61 offen offset:2048 lds
    v_exp_f32 v204, v204
    v_mfma_f32_16x16x32_bf16 v[64:67], a[144:147], v[208:211], v[64:67]
    ds_read_b64_tr_b16 v[38:39], v25 offset:2048
    v_add_f32 v237, v237, v203
    v_cvt_pk_bf16_f32 v213, v202, v203
    v_mfma_f32_16x16x32_bf16 v[68:71], a[148:151], v[208:211], v[68:71]
    buffer_load_dwordx4 v244, s[64:67], s61 offen offset:3072 lds
    v_exp_f32 v205, v205
    v_mfma_f32_16x16x32_bf16 v[72:75], a[152:155], v[208:211], v[72:75]
    v_exp_f32 v206, v206
    v_mfma_f32_16x16x32_bf16 v[76:79], a[156:159], v[208:211], v[76:79]
    ds_read_b64_tr_b16 v[40:41], v26 offset:0
    v_add_f32 v237, v237, v204
    v_add_f32 v237, v237, v205
    v_mfma_f32_16x16x32_bf16 v[80:83], a[160:163], v[208:211], v[80:83]
    v_exp_f32 v207, v207
    v_mfma_f32_16x16x32_bf16 v[84:87], a[164:167], v[208:211], v[84:87]
    ds_read_b64_tr_b16 v[42:43], v26 offset:2048
    v_cvt_pk_bf16_f32 v214, v204, v205
    v_mfma_f32_16x16x32_bf16 v[88:91], a[168:171], v[208:211], v[88:91]
    ds_read_b64_tr_b16 v[44:45], v27 offset:0
    v_add_f32 v237, v237, v206
    v_mfma_f32_16x16x32_bf16 v[92:95], a[172:175], v[208:211], v[92:95]
    ds_read_b64_tr_b16 v[46:47], v27 offset:2048
    v_add_f32 v237, v237, v207
    v_cvt_pk_bf16_f32 v215, v206, v207
    s_waitcnt vmcnt(35)
    v_mfma_f32_16x16x32_bf16 v[200:203], a[112:115], a[32:35], v[224:227]
    s_add_u32 m0, s45, 114688
    v_exp_f32 v192, v192
    v_mov_b32 v220, v237
    v_mfma_f32_16x16x32_bf16 v[200:203], a[116:119], a[36:39], v[200:203]
    s_xor_b32 s61, s3, 196608
    v_exp_f32 v193, v193
    s_nop 1
    v_permlane32_swap_b32 v237, v220
    v_mfma_f32_16x16x32_bf16 v[200:203], a[120:123], a[40:43], v[200:203]
    ds_read_b64_tr_b16 v[48:49], v20 offset:16384
    v_add_f32 v238, v238, v192
    v_add_f32 v238, v238, v193
    v_mfma_f32_16x16x32_bf16 v[200:203], a[124:127], a[44:47], v[200:203]
    buffer_load_dwordx4 v241, s[64:67], s61 offen offset:0 lds
    v_exp_f32 v194, v194
    v_add_f32 v237, v237, v220
    v_mfma_f32_16x16x32_bf16 v[204:207], a[128:131], a[32:35], v[224:227]
    buffer_load_dwordx4 v242, s[64:67], s61 offen offset:1024 lds
    v_exp_f32 v195, v195
    v_mfma_f32_16x16x32_bf16 v[204:207], a[132:135], a[36:39], v[204:207]
    ds_read_b64_tr_b16 v[50:51], v20 offset:18432
    v_cvt_pk_bf16_f32 v208, v192, v193
    v_mov_b32 v220, v237
    v_mfma_f32_16x16x32_bf16 v[204:207], a[136:139], a[40:43], v[204:207]
    ds_read_b64_tr_b16 v[52:53], v21 offset:16384
    v_add_f32 v238, v238, v194
    v_mfma_f32_16x16x32_bf16 v[204:207], a[140:143], a[44:47], v[204:207]
    buffer_load_dwordx4 v243, s[64:67], s61 offen offset:2048 lds
    v_exp_f32 v196, v196
    s_nop 1
    v_permlane16_swap_b32 v237, v220
    v_mfma_f32_16x16x32_bf16 v[64:67], a[176:179], v[212:215], v[64:67]
    ds_read_b64_tr_b16 v[54:55], v21 offset:18432
    v_add_f32 v238, v238, v195
    v_cvt_pk_bf16_f32 v209, v194, v195
    v_add_f32 v237, v237, v220
    v_mfma_f32_16x16x32_bf16 v[68:71], a[180:183], v[212:215], v[68:71]
    buffer_load_dwordx4 v244, s[64:67], s61 offen offset:3072 lds
    v_exp_f32 v197, v197
    v_mfma_f32_16x16x32_bf16 v[72:75], a[184:187], v[212:215], v[72:75]
    v_exp_f32 v198, v198
    v_cmp_nge_f32 vcc, 0x53800000, v237
    v_mfma_f32_16x16x32_bf16 v[76:79], a[188:191], v[212:215], v[76:79]
    ds_read_b64_tr_b16 v[56:57], v22 offset:16384
    v_add_f32 v238, v238, v196
    v_add_f32 v238, v238, v197
    v_mfma_f32_16x16x32_bf16 v[80:83], a[192:195], v[212:215], v[80:83]
    v_exp_f32 v199, v199
    v_rcp_f32 v220, v237
    v_mfma_f32_16x16x32_bf16 v[84:87], a[196:199], v[212:215], v[84:87]
    ds_read_b64_tr_b16 v[58:59], v22 offset:18432
    v_cvt_pk_bf16_f32 v210, v196, v197
    v_mfma_f32_16x16x32_bf16 v[88:91], a[200:203], v[212:215], v[88:91]
    ds_read_b64_tr_b16 v[60:61], v23 offset:16384
    v_add_f32 v238, v238, v198
    s_cmp_lg_u64 vcc, 0
    s_cselect_b32 s88, 2, 0
    s_or_b32 s59, s59, s88
    v_mfma_f32_16x16x32_bf16 v[92:95], a[204:207], v[212:215], v[92:95]
    ds_read_b64_tr_b16 v[62:63], v23 offset:18432
    v_add_f32 v238, v238, v199
    v_cvt_pk_bf16_f32 v211, v198, v199
    s_waitcnt lgkmcnt(0)
    v_mov_b32 v221, v220
.p2align 3
    v_pk_mul_f32 v[64:65], v[64:65], v[220:221]
    v_pk_mul_f32 v[66:67], v[66:67], v[220:221]
    v_pk_mul_f32 v[68:69], v[68:69], v[220:221]
    v_pk_mul_f32 v[70:71], v[70:71], v[220:221]
    v_cvt_pk_bf16_f32 v64, v64, v65
    v_cvt_pk_bf16_f32 v65, v66, v67
    v_cvt_pk_bf16_f32 v66, v68, v69
    v_cvt_pk_bf16_f32 v67, v70, v71
    buffer_store_dwordx4 v[64:67], v246, s[36:39], 0 offen offset:0 sc1
    v_pk_mul_f32 v[72:73], v[72:73], v[220:221]
    v_pk_mul_f32 v[74:75], v[74:75], v[220:221]
    v_pk_mul_f32 v[76:77], v[76:77], v[220:221]
    v_pk_mul_f32 v[78:79], v[78:79], v[220:221]
    v_cvt_pk_bf16_f32 v72, v72, v73
    v_cvt_pk_bf16_f32 v73, v74, v75
    v_cvt_pk_bf16_f32 v74, v76, v77
    v_cvt_pk_bf16_f32 v75, v78, v79
    buffer_store_dwordx4 v[72:75], v246, s[36:39], 0 offen offset:1024 sc1
    v_pk_mul_f32 v[80:81], v[80:81], v[220:221]
    v_pk_mul_f32 v[82:83], v[82:83], v[220:221]
    v_pk_mul_f32 v[84:85], v[84:85], v[220:221]
    v_pk_mul_f32 v[86:87], v[86:87], v[220:221]
    v_cvt_pk_bf16_f32 v80, v80, v81
    v_cvt_pk_bf16_f32 v81, v82, v83
    v_cvt_pk_bf16_f32 v82, v84, v85
    v_cvt_pk_bf16_f32 v83, v86, v87
    buffer_store_dwordx4 v[80:83], v246, s[36:39], 0 offen offset:2048 sc1
    v_pk_mul_f32 v[88:89], v[88:89], v[220:221]
    v_pk_mul_f32 v[90:91], v[90:91], v[220:221]
    v_pk_mul_f32 v[92:93], v[92:93], v[220:221]
    v_pk_mul_f32 v[94:95], v[94:95], v[220:221]
    v_cvt_pk_bf16_f32 v88, v88, v89
    v_cvt_pk_bf16_f32 v89, v90, v91
    v_cvt_pk_bf16_f32 v90, v92, v93
    v_cvt_pk_bf16_f32 v91, v94, v95
    buffer_store_dwordx4 v[88:91], v246, s[36:39], 0 offen offset:3072 sc1
    s_waitcnt vmcnt(38)
    v_mfma_f32_16x16x32_bf16 v[192:195], a[80:83], a[48:51], v[228:231]
    s_add_u32 m0, s45, 65536
    v_exp_f32 v200, v200
    v_mfma_f32_16x16x32_bf16 v[192:195], a[84:87], a[52:55], v[192:195]
    s_xor_b32 s61, s3, 196736
    v_exp_f32 v201, v201
    v_mfma_f32_16x16x32_bf16 v[192:195], a[88:91], a[56:59], v[192:195]
    ds_read_b64_tr_b16 v[64:65], v24 offset:16384
    v_add_f32 v238, v238, v200
    v_add_f32 v238, v238, v201
    v_mfma_f32_16x16x32_bf16 v[192:195], a[92:95], a[60:63], v[192:195]
    buffer_load_dwordx4 v241, s[64:67], s61 offen offset:0 lds
    v_exp_f32 v202, v202
    v_mfma_f32_16x16x32_bf16 v[196:199], a[96:99], a[48:51], v[228:231]
    buffer_load_dwordx4 v242, s[64:67], s61 offen offset:1024 lds
    v_exp_f32 v203, v203
    v_mfma_f32_16x16x32_bf16 v[196:199], a[100:103], a[52:55], v[196:199]
    ds_read_b64_tr_b16 v[66:67], v24 offset:18432
    v_cvt_pk_bf16_f32 v212, v200, v201
    v_mfma_f32_16x16x32_bf16 v[196:199], a[104:107], a[56:59], v[196:199]
    ds_read_b64_tr_b16 v[68:69], v25 offset:16384
    v_add_f32 v238, v238, v202
    v_mfma_f32_16x16x32_bf16 v[196:199], a[108:111], a[60:63], v[196:199]
    buffer_load_dwordx4 v243, s[64:67], s61 offen offset:2048 lds
    v_exp_f32 v204, v204
    v_mfma_f32_16x16x32_bf16 v[96:99], a[144:147], v[208:211], v[96:99]
    ds_read_b64_tr_b16 v[70:71], v25 offset:18432
    v_add_f32 v238, v238, v203
    v_cvt_pk_bf16_f32 v213, v202, v203
    v_mfma_f32_16x16x32_bf16 v[100:103], a[148:151], v[208:211], v[100:103]
    buffer_load_dwordx4 v244, s[64:67], s61 offen offset:3072 lds
    v_exp_f32 v205, v205
    v_mfma_f32_16x16x32_bf16 v[104:107], a[152:155], v[208:211], v[104:107]
    v_exp_f32 v206, v206
    v_mfma_f32_16x16x32_bf16 v[108:111], a[156:159], v[208:211], v[108:111]
    ds_read_b64_tr_b16 v[72:73], v26 offset:16384
    v_add_f32 v238, v238, v204
    v_add_f32 v238, v238, v205
    v_mfma_f32_16x16x32_bf16 v[112:115], a[160:163], v[208:211], v[112:115]
    v_exp_f32 v207, v207
    v_mfma_f32_16x16x32_bf16 v[116:119], a[164:167], v[208:211], v[116:119]
    ds_read_b64_tr_b16 v[74:75], v26 offset:18432
    v_cvt_pk_bf16_f32 v214, v204, v205
    v_mfma_f32_16x16x32_bf16 v[120:123], a[168:171], v[208:211], v[120:123]
    ds_read_b64_tr_b16 v[76:77], v27 offset:16384
    v_add_f32 v238, v238, v206
    v_mfma_f32_16x16x32_bf16 v[124:127], a[172:175], v[208:211], v[124:127]
    ds_read_b64_tr_b16 v[78:79], v27 offset:18432
    v_add_f32 v238, v238, v207
    v_cvt_pk_bf16_f32 v215, v206, v207
    s_waitcnt vmcnt(38)
    v_mfma_f32_16x16x32_bf16 v[200:203], a[112:115], a[48:51], v[228:231]
    s_add_u32 m0, s45, 16384
    v_exp_f32 v192, v192
    v_mov_b32 v224, v238
    v_mfma_f32_16x16x32_bf16 v[200:203], a[116:119], a[52:55], v[200:203]
    s_xor_b32 s61, s3, 229376
    v_exp_f32 v193, v193
    s_nop 1
    v_permlane32_swap_b32 v238, v224
    v_mfma_f32_16x16x32_bf16 v[200:203], a[120:123], a[56:59], v[200:203]
    ds_read_b64_tr_b16 v[80:81], v28 offset:0
    v_add_f32 v239, v239, v192
    v_add_f32 v239, v239, v193
    v_mfma_f32_16x16x32_bf16 v[200:203], a[124:127], a[60:63], v[200:203]
    buffer_load_dwordx4 v241, s[64:67], s61 offen offset:0 lds
    v_exp_f32 v194, v194
    v_add_f32 v238, v238, v224
    v_mfma_f32_16x16x32_bf16 v[204:207], a[128:131], a[48:51], v[228:231]
    buffer_load_dwordx4 v242, s[64:67], s61 offen offset:1024 lds
    v_exp_f32 v195, v195
    v_mfma_f32_16x16x32_bf16 v[204:207], a[132:135], a[52:55], v[204:207]
    ds_read_b64_tr_b16 v[82:83], v28 offset:2048
    v_cvt_pk_bf16_f32 v208, v192, v193
    v_mov_b32 v224, v238
    v_mfma_f32_16x16x32_bf16 v[204:207], a[136:139], a[56:59], v[204:207]
    ds_read_b64_tr_b16 v[84:85], v29 offset:0
    v_add_f32 v239, v239, v194
    v_mfma_f32_16x16x32_bf16 v[204:207], a[140:143], a[60:63], v[204:207]
    buffer_load_dwordx4 v243, s[64:67], s61 offen offset:2048 lds
    v_exp_f32 v196, v196
    s_nop 1
    v_permlane16_swap_b32 v238, v224
    v_mfma_f32_16x16x32_bf16 v[96:99], a[176:179], v[212:215], v[96:99]
    ds_read_b64_tr_b16 v[86:87], v29 offset:2048
    v_add_f32 v239, v239, v195
    v_cvt_pk_bf16_f32 v209, v194, v195
    v_add_f32 v238, v238, v224
    v_mfma_f32_16x16x32_bf16 v[100:103], a[180:183], v[212:215], v[100:103]
    buffer_load_dwordx4 v244, s[64:67], s61 offen offset:3072 lds
    v_exp_f32 v197, v197
    v_mfma_f32_16x16x32_bf16 v[104:107], a[184:187], v[212:215], v[104:107]
    v_exp_f32 v198, v198
    v_cmp_nge_f32 vcc, 0x53800000, v238
    v_mfma_f32_16x16x32_bf16 v[108:111], a[188:191], v[212:215], v[108:111]
    ds_read_b64_tr_b16 v[88:89], v30 offset:0
    v_add_f32 v239, v239, v196
    v_add_f32 v239, v239, v197
    v_mfma_f32_16x16x32_bf16 v[112:115], a[192:195], v[212:215], v[112:115]
    v_exp_f32 v199, v199
    v_rcp_f32 v224, v238
    v_mfma_f32_16x16x32_bf16 v[116:119], a[196:199], v[212:215], v[116:119]
    ds_read_b64_tr_b16 v[90:91], v30 offset:2048
    v_cvt_pk_bf16_f32 v210, v196, v197
    v_mfma_f32_16x16x32_bf16 v[120:123], a[200:203], v[212:215], v[120:123]
    ds_read_b64_tr_b16 v[92:93], v31 offset:0
    v_add_f32 v239, v239, v198
    s_cmp_lg_u64 vcc, 0
    s_cselect_b32 s88, 4, 0
    s_or_b32 s59, s59, s88
    v_mfma_f32_16x16x32_bf16 v[124:127], a[204:207], v[212:215], v[124:127]
    ds_read_b64_tr_b16 v[94:95], v31 offset:2048
    v_add_f32 v239, v239, v199
    v_cvt_pk_bf16_f32 v211, v198, v199
    v_mov_b32 v225, v224
.p2align 3
    v_pk_mul_f32 v[96:97], v[96:97], v[224:225]
    v_pk_mul_f32 v[98:99], v[98:99], v[224:225]
    v_pk_mul_f32 v[100:101], v[100:101], v[224:225]
    v_pk_mul_f32 v[102:103], v[102:103], v[224:225]
    v_cvt_pk_bf16_f32 v96, v96, v97
    v_cvt_pk_bf16_f32 v97, v98, v99
    v_cvt_pk_bf16_f32 v98, v100, v101
    v_cvt_pk_bf16_f32 v99, v102, v103
    buffer_store_dwordx4 v[96:99], v247, s[36:39], 0 offen offset:0 sc1
    v_pk_mul_f32 v[104:105], v[104:105], v[224:225]
    v_pk_mul_f32 v[106:107], v[106:107], v[224:225]
    v_pk_mul_f32 v[108:109], v[108:109], v[224:225]
    v_pk_mul_f32 v[110:111], v[110:111], v[224:225]
    v_cvt_pk_bf16_f32 v104, v104, v105
    v_cvt_pk_bf16_f32 v105, v106, v107
    v_cvt_pk_bf16_f32 v106, v108, v109
    v_cvt_pk_bf16_f32 v107, v110, v111
    buffer_store_dwordx4 v[104:107], v247, s[36:39], 0 offen offset:1024 sc1
    v_pk_mul_f32 v[112:113], v[112:113], v[224:225]
    v_pk_mul_f32 v[114:115], v[114:115], v[224:225]
    v_pk_mul_f32 v[116:117], v[116:117], v[224:225]
    v_pk_mul_f32 v[118:119], v[118:119], v[224:225]
    v_cvt_pk_bf16_f32 v112, v112, v113
    v_cvt_pk_bf16_f32 v113, v114, v115
    v_cvt_pk_bf16_f32 v114, v116, v117
    v_cvt_pk_bf16_f32 v115, v118, v119
    buffer_store_dwordx4 v[112:115], v247, s[36:39], 0 offen offset:2048 sc1
    v_pk_mul_f32 v[120:121], v[120:121], v[224:225]
    v_pk_mul_f32 v[122:123], v[122:123], v[224:225]
    v_pk_mul_f32 v[124:125], v[124:125], v[224:225]
    v_pk_mul_f32 v[126:127], v[126:127], v[224:225]
    v_cvt_pk_bf16_f32 v120, v120, v121
    v_cvt_pk_bf16_f32 v121, v122, v123
    v_cvt_pk_bf16_f32 v122, v124, v125
    v_cvt_pk_bf16_f32 v123, v126, v127
    buffer_store_dwordx4 v[120:123], v247, s[36:39], 0 offen offset:3072 sc1
    s_waitcnt vmcnt(42)
    v_mfma_f32_16x16x32_bf16 v[192:195], a[80:83], a[64:67], v[232:235]
    v_exp_f32 v200, v200
    v_mfma_f32_16x16x32_bf16 v[192:195], a[84:87], a[68:71], v[192:195]
    v_exp_f32 v201, v201
    v_mfma_f32_16x16x32_bf16 v[192:195], a[88:91], a[72:75], v[192:195]
    ds_read_b64_tr_b16 v[96:97], v28 offset:4096
    v_add_f32 v239, v239, v200
    v_add_f32 v239, v239, v201
    v_mfma_f32_16x16x32_bf16 v[192:195], a[92:95], a[76:79], v[192:195]
    v_exp_f32 v202, v202
    v_mfma_f32_16x16x32_bf16 v[196:199], a[96:99], a[64:67], v[232:235]
    v_exp_f32 v203, v203
    v_mfma_f32_16x16x32_bf16 v[196:199], a[100:103], a[68:71], v[196:199]
    ds_read_b64_tr_b16 v[98:99], v28 offset:6144
    v_cvt_pk_bf16_f32 v212, v200, v201
    v_mfma_f32_16x16x32_bf16 v[196:199], a[104:107], a[72:75], v[196:199]
    ds_read_b64_tr_b16 v[100:101], v29 offset:4096
    v_add_f32 v239, v239, v202
    v_mfma_f32_16x16x32_bf16 v[196:199], a[108:111], a[76:79], v[196:199]
    v_exp_f32 v204, v204
    v_mfma_f32_16x16x32_bf16 v[128:131], a[144:147], v[208:211], v[128:131]
    ds_read_b64_tr_b16 v[102:103], v29 offset:6144
    v_add_f32 v239, v239, v203
    v_cvt_pk_bf16_f32 v213, v202, v203
    v_mfma_f32_16x16x32_bf16 v[132:135], a[148:151], v[208:211], v[132:135]
    v_exp_f32 v205, v205
    v_mfma_f32_16x16x32_bf16 v[136:139], a[152:155], v[208:211], v[136:139]
    v_exp_f32 v206, v206
    v_mfma_f32_16x16x32_bf16 v[140:143], a[156:159], v[208:211], v[140:143]
    ds_read_b64_tr_b16 v[104:105], v30 offset:4096
    v_add_f32 v239, v239, v204
    v_add_f32 v239, v239, v205
    v_mfma_f32_16x16x32_bf16 v[144:147], a[160:163], v[208:211], v[144:147]
    v_exp_f32 v207, v207
    v_mfma_f32_16x16x32_bf16 v[148:151], a[164:167], v[208:211], v[148:151]
    ds_read_b64_tr_b16 v[106:107], v30 offset:6144
    v_cvt_pk_bf16_f32 v214, v204, v205
    v_mfma_f32_16x16x32_bf16 v[152:155], a[168:171], v[208:211], v[152:155]
    ds_read_b64_tr_b16 v[108:109], v31 offset:4096
    v_add_f32 v239, v239, v206
    v_mfma_f32_16x16x32_bf16 v[156:159], a[172:175], v[208:211], v[156:159]
    ds_read_b64_tr_b16 v[110:111], v31 offset:6144
    v_add_f32 v239, v239, v207
    v_cvt_pk_bf16_f32 v215, v206, v207
    s_waitcnt vmcnt(37)
    v_mfma_f32_16x16x32_bf16 v[200:203], a[112:115], a[64:67], v[232:235]
    v_exp_f32 v192, v192
    v_mov_b32 v228, v239
    v_mfma_f32_16x16x32_bf16 v[200:203], a[116:119], a[68:71], v[200:203]
    v_exp_f32 v193, v193
    s_nop 1
    v_permlane32_swap_b32 v239, v228
    v_mfma_f32_16x16x32_bf16 v[200:203], a[120:123], a[72:75], v[200:203]
    ds_read_b64_tr_b16 v[112:113], v20 offset:0
    v_add_f32 v240, v240, v192
    v_add_f32 v240, v240, v193
    v_mfma_f32_16x16x32_bf16 v[200:203], a[124:127], a[76:79], v[200:203]
    v_exp_f32 v194, v194
    v_add_f32 v239, v239, v228
    v_mfma_f32_16x16x32_bf16 v[204:207], a[128:131], a[64:67], v[232:235]
    v_exp_f32 v195, v195
    v_mfma_f32_16x16x32_bf16 v[204:207], a[132:135], a[68:71], v[204:207]
    ds_read_b64_tr_b16 v[114:115], v20 offset:2048
    v_cvt_pk_bf16_f32 v208, v192, v193
    v_mov_b32 v228, v239
    v_mfma_f32_16x16x32_bf16 v[204:207], a[136:139], a[72:75], v[204:207]
    ds_read_b64_tr_b16 v[116:117], v21 offset:0
    v_add_f32 v240, v240, v194
    v_mfma_f32_16x16x32_bf16 v[204:207], a[140:143], a[76:79], v[204:207]
    v_exp_f32 v196, v196
    s_nop 1
    v_permlane16_swap_b32 v239, v228
    v_mfma_f32_16x16x32_bf16 v[128:131], a[176:179], v[212:215], v[128:131]
    ds_read_b64_tr_b16 v[118:119], v21 offset:2048
    v_add_f32 v240, v240, v195
    v_cvt_pk_bf16_f32 v209, v194, v195
    v_add_f32 v239, v239, v228
    v_mfma_f32_16x16x32_bf16 v[132:135], a[180:183], v[212:215], v[132:135]
    v_exp_f32 v197, v197
    v_mfma_f32_16x16x32_bf16 v[136:139], a[184:187], v[212:215], v[136:139]
    v_exp_f32 v198, v198
    v_cmp_nge_f32 vcc, 0x53800000, v239
    v_mfma_f32_16x16x32_bf16 v[140:143], a[188:191], v[212:215], v[140:143]
    ds_read_b64_tr_b16 v[120:121], v22 offset:0
    v_add_f32 v240, v240, v196
    v_add_f32 v240, v240, v197
    v_mfma_f32_16x16x32_bf16 v[144:147], a[192:195], v[212:215], v[144:147]
    v_exp_f32 v199, v199
    v_rcp_f32 v228, v239
    v_mfma_f32_16x16x32_bf16 v[148:151], a[196:199], v[212:215], v[148:151]
    ds_read_b64_tr_b16 v[122:123], v22 offset:2048
    v_cvt_pk_bf16_f32 v210, v196, v197
    v_mfma_f32_16x16x32_bf16 v[152:155], a[200:203], v[212:215], v[152:155]
    ds_read_b64_tr_b16 v[124:125], v23 offset:0
    v_add_f32 v240, v240, v198
    s_cmp_lg_u64 vcc, 0
    s_cselect_b32 s88, 8, 0
    s_or_b32 s59, s59, s88
    v_mfma_f32_16x16x32_bf16 v[156:159], a[204:207], v[212:215], v[156:159]
    ds_read_b64_tr_b16 v[126:127], v23 offset:2048
    v_add_f32 v240, v240, v199
    v_cvt_pk_bf16_f32 v211, v198, v199
    v_mov_b32 v229, v228
.p2align 3
    v_pk_mul_f32 v[128:129], v[128:129], v[228:229]
    v_pk_mul_f32 v[130:131], v[130:131], v[228:229]
    v_pk_mul_f32 v[132:133], v[132:133], v[228:229]
    v_pk_mul_f32 v[134:135], v[134:135], v[228:229]
    v_cvt_pk_bf16_f32 v128, v128, v129
    v_cvt_pk_bf16_f32 v129, v130, v131
    v_cvt_pk_bf16_f32 v130, v132, v133
    v_cvt_pk_bf16_f32 v131, v134, v135
    buffer_store_dwordx4 v[128:131], v248, s[36:39], 0 offen offset:0 sc1
    v_pk_mul_f32 v[136:137], v[136:137], v[228:229]
    v_pk_mul_f32 v[138:139], v[138:139], v[228:229]
    v_pk_mul_f32 v[140:141], v[140:141], v[228:229]
    v_pk_mul_f32 v[142:143], v[142:143], v[228:229]
    v_cvt_pk_bf16_f32 v136, v136, v137
    v_cvt_pk_bf16_f32 v137, v138, v139
    v_cvt_pk_bf16_f32 v138, v140, v141
    v_cvt_pk_bf16_f32 v139, v142, v143
    buffer_store_dwordx4 v[136:139], v248, s[36:39], 0 offen offset:1024 sc1
    v_pk_mul_f32 v[144:145], v[144:145], v[228:229]
    v_pk_mul_f32 v[146:147], v[146:147], v[228:229]
    v_pk_mul_f32 v[148:149], v[148:149], v[228:229]
    v_pk_mul_f32 v[150:151], v[150:151], v[228:229]
    v_cvt_pk_bf16_f32 v144, v144, v145
    v_cvt_pk_bf16_f32 v145, v146, v147
    v_cvt_pk_bf16_f32 v146, v148, v149
    v_cvt_pk_bf16_f32 v147, v150, v151
    buffer_store_dwordx4 v[144:147], v248, s[36:39], 0 offen offset:2048 sc1
    v_pk_mul_f32 v[152:153], v[152:153], v[228:229]
    v_pk_mul_f32 v[154:155], v[154:155], v[228:229]
    v_pk_mul_f32 v[156:157], v[156:157], v[228:229]
    v_pk_mul_f32 v[158:159], v[158:159], v[228:229]
    v_cvt_pk_bf16_f32 v152, v152, v153
    v_cvt_pk_bf16_f32 v153, v154, v155
    v_cvt_pk_bf16_f32 v154, v156, v157
    v_cvt_pk_bf16_f32 v155, v158, v159
    buffer_store_dwordx4 v[152:155], v248, s[36:39], 0 offen offset:3072 sc1
    s_nop 1
    v_mfma_f32_16x16x32_bf16 v[160:163], a[144:147], v[208:211], v[160:163]
    v_exp_f32 v200, v200
    v_exp_f32 v201, v201
    v_add_f32 v240, v240, v200
    v_mfma_f32_16x16x32_bf16 v[164:167], a[148:151], v[208:211], v[164:167]
    v_add_f32 v240, v240, v201
    v_exp_f32 v202, v202
    v_mfma_f32_16x16x32_bf16 v[168:171], a[152:155], v[208:211], v[168:171]
    v_exp_f32 v203, v203
    v_cvt_pk_bf16_f32 v212, v200, v201
    v_add_f32 v240, v240, v202
    v_mfma_f32_16x16x32_bf16 v[172:175], a[156:159], v[208:211], v[172:175]
    v_exp_f32 v204, v204
    v_add_f32 v240, v240, v203
    v_mfma_f32_16x16x32_bf16 v[176:179], a[160:163], v[208:211], v[176:179]
    v_cvt_pk_bf16_f32 v213, v202, v203
    v_exp_f32 v205, v205
    v_exp_f32 v206, v206
    v_mfma_f32_16x16x32_bf16 v[180:183], a[164:167], v[208:211], v[180:183]
    v_add_f32 v240, v240, v204
    v_add_f32 v240, v240, v205
    v_mfma_f32_16x16x32_bf16 v[184:187], a[168:171], v[208:211], v[184:187]
    v_exp_f32 v207, v207
    v_cvt_pk_bf16_f32 v214, v204, v205
    v_add_f32 v240, v240, v206
    v_mfma_f32_16x16x32_bf16 v[188:191], a[172:175], v[208:211], v[188:191]
    v_add_f32 v240, v240, v207
    v_cvt_pk_bf16_f32 v215, v206, v207
    s_nop 1
    v_mfma_f32_16x16x32_bf16 v[160:163], a[176:179], v[212:215], v[160:163]
    v_mov_b32 v232, v240
    s_nop 1
    v_permlane32_swap_b32 v240, v232
    v_mfma_f32_16x16x32_bf16 v[164:167], a[180:183], v[212:215], v[164:167]
    v_add_f32 v240, v240, v232
    v_mfma_f32_16x16x32_bf16 v[168:171], a[184:187], v[212:215], v[168:171]
    v_mov_b32 v232, v240
    v_mfma_f32_16x16x32_bf16 v[172:175], a[188:191], v[212:215], v[172:175]
    s_nop 1
    v_permlane16_swap_b32 v240, v232
    v_mfma_f32_16x16x32_bf16 v[176:179], a[192:195], v[212:215], v[176:179]
    v_add_f32 v240, v240, v232
    v_mfma_f32_16x16x32_bf16 v[180:183], a[196:199], v[212:215], v[180:183]
    v_cmp_nge_f32 vcc, 0x53800000, v240
    v_mfma_f32_16x16x32_bf16 v[184:187], a[200:203], v[212:215], v[184:187]
    v_rcp_f32 v232, v240
    v_mfma_f32_16x16x32_bf16 v[188:191], a[204:207], v[212:215], v[188:191]
    s_cmp_lg_u64 vcc, 0
    s_cselect_b32 s88, 16, 0
    s_or_b32 s59, s59, s88
    v_mov_b32 v233, v232
.p2align 3
    v_pk_mul_f32 v[160:161], v[160:161], v[232:233]
    v_pk_mul_f32 v[162:163], v[162:163], v[232:233]
    v_pk_mul_f32 v[164:165], v[164:165], v[232:233]
    v_pk_mul_f32 v[166:167], v[166:167], v[232:233]
    v_cvt_pk_bf16_f32 v160, v160, v161
    v_cvt_pk_bf16_f32 v161, v162, v163
    v_cvt_pk_bf16_f32 v162, v164, v165
    v_cvt_pk_bf16_f32 v163, v166, v167
    buffer_store_dwordx4 v[160:163], v249, s[36:39], 0 offen offset:0 sc1
    v_pk_mul_f32 v[168:169], v[168:169], v[232:233]
    v_pk_mul_f32 v[170:171], v[170:171], v[232:233]
    v_pk_mul_f32 v[172:173], v[172:173], v[232:233]
    v_pk_mul_f32 v[174:175], v[174:175], v[232:233]
    v_cvt_pk_bf16_f32 v168, v168, v169
    v_cvt_pk_bf16_f32 v169, v170, v171
    v_cvt_pk_bf16_f32 v170, v172, v173
    v_cvt_pk_bf16_f32 v171, v174, v175
    buffer_store_dwordx4 v[168:171], v249, s[36:39], 0 offen offset:1024 sc1
    v_pk_mul_f32 v[176:177], v[176:177], v[232:233]
    v_pk_mul_f32 v[178:179], v[178:179], v[232:233]
    v_pk_mul_f32 v[180:181], v[180:181], v[232:233]
    v_pk_mul_f32 v[182:183], v[182:183], v[232:233]
    v_cvt_pk_bf16_f32 v176, v176, v177
    v_cvt_pk_bf16_f32 v177, v178, v179
    v_cvt_pk_bf16_f32 v178, v180, v181
    v_cvt_pk_bf16_f32 v179, v182, v183
    buffer_store_dwordx4 v[176:179], v249, s[36:39], 0 offen offset:2048 sc1
    v_pk_mul_f32 v[184:185], v[184:185], v[232:233]
    v_pk_mul_f32 v[186:187], v[186:187], v[232:233]
    v_pk_mul_f32 v[188:189], v[188:189], v[232:233]
    v_pk_mul_f32 v[190:191], v[190:191], v[232:233]
    v_cvt_pk_bf16_f32 v184, v184, v185
    v_cvt_pk_bf16_f32 v185, v186, v187
    v_cvt_pk_bf16_f32 v186, v188, v189
    v_cvt_pk_bf16_f32 v187, v190, v191
    buffer_store_dwordx4 v[184:187], v249, s[36:39], 0 offen offset:3072 sc1
    s_branch L_fin
L_regw_a:
    s_sub_u32 s56, s56, 1
    s_cbranch_scc1 L_end
    s_sleep 8
    v_mov_b32 v252, s1
    global_load_dword v252, v252, s[80:81] sc1
    s_waitcnt vmcnt(0)
    v_readfirstlane_b32 s54, v252
    s_cmp_eq_u32 s54, 0
    s_cbranch_scc1 L_regw_a
    s_branch L_rdy_a
L_w3:
    s_add_u32 s51, s49, 0
    s_bfe_u32 s51, s51, 0x0a0000
    s_add_u32 m0, s44, 0
    s_lshl_b32 s51, s51, 12
    buffer_load_dwordx4 v196, s[24:27], s51 offen offset:0 lds
    buffer_load_dwordx4 v197, s[24:27], s51 offen offset:1024 lds
    s_add_u32 s50, s49, 0
    s_bfe_u32 s50, s50, 0x0a0000
    s_add_u32 m0, s43, 0
    s_nop 0
    buffer_load_dwordx4 v192, s[20:23], s50 offen offset:0 lds
    buffer_load_dwordx4 v193, s[20:23], s50 offen offset:1024 lds
    buffer_load_dwordx4 v194, s[20:23], s50 offen offset:2048 lds
    buffer_load_dwordx4 v195, s[20:23], s50 offen offset:3072 lds
    s_add_u32 s50, s50, 0x8000
    s_add_u32 m0, s43, 4096
    s_nop 0
    buffer_load_dwordx4 v192, s[20:23], s50 offen offset:0 lds
    buffer_load_dwordx4 v193, s[20:23], s50 offen offset:1024 lds
    buffer_load_dwordx4 v194, s[20:23], s50 offen offset:2048 lds
    buffer_load_dwordx4 v195, s[20:23], s50 offen offset:3072 lds
    s_add_u32 s51, s49, 64
    s_bfe_u32 s51, s51, 0x0a0000
    s_add_u32 m0, s44, 8192
    s_lshl_b32 s51, s51, 12
    buffer_load_dwordx4 v196, s[24:27], s51 offen offset:0 lds
    buffer_load_dwordx4 v197, s[24:27], s51 offen offset:1024 lds
    s_mul_i32 s86, s85, 2850
    s_lshr_b32 s86, s86, 16
    s_mul_i32 s86, s86, 23
    s_sub_u32 s86, s85, s86
    s_lshl_b32 s86, s86, 12
    v_lshlrev_b32 v209, 6, v204
    v_add_u32 v209, s86, v209
    v_min_u32 v254, 0x15854, v209
    global_load_dword v251, v254, s[100:101]
    v_bfe_u32 v207, v204, 2, 2
    v_and_b32 v208, 3, v204
    v_lshrrev_b32 v209, 1, v205
    v_xor_b32 v209, v209, v206
    v_lshlrev_b32 v209, 4, v209
    v_lshl_add_u32 v209, v205, 7, v209
    v_add_u32 v198, s43, v209
    v_xor_b32 v199, 64, v198
    v_lshl_add_u32 v209, v206, 3, v207
    v_lshlrev_b32 v209, 8, v209
    v_lshl_add_u32 v209, v208, 4, v209
    v_add_u32 v209, 32768, v209
    v_xor_b32 v210, 0, v207
    v_lshl_add_u32 v200, v210, 6, v209
    v_xor_b32 v210, 1, v207
    v_lshl_add_u32 v201, v210, 6, v209
    v_xor_b32 v210, 2, v207
    v_lshl_add_u32 v202, v210, 6, v209
    v_xor_b32 v210, 3, v207
    v_lshl_add_u32 v203, v210, 6, v209
    s_add_u32 s50, s49, 128
    s_bfe_u32 s50, s50, 0x0a0000
    s_add_u32 m0, s43, 40960
    s_nop 0
    buffer_load_dwordx4 v192, s[20:23], s50 offen offset:0 lds
    buffer_load_dwordx4 v193, s[20:23], s50 offen offset:1024 lds
    buffer_load_dwordx4 v194, s[20:23], s50 offen offset:2048 lds
    buffer_load_dwordx4 v195, s[20:23], s50 offen offset:3072 lds
    s_add_u32 s50, s50, 0x8000
    s_add_u32 m0, s43, 45056
    s_nop 0
    buffer_load_dwordx4 v192, s[20:23], s50 offen offset:0 lds
    buffer_load_dwordx4 v193, s[20:23], s50 offen offset:1024 lds
    buffer_load_dwordx4 v194, s[20:23], s50 offen offset:2048 lds
    buffer_load_dwordx4 v195, s[20:23], s50 offen offset:3072 lds
    s_add_u32 s51, s49, 128
    s_bfe_u32 s51, s51, 0x0a0000
    s_add_u32 m0, s44, 16384
    s_lshl_b32 s51, s51, 12
    buffer_load_dwordx4 v196, s[24:27], s51 offen offset:0 lds
    buffer_load_dwordx4 v197, s[24:27], s51 offen offset:1024 lds
    s_waitcnt vmcnt(13)
    s_barrier
    ds_read_b128 a[0:3], v198 offset:0
    ds_read_b128 a[4:7], v198 offset:2048
    ds_read_b128 a[8:11], v198 offset:4096
    ds_read_b128 a[12:15], v198 offset:6144
    ds_read_b64_tr_b16 a[80:81], v200 offset:0
    ds_read_b64_tr_b16 a[82:83], v200 offset:1024
    ds_read_b64_tr_b16 a[84:85], v200 offset:8
    ds_read_b64_tr_b16 a[86:87], v200 offset:1032
    ds_read_b64_tr_b16 a[88:89], v201 offset:0
    ds_read_b64_tr_b16 a[90:91], v201 offset:1024
    ds_read_b64_tr_b16 a[92:93], v201 offset:8
    ds_read_b64_tr_b16 a[94:95], v201 offset:1032
    ds_read_b64_tr_b16 a[96:97], v202 offset:0
    ds_read_b64_tr_b16 a[98:99], v202 offset:1024
    ds_read_b64_tr_b16 a[100:101], v202 offset:8
    ds_read_b64_tr_b16 a[102:103], v202 offset:1032
    ds_read_b64_tr_b16 a[104:105], v203 offset:0
    ds_read_b64_tr_b16 a[106:107], v203 offset:1024
    ds_read_b64_tr_b16 a[108:109], v203 offset:8
    ds_read_b64_tr_b16 a[110:111], v203 offset:1032
    ds_read_b128 a[20:23], v199 offset:0
    ds_read_b128 a[24:27], v199 offset:2048
    ds_read_b128 a[28:31], v199 offset:4096
    ds_read_b128 a[32:35], v199 offset:6144
    s_waitcnt vmcnt(11) lgkmcnt(0)
    s_barrier
    v_mfma_f32_16x16x32_bf16 v[32:35], a[80:83], a[0:3], 0
    s_add_u32 s51, s49, 192
    ds_read_b64_tr_b16 a[112:113], v200 offset:8192
    v_lshlrev_b32 v19, 4, v204
    v_mfma_f32_16x16x32_bf16 v[64:67], a[80:83], a[4:7], 0
    s_bfe_u32 s51, s51, 0x0a0000
    ds_read_b64_tr_b16 a[114:115], v200 offset:9216
    v_mov_b32 v250, 0
    v_mfma_f32_16x16x32_bf16 v[96:99], a[80:83], a[8:11], 0
    s_add_u32 m0, s44, 24576
    ds_read_b64_tr_b16 a[116:117], v200 offset:8200
    v_mfma_f32_16x16x32_bf16 v[128:131], a[80:83], a[12:15], 0
    s_lshl_b32 s51, s51, 12
    ds_read_b64_tr_b16 a[118:119], v200 offset:9224
    v_mfma_f32_16x16x32_bf16 v[36:39], a[84:87], a[0:3], 0
    buffer_load_dwordx4 v196, s[24:27], s51 offen offset:0 lds
    v_mfma_f32_16x16x32_bf16 v[68:71], a[84:87], a[4:7], 0
    buffer_load_dwordx4 v197, s[24:27], s51 offen offset:1024 lds
    v_mfma_f32_16x16x32_bf16 v[100:103], a[84:87], a[8:11], 0
    s_add_u32 s50, s49, 256
    ds_read_b64_tr_b16 a[120:121], v201 offset:8192
    v_mfma_f32_16x16x32_bf16 v[132:135], a[84:87], a[12:15], 0
    s_bfe_u32 s50, s50, 0x0a0000
    ds_read_b64_tr_b16 a[122:123], v201 offset:9216
    v_mfma_f32_16x16x32_bf16 v[40:43], a[88:91], a[0:3], 0
    s_add_u32 m0, s43, 0
    ds_read_b64_tr_b16 a[124:125], v201 offset:8200
    v_mfma_f32_16x16x32_bf16 v[72:75], a[88:91], a[4:7], 0
    buffer_load_dwordx4 v192, s[20:23], s50 offen offset:0 lds
    v_mfma_f32_16x16x32_bf16 v[104:107], a[88:91], a[8:11], 0
    buffer_load_dwordx4 v193, s[20:23], s50 offen offset:1024 lds
    v_mfma_f32_16x16x32_bf16 v[136:139], a[88:91], a[12:15], 0
    s_lshl_b32 s86, s41, 14
    ds_read_b64_tr_b16 a[126:127], v201 offset:9224
    v_mfma_f32_16x16x32_bf16 v[44:47], a[92:95], a[0:3], 0
    buffer_load_dwordx4 v194, s[20:23], s50 offen offset:2048 lds
    v_mfma_f32_16x16x32_bf16 v[76:79], a[92:95], a[4:7], 0
    s_add_u32 s86, s86, 33554432
    ds_read_b64_tr_b16 a[128:129], v202 offset:8192
    v_mfma_f32_16x16x32_bf16 v[108:111], a[92:95], a[8:11], 0
    buffer_load_dwordx4 v195, s[20:23], s50 offen offset:3072 lds
    v_mfma_f32_16x16x32_bf16 v[140:143], a[92:95], a[12:15], 0
    s_add_u32 s50, s50, 0x8000
    ds_read_b64_tr_b16 a[130:131], v202 offset:9216
    v_mfma_f32_16x16x32_bf16 v[48:51], a[96:99], a[0:3], 0
    s_add_u32 m0, s43, 4096
    ds_read_b64_tr_b16 a[132:133], v202 offset:8200
    v_mfma_f32_16x16x32_bf16 v[80:83], a[96:99], a[4:7], 0
    buffer_load_dwordx4 v192, s[20:23], s50 offen offset:0 lds
    v_mfma_f32_16x16x32_bf16 v[112:115], a[96:99], a[8:11], 0
    s_add_u32 s94, s18, s86
    s_addc_u32 s95, s19, 0
    ds_read_b64_tr_b16 a[134:135], v202 offset:9224
    v_add_u32 v209, 0, v206
    v_mfma_f32_16x16x32_bf16 v[144:147], a[96:99], a[12:15], 0
    ds_read_b64_tr_b16 a[136:137], v203 offset:8192
    v_xor_b32 v209, v209, v205
    v_mfma_f32_16x16x32_bf16 v[52:55], a[100:103], a[0:3], 0
    buffer_load_dwordx4 v193, s[20:23], s50 offen offset:1024 lds
    v_mfma_f32_16x16x32_bf16 v[84:87], a[100:103], a[4:7], 0
    s_add_u32 s51, s49, 256
    ds_read_b64_tr_b16 a[138:139], v203 offset:9216
    v_lshlrev_b32 v209, 4, v209
    v_mfma_f32_16x16x32_bf16 v[116:119], a[100:103], a[8:11], 0
    s_bfe_u32 s51, s51, 0x0a0000
    ds_read_b64_tr_b16 a[140:141], v203 offset:8200
    v_lshl_add_u32 v1, v205, 8, v209
    v_mfma_f32_16x16x32_bf16 v[148:151], a[100:103], a[12:15], 0
    s_add_u32 m0, s44, 0
    ds_read_b64_tr_b16 a[142:143], v203 offset:9224
    v_lshl_add_u32 v13, v206, 8, v209
    v_mfma_f32_16x16x32_bf16 v[56:59], a[104:107], a[0:3], 0
    s_lshl_b32 s51, s51, 12
    v_add_u32 v209, 4, v206
    v_xor_b32 v209, v209, v205
    v_mfma_f32_16x16x32_bf16 v[88:91], a[104:107], a[4:7], 0
    v_lshlrev_b32 v209, 4, v209
    v_lshl_add_u32 v2, v205, 8, v209
    v_mfma_f32_16x16x32_bf16 v[120:123], a[104:107], a[8:11], 0
    v_lshl_add_u32 v14, v206, 8, v209
    v_add_u32 v209, 8, v206
    v_mfma_f32_16x16x32_bf16 v[152:155], a[104:107], a[12:15], 0
    v_xor_b32 v209, v209, v205
    v_lshlrev_b32 v209, 4, v209
    v_mfma_f32_16x16x32_bf16 v[60:63], a[108:111], a[0:3], 0
    v_lshl_add_u32 v3, v205, 8, v209
    v_lshl_add_u32 v15, v206, 8, v209
    v_mfma_f32_16x16x32_bf16 v[92:95], a[108:111], a[4:7], 0
    v_add_u32 v209, 12, v206
    v_xor_b32 v209, v209, v205
    s_nop 0
    buffer_load_dwordx4 v196, s[24:27], s51 offen offset:0 lds
    buffer_load_dwordx4 v197, s[24:27], s51 offen offset:1024 lds
    v_mfma_f32_16x16x32_bf16 v[124:127], a[108:111], a[8:11], 0
    s_waitcnt vmcnt(10) lgkmcnt(0)
    v_mfma_f32_16x16x32_bf16 v[156:159], a[108:111], a[12:15], 0
    s_barrier
    v_mfma_f32_16x16x32_bf16 v[32:35], a[112:115], a[20:23], v[32:35]
    s_add_u32 m0, s43, 4096
    ds_read_b64_tr_b16 a[80:81], v200 offset:16384
    v_lshlrev_b32 v209, 4, v209
    v_mfma_f32_16x16x32_bf16 v[64:67], a[112:115], a[24:27], v[64:67]
    buffer_load_dwordx4 v194, s[20:23], s50 offen offset:2048 lds
    v_mfma_f32_16x16x32_bf16 v[96:99], a[112:115], a[28:31], v[96:99]
    ds_read_b128 a[40:43], v198 offset:40960
    v_lshl_add_u32 v4, v205, 8, v209
    v_mfma_f32_16x16x32_bf16 v[128:131], a[112:115], a[32:35], v[128:131]
    ds_read_b64_tr_b16 a[82:83], v200 offset:17408
    v_lshl_add_u32 v16, v206, 8, v209
    v_mfma_f32_16x16x32_bf16 v[36:39], a[116:119], a[20:23], v[36:39]
    ds_read_b128 a[44:47], v198 offset:43008
    v_lshl_add_u32 v212, v206, 2, v207
    v_mfma_f32_16x16x32_bf16 v[68:71], a[116:119], a[24:27], v[68:71]
    ds_read_b64_tr_b16 a[84:85], v200 offset:16392
    v_and_b32 v210, 7, v212
    v_mfma_f32_16x16x32_bf16 v[100:103], a[116:119], a[28:31], v[100:103]
    ds_read_b128 a[48:51], v198 offset:45056
    v_lshlrev_b32 v209, 8, v212
    v_mfma_f32_16x16x32_bf16 v[132:135], a[116:119], a[32:35], v[132:135]
    ds_read_b64_tr_b16 a[86:87], v200 offset:17416
    v_lshl_add_u32 v209, v208, 3, v209
    v_mfma_f32_16x16x32_bf16 v[40:43], a[120:123], a[20:23], v[40:43]
    ds_read_b128 a[52:55], v198 offset:47104
    v_add_u32 v209, 65536, v209
    v_mfma_f32_16x16x32_bf16 v[72:75], a[120:123], a[24:27], v[72:75]
    ds_read_b64_tr_b16 a[88:89], v201 offset:16384
    v_xor_b32 v211, 0, v210
    v_mfma_f32_16x16x32_bf16 v[104:107], a[120:123], a[28:31], v[104:107]
    ds_read_b128 a[60:63], v199 offset:40960
    v_lshl_add_u32 v5, v211, 5, v209
    v_mfma_f32_16x16x32_bf16 v[136:139], a[120:123], a[32:35], v[136:139]
    ds_read_b64_tr_b16 a[90:91], v201 offset:17408
    v_xor_b32 v211, 1, v210
    v_mfma_f32_16x16x32_bf16 v[44:47], a[124:127], a[20:23], v[44:47]
    ds_read_b128 a[64:67], v199 offset:43008
    v_lshl_add_u32 v6, v211, 5, v209
    v_mfma_f32_16x16x32_bf16 v[76:79], a[124:127], a[24:27], v[76:79]
    ds_read_b64_tr_b16 a[92:93], v201 offset:16392
    v_xor_b32 v211, 2, v210
    v_mfma_f32_16x16x32_bf16 v[108:111], a[124:127], a[28:31], v[108:111]
    ds_read_b128 a[68:71], v199 offset:45056
    v_lshl_add_u32 v7, v211, 5, v209
    v_mfma_f32_16x16x32_bf16 v[140:143], a[124:127], a[32:35], v[140:143]
    ds_read_b64_tr_b16 a[94:95], v201 offset:17416
    v_xor_b32 v211, 3, v210
    v_mfma_f32_16x16x32_bf16 v[48:51], a[128:131], a[20:23], v[48:51]
    ds_read_b128 a[72:75], v199 offset:47104
    v_lshl_add_u32 v8, v211, 5, v209
    v_mfma_f32_16x16x32_bf16 v[80:83], a[128:131], a[24:27], v[80:83]
    ds_read_b64_tr_b16 a[96:97], v202 offset:16384
    v_xor_b32 v211, 4, v210
    v_mfma_f32_16x16x32_bf16 v[112:115], a[128:131], a[28:31], v[112:115]
    ds_read_b64_tr_b16 a[98:99], v202 offset:17408
    v_lshl_add_u32 v9, v211, 5, v209
    v_mfma_f32_16x16x32_bf16 v[144:147], a[128:131], a[32:35], v[144:147]
    ds_read_b64_tr_b16 a[100:101], v202 offset:16392
    v_xor_b32 v211, 5, v210
    v_mfma_f32_16x16x32_bf16 v[52:55], a[132:135], a[20:23], v[52:55]
    ds_read_b64_tr_b16 a[102:103], v202 offset:17416
    v_lshl_add_u32 v10, v211, 5, v209
    v_mfma_f32_16x16x32_bf16 v[84:87], a[132:135], a[24:27], v[84:87]
    ds_read_b64_tr_b16 a[104:105], v203 offset:16384
    v_xor_b32 v211, 6, v210
    v_mfma_f32_16x16x32_bf16 v[116:119], a[132:135], a[28:31], v[116:119]
    ds_read_b64_tr_b16 a[106:107], v203 offset:17408
    v_lshl_add_u32 v11, v211, 5, v209
    v_mfma_f32_16x16x32_bf16 v[148:151], a[132:135], a[32:35], v[148:151]
    ds_read_b64_tr_b16 a[108:109], v203 offset:16392
    v_xor_b32 v211, 7, v210
    v_mfma_f32_16x16x32_bf16 v[56:59], a[136:139], a[20:23], v[56:59]
    ds_read_b64_tr_b16 a[110:111], v203 offset:17416
    v_lshl_add_u32 v12, v211, 5, v209
    v_mfma_f32_16x16x32_bf16 v[88:91], a[136:139], a[24:27], v[88:91]
    v_add_u32 v209, 0, v206
    v_lshlrev_b32 v209, 1, v209
    v_mfma_f32_16x16x32_bf16 v[120:123], a[136:139], a[28:31], v[120:123]
    v_xor_b32 v209, v209, v205
    v_lshlrev_b32 v209, 4, v209
    v_mfma_f32_16x16x32_bf16 v[152:155], a[136:139], a[32:35], v[152:155]
    v_lshl_add_u32 v17, v206, 8, v209
    v_add_u32 v209, 4, v206
    v_mfma_f32_16x16x32_bf16 v[60:63], a[140:143], a[20:23], v[60:63]
    v_lshlrev_b32 v209, 1, v209
    v_xor_b32 v209, v209, v205
    v_mfma_f32_16x16x32_bf16 v[92:95], a[140:143], a[24:27], v[92:95]
    v_lshlrev_b32 v209, 4, v209
    v_lshl_add_u32 v18, v206, 8, v209
    s_nop 0
    buffer_load_dwordx4 v195, s[20:23], s50 offen offset:3072 lds
    s_add_u32 s51, s49, 320
    s_bfe_u32 s51, s51, 0x0a0000
    s_add_u32 m0, s44, 8192
    s_nop 0
    s_lshl_b32 s51, s51, 12
    buffer_load_dwordx4 v196, s[24:27], s51 offen offset:0 lds
    buffer_load_dwordx4 v197, s[24:27], s51 offen offset:1024 lds
    v_mfma_f32_16x16x32_bf16 v[124:127], a[140:143], a[28:31], v[124:127]
    s_waitcnt vmcnt(12) lgkmcnt(0)
    v_mfma_f32_16x16x32_bf16 v[156:159], a[140:143], a[32:35], v[156:159]
    s_barrier
    v_mfma_f32_16x16x32_bf16 v[32:35], a[80:83], a[40:43], v[32:35]
    s_add_u32 s50, s49, 384
    ds_read_b64_tr_b16 a[112:113], v200 offset:24576
    v_mfma_f32_16x16x32_bf16 v[64:67], a[80:83], a[44:47], v[64:67]
    s_bfe_u32 s50, s50, 0x0a0000
    ds_read_b64_tr_b16 a[114:115], v200 offset:25600
    v_mfma_f32_16x16x32_bf16 v[96:99], a[80:83], a[48:51], v[96:99]
    s_add_u32 m0, s43, 40960
    ds_read_b64_tr_b16 a[116:117], v200 offset:24584
    v_mfma_f32_16x16x32_bf16 v[128:131], a[80:83], a[52:55], v[128:131]
    buffer_load_dwordx4 v192, s[20:23], s50 offen offset:0 lds
    v_mfma_f32_16x16x32_bf16 v[36:39], a[84:87], a[40:43], v[36:39]
    buffer_load_dwordx4 v193, s[20:23], s50 offen offset:1024 lds
    v_mfma_f32_16x16x32_bf16 v[68:71], a[84:87], a[44:47], v[68:71]
    s_lshl_b32 s45, s40, 12
    ds_read_b64_tr_b16 a[118:119], v200 offset:25608
    v_mfma_f32_16x16x32_bf16 v[100:103], a[84:87], a[48:51], v[100:103]
    s_lshl_b32 s63, s40, 13
    ds_read_b64_tr_b16 a[120:121], v201 offset:24576
    v_mfma_f32_16x16x32_bf16 v[132:135], a[84:87], a[52:55], v[132:135]
    buffer_load_dwordx4 v194, s[20:23], s50 offen offset:2048 lds
    v_mfma_f32_16x16x32_bf16 v[40:43], a[88:91], a[40:43], v[40:43]
    s_add_u32 s63, s63, 131072
    ds_read_b64_tr_b16 a[122:123], v201 offset:25600
    v_mfma_f32_16x16x32_bf16 v[72:75], a[88:91], a[44:47], v[72:75]
    s_lshl_b32 s86, s41, 5
    ds_read_b64_tr_b16 a[124:125], v201 offset:24584
    v_mfma_f32_16x16x32_bf16 v[104:107], a[88:91], a[48:51], v[104:107]
    s_add_u32 s86, s86, s42
    ds_read_b64_tr_b16 a[126:127], v201 offset:25608
    v_mfma_f32_16x16x32_bf16 v[136:139], a[88:91], a[52:55], v[136:139]
    buffer_load_dwordx4 v195, s[20:23], s50 offen offset:3072 lds
    v_mfma_f32_16x16x32_bf16 v[44:47], a[92:95], a[40:43], v[44:47]
    s_add_u32 s50, s50, 0x8000
    ds_read_b64_tr_b16 a[128:129], v202 offset:24576
    v_mfma_f32_16x16x32_bf16 v[76:79], a[92:95], a[44:47], v[76:79]
    s_add_u32 m0, s43, 45056
    ds_read_b64_tr_b16 a[130:131], v202 offset:25600
    v_mfma_f32_16x16x32_bf16 v[108:111], a[92:95], a[48:51], v[108:111]
    buffer_load_dwordx4 v192, s[20:23], s50 offen offset:0 lds
    v_mfma_f32_16x16x32_bf16 v[140:143], a[92:95], a[52:55], v[140:143]
    s_lshl_b32 s86, s86, 18
    ds_read_b64_tr_b16 a[132:133], v202 offset:24584
    v_mfma_f32_16x16x32_bf16 v[48:51], a[96:99], a[40:43], v[48:51]
    s_add_u32 s28, s6, s86
    s_addc_u32 s29, s7, 0
    ds_read_b64_tr_b16 a[134:135], v202 offset:25608
    v_mfma_f32_16x16x32_bf16 v[80:83], a[96:99], a[44:47], v[80:83]
    s_mov_b32 s30, 262144
    ds_read_b64_tr_b16 a[136:137], v203 offset:24576
    v_mfma_f32_16x16x32_bf16 v[112:115], a[96:99], a[48:51], v[112:115]
    buffer_load_dwordx4 v193, s[20:23], s50 offen offset:1024 lds
    v_mfma_f32_16x16x32_bf16 v[144:147], a[96:99], a[52:55], v[144:147]
    s_add_u32 s51, s49, 384
    ds_read_b64_tr_b16 a[138:139], v203 offset:25600
    v_mfma_f32_16x16x32_bf16 v[52:55], a[100:103], a[40:43], v[52:55]
    s_bfe_u32 s51, s51, 0x0a0000
    ds_read_b64_tr_b16 a[140:141], v203 offset:24584
    v_mfma_f32_16x16x32_bf16 v[84:87], a[100:103], a[44:47], v[84:87]
    s_add_u32 m0, s44, 16384
    ds_read_b64_tr_b16 a[142:143], v203 offset:25608
    v_mfma_f32_16x16x32_bf16 v[116:119], a[100:103], a[48:51], v[116:119]
    s_lshl_b32 s51, s51, 12
    v_mfma_f32_16x16x32_bf16 v[148:151], a[100:103], a[52:55], v[148:151]
    buffer_load_dwordx4 v196, s[24:27], s51 offen offset:0 lds
    v_mfma_f32_16x16x32_bf16 v[56:59], a[104:107], a[40:43], v[56:59]
    buffer_load_dwordx4 v197, s[24:27], s51 offen offset:1024 lds
    v_mfma_f32_16x16x32_bf16 v[88:91], a[104:107], a[44:47], v[88:91]
    s_mov_b32 s31, 0x20000
    v_mfma_f32_16x16x32_bf16 v[120:123], a[104:107], a[48:51], v[120:123]
    s_add_u32 s32, s8, s86
    s_addc_u32 s33, s9, 0
    v_mfma_f32_16x16x32_bf16 v[152:155], a[104:107], a[52:55], v[152:155]
    s_mov_b32 s34, 262144
    v_mfma_f32_16x16x32_bf16 v[60:63], a[108:111], a[40:43], v[60:63]
    s_mov_b32 s35, 0x20000
    v_mfma_f32_16x16x32_bf16 v[92:95], a[108:111], a[44:47], v[92:95]
    s_mov_b32 s86, 0
    v_mfma_f32_16x16x32_bf16 v[124:127], a[108:111], a[48:51], v[124:127]
    s_waitcnt vmcnt(10) lgkmcnt(0)
    v_mfma_f32_16x16x32_bf16 v[156:159], a[108:111], a[52:55], v[156:159]
    s_barrier
    v_mfma_f32_16x16x32_bf16 v[32:35], a[112:115], a[60:63], v[32:35]
    s_add_u32 m0, s43, 45056
    ds_read_b64_tr_b16 a[80:81], v200 offset:0
    v_mfma_f32_16x16x32_bf16 v[64:67], a[112:115], a[64:67], v[64:67]
    buffer_load_dwordx4 v194, s[20:23], s50 offen offset:2048 lds
    v_mfma_f32_16x16x32_bf16 v[96:99], a[112:115], a[68:71], v[96:99]
    s_add_u32 s86, s86, s45
    ds_read_b128 a[0:3], v198 offset:0
    v_mfma_f32_16x16x32_bf16 v[128:131], a[112:115], a[72:75], v[128:131]
    s_add_u32 s57, s86, 0
    ds_read_b64_tr_b16 a[82:83], v200 offset:1024
    v_mfma_f32_16x16x32_bf16 v[36:39], a[116:119], a[60:63], v[36:39]
    s_and_b32 s57, s57, 0x3ffff
    ds_read_b128 a[4:7], v198 offset:2048
    v_mfma_f32_16x16x32_bf16 v[68:71], a[116:119], a[64:67], v[68:71]
    s_add_u32 s52, s86, 16384
    ds_read_b64_tr_b16 a[84:85], v200 offset:8
    v_mfma_f32_16x16x32_bf16 v[100:103], a[116:119], a[68:71], v[100:103]
    s_and_b32 s52, s52, 0x3ffff
    ds_read_b128 a[8:11], v198 offset:4096
    v_mfma_f32_16x16x32_bf16 v[132:135], a[116:119], a[72:75], v[132:135]
    s_add_u32 s53, s86, 32768
    ds_read_b64_tr_b16 a[86:87], v200 offset:1032
    v_mfma_f32_16x16x32_bf16 v[40:43], a[120:123], a[60:63], v[40:43]
    s_and_b32 s53, s53, 0x3ffff
    ds_read_b128 a[12:15], v198 offset:6144
    v_mfma_f32_16x16x32_bf16 v[72:75], a[120:123], a[64:67], v[72:75]
    s_add_u32 s46, s86, 49152
    ds_read_b64_tr_b16 a[88:89], v201 offset:0
    v_mfma_f32_16x16x32_bf16 v[104:107], a[120:123], a[68:71], v[104:107]
    s_and_b32 s46, s46, 0x3ffff
    ds_read_b128 a[20:23], v199 offset:0
    v_bfe_u32 v210, v212, 1, 2
    v_mfma_f32_16x16x32_bf16 v[136:139], a[120:123], a[72:75], v[136:139]
    ds_read_b64_tr_b16 a[90:91], v201 offset:1024
    v_lshlrev_b32 v209, 7, v212
    v_mfma_f32_16x16x32_bf16 v[44:47], a[124:127], a[60:63], v[44:47]
    ds_read_b128 a[24:27], v199 offset:2048
    v_lshl_add_u32 v209, v208, 3, v209
    v_mfma_f32_16x16x32_bf16 v[76:79], a[124:127], a[64:67], v[76:79]
    s_add_u32 s86, s40, 0
    ds_read_b64_tr_b16 a[92:93], v201 offset:8
    v_mfma_f32_16x16x32_bf16 v[108:111], a[124:127], a[68:71], v[108:111]
    s_and_b32 s86, s86, 3
    ds_read_b128 a[28:31], v199 offset:4096
    v_xor_b32 v211, s86, v210
    v_mfma_f32_16x16x32_bf16 v[140:143], a[124:127], a[72:75], v[140:143]
    ds_read_b64_tr_b16 a[94:95], v201 offset:1032
    v_lshl_add_u32 v211, v211, 5, v209
    v_mfma_f32_16x16x32_bf16 v[48:51], a[128:131], a[60:63], v[48:51]
    ds_read_b128 a[32:35], v199 offset:6144
    v_add_u32 v20, s45, v211
    v_mfma_f32_16x16x32_bf16 v[80:83], a[128:131], a[64:67], v[80:83]
    ds_read_b64_tr_b16 a[96:97], v202 offset:0
    v_add_u32 v24, 65536, v20
    v_mfma_f32_16x16x32_bf16 v[112:115], a[128:131], a[68:71], v[112:115]
    ds_read_b64_tr_b16 a[98:99], v202 offset:1024
    v_add_u32 v28, s63, v211
    v_mfma_f32_16x16x32_bf16 v[144:147], a[128:131], a[72:75], v[144:147]
    s_add_u32 s86, s40, 1
    ds_read_b64_tr_b16 a[100:101], v202 offset:8
    v_mfma_f32_16x16x32_bf16 v[52:55], a[132:135], a[60:63], v[52:55]
    s_and_b32 s86, s86, 3
    ds_read_b64_tr_b16 a[102:103], v202 offset:1032
    v_xor_b32 v211, s86, v210
    v_mfma_f32_16x16x32_bf16 v[84:87], a[132:135], a[64:67], v[84:87]
    ds_read_b64_tr_b16 a[104:105], v203 offset:0
    v_lshl_add_u32 v211, v211, 5, v209
    v_mfma_f32_16x16x32_bf16 v[116:119], a[132:135], a[68:71], v[116:119]
    ds_read_b64_tr_b16 a[106:107], v203 offset:1024
    v_add_u32 v21, s45, v211
    v_mfma_f32_16x16x32_bf16 v[148:151], a[132:135], a[72:75], v[148:151]
    ds_read_b64_tr_b16 a[108:109], v203 offset:8
    v_add_u32 v25, 65536, v21
    v_mfma_f32_16x16x32_bf16 v[56:59], a[136:139], a[60:63], v[56:59]
    ds_read_b64_tr_b16 a[110:111], v203 offset:1032
    v_add_u32 v29, s63, v211
    v_mfma_f32_16x16x32_bf16 v[88:91], a[136:139], a[64:67], v[88:91]
    s_add_u32 s86, s40, 2
    v_mfma_f32_16x16x32_bf16 v[120:123], a[136:139], a[68:71], v[120:123]
    s_and_b32 s86, s86, 3
    v_xor_b32 v211, s86, v210
    v_lshl_add_u32 v211, v211, 5, v209
    v_mfma_f32_16x16x32_bf16 v[152:155], a[136:139], a[72:75], v[152:155]
    v_add_u32 v22, s45, v211
    v_add_u32 v26, 65536, v22
    v_mfma_f32_16x16x32_bf16 v[60:63], a[140:143], a[60:63], v[60:63]
    v_add_u32 v30, s63, v211
    v_mfma_f32_16x16x32_bf16 v[92:95], a[140:143], a[64:67], v[92:95]
    s_add_u32 s86, s40, 3
    s_nop 0
    buffer_load_dwordx4 v195, s[20:23], s50 offen offset:3072 lds
    s_add_u32 s51, s49, 448
    s_bfe_u32 s51, s51, 0x0a0000
    s_add_u32 m0, s44, 24576
    s_nop 0
    s_lshl_b32 s51, s51, 12
    buffer_load_dwordx4 v196, s[24:27], s51 offen offset:0 lds
    buffer_load_dwordx4 v197, s[24:27], s51 offen offset:1024 lds
    v_mfma_f32_16x16x32_bf16 v[124:127], a[140:143], a[68:71], v[124:127]
    s_waitcnt vmcnt(12) lgkmcnt(0)
    v_mfma_f32_16x16x32_bf16 v[156:159], a[140:143], a[72:75], v[156:159]
    s_barrier
    v_mfma_f32_16x16x32_bf16 v[32:35], a[80:83], a[0:3], v[32:35]
    s_add_u32 s50, s49, 512
    ds_read_b64_tr_b16 a[112:113], v200 offset:8192
    v_mfma_f32_16x16x32_bf16 v[64:67], a[80:83], a[4:7], v[64:67]
    s_bfe_u32 s50, s50, 0x0a0000
    ds_read_b64_tr_b16 a[114:115], v200 offset:9216
    v_mfma_f32_16x16x32_bf16 v[96:99], a[80:83], a[8:11], v[96:99]
    s_add_u32 m0, s43, 0
    ds_read_b64_tr_b16 a[116:117], v200 offset:8200
    v_mfma_f32_16x16x32_bf16 v[128:131], a[80:83], a[12:15], v[128:131]
    buffer_load_dwordx4 v192, s[20:23], s50 offen offset:0 lds
    v_mfma_f32_16x16x32_bf16 v[36:39], a[84:87], a[0:3], v[36:39]
    buffer_load_dwordx4 v193, s[20:23], s50 offen offset:1024 lds
    v_mfma_f32_16x16x32_bf16 v[68:71], a[84:87], a[4:7], v[68:71]
    s_and_b32 s86, s86, 3
    ds_read_b64_tr_b16 a[118:119], v200 offset:9224
    v_xor_b32 v211, s86, v210
    v_mfma_f32_16x16x32_bf16 v[100:103], a[84:87], a[8:11], v[100:103]
    ds_read_b64_tr_b16 a[120:121], v201 offset:8192
    v_lshl_add_u32 v211, v211, 5, v209
    v_mfma_f32_16x16x32_bf16 v[132:135], a[84:87], a[12:15], v[132:135]
    buffer_load_dwordx4 v194, s[20:23], s50 offen offset:2048 lds
    v_mfma_f32_16x16x32_bf16 v[40:43], a[88:91], a[0:3], v[40:43]
    ds_read_b64_tr_b16 a[122:123], v201 offset:9216
    v_add_u32 v23, s45, v211
    v_mfma_f32_16x16x32_bf16 v[72:75], a[88:91], a[4:7], v[72:75]
    ds_read_b64_tr_b16 a[124:125], v201 offset:8200
    v_add_u32 v27, 65536, v23
    v_mfma_f32_16x16x32_bf16 v[104:107], a[88:91], a[8:11], v[104:107]
    ds_read_b64_tr_b16 a[126:127], v201 offset:9224
    v_add_u32 v31, s63, v211
    v_mfma_f32_16x16x32_bf16 v[136:139], a[88:91], a[12:15], v[136:139]
    buffer_load_dwordx4 v195, s[20:23], s50 offen offset:3072 lds
    v_mfma_f32_16x16x32_bf16 v[44:47], a[92:95], a[0:3], v[44:47]
    s_add_u32 s50, s50, 0x8000
    ds_read_b64_tr_b16 a[128:129], v202 offset:8192
    v_and_b32 v209, 7, v204
    v_mfma_f32_16x16x32_bf16 v[76:79], a[92:95], a[4:7], v[76:79]
    s_add_u32 m0, s43, 4096
    ds_read_b64_tr_b16 a[130:131], v202 offset:9216
    v_lshlrev_b32 v210, 1, v206
    v_mfma_f32_16x16x32_bf16 v[108:111], a[92:95], a[8:11], v[108:111]
    buffer_load_dwordx4 v192, s[20:23], s50 offen offset:0 lds
    v_mfma_f32_16x16x32_bf16 v[140:143], a[92:95], a[12:15], v[140:143]
    ds_read_b64_tr_b16 a[132:133], v202 offset:8200
    v_xor_b32 v209, v209, v210
    v_mfma_f32_16x16x32_bf16 v[48:51], a[96:99], a[0:3], v[48:51]
    ds_read_b64_tr_b16 a[134:135], v202 offset:9224
    v_lshlrev_b32 v209, 4, v209
    v_mfma_f32_16x16x32_bf16 v[80:83], a[96:99], a[4:7], v[80:83]
    ds_read_b64_tr_b16 a[136:137], v203 offset:8192
    v_lshrrev_b32 v210, 3, v204
    v_mfma_f32_16x16x32_bf16 v[112:115], a[96:99], a[8:11], v[112:115]
    buffer_load_dwordx4 v193, s[20:23], s50 offen offset:1024 lds
    v_mfma_f32_16x16x32_bf16 v[144:147], a[96:99], a[12:15], v[144:147]
    s_add_u32 s51, s49, 512
    ds_read_b64_tr_b16 a[138:139], v203 offset:9216
    v_lshl_add_u32 v241, v210, 10, v209
    v_mfma_f32_16x16x32_bf16 v[52:55], a[100:103], a[0:3], v[52:55]
    s_bfe_u32 s51, s51, 0x0a0000
    ds_read_b64_tr_b16 a[140:141], v203 offset:8200
    v_add_u32 v242, 7168, v241
    v_mfma_f32_16x16x32_bf16 v[84:87], a[100:103], a[4:7], v[84:87]
    s_add_u32 m0, s44, 0
    ds_read_b64_tr_b16 a[142:143], v203 offset:9224
    v_add_u32 v243, 14336, v241
    v_mfma_f32_16x16x32_bf16 v[116:119], a[100:103], a[8:11], v[116:119]
    s_lshl_b32 s51, s51, 12
    v_add_u32 v244, 21504, v241
    v_add_u32 v245, 0, v19
    v_mfma_f32_16x16x32_bf16 v[148:151], a[100:103], a[12:15], v[148:151]
    buffer_load_dwordx4 v196, s[24:27], s51 offen offset:0 lds
    v_mfma_f32_16x16x32_bf16 v[56:59], a[104:107], a[0:3], v[56:59]
    buffer_load_dwordx4 v197, s[24:27], s51 offen offset:1024 lds
    v_mfma_f32_16x16x32_bf16 v[88:91], a[104:107], a[4:7], v[88:91]
    v_add_u32 v246, 4096, v19
    v_add_u32 v247, 8192, v19
    v_mfma_f32_16x16x32_bf16 v[120:123], a[104:107], a[8:11], v[120:123]
    v_add_u32 v248, 12288, v19
    v_add_u32 v249, 16384, v19
    v_mfma_f32_16x16x32_bf16 v[152:155], a[104:107], a[12:15], v[152:155]
    s_lshl_b32 s88, s41, 2
    v_mfma_f32_16x16x32_bf16 v[60:63], a[108:111], a[0:3], v[60:63]
    s_add_u32 s86, s88, s40
    v_mfma_f32_16x16x32_bf16 v[92:95], a[108:111], a[4:7], v[92:95]
    s_lshl_b32 s86, s86, 5
    v_mfma_f32_16x16x32_bf16 v[124:127], a[108:111], a[8:11], v[124:127]
    s_waitcnt vmcnt(10) lgkmcnt(0)
    v_mfma_f32_16x16x32_bf16 v[156:159], a[108:111], a[12:15], v[156:159]
    s_barrier
    v_mfma_f32_16x16x32_bf16 v[32:35], a[112:115], a[20:23], v[32:35]
    s_add_u32 m0, s43, 4096
    ds_read_b64_tr_b16 a[80:81], v200 offset:16384
    v_mfma_f32_16x16x32_bf16 v[64:67], a[112:115], a[24:27], v[64:67]
    buffer_load_dwordx4 v194, s[20:23], s50 offen offset:2048 lds
    v_mfma_f32_16x16x32_bf16 v[96:99], a[112:115], a[28:31], v[96:99]
    s_add_u32 s86, s86, s42
    ds_read_b128 a[40:43], v198 offset:40960
    v_mfma_f32_16x16x32_bf16 v[128:131], a[112:115], a[32:35], v[128:131]
    s_lshl_b32 s77, s86, 15
    ds_read_b64_tr_b16 a[82:83], v200 offset:17408
    v_mfma_f32_16x16x32_bf16 v[36:39], a[116:119], a[20:23], v[36:39]
    s_add_u32 s36, s18, s77
    s_addc_u32 s37, s19, 0
    ds_read_b128 a[44:47], v198 offset:43008
    v_mfma_f32_16x16x32_bf16 v[68:71], a[116:119], a[24:27], v[68:71]
    s_mov_b32 s38, 32768
    ds_read_b64_tr_b16 a[84:85], v200 offset:16392
    v_mfma_f32_16x16x32_bf16 v[100:103], a[116:119], a[28:31], v[100:103]
    s_mov_b32 s39, 0x20000
    ds_read_b128 a[48:51], v198 offset:45056
    v_mfma_f32_16x16x32_bf16 v[132:135], a[116:119], a[32:35], v[132:135]
    s_and_b32 s89, s42, 3
    ds_read_b64_tr_b16 a[86:87], v200 offset:17416
    v_mfma_f32_16x16x32_bf16 v[40:43], a[120:123], a[20:23], v[40:43]
    s_bfe_u32 s90, s42, 0x20002
    ds_read_b128 a[52:55], v198 offset:47104
    v_mfma_f32_16x16x32_bf16 v[72:75], a[120:123], a[24:27], v[72:75]
    s_lshr_b32 s92, s42, 4
    ds_read_b64_tr_b16 a[88:89], v201 offset:16384
    v_mfma_f32_16x16x32_bf16 v[104:107], a[120:123], a[28:31], v[104:107]
    s_lshl_b32 s93, s92, 2
    ds_read_b128 a[60:63], v199 offset:40960
    v_mfma_f32_16x16x32_bf16 v[136:139], a[120:123], a[32:35], v[136:139]
    s_add_u32 s93, s93, s40
    ds_read_b64_tr_b16 a[90:91], v201 offset:17408
    v_mfma_f32_16x16x32_bf16 v[44:47], a[124:127], a[20:23], v[44:47]
    s_add_u32 s86, s88, s89
    ds_read_b128 a[64:67], v199 offset:43008
    v_mfma_f32_16x16x32_bf16 v[76:79], a[124:127], a[24:27], v[76:79]
    s_lshl_b32 s86, s86, 3
    ds_read_b64_tr_b16 a[92:93], v201 offset:16392
    v_mfma_f32_16x16x32_bf16 v[108:111], a[124:127], a[28:31], v[108:111]
    s_add_u32 s86, s86, s93
    ds_read_b128 a[68:71], v199 offset:45056
    v_mfma_f32_16x16x32_bf16 v[140:143], a[124:127], a[32:35], v[140:143]
    s_lshl_b32 s86, s86, 17
    ds_read_b64_tr_b16 a[94:95], v201 offset:17416
    v_mfma_f32_16x16x32_bf16 v[48:51], a[128:131], a[20:23], v[48:51]
    s_add_u32 s68, s18, s86
    s_addc_u32 s69, s19, 0
    ds_read_b128 a[72:75], v199 offset:47104
    v_mfma_f32_16x16x32_bf16 v[80:83], a[128:131], a[24:27], v[80:83]
    s_mov_b32 s70, 131072
    ds_read_b64_tr_b16 a[96:97], v202 offset:16384
    v_mfma_f32_16x16x32_bf16 v[112:115], a[128:131], a[28:31], v[112:115]
    s_mov_b32 s71, 0x20000
    ds_read_b64_tr_b16 a[98:99], v202 offset:17408
    v_mfma_f32_16x16x32_bf16 v[144:147], a[128:131], a[32:35], v[144:147]
    s_cmp_eq_u32 s89, 3
    s_cselect_b32 s91, 4, 5
    ds_read_b64_tr_b16 a[100:101], v202 offset:16392
    v_mfma_f32_16x16x32_bf16 v[52:55], a[132:135], a[20:23], v[52:55]
    s_lshl_b32 s60, s93, 19
    ds_read_b64_tr_b16 a[102:103], v202 offset:17416
    v_mfma_f32_16x16x32_bf16 v[84:87], a[132:135], a[24:27], v[84:87]
    s_lshl_b32 s87, s90, 8
    ds_read_b64_tr_b16 a[104:105], v203 offset:16384
    v_mfma_f32_16x16x32_bf16 v[116:119], a[132:135], a[28:31], v[116:119]
    s_add_u32 s86, s60, s87
    ds_read_b64_tr_b16 a[106:107], v203 offset:17408
    v_mfma_f32_16x16x32_bf16 v[148:151], a[132:135], a[32:35], v[148:151]
    s_add_u32 s64, s12, s86
    s_addc_u32 s65, s13, 0
    ds_read_b64_tr_b16 a[108:109], v203 offset:16392
    v_mfma_f32_16x16x32_bf16 v[56:59], a[136:139], a[20:23], v[56:59]
    s_mov_b32 s67, 0x20000
    ds_read_b64_tr_b16 a[110:111], v203 offset:17416
    v_mfma_f32_16x16x32_bf16 v[88:91], a[136:139], a[24:27], v[88:91]
    s_sub_u32 s66, 4194304, s86
    v_mfma_f32_16x16x32_bf16 v[120:123], a[136:139], a[28:31], v[120:123]
    s_lshl_b32 s88, s92, 7
    v_mfma_f32_16x16x32_bf16 v[152:155], a[136:139], a[32:35], v[152:155]
    s_xor_b32 s3, s88, 128
    v_mfma_f32_16x16x32_bf16 v[60:63], a[140:143], a[20:23], v[60:63]
    s_add_u32 s87, s87, s88
    v_mfma_f32_16x16x32_bf16 v[92:95], a[140:143], a[24:27], v[92:95]
    s_mul_i32 s86, s41, 304
    s_nop 0
    buffer_load_dwordx4 v195, s[20:23], s50 offen offset:3072 lds
    s_add_u32 s51, s49, 576
    s_bfe_u32 s51, s51, 0x0a0000
    s_add_u32 m0, s44, 8192
    s_nop 0
    s_lshl_b32 s51, s51, 12
    buffer_load_dwordx4 v196, s[24:27], s51 offen offset:0 lds
    buffer_load_dwordx4 v197, s[24:27], s51 offen offset:1024 lds
    s_add_u32 m0, s45, 0
    s_nop 0
    buffer_load_dwordx4 v13, s[28:31], s57 offen offset:0 nt lds
    buffer_load_dwordx4 v14, s[28:31], s57 offen offset:1024 nt lds
    buffer_load_dwordx4 v15, s[28:31], s57 offen offset:2048 nt lds
    v_mfma_f32_16x16x32_bf16 v[124:127], a[140:143], a[28:31], v[124:127]
    s_waitcnt vmcnt(15) lgkmcnt(0)
    v_mfma_f32_16x16x32_bf16 v[156:159], a[140:143], a[32:35], v[156:159]
    s_barrier
    v_mfma_f32_16x16x32_bf16 v[32:35], a[80:83], a[40:43], v[32:35]
    s_add_u32 s50, s49, 640
    ds_read_b64_tr_b16 a[112:113], v200 offset:24576
    v_mfma_f32_16x16x32_bf16 v[64:67], a[80:83], a[44:47], v[64:67]
    s_bfe_u32 s50, s50, 0x0a0000
    ds_read_b64_tr_b16 a[114:115], v200 offset:25600
    v_mfma_f32_16x16x32_bf16 v[96:99], a[80:83], a[48:51], v[96:99]
    s_add_u32 m0, s43, 40960
    ds_read_b64_tr_b16 a[116:117], v200 offset:24584
    v_mfma_f32_16x16x32_bf16 v[128:131], a[80:83], a[52:55], v[128:131]
    buffer_load_dwordx4 v192, s[20:23], s50 offen offset:0 lds
    v_mfma_f32_16x16x32_bf16 v[36:39], a[84:87], a[40:43], v[36:39]
    buffer_load_dwordx4 v193, s[20:23], s50 offen offset:1024 lds
    v_mfma_f32_16x16x32_bf16 v[68:71], a[84:87], a[44:47], v[68:71]
    s_mul_i32 s88, s89, 80
    ds_read_b64_tr_b16 a[118:119], v200 offset:25608
    v_mfma_f32_16x16x32_bf16 v[100:103], a[84:87], a[48:51], v[100:103]
    s_add_u32 s86, s86, s88
    ds_read_b64_tr_b16 a[120:121], v201 offset:24576
    v_mfma_f32_16x16x32_bf16 v[132:135], a[84:87], a[52:55], v[132:135]
    buffer_load_dwordx4 v194, s[20:23], s50 offen offset:2048 lds
    v_mfma_f32_16x16x32_bf16 v[40:43], a[88:91], a[40:43], v[40:43]
    s_lshl_b32 s86, s86, 10
    ds_read_b64_tr_b16 a[122:123], v201 offset:25600
    v_mfma_f32_16x16x32_bf16 v[72:75], a[88:91], a[44:47], v[72:75]
    s_lshl_b32 s88, s40, 5
    ds_read_b64_tr_b16 a[124:125], v201 offset:24584
    v_mfma_f32_16x16x32_bf16 v[104:107], a[88:91], a[48:51], v[104:107]
    s_add_u32 s87, s87, s88
    ds_read_b64_tr_b16 a[126:127], v201 offset:25608
    v_mfma_f32_16x16x32_bf16 v[136:139], a[88:91], a[52:55], v[136:139]
    buffer_load_dwordx4 v195, s[20:23], s50 offen offset:3072 lds
    v_mfma_f32_16x16x32_bf16 v[44:47], a[92:95], a[40:43], v[44:47]
    s_add_u32 s50, s50, 0x8000
    ds_read_b64_tr_b16 a[128:129], v202 offset:24576
    v_mfma_f32_16x16x32_bf16 v[76:79], a[92:95], a[44:47], v[76:79]
    s_add_u32 m0, s43, 45056
    ds_read_b64_tr_b16 a[130:131], v202 offset:25600
    v_mfma_f32_16x16x32_bf16 v[108:111], a[92:95], a[48:51], v[108:111]
    buffer_load_dwordx4 v192, s[20:23], s50 offen offset:0 lds
    v_mfma_f32_16x16x32_bf16 v[140:143], a[92:95], a[52:55], v[140:143]
    s_add_u32 s86, s86, s87
    ds_read_b64_tr_b16 a[132:133], v202 offset:24584
    v_mfma_f32_16x16x32_bf16 v[48:51], a[96:99], a[40:43], v[48:51]
    s_add_u32 s72, s14, s86
    s_addc_u32 s73, s15, 0
    ds_read_b64_tr_b16 a[134:135], v202 offset:25608
    v_mfma_f32_16x16x32_bf16 v[80:83], a[96:99], a[44:47], v[80:83]
    s_mov_b32 s75, 0x20000
    ds_read_b64_tr_b16 a[136:137], v203 offset:24576
    v_mfma_f32_16x16x32_bf16 v[112:115], a[96:99], a[48:51], v[112:115]
    buffer_load_dwordx4 v193, s[20:23], s50 offen offset:1024 lds
    v_mfma_f32_16x16x32_bf16 v[144:147], a[96:99], a[52:55], v[144:147]
    s_add_u32 s51, s49, 640
    ds_read_b64_tr_b16 a[138:139], v203 offset:25600
    v_mfma_f32_16x16x32_bf16 v[52:55], a[100:103], a[40:43], v[52:55]
    s_bfe_u32 s51, s51, 0x0a0000
    ds_read_b64_tr_b16 a[140:141], v203 offset:24584
    v_mfma_f32_16x16x32_bf16 v[84:87], a[100:103], a[44:47], v[84:87]
    s_add_u32 m0, s44, 16384
    ds_read_b64_tr_b16 a[142:143], v203 offset:25608
    v_mfma_f32_16x16x32_bf16 v[116:119], a[100:103], a[48:51], v[116:119]
    s_lshl_b32 s51, s51, 12
    v_mfma_f32_16x16x32_bf16 v[148:151], a[100:103], a[52:55], v[148:151]
    buffer_load_dwordx4 v196, s[24:27], s51 offen offset:0 lds
    v_mfma_f32_16x16x32_bf16 v[56:59], a[104:107], a[40:43], v[56:59]
    buffer_load_dwordx4 v197, s[24:27], s51 offen offset:1024 lds
    v_mfma_f32_16x16x32_bf16 v[88:91], a[104:107], a[44:47], v[88:91]
    s_lshl_b32 s74, s91, 14
    v_mfma_f32_16x16x32_bf16 v[120:123], a[104:107], a[48:51], v[120:123]
    s_sub_u32 s74, s74, s87
    v_mfma_f32_16x16x32_bf16 v[152:155], a[104:107], a[52:55], v[152:155]
    s_lshl_b32 s86, s41, 2
    v_mfma_f32_16x16x32_bf16 v[60:63], a[108:111], a[40:43], v[60:63]
    s_add_u32 s87, s86, s89
    v_mfma_f32_16x16x32_bf16 v[92:95], a[108:111], a[44:47], v[92:95]
    s_lshl_b32 s87, s87, 12
    v_mfma_f32_16x16x32_bf16 v[124:127], a[108:111], a[48:51], v[124:127]
    s_waitcnt vmcnt(13) lgkmcnt(0)
    v_mfma_f32_16x16x32_bf16 v[156:159], a[108:111], a[52:55], v[156:159]
    s_barrier
    v_mfma_f32_16x16x32_bf16 v[32:35], a[112:115], a[60:63], v[32:35]
    s_add_u32 m0, s43, 45056
    ds_read_b64_tr_b16 a[80:81], v200 offset:0
    v_mfma_f32_16x16x32_bf16 v[64:67], a[112:115], a[64:67], v[64:67]
    buffer_load_dwordx4 v194, s[20:23], s50 offen offset:2048 lds
    v_mfma_f32_16x16x32_bf16 v[96:99], a[112:115], a[68:71], v[96:99]
    s_lshl_b32 s88, s93, 9
    ds_read_b128 a[0:3], v198 offset:0
    v_mfma_f32_16x16x32_bf16 v[128:131], a[112:115], a[72:75], v[128:131]
    s_add_u32 s87, s87, s88
    ds_read_b64_tr_b16 a[82:83], v200 offset:1024
    v_mfma_f32_16x16x32_bf16 v[36:39], a[116:119], a[60:63], v[36:39]
    s_add_u32 s87, s87, 33554432
    ds_read_b128 a[4:7], v198 offset:2048
    v_mfma_f32_16x16x32_bf16 v[68:71], a[116:119], a[64:67], v[68:71]
    s_mov_b32 s76, s87
    ds_read_b64_tr_b16 a[84:85], v200 offset:8
    v_mfma_f32_16x16x32_bf16 v[100:103], a[116:119], a[68:71], v[100:103]
    s_add_u32 s87, s86, s40
    ds_read_b128 a[8:11], v198 offset:4096
    v_mfma_f32_16x16x32_bf16 v[132:135], a[116:119], a[72:75], v[132:135]
    s_lshl_b32 s87, s87, 12
    ds_read_b64_tr_b16 a[86:87], v200 offset:1032
    v_mfma_f32_16x16x32_bf16 v[40:43], a[120:123], a[60:63], v[40:43]
    s_lshl_b32 s88, s42, 7
    ds_read_b128 a[12:15], v198 offset:6144
    v_mfma_f32_16x16x32_bf16 v[72:75], a[120:123], a[64:67], v[72:75]
    s_add_u32 s87, s87, s88
    ds_read_b64_tr_b16 a[88:89], v201 offset:0
    v_mfma_f32_16x16x32_bf16 v[104:107], a[120:123], a[68:71], v[104:107]
    s_add_u32 s87, s87, 33554432
    ds_read_b128 a[20:23], v199 offset:0
    v_mfma_f32_16x16x32_bf16 v[136:139], a[120:123], a[72:75], v[136:139]
    s_add_u32 s78, s18, s87
    s_addc_u32 s79, s19, 0
    ds_read_b64_tr_b16 a[90:91], v201 offset:1024
    v_mfma_f32_16x16x32_bf16 v[44:47], a[124:127], a[60:63], v[44:47]
    s_xor_b32 s0, s87, 0x800
    ds_read_b128 a[24:27], v199 offset:2048
    v_mfma_f32_16x16x32_bf16 v[76:79], a[124:127], a[64:67], v[76:79]
    s_and_b32 s55, s87, 0xfffff87f
    ds_read_b64_tr_b16 a[92:93], v201 offset:8
    v_mfma_f32_16x16x32_bf16 v[108:111], a[124:127], a[68:71], v[108:111]
    s_lshl_b32 s88, s40, 7
    ds_read_b128 a[28:31], v199 offset:4096
    v_mfma_f32_16x16x32_bf16 v[140:143], a[124:127], a[72:75], v[140:143]
    s_add_u32 s55, s55, s88
    ds_read_b64_tr_b16 a[94:95], v201 offset:1032
    v_mfma_f32_16x16x32_bf16 v[48:51], a[128:131], a[60:63], v[48:51]
    s_add_u32 s76, s76, 131072
    ds_read_b128 a[32:35], v199 offset:6144
    v_mfma_f32_16x16x32_bf16 v[80:83], a[128:131], a[64:67], v[80:83]
    s_getreg_b32 s58, hwreg(HW_REG_XCC_ID, 0, 4)
    ds_read_b64_tr_b16 a[96:97], v202 offset:0
    v_mfma_f32_16x16x32_bf16 v[112:115], a[128:131], a[68:71], v[112:115]
    s_add_u32 s58, s58, 1
    ds_read_b64_tr_b16 a[98:99], v202 offset:1024
    v_mfma_f32_16x16x32_bf16 v[144:147], a[128:131], a[72:75], v[144:147]
    s_lshl_b32 s1, s41, 2
    ds_read_b64_tr_b16 a[100:101], v202 offset:8
    v_mfma_f32_16x16x32_bf16 v[52:55], a[132:135], a[60:63], v[52:55]
    s_add_u32 s80, s16, 0
    s_addc_u32 s81, s17, 0
    ds_read_b64_tr_b16 a[102:103], v202 offset:1032
    v_mfma_f32_16x16x32_bf16 v[84:87], a[132:135], a[64:67], v[84:87]
    ds_read_b64_tr_b16 a[104:105], v203 offset:0
    v_mfma_f32_16x16x32_bf16 v[116:119], a[132:135], a[68:71], v[116:119]
    ds_read_b64_tr_b16 a[106:107], v203 offset:1024
    v_mfma_f32_16x16x32_bf16 v[148:151], a[132:135], a[72:75], v[148:151]
    ds_read_b64_tr_b16 a[108:109], v203 offset:8
    v_mfma_f32_16x16x32_bf16 v[56:59], a[136:139], a[60:63], v[56:59]
    ds_read_b64_tr_b16 a[110:111], v203 offset:1032
    v_mfma_f32_16x16x32_bf16 v[88:91], a[136:139], a[64:67], v[88:91]
    v_mfma_f32_16x16x32_bf16 v[120:123], a[136:139], a[68:71], v[120:123]
    v_mfma_f32_16x16x32_bf16 v[152:155], a[136:139], a[72:75], v[152:155]
    v_mfma_f32_16x16x32_bf16 v[60:63], a[140:143], a[60:63], v[60:63]
    v_mfma_f32_16x16x32_bf16 v[92:95], a[140:143], a[64:67], v[92:95]
    s_nop 0
    buffer_load_dwordx4 v195, s[20:23], s50 offen offset:3072 lds
    s_add_u32 s51, s49, 704
    s_bfe_u32 s51, s51, 0x0a0000
    s_add_u32 m0, s44, 24576
    s_nop 0
    s_lshl_b32 s51, s51, 12
    buffer_load_dwordx4 v196, s[24:27], s51 offen offset:0 lds
    buffer_load_dwordx4 v197, s[24:27], s51 offen offset:1024 lds
    s_add_u32 m0, s45, 0
    s_nop 0
    buffer_load_dwordx4 v16, s[28:31], s57 offen offset:3072 nt lds
    s_add_u32 m0, s45, 65536
    s_nop 0
    buffer_load_dwordx4 v17, s[32:35], s57 offen offset:0 nt lds
    buffer_load_dwordx4 v18, s[32:35], s57 offen offset:1024 nt lds
    v_mfma_f32_16x16x32_bf16 v[124:127], a[140:143], a[68:71], v[124:127]
    s_waitcnt vmcnt(18) lgkmcnt(0)
    v_mfma_f32_16x16x32_bf16 v[156:159], a[140:143], a[72:75], v[156:159]
    s_barrier
    v_mfma_f32_16x16x32_bf16 v[32:35], a[80:83], a[0:3], v[32:35]
    s_add_u32 s50, s49, 768
    ds_read_b64_tr_b16 a[112:113], v200 offset:8192
    v_mfma_f32_16x16x32_bf16 v[64:67], a[80:83], a[4:7], v[64:67]
    s_bfe_u32 s50, s50, 0x0a0000
    ds_read_b64_tr_b16 a[114:115], v200 offset:9216
    v_mfma_f32_16x16x32_bf16 v[96:99], a[80:83], a[8:11], v[96:99]
    s_add_u32 m0, s43, 0
    ds_read_b64_tr_b16 a[116:117], v200 offset:8200
    v_mfma_f32_16x16x32_bf16 v[128:131], a[80:83], a[12:15], v[128:131]
    buffer_load_dwordx4 v192, s[20:23], s50 offen offset:0 lds
    v_mfma_f32_16x16x32_bf16 v[36:39], a[84:87], a[0:3], v[36:39]
    buffer_load_dwordx4 v193, s[20:23], s50 offen offset:1024 lds
    v_mfma_f32_16x16x32_bf16 v[68:71], a[84:87], a[4:7], v[68:71]
    ds_read_b64_tr_b16 a[118:119], v200 offset:9224
    v_mfma_f32_16x16x32_bf16 v[100:103], a[84:87], a[8:11], v[100:103]
    ds_read_b64_tr_b16 a[120:121], v201 offset:8192
    v_mfma_f32_16x16x32_bf16 v[132:135], a[84:87], a[12:15], v[132:135]
    buffer_load_dwordx4 v194, s[20:23], s50 offen offset:2048 lds
    v_mfma_f32_16x16x32_bf16 v[40:43], a[88:91], a[0:3], v[40:43]
    ds_read_b64_tr_b16 a[122:123], v201 offset:9216
    v_mfma_f32_16x16x32_bf16 v[72:75], a[88:91], a[4:7], v[72:75]
    ds_read_b64_tr_b16 a[124:125], v201 offset:8200
    v_mfma_f32_16x16x32_bf16 v[104:107], a[88:91], a[8:11], v[104:107]
    ds_read_b64_tr_b16 a[126:127], v201 offset:9224
    v_mfma_f32_16x16x32_bf16 v[136:139], a[88:91], a[12:15], v[136:139]
    buffer_load_dwordx4 v195, s[20:23], s50 offen offset:3072 lds
    v_mfma_f32_16x16x32_bf16 v[44:47], a[92:95], a[0:3], v[44:47]
    s_add_u32 s50, s50, 0x8000
    ds_read_b64_tr_b16 a[128:129], v202 offset:8192
    v_mfma_f32_16x16x32_bf16 v[76:79], a[92:95], a[4:7], v[76:79]
    s_add_u32 m0, s43, 4096
    ds_read_b64_tr_b16 a[130:131], v202 offset:9216
    v_mfma_f32_16x16x32_bf16 v[108:111], a[92:95], a[8:11], v[108:111]
    buffer_load_dwordx4 v192, s[20:23], s50 offen offset:0 lds
    v_mfma_f32_16x16x32_bf16 v[140:143], a[92:95], a[12:15], v[140:143]
    ds_read_b64_tr_b16 a[132:133], v202 offset:8200
    v_mfma_f32_16x16x32_bf16 v[48:51], a[96:99], a[0:3], v[48:51]
    ds_read_b64_tr_b16 a[134:135], v202 offset:9224
    v_mfma_f32_16x16x32_bf16 v[80:83], a[96:99], a[4:7], v[80:83]
    ds_read_b64_tr_b16 a[136:137], v203 offset:8192
    v_mfma_f32_16x16x32_bf16 v[112:115], a[96:99], a[8:11], v[112:115]
    buffer_load_dwordx4 v193, s[20:23], s50 offen offset:1024 lds
    v_mfma_f32_16x16x32_bf16 v[144:147], a[96:99], a[12:15], v[144:147]
    s_add_u32 s51, s49, 768
    ds_read_b64_tr_b16 a[138:139], v203 offset:9216
    v_mfma_f32_16x16x32_bf16 v[52:55], a[100:103], a[0:3], v[52:55]
    s_bfe_u32 s51, s51, 0x0a0000
    ds_read_b64_tr_b16 a[140:141], v203 offset:8200
    v_mfma_f32_16x16x32_bf16 v[84:87], a[100:103], a[4:7], v[84:87]
    s_add_u32 m0, s44, 0
    ds_read_b64_tr_b16 a[142:143], v203 offset:9224
    v_mfma_f32_16x16x32_bf16 v[116:119], a[100:103], a[8:11], v[116:119]
    s_lshl_b32 s51, s51, 12
    v_mfma_f32_16x16x32_bf16 v[148:151], a[100:103], a[12:15], v[148:151]
    buffer_load_dwordx4 v196, s[24:27], s51 offen offset:0 lds
    v_mfma_f32_16x16x32_bf16 v[56:59], a[104:107], a[0:3], v[56:59]
    buffer_load_dwordx4 v197, s[24:27], s51 offen offset:1024 lds
    v_mfma_f32_16x16x32_bf16 v[88:91], a[104:107], a[4:7], v[88:91]
    v_mfma_f32_16x16x32_bf16 v[120:123], a[104:107], a[8:11], v[120:123]
    v_mfma_f32_16x16x32_bf16 v[152:155], a[104:107], a[12:15], v[152:155]
    v_mfma_f32_16x16x32_bf16 v[60:63], a[108:111], a[0:3], v[60:63]
    v_mfma_f32_16x16x32_bf16 v[92:95], a[108:111], a[4:7], v[92:95]
    v_mfma_f32_16x16x32_bf16 v[124:127], a[108:111], a[8:11], v[124:127]
    s_waitcnt vmcnt(13) lgkmcnt(0)
    v_mfma_f32_16x16x32_bf16 v[156:159], a[108:111], a[12:15], v[156:159]
    s_barrier
    v_mfma_f32_16x16x32_bf16 v[32:35], a[112:115], a[20:23], v[32:35]
    s_add_u32 m0, s43, 4096
    ds_read_b64_tr_b16 a[80:81], v200 offset:16384
    v_mfma_f32_16x16x32_bf16 v[64:67], a[112:115], a[24:27], v[64:67]
    buffer_load_dwordx4 v194, s[20:23], s50 offen offset:2048 lds
    v_mfma_f32_16x16x32_bf16 v[96:99], a[112:115], a[28:31], v[96:99]
    ds_read_b128 a[40:43], v198 offset:40960
    v_mfma_f32_16x16x32_bf16 v[128:131], a[112:115], a[32:35], v[128:131]
    ds_read_b64_tr_b16 a[82:83], v200 offset:17408
    v_mfma_f32_16x16x32_bf16 v[36:39], a[116:119], a[20:23], v[36:39]
    ds_read_b128 a[44:47], v198 offset:43008
    v_mfma_f32_16x16x32_bf16 v[68:71], a[116:119], a[24:27], v[68:71]
    ds_read_b64_tr_b16 a[84:85], v200 offset:16392
    v_mfma_f32_16x16x32_bf16 v[100:103], a[116:119], a[28:31], v[100:103]
    ds_read_b128 a[48:51], v198 offset:45056
    v_mfma_f32_16x16x32_bf16 v[132:135], a[116:119], a[32:35], v[132:135]
    ds_read_b64_tr_b16 a[86:87], v200 offset:17416
    v_mfma_f32_16x16x32_bf16 v[40:43], a[120:123], a[20:23], v[40:43]
    ds_read_b128 a[52:55], v198 offset:47104
    v_mfma_f32_16x16x32_bf16 v[72:75], a[120:123], a[24:27], v[72:75]
    ds_read_b64_tr_b16 a[88:89], v201 offset:16384
    v_mfma_f32_16x16x32_bf16 v[104:107], a[120:123], a[28:31], v[104:107]
    ds_read_b128 a[60:63], v199 offset:40960
    v_mfma_f32_16x16x32_bf16 v[136:139], a[120:123], a[32:35], v[136:139]
    ds_read_b64_tr_b16 a[90:91], v201 offset:17408
    v_mfma_f32_16x16x32_bf16 v[44:47], a[124:127], a[20:23], v[44:47]
    ds_read_b128 a[64:67], v199 offset:43008
    v_mfma_f32_16x16x32_bf16 v[76:79], a[124:127], a[24:27], v[76:79]
    ds_read_b64_tr_b16 a[92:93], v201 offset:16392
    v_mfma_f32_16x16x32_bf16 v[108:111], a[124:127], a[28:31], v[108:111]
    ds_read_b128 a[68:71], v199 offset:45056
    v_mfma_f32_16x16x32_bf16 v[140:143], a[124:127], a[32:35], v[140:143]
    ds_read_b64_tr_b16 a[94:95], v201 offset:17416
    v_mfma_f32_16x16x32_bf16 v[48:51], a[128:131], a[20:23], v[48:51]
    ds_read_b128 a[72:75], v199 offset:47104
    v_mfma_f32_16x16x32_bf16 v[80:83], a[128:131], a[24:27], v[80:83]
    ds_read_b64_tr_b16 a[96:97], v202 offset:16384
    v_mfma_f32_16x16x32_bf16 v[112:115], a[128:131], a[28:31], v[112:115]
    ds_read_b64_tr_b16 a[98:99], v202 offset:17408
    v_mfma_f32_16x16x32_bf16 v[144:147], a[128:131], a[32:35], v[144:147]
    ds_read_b64_tr_b16 a[100:101], v202 offset:16392
    v_mfma_f32_16x16x32_bf16 v[52:55], a[132:135], a[20:23], v[52:55]
    ds_read_b64_tr_b16 a[102:103], v202 offset:17416
    v_mfma_f32_16x16x32_bf16 v[84:87], a[132:135], a[24:27], v[84:87]
    ds_read_b64_tr_b16 a[104:105], v203 offset:16384
    v_mfma_f32_16x16x32_bf16 v[116:119], a[132:135], a[28:31], v[116:119]
    ds_read_b64_tr_b16 a[106:107], v203 offset:17408
    v_mfma_f32_16x16x32_bf16 v[148:151], a[132:135], a[32:35], v[148:151]
    ds_read_b64_tr_b16 a[108:109], v203 offset:16392
    v_mfma_f32_16x16x32_bf16 v[56:59], a[136:139], a[20:23], v[56:59]
    ds_read_b64_tr_b16 a[110:111], v203 offset:17416
    v_mfma_f32_16x16x32_bf16 v[88:91], a[136:139], a[24:27], v[88:91]
    v_mfma_f32_16x16x32_bf16 v[120:123], a[136:139], a[28:31], v[120:123]
    v_mfma_f32_16x16x32_bf16 v[152:155], a[136:139], a[32:35], v[152:155]
    v_mfma_f32_16x16x32_bf16 v[60:63], a[140:143], a[20:23], v[60:63]
    v_mfma_f32_16x16x32_bf16 v[92:95], a[140:143], a[24:27], v[92:95]
    s_nop 0
    buffer_load_dwordx4 v195, s[20:23], s50 offen offset:3072 lds
    s_add_u32 s51, s49, 832
    s_bfe_u32 s51, s51, 0x0a0000
    s_add_u32 m0, s44, 8192
    s_nop 0
    s_lshl_b32 s51, s51, 12
    buffer_load_dwordx4 v196, s[24:27], s51 offen offset:0 lds
    buffer_load_dwordx4 v197, s[24:27], s51 offen offset:1024 lds
    s_add_u32 m0, s45, 65536
    s_nop 0
    buffer_load_dwordx4 v17, s[32:35], s57 offen offset:2048 nt lds
    buffer_load_dwordx4 v18, s[32:35], s57 offen offset:3072 nt lds
    s_add_u32 m0, s45, 16384
    s_nop 0
    buffer_load_dwordx4 v13, s[28:31], s52 offen offset:0 nt lds
    v_mfma_f32_16x16x32_bf16 v[124:127], a[140:143], a[28:31], v[124:127]
    s_waitcnt vmcnt(18) lgkmcnt(0)
    v_mfma_f32_16x16x32_bf16 v[156:159], a[140:143], a[32:35], v[156:159]
    s_barrier
    v_mfma_f32_16x16x32_bf16 v[32:35], a[80:83], a[40:43], v[32:35]
    s_add_u32 s50, s49, 896
    ds_read_b64_tr_b16 a[112:113], v200 offset:24576
    v_mfma_f32_16x16x32_bf16 v[64:67], a[80:83], a[44:47], v[64:67]
    s_bfe_u32 s50, s50, 0x0a0000
    ds_read_b64_tr_b16 a[114:115], v200 offset:25600
    v_mfma_f32_16x16x32_bf16 v[96:99], a[80:83], a[48:51], v[96:99]
    s_add_u32 m0, s43, 40960
    ds_read_b64_tr_b16 a[116:117], v200 offset:24584
    v_mfma_f32_16x16x32_bf16 v[128:131], a[80:83], a[52:55], v[128:131]
    buffer_load_dwordx4 v192, s[20:23], s50 offen offset:0 lds
    v_mfma_f32_16x16x32_bf16 v[36:39], a[84:87], a[40:43], v[36:39]
    buffer_load_dwordx4 v193, s[20:23], s50 offen offset:1024 lds
    v_mfma_f32_16x16x32_bf16 v[68:71], a[84:87], a[44:47], v[68:71]
    ds_read_b64_tr_b16 a[118:119], v200 offset:25608
    v_mfma_f32_16x16x32_bf16 v[100:103], a[84:87], a[48:51], v[100:103]
    ds_read_b64_tr_b16 a[120:121], v201 offset:24576
    v_mfma_f32_16x16x32_bf16 v[132:135], a[84:87], a[52:55], v[132:135]
    buffer_load_dwordx4 v194, s[20:23], s50 offen offset:2048 lds
    v_mfma_f32_16x16x32_bf16 v[40:43], a[88:91], a[40:43], v[40:43]
    ds_read_b64_tr_b16 a[122:123], v201 offset:25600
    v_mfma_f32_16x16x32_bf16 v[72:75], a[88:91], a[44:47], v[72:75]
    ds_read_b64_tr_b16 a[124:125], v201 offset:24584
    v_mfma_f32_16x16x32_bf16 v[104:107], a[88:91], a[48:51], v[104:107]
    ds_read_b64_tr_b16 a[126:127], v201 offset:25608
    v_mfma_f32_16x16x32_bf16 v[136:139], a[88:91], a[52:55], v[136:139]
    buffer_load_dwordx4 v195, s[20:23], s50 offen offset:3072 lds
    v_mfma_f32_16x16x32_bf16 v[44:47], a[92:95], a[40:43], v[44:47]
    s_add_u32 s50, s50, 0x8000
    ds_read_b64_tr_b16 a[128:129], v202 offset:24576
    v_mfma_f32_16x16x32_bf16 v[76:79], a[92:95], a[44:47], v[76:79]
    s_add_u32 m0, s43, 45056
    ds_read_b64_tr_b16 a[130:131], v202 offset:25600
    v_mfma_f32_16x16x32_bf16 v[108:111], a[92:95], a[48:51], v[108:111]
    buffer_load_dwordx4 v192, s[20:23], s50 offen offset:0 lds
    v_mfma_f32_16x16x32_bf16 v[140:143], a[92:95], a[52:55], v[140:143]
    ds_read_b64_tr_b16 a[132:133], v202 offset:24584
    v_mfma_f32_16x16x32_bf16 v[48:51], a[96:99], a[40:43], v[48:51]
    ds_read_b64_tr_b16 a[134:135], v202 offset:25608
    v_mfma_f32_16x16x32_bf16 v[80:83], a[96:99], a[44:47], v[80:83]
    ds_read_b64_tr_b16 a[136:137], v203 offset:24576
    v_mfma_f32_16x16x32_bf16 v[112:115], a[96:99], a[48:51], v[112:115]
    buffer_load_dwordx4 v193, s[20:23], s50 offen offset:1024 lds
    v_mfma_f32_16x16x32_bf16 v[144:147], a[96:99], a[52:55], v[144:147]
    s_add_u32 s51, s49, 896
    ds_read_b64_tr_b16 a[138:139], v203 offset:25600
    v_mfma_f32_16x16x32_bf16 v[52:55], a[100:103], a[40:43], v[52:55]
    s_bfe_u32 s51, s51, 0x0a0000
    ds_read_b64_tr_b16 a[140:141], v203 offset:24584
    v_mfma_f32_16x16x32_bf16 v[84:87], a[100:103], a[44:47], v[84:87]
    s_add_u32 m0, s44, 16384
    ds_read_b64_tr_b16 a[142:143], v203 offset:25608
    v_mfma_f32_16x16x32_bf16 v[116:119], a[100:103], a[48:51], v[116:119]
    s_lshl_b32 s51, s51, 12
    v_mfma_f32_16x16x32_bf16 v[148:151], a[100:103], a[52:55], v[148:151]
    buffer_load_dwordx4 v196, s[24:27], s51 offen offset:0 lds
    v_mfma_f32_16x16x32_bf16 v[56:59], a[104:107], a[40:43], v[56:59]
    buffer_load_dwordx4 v197, s[24:27], s51 offen offset:1024 lds
    v_mfma_f32_16x16x32_bf16 v[88:91], a[104:107], a[44:47], v[88:91]
    v_mfma_f32_16x16x32_bf16 v[120:123], a[104:107], a[48:51], v[120:123]
    v_mfma_f32_16x16x32_bf16 v[152:155], a[104:107], a[52:55], v[152:155]
    v_mfma_f32_16x16x32_bf16 v[60:63], a[108:111], a[40:43], v[60:63]
    v_mfma_f32_16x16x32_bf16 v[92:95], a[108:111], a[44:47], v[92:95]
    v_mfma_f32_16x16x32_bf16 v[124:127], a[108:111], a[48:51], v[124:127]
    s_waitcnt vmcnt(13) lgkmcnt(0)
    v_mfma_f32_16x16x32_bf16 v[156:159], a[108:111], a[52:55], v[156:159]
    s_barrier
    v_mfma_f32_16x16x32_bf16 v[32:35], a[112:115], a[60:63], v[32:35]
    s_add_u32 m0, s43, 45056
    ds_read_b64_tr_b16 a[80:81], v200 offset:0
    v_mfma_f32_16x16x32_bf16 v[64:67], a[112:115], a[64:67], v[64:67]
    buffer_load_dwordx4 v194, s[20:23], s50 offen offset:2048 lds
    v_mfma_f32_16x16x32_bf16 v[96:99], a[112:115], a[68:71], v[96:99]
    ds_read_b128 a[0:3], v198 offset:0
    v_mfma_f32_16x16x32_bf16 v[128:131], a[112:115], a[72:75], v[128:131]
    ds_read_b64_tr_b16 a[82:83], v200 offset:1024
    v_mfma_f32_16x16x32_bf16 v[36:39], a[116:119], a[60:63], v[36:39]
    ds_read_b128 a[4:7], v198 offset:2048
    v_mfma_f32_16x16x32_bf16 v[68:71], a[116:119], a[64:67], v[68:71]
    ds_read_b64_tr_b16 a[84:85], v200 offset:8
    v_mfma_f32_16x16x32_bf16 v[100:103], a[116:119], a[68:71], v[100:103]
    ds_read_b128 a[8:11], v198 offset:4096
    v_mfma_f32_16x16x32_bf16 v[132:135], a[116:119], a[72:75], v[132:135]
    ds_read_b64_tr_b16 a[86:87], v200 offset:1032
    v_mfma_f32_16x16x32_bf16 v[40:43], a[120:123], a[60:63], v[40:43]
    ds_read_b128 a[12:15], v198 offset:6144
    v_mfma_f32_16x16x32_bf16 v[72:75], a[120:123], a[64:67], v[72:75]
    ds_read_b64_tr_b16 a[88:89], v201 offset:0
    v_mfma_f32_16x16x32_bf16 v[104:107], a[120:123], a[68:71], v[104:107]
    ds_read_b128 a[20:23], v199 offset:0
    v_mfma_f32_16x16x32_bf16 v[136:139], a[120:123], a[72:75], v[136:139]
    ds_read_b64_tr_b16 a[90:91], v201 offset:1024
    v_mfma_f32_16x16x32_bf16 v[44:47], a[124:127], a[60:63], v[44:47]
    ds_read_b128 a[24:27], v199 offset:2048
    v_mfma_f32_16x16x32_bf16 v[76:79], a[124:127], a[64:67], v[76:79]
    ds_read_b64_tr_b16 a[92:93], v201 offset:8
    v_mfma_f32_16x16x32_bf16 v[108:111], a[124:127], a[68:71], v[108:111]
    ds_read_b128 a[28:31], v199 offset:4096
    v_mfma_f32_16x16x32_bf16 v[140:143], a[124:127], a[72:75], v[140:143]
    ds_read_b64_tr_b16 a[94:95], v201 offset:1032
    v_mfma_f32_16x16x32_bf16 v[48:51], a[128:131], a[60:63], v[48:51]
    ds_read_b128 a[32:35], v199 offset:6144
    v_mfma_f32_16x16x32_bf16 v[80:83], a[128:131], a[64:67], v[80:83]
    ds_read_b64_tr_b16 a[96:97], v202 offset:0
    v_mfma_f32_16x16x32_bf16 v[112:115], a[128:131], a[68:71], v[112:115]
    ds_read_b64_tr_b16 a[98:99], v202 offset:1024
    v_mfma_f32_16x16x32_bf16 v[144:147], a[128:131], a[72:75], v[144:147]
    ds_read_b64_tr_b16 a[100:101], v202 offset:8
    v_mfma_f32_16x16x32_bf16 v[52:55], a[132:135], a[60:63], v[52:55]
    ds_read_b64_tr_b16 a[102:103], v202 offset:1032
    v_mfma_f32_16x16x32_bf16 v[84:87], a[132:135], a[64:67], v[84:87]
    ds_read_b64_tr_b16 a[104:105], v203 offset:0
    v_mfma_f32_16x16x32_bf16 v[116:119], a[132:135], a[68:71], v[116:119]
    ds_read_b64_tr_b16 a[106:107], v203 offset:1024
    v_mfma_f32_16x16x32_bf16 v[148:151], a[132:135], a[72:75], v[148:151]
    ds_read_b64_tr_b16 a[108:109], v203 offset:8
    v_mfma_f32_16x16x32_bf16 v[56:59], a[136:139], a[60:63], v[56:59]
    ds_read_b64_tr_b16 a[110:111], v203 offset:1032
    v_mfma_f32_16x16x32_bf16 v[88:91], a[136:139], a[64:67], v[88:91]
    v_mfma_f32_16x16x32_bf16 v[120:123], a[136:139], a[68:71], v[120:123]
    v_mfma_f32_16x16x32_bf16 v[152:155], a[136:139], a[72:75], v[152:155]
    v_mfma_f32_16x16x32_bf16 v[60:63], a[140:143], a[60:63], v[60:63]
    v_mfma_f32_16x16x32_bf16 v[92:95], a[140:143], a[64:67], v[92:95]
    s_nop 0
    buffer_load_dwordx4 v195, s[20:23], s50 offen offset:3072 lds
    s_add_u32 s51, s49, 960
    s_bfe_u32 s51, s51, 0x0a0000
    s_add_u32 m0, s44, 24576
    s_nop 0
    s_lshl_b32 s51, s51, 12
    buffer_load_dwordx4 v196, s[24:27], s51 offen offset:0 lds
    buffer_load_dwordx4 v197, s[24:27], s51 offen offset:1024 lds
    s_add_u32 m0, s45, 16384
    s_nop 0
    buffer_load_dwordx4 v14, s[28:31], s52 offen offset:1024 nt lds
    buffer_load_dwordx4 v15, s[28:31], s52 offen offset:2048 nt lds
    buffer_load_dwordx4 v16, s[28:31], s52 offen offset:3072 nt lds
    global_load_dword v251, v254, s[100:101]
    v_mfma_f32_16x16x32_bf16 v[124:127], a[140:143], a[68:71], v[124:127]
    s_waitcnt vmcnt(19) lgkmcnt(0)
    v_mfma_f32_16x16x32_bf16 v[156:159], a[140:143], a[72:75], v[156:159]
    s_barrier
    v_mfma_f32_16x16x32_bf16 v[32:35], a[80:83], a[0:3], v[32:35]
    s_add_u32 m0, s45, 81920
    ds_read_b64_tr_b16 a[112:113], v200 offset:8192
    v_mfma_f32_16x16x32_bf16 v[64:67], a[80:83], a[4:7], v[64:67]
    buffer_load_dwordx4 v17, s[32:35], s52 offen offset:0 nt lds
    v_mfma_f32_16x16x32_bf16 v[96:99], a[80:83], a[8:11], v[96:99]
    ds_read_b64_tr_b16 a[114:115], v200 offset:9216
    v_mfma_f32_16x16x32_bf16 v[128:131], a[80:83], a[12:15], v[128:131]
    ds_read_b64_tr_b16 a[116:117], v200 offset:8200
    v_mfma_f32_16x16x32_bf16 v[36:39], a[84:87], a[0:3], v[36:39]
    ds_read_b64_tr_b16 a[118:119], v200 offset:9224
    v_mfma_f32_16x16x32_bf16 v[68:71], a[84:87], a[4:7], v[68:71]
    ds_read_b64_tr_b16 a[120:121], v201 offset:8192
    v_mfma_f32_16x16x32_bf16 v[100:103], a[84:87], a[8:11], v[100:103]
    ds_read_b64_tr_b16 a[122:123], v201 offset:9216
    v_mfma_f32_16x16x32_bf16 v[132:135], a[84:87], a[12:15], v[132:135]
    ds_read_b64_tr_b16 a[124:125], v201 offset:8200
    v_mfma_f32_16x16x32_bf16 v[40:43], a[88:91], a[0:3], v[40:43]
    ds_read_b64_tr_b16 a[126:127], v201 offset:9224
    v_mfma_f32_16x16x32_bf16 v[72:75], a[88:91], a[4:7], v[72:75]
    ds_read_b64_tr_b16 a[128:129], v202 offset:8192
    v_mfma_f32_16x16x32_bf16 v[104:107], a[88:91], a[8:11], v[104:107]
    ds_read_b64_tr_b16 a[130:131], v202 offset:9216
    v_mfma_f32_16x16x32_bf16 v[136:139], a[88:91], a[12:15], v[136:139]
    ds_read_b64_tr_b16 a[132:133], v202 offset:8200
    v_mfma_f32_16x16x32_bf16 v[44:47], a[92:95], a[0:3], v[44:47]
    ds_read_b64_tr_b16 a[134:135], v202 offset:9224
    v_mfma_f32_16x16x32_bf16 v[76:79], a[92:95], a[4:7], v[76:79]
    ds_read_b64_tr_b16 a[136:137], v203 offset:8192
    v_mfma_f32_16x16x32_bf16 v[108:111], a[92:95], a[8:11], v[108:111]
    buffer_load_dwordx4 v18, s[32:35], s52 offen offset:1024 nt lds
    v_mfma_f32_16x16x32_bf16 v[140:143], a[92:95], a[12:15], v[140:143]
    ds_read_b64_tr_b16 a[138:139], v203 offset:9216
    v_mfma_f32_16x16x32_bf16 v[48:51], a[96:99], a[0:3], v[48:51]
    ds_read_b64_tr_b16 a[140:141], v203 offset:8200
    v_mfma_f32_16x16x32_bf16 v[80:83], a[96:99], a[4:7], v[80:83]
    ds_read_b64_tr_b16 a[142:143], v203 offset:9224
    v_mfma_f32_16x16x32_bf16 v[112:115], a[96:99], a[8:11], v[112:115]
    v_mfma_f32_16x16x32_bf16 v[144:147], a[96:99], a[12:15], v[144:147]
    v_mfma_f32_16x16x32_bf16 v[52:55], a[100:103], a[0:3], v[52:55]
    v_mfma_f32_16x16x32_bf16 v[84:87], a[100:103], a[4:7], v[84:87]
    v_mfma_f32_16x16x32_bf16 v[116:119], a[100:103], a[8:11], v[116:119]
    v_mfma_f32_16x16x32_bf16 v[148:151], a[100:103], a[12:15], v[148:151]
    v_mfma_f32_16x16x32_bf16 v[56:59], a[104:107], a[0:3], v[56:59]
    v_mfma_f32_16x16x32_bf16 v[88:91], a[104:107], a[4:7], v[88:91]
    v_mfma_f32_16x16x32_bf16 v[120:123], a[104:107], a[8:11], v[120:123]
    v_mfma_f32_16x16x32_bf16 v[152:155], a[104:107], a[12:15], v[152:155]
    v_mfma_f32_16x16x32_bf16 v[60:63], a[108:111], a[0:3], v[60:63]
    v_mfma_f32_16x16x32_bf16 v[92:95], a[108:111], a[4:7], v[92:95]
    v_mfma_f32_16x16x32_bf16 v[124:127], a[108:111], a[8:11], v[124:127]
    s_waitcnt vmcnt(8) lgkmcnt(0)
    v_mfma_f32_16x16x32_bf16 v[156:159], a[108:111], a[12:15], v[156:159]
    s_barrier
    v_mfma_f32_16x16x32_bf16 v[32:35], a[112:115], a[20:23], v[32:35]
    s_add_u32 m0, s45, 81920
    ds_read_b64_tr_b16 a[80:81], v200 offset:16384
    v_mfma_f32_16x16x32_bf16 v[64:67], a[112:115], a[24:27], v[64:67]
    buffer_load_dwordx4 v17, s[32:35], s52 offen offset:2048 nt lds
    v_mfma_f32_16x16x32_bf16 v[96:99], a[112:115], a[28:31], v[96:99]
    ds_read_b128 a[40:43], v198 offset:40960
    v_mfma_f32_16x16x32_bf16 v[128:131], a[112:115], a[32:35], v[128:131]
    ds_read_b64_tr_b16 a[82:83], v200 offset:17408
    v_mfma_f32_16x16x32_bf16 v[36:39], a[116:119], a[20:23], v[36:39]
    ds_read_b128 a[44:47], v198 offset:43008
    v_mfma_f32_16x16x32_bf16 v[68:71], a[116:119], a[24:27], v[68:71]
    ds_read_b64_tr_b16 a[84:85], v200 offset:16392
    v_mfma_f32_16x16x32_bf16 v[100:103], a[116:119], a[28:31], v[100:103]
    ds_read_b128 a[48:51], v198 offset:45056
    v_mfma_f32_16x16x32_bf16 v[132:135], a[116:119], a[32:35], v[132:135]
    ds_read_b64_tr_b16 a[86:87], v200 offset:17416
    v_mfma_f32_16x16x32_bf16 v[40:43], a[120:123], a[20:23], v[40:43]
    ds_read_b128 a[52:55], v198 offset:47104
    v_mfma_f32_16x16x32_bf16 v[72:75], a[120:123], a[24:27], v[72:75]
    ds_read_b64_tr_b16 a[88:89], v201 offset:16384
    v_mfma_f32_16x16x32_bf16 v[104:107], a[120:123], a[28:31], v[104:107]
    ds_read_b128 a[60:63], v199 offset:40960
    v_mfma_f32_16x16x32_bf16 v[136:139], a[120:123], a[32:35], v[136:139]
    ds_read_b64_tr_b16 a[90:91], v201 offset:17408
    v_mfma_f32_16x16x32_bf16 v[44:47], a[124:127], a[20:23], v[44:47]
    ds_read_b128 a[64:67], v199 offset:43008
    v_mfma_f32_16x16x32_bf16 v[76:79], a[124:127], a[24:27], v[76:79]
    ds_read_b64_tr_b16 a[92:93], v201 offset:16392
    v_mfma_f32_16x16x32_bf16 v[108:111], a[124:127], a[28:31], v[108:111]
    ds_read_b128 a[68:71], v199 offset:45056
    v_mfma_f32_16x16x32_bf16 v[140:143], a[124:127], a[32:35], v[140:143]
    ds_read_b64_tr_b16 a[94:95], v201 offset:17416
    v_mfma_f32_16x16x32_bf16 v[48:51], a[128:131], a[20:23], v[48:51]
    ds_read_b128 a[72:75], v199 offset:47104
    v_mfma_f32_16x16x32_bf16 v[80:83], a[128:131], a[24:27], v[80:83]
    ds_read_b64_tr_b16 a[96:97], v202 offset:16384
    v_mfma_f32_16x16x32_bf16 v[112:115], a[128:131], a[28:31], v[112:115]
    ds_read_b64_tr_b16 a[98:99], v202 offset:17408
    v_mfma_f32_16x16x32_bf16 v[144:147], a[128:131], a[32:35], v[144:147]
    ds_read_b64_tr_b16 a[100:101], v202 offset:16392
    v_mfma_f32_16x16x32_bf16 v[52:55], a[132:135], a[20:23], v[52:55]
    ds_read_b64_tr_b16 a[102:103], v202 offset:17416
    v_mfma_f32_16x16x32_bf16 v[84:87], a[132:135], a[24:27], v[84:87]
    ds_read_b64_tr_b16 a[104:105], v203 offset:16384
    v_mfma_f32_16x16x32_bf16 v[116:119], a[132:135], a[28:31], v[116:119]
    ds_read_b64_tr_b16 a[106:107], v203 offset:17408
    v_mfma_f32_16x16x32_bf16 v[148:151], a[132:135], a[32:35], v[148:151]
    ds_read_b64_tr_b16 a[108:109], v203 offset:16392
    v_mfma_f32_16x16x32_bf16 v[56:59], a[136:139], a[20:23], v[56:59]
    ds_read_b64_tr_b16 a[110:111], v203 offset:17416
    v_mfma_f32_16x16x32_bf16 v[88:91], a[136:139], a[24:27], v[88:91]
    v_mfma_f32_16x16x32_bf16 v[120:123], a[136:139], a[28:31], v[120:123]
    v_mfma_f32_16x16x32_bf16 v[152:155], a[136:139], a[32:35], v[152:155]
    v_mfma_f32_16x16x32_bf16 v[60:63], a[140:143], a[20:23], v[60:63]
    v_mfma_f32_16x16x32_bf16 v[92:95], a[140:143], a[24:27], v[92:95]
    s_nop 0
    buffer_load_dwordx4 v18, s[32:35], s52 offen offset:3072 nt lds
    v_mfma_f32_16x16x32_bf16 v[124:127], a[140:143], a[28:31], v[124:127]
    s_waitcnt vmcnt(8) lgkmcnt(0)
    v_mfma_f32_16x16x32_bf16 v[156:159], a[140:143], a[32:35], v[156:159]
    s_barrier
    v_mfma_f32_16x16x32_bf16 v[32:35], a[80:83], a[40:43], v[32:35]
    s_add_u32 m0, s45, 32768
    ds_read_b64_tr_b16 a[112:113], v200 offset:24576
    v_mfma_f32_16x16x32_bf16 v[64:67], a[80:83], a[44:47], v[64:67]
    buffer_load_dwordx4 v13, s[28:31], s53 offen offset:0 nt lds
    v_mfma_f32_16x16x32_bf16 v[96:99], a[80:83], a[48:51], v[96:99]
    ds_read_b64_tr_b16 a[114:115], v200 offset:25600
    v_mfma_f32_16x16x32_bf16 v[128:131], a[80:83], a[52:55], v[128:131]
    ds_read_b64_tr_b16 a[116:117], v200 offset:24584
    v_mfma_f32_16x16x32_bf16 v[36:39], a[84:87], a[40:43], v[36:39]
    ds_read_b64_tr_b16 a[118:119], v200 offset:25608
    v_mfma_f32_16x16x32_bf16 v[68:71], a[84:87], a[44:47], v[68:71]
    ds_read_b64_tr_b16 a[120:121], v201 offset:24576
    v_mfma_f32_16x16x32_bf16 v[100:103], a[84:87], a[48:51], v[100:103]
    ds_read_b64_tr_b16 a[122:123], v201 offset:25600
    v_mfma_f32_16x16x32_bf16 v[132:135], a[84:87], a[52:55], v[132:135]
    ds_read_b64_tr_b16 a[124:125], v201 offset:24584
    v_mfma_f32_16x16x32_bf16 v[40:43], a[88:91], a[40:43], v[40:43]
    ds_read_b64_tr_b16 a[126:127], v201 offset:25608
    v_mfma_f32_16x16x32_bf16 v[72:75], a[88:91], a[44:47], v[72:75]
    ds_read_b64_tr_b16 a[128:129], v202 offset:24576
    v_mfma_f32_16x16x32_bf16 v[104:107], a[88:91], a[48:51], v[104:107]
    ds_read_b64_tr_b16 a[130:131], v202 offset:25600
    v_mfma_f32_16x16x32_bf16 v[136:139], a[88:91], a[52:55], v[136:139]
    ds_read_b64_tr_b16 a[132:133], v202 offset:24584
    v_mfma_f32_16x16x32_bf16 v[44:47], a[92:95], a[40:43], v[44:47]
    ds_read_b64_tr_b16 a[134:135], v202 offset:25608
    v_mfma_f32_16x16x32_bf16 v[76:79], a[92:95], a[44:47], v[76:79]
    ds_read_b64_tr_b16 a[136:137], v203 offset:24576
    v_mfma_f32_16x16x32_bf16 v[108:111], a[92:95], a[48:51], v[108:111]
    buffer_load_dwordx4 v14, s[28:31], s53 offen offset:1024 nt lds
    v_mfma_f32_16x16x32_bf16 v[140:143], a[92:95], a[52:55], v[140:143]
    ds_read_b64_tr_b16 a[138:139], v203 offset:25600
    v_mfma_f32_16x16x32_bf16 v[48:51], a[96:99], a[40:43], v[48:51]
    ds_read_b64_tr_b16 a[140:141], v203 offset:24584
    v_mfma_f32_16x16x32_bf16 v[80:83], a[96:99], a[44:47], v[80:83]
    ds_read_b64_tr_b16 a[142:143], v203 offset:25608
    v_mfma_f32_16x16x32_bf16 v[112:115], a[96:99], a[48:51], v[112:115]
    v_mfma_f32_16x16x32_bf16 v[144:147], a[96:99], a[52:55], v[144:147]
    v_mfma_f32_16x16x32_bf16 v[52:55], a[100:103], a[40:43], v[52:55]
    v_mfma_f32_16x16x32_bf16 v[84:87], a[100:103], a[44:47], v[84:87]
    v_mfma_f32_16x16x32_bf16 v[116:119], a[100:103], a[48:51], v[116:119]
    v_mfma_f32_16x16x32_bf16 v[148:151], a[100:103], a[52:55], v[148:151]
    v_mfma_f32_16x16x32_bf16 v[56:59], a[104:107], a[40:43], v[56:59]
    v_mfma_f32_16x16x32_bf16 v[88:91], a[104:107], a[44:47], v[88:91]
    v_mfma_f32_16x16x32_bf16 v[120:123], a[104:107], a[48:51], v[120:123]
    v_mfma_f32_16x16x32_bf16 v[152:155], a[104:107], a[52:55], v[152:155]
    v_mfma_f32_16x16x32_bf16 v[60:63], a[108:111], a[40:43], v[60:63]
    v_mfma_f32_16x16x32_bf16 v[92:95], a[108:111], a[44:47], v[92:95]
    v_mfma_f32_16x16x32_bf16 v[124:127], a[108:111], a[48:51], v[124:127]
    s_waitcnt vmcnt(23) lgkmcnt(0)
    v_mfma_f32_16x16x32_bf16 v[156:159], a[108:111], a[52:55], v[156:159]
    s_barrier
    v_mfma_f32_16x16x32_bf16 v[32:35], a[112:115], a[60:63], v[32:35]
    s_add_u32 m0, s45, 32768
    ds_read_b128 a[80:83], v1 offset:0
    v_mfma_f32_16x16x32_bf16 v[64:67], a[112:115], a[64:67], v[64:67]
    buffer_load_dwordx4 v15, s[28:31], s53 offen offset:2048 nt lds
    v_mfma_f32_16x16x32_bf16 v[96:99], a[112:115], a[68:71], v[96:99]
    ds_read_b128 a[84:87], v2 offset:0
    v_mfma_f32_16x16x32_bf16 v[128:131], a[112:115], a[72:75], v[128:131]
    ds_read_b128 a[88:91], v3 offset:0
    v_mfma_f32_16x16x32_bf16 v[36:39], a[116:119], a[60:63], v[36:39]
    ds_read_b128 a[92:95], v4 offset:0
    v_mfma_f32_16x16x32_bf16 v[68:71], a[116:119], a[64:67], v[68:71]
    ds_read_b128 a[96:99], v1 offset:4096
    v_mfma_f32_16x16x32_bf16 v[100:103], a[116:119], a[68:71], v[100:103]
    ds_read_b128 a[100:103], v2 offset:4096
    v_mfma_f32_16x16x32_bf16 v[132:135], a[116:119], a[72:75], v[132:135]
    ds_read_b128 a[104:107], v3 offset:4096
    v_mfma_f32_16x16x32_bf16 v[40:43], a[120:123], a[60:63], v[40:43]
    ds_read_b128 a[108:111], v4 offset:4096
    v_mfma_f32_16x16x32_bf16 v[72:75], a[120:123], a[64:67], v[72:75]
    ds_read_b64_tr_b16 a[144:145], v5 offset:0
    v_mfma_f32_16x16x32_bf16 v[104:107], a[120:123], a[68:71], v[104:107]
    ds_read_b64_tr_b16 a[146:147], v5 offset:4096
    v_mfma_f32_16x16x32_bf16 v[136:139], a[120:123], a[72:75], v[136:139]
    ds_read_b64_tr_b16 a[148:149], v6 offset:0
    v_mfma_f32_16x16x32_bf16 v[44:47], a[124:127], a[60:63], v[44:47]
    ds_read_b64_tr_b16 a[150:151], v6 offset:4096
    v_mfma_f32_16x16x32_bf16 v[76:79], a[124:127], a[64:67], v[76:79]
    ds_read_b64_tr_b16 a[152:153], v7 offset:0
    v_mfma_f32_16x16x32_bf16 v[108:111], a[124:127], a[68:71], v[108:111]
    ds_read_b64_tr_b16 a[154:155], v7 offset:4096
    v_mfma_f32_16x16x32_bf16 v[140:143], a[124:127], a[72:75], v[140:143]
    ds_read_b64_tr_b16 a[156:157], v8 offset:0
    v_mfma_f32_16x16x32_bf16 v[48:51], a[128:131], a[60:63], v[48:51]
    ds_read_b64_tr_b16 a[158:159], v8 offset:4096
    v_mfma_f32_16x16x32_bf16 v[80:83], a[128:131], a[64:67], v[80:83]
    ds_read_b64_tr_b16 a[160:161], v9 offset:0
    v_mfma_f32_16x16x32_bf16 v[112:115], a[128:131], a[68:71], v[112:115]
    ds_read_b64_tr_b16 a[162:163], v9 offset:4096
    v_mfma_f32_16x16x32_bf16 v[144:147], a[128:131], a[72:75], v[144:147]
    ds_read_b64_tr_b16 a[164:165], v10 offset:0
    v_mfma_f32_16x16x32_bf16 v[52:55], a[132:135], a[60:63], v[52:55]
    ds_read_b64_tr_b16 a[166:167], v10 offset:4096
    v_mfma_f32_16x16x32_bf16 v[84:87], a[132:135], a[64:67], v[84:87]
    ds_read_b64_tr_b16 a[168:169], v11 offset:0
    v_mfma_f32_16x16x32_bf16 v[116:119], a[132:135], a[68:71], v[116:119]
    ds_read_b64_tr_b16 a[170:171], v11 offset:4096
    v_mfma_f32_16x16x32_bf16 v[148:151], a[132:135], a[72:75], v[148:151]
    ds_read_b64_tr_b16 a[172:173], v12 offset:0
    v_mfma_f32_16x16x32_bf16 v[56:59], a[136:139], a[60:63], v[56:59]
    ds_read_b64_tr_b16 a[174:175], v12 offset:4096
    v_mfma_f32_16x16x32_bf16 v[88:91], a[136:139], a[64:67], v[88:91]
    v_mfma_f32_16x16x32_bf16 v[120:123], a[136:139], a[68:71], v[120:123]
    v_mfma_f32_16x16x32_bf16 v[152:155], a[136:139], a[72:75], v[152:155]
    v_mfma_f32_16x16x32_bf16 v[60:63], a[140:143], a[60:63], v[60:63]
    v_mfma_f32_16x16x32_bf16 v[92:95], a[140:143], a[64:67], v[92:95]
    s_nop 0
    buffer_load_dwordx4 v16, s[28:31], s53 offen offset:3072 nt lds
    v_mfma_f32_16x16x32_bf16 v[124:127], a[140:143], a[68:71], v[124:127]
    v_mfma_f32_16x16x32_bf16 v[156:159], a[140:143], a[72:75], v[156:159]
    v_mov_b32 v252, 0x3e0293ee
    v_mov_b32 v253, 0x3e0293ee
    s_nop 4
.p2align 3
    v_pk_mul_f32 v[32:33], v[32:33], v[252:253]
    v_pk_mul_f32 v[34:35], v[34:35], v[252:253]
    v_pk_mul_f32 v[36:37], v[36:37], v[252:253]
    v_pk_mul_f32 v[38:39], v[38:39], v[252:253]
    v_pk_mul_f32 v[40:41], v[40:41], v[252:253]
    v_pk_mul_f32 v[42:43], v[42:43], v[252:253]
    v_pk_mul_f32 v[44:45], v[44:45], v[252:253]
    v_pk_mul_f32 v[46:47], v[46:47], v[252:253]
    v_pk_mul_f32 v[48:49], v[48:49], v[252:253]
    v_pk_mul_f32 v[50:51], v[50:51], v[252:253]
    v_pk_mul_f32 v[52:53], v[52:53], v[252:253]
    v_pk_mul_f32 v[54:55], v[54:55], v[252:253]
    v_pk_mul_f32 v[56:57], v[56:57], v[252:253]
    v_pk_mul_f32 v[58:59], v[58:59], v[252:253]
    v_pk_mul_f32 v[60:61], v[60:61], v[252:253]
    v_pk_mul_f32 v[62:63], v[62:63], v[252:253]
    v_pk_mul_f32 v[64:65], v[64:65], v[252:253]
    v_pk_mul_f32 v[66:67], v[66:67], v[252:253]
    v_pk_mul_f32 v[68:69], v[68:69], v[252:253]
    v_pk_mul_f32 v[70:71], v[70:71], v[252:253]
    v_pk_mul_f32 v[72:73], v[72:73], v[252:253]
    v_pk_mul_f32 v[74:75], v[74:75], v[252:253]
    v_pk_mul_f32 v[76:77], v[76:77], v[252:253]
    v_pk_mul_f32 v[78:79], v[78:79], v[252:253]
    v_pk_mul_f32 v[80:81], v[80:81], v[252:253]
    v_pk_mul_f32 v[82:83], v[82:83], v[252:253]
    v_pk_mul_f32 v[84:85], v[84:85], v[252:253]
    v_pk_mul_f32 v[86:87], v[86:87], v[252:253]
    v_pk_mul_f32 v[88:89], v[88:89], v[252:253]
    v_pk_mul_f32 v[90:91], v[90:91], v[252:253]
    v_pk_mul_f32 v[92:93], v[92:93], v[252:253]
    v_pk_mul_f32 v[94:95], v[94:95], v[252:253]
    v_pk_mul_f32 v[96:97], v[96:97], v[252:253]
    v_pk_mul_f32 v[98:99], v[98:99], v[252:253]
    v_pk_mul_f32 v[100:101], v[100:101], v[252:253]
    v_pk_mul_f32 v[102:103], v[102:103], v[252:253]
    v_pk_mul_f32 v[104:105], v[104:105], v[252:253]
    v_pk_mul_f32 v[106:107], v[106:107], v[252:253]
    v_pk_mul_f32 v[108:109], v[108:109], v[252:253]
    v_pk_mul_f32 v[110:111], v[110:111], v[252:253]
    v_pk_mul_f32 v[112:113], v[112:113], v[252:253]
    v_pk_mul_f32 v[114:115], v[114:115], v[252:253]
    v_pk_mul_f32 v[116:117], v[116:117], v[252:253]
    v_pk_mul_f32 v[118:119], v[118:119], v[252:253]
    v_pk_mul_f32 v[120:121], v[120:121], v[252:253]
    v_pk_mul_f32 v[122:123], v[122:123], v[252:253]
    v_pk_mul_f32 v[124:125], v[124:125], v[252:253]
    v_pk_mul_f32 v[126:127], v[126:127], v[252:253]
    v_pk_mul_f32 v[128:129], v[128:129], v[252:253]
    v_pk_mul_f32 v[130:131], v[130:131], v[252:253]
    v_pk_mul_f32 v[132:133], v[132:133], v[252:253]
    v_pk_mul_f32 v[134:135], v[134:135], v[252:253]
    v_pk_mul_f32 v[136:137], v[136:137], v[252:253]
    v_pk_mul_f32 v[138:139], v[138:139], v[252:253]
    v_pk_mul_f32 v[140:141], v[140:141], v[252:253]
    v_pk_mul_f32 v[142:143], v[142:143], v[252:253]
    v_pk_mul_f32 v[144:145], v[144:145], v[252:253]
    v_pk_mul_f32 v[146:147], v[146:147], v[252:253]
    v_pk_mul_f32 v[148:149], v[148:149], v[252:253]
    v_pk_mul_f32 v[150:151], v[150:151], v[252:253]
    v_pk_mul_f32 v[152:153], v[152:153], v[252:253]
    v_pk_mul_f32 v[154:155], v[154:155], v[252:253]
    v_pk_mul_f32 v[156:157], v[156:157], v[252:253]
    v_pk_mul_f32 v[158:159], v[158:159], v[252:253]
    s_add_u32 m0, s45, 98304
    s_nop 0
    buffer_load_dwordx4 v17, s[32:35], s53 offen offset:0 nt lds
    buffer_load_dwordx4 v18, s[32:35], s53 offen offset:1024 nt lds
    buffer_load_dwordx4 v17, s[32:35], s53 offen offset:2048 nt lds
    buffer_load_dwordx4 v18, s[32:35], s53 offen offset:3072 nt lds
    v_cvt_pk_bf16_f32 v32, v32, v33
    v_cvt_pk_bf16_f32 v33, v34, v35
    v_cvt_pk_bf16_f32 v34, v36, v37
    v_cvt_pk_bf16_f32 v35, v38, v39
    v_accvgpr_write_b32 a0, v32
    v_accvgpr_write_b32 a1, v33
    v_accvgpr_write_b32 a2, v34
    v_accvgpr_write_b32 a3, v35
    v_cvt_pk_bf16_f32 v40, v40, v41
    v_cvt_pk_bf16_f32 v41, v42, v43
    v_cvt_pk_bf16_f32 v42, v44, v45
    v_cvt_pk_bf16_f32 v43, v46, v47
    v_accvgpr_write_b32 a4, v40
    v_accvgpr_write_b32 a5, v41
    v_accvgpr_write_b32 a6, v42
    v_accvgpr_write_b32 a7, v43
    v_cvt_pk_bf16_f32 v48, v48, v49
    v_cvt_pk_bf16_f32 v49, v50, v51
    v_cvt_pk_bf16_f32 v50, v52, v53
    v_cvt_pk_bf16_f32 v51, v54, v55
    v_accvgpr_write_b32 a8, v48
    v_accvgpr_write_b32 a9, v49
    v_accvgpr_write_b32 a10, v50
    v_accvgpr_write_b32 a11, v51
    v_cvt_pk_bf16_f32 v56, v56, v57
    v_cvt_pk_bf16_f32 v57, v58, v59
    v_cvt_pk_bf16_f32 v58, v60, v61
    v_cvt_pk_bf16_f32 v59, v62, v63
    v_accvgpr_write_b32 a12, v56
    v_accvgpr_write_b32 a13, v57
    v_accvgpr_write_b32 a14, v58
    v_accvgpr_write_b32 a15, v59
    s_waitcnt lgkmcnt(0)
    s_nop 0
    v_mfma_f32_16x16x32_bf16 v[32:35], a[80:83], a[0:3], 0
    v_cvt_pk_bf16_f32 v64, v64, v65
    v_cvt_pk_bf16_f32 v65, v66, v67
    v_cvt_pk_bf16_f32 v66, v68, v69
    v_cvt_pk_bf16_f32 v67, v70, v71
    v_mfma_f32_16x16x32_bf16 v[32:35], a[84:87], a[4:7], v[32:35]
    v_accvgpr_write_b32 a16, v64
    v_accvgpr_write_b32 a17, v65
    v_accvgpr_write_b32 a18, v66
    v_accvgpr_write_b32 a19, v67
    v_mfma_f32_16x16x32_bf16 v[32:35], a[88:91], a[8:11], v[32:35]
    v_cvt_pk_bf16_f32 v72, v72, v73
    v_cvt_pk_bf16_f32 v73, v74, v75
    v_cvt_pk_bf16_f32 v74, v76, v77
    v_cvt_pk_bf16_f32 v75, v78, v79
    v_mfma_f32_16x16x32_bf16 v[32:35], a[92:95], a[12:15], v[32:35]
    v_accvgpr_write_b32 a20, v72
    v_accvgpr_write_b32 a21, v73
    v_accvgpr_write_b32 a22, v74
    v_accvgpr_write_b32 a23, v75
    v_mfma_f32_16x16x32_bf16 v[36:39], a[96:99], a[0:3], 0
    v_cvt_pk_bf16_f32 v80, v80, v81
    v_cvt_pk_bf16_f32 v81, v82, v83
    v_cvt_pk_bf16_f32 v82, v84, v85
    v_cvt_pk_bf16_f32 v83, v86, v87
    v_mfma_f32_16x16x32_bf16 v[36:39], a[100:103], a[4:7], v[36:39]
    v_accvgpr_write_b32 a24, v80
    v_accvgpr_write_b32 a25, v81
    v_accvgpr_write_b32 a26, v82
    v_accvgpr_write_b32 a27, v83
    v_mfma_f32_16x16x32_bf16 v[36:39], a[104:107], a[8:11], v[36:39]
    v_cvt_pk_bf16_f32 v88, v88, v89
    v_cvt_pk_bf16_f32 v89, v90, v91
    v_cvt_pk_bf16_f32 v90, v92, v93
    v_cvt_pk_bf16_f32 v91, v94, v95
    v_mfma_f32_16x16x32_bf16 v[36:39], a[108:111], a[12:15], v[36:39]
    v_accvgpr_write_b32 a28, v88
    v_accvgpr_write_b32 a29, v89
    v_accvgpr_write_b32 a30, v90
    v_accvgpr_write_b32 a31, v91
    s_nop 1
    v_mfma_f32_16x16x32_bf16 v[64:67], a[80:83], a[16:19], 0
    v_cvt_pk_bf16_f32 v96, v96, v97
    v_cvt_pk_bf16_f32 v97, v98, v99
    v_cvt_pk_bf16_f32 v98, v100, v101
    v_cvt_pk_bf16_f32 v99, v102, v103
    v_mfma_f32_16x16x32_bf16 v[64:67], a[84:87], a[20:23], v[64:67]
    v_accvgpr_write_b32 a32, v96
    v_accvgpr_write_b32 a33, v97
    v_accvgpr_write_b32 a34, v98
    v_accvgpr_write_b32 a35, v99
    v_mfma_f32_16x16x32_bf16 v[64:67], a[88:91], a[24:27], v[64:67]
    v_cvt_pk_bf16_f32 v104, v104, v105
    v_cvt_pk_bf16_f32 v105, v106, v107
    v_cvt_pk_bf16_f32 v106, v108, v109
    v_cvt_pk_bf16_f32 v107, v110, v111
    v_mfma_f32_16x16x32_bf16 v[64:67], a[92:95], a[28:31], v[64:67]
    v_accvgpr_write_b32 a36, v104
    v_accvgpr_write_b32 a37, v105
    v_accvgpr_write_b32 a38, v106
    v_accvgpr_write_b32 a39, v107
    v_mfma_f32_16x16x32_bf16 v[68:71], a[96:99], a[16:19], 0
    v_cvt_pk_bf16_f32 v112, v112, v113
    v_cvt_pk_bf16_f32 v113, v114, v115
    v_cvt_pk_bf16_f32 v114, v116, v117
    v_cvt_pk_bf16_f32 v115, v118, v119
    v_mfma_f32_16x16x32_bf16 v[68:71], a[100:103], a[20:23], v[68:71]
    v_accvgpr_write_b32 a40, v112
    v_accvgpr_write_b32 a41, v113
    v_accvgpr_write_b32 a42, v114
    v_accvgpr_write_b32 a43, v115
    v_mfma_f32_16x16x32_bf16 v[68:71], a[104:107], a[24:27], v[68:71]
    v_cvt_pk_bf16_f32 v120, v120, v121
    v_cvt_pk_bf16_f32 v121, v122, v123
    v_cvt_pk_bf16_f32 v122, v124, v125
    v_cvt_pk_bf16_f32 v123, v126, v127
    v_mfma_f32_16x16x32_bf16 v[68:71], a[108:111], a[28:31], v[68:71]
    v_accvgpr_write_b32 a44, v120
    v_accvgpr_write_b32 a45, v121
    v_accvgpr_write_b32 a46, v122
    v_accvgpr_write_b32 a47, v123
    s_nop 1
    v_mfma_f32_16x16x32_bf16 v[96:99], a[80:83], a[32:35], 0
    v_cvt_pk_bf16_f32 v128, v128, v129
    v_cvt_pk_bf16_f32 v129, v130, v131
    v_cvt_pk_bf16_f32 v130, v132, v133
    v_cvt_pk_bf16_f32 v131, v134, v135
    v_mfma_f32_16x16x32_bf16 v[96:99], a[84:87], a[36:39], v[96:99]
    v_accvgpr_write_b32 a48, v128
    v_accvgpr_write_b32 a49, v129
    v_accvgpr_write_b32 a50, v130
    v_accvgpr_write_b32 a51, v131
    v_mfma_f32_16x16x32_bf16 v[96:99], a[88:91], a[40:43], v[96:99]
    v_cvt_pk_bf16_f32 v136, v136, v137
    v_cvt_pk_bf16_f32 v137, v138, v139
    v_cvt_pk_bf16_f32 v138, v140, v141
    v_cvt_pk_bf16_f32 v139, v142, v143
    v_mfma_f32_16x16x32_bf16 v[96:99], a[92:95], a[44:47], v[96:99]
    v_accvgpr_write_b32 a52, v136
    v_accvgpr_write_b32 a53, v137
    v_accvgpr_write_b32 a54, v138
    v_accvgpr_write_b32 a55, v139
    v_mfma_f32_16x16x32_bf16 v[100:103], a[96:99], a[32:35], 0
    v_cvt_pk_bf16_f32 v144, v144, v145
    v_cvt_pk_bf16_f32 v145, v146, v147
    v_cvt_pk_bf16_f32 v146, v148, v149
    v_cvt_pk_bf16_f32 v147, v150, v151
    v_mfma_f32_16x16x32_bf16 v[100:103], a[100:103], a[36:39], v[100:103]
    v_accvgpr_write_b32 a56, v144
    v_accvgpr_write_b32 a57, v145
    v_accvgpr_write_b32 a58, v146
    v_accvgpr_write_b32 a59, v147
    v_mfma_f32_16x16x32_bf16 v[100:103], a[104:107], a[40:43], v[100:103]
    v_cvt_pk_bf16_f32 v152, v152, v153
    v_cvt_pk_bf16_f32 v153, v154, v155
    v_cvt_pk_bf16_f32 v154, v156, v157
    v_cvt_pk_bf16_f32 v155, v158, v159
    v_mfma_f32_16x16x32_bf16 v[100:103], a[108:111], a[44:47], v[100:103]
    v_accvgpr_write_b32 a60, v152
    v_accvgpr_write_b32 a61, v153
    v_accvgpr_write_b32 a62, v154
    v_accvgpr_write_b32 a63, v155
    s_nop 1
    v_mfma_f32_16x16x32_bf16 v[128:131], a[80:83], a[48:51], 0
    ds_read_b128 a[112:115], v1 offset:8192
    v_max3_f32 v216, v32, v33, v34
    v_mfma_f32_16x16x32_bf16 v[128:131], a[84:87], a[52:55], v[128:131]
    v_max3_f32 v217, v35, v36, v37
    v_max3_f32 v216, v216, v38, v39
    v_mfma_f32_16x16x32_bf16 v[128:131], a[88:91], a[56:59], v[128:131]
    ds_read_b128 a[116:119], v2 offset:8192
    v_max_f32_e64 v216, v216, v217
    v_mfma_f32_16x16x32_bf16 v[128:131], a[92:95], a[60:63], v[128:131]
    v_max3_f32 v220, v64, v65, v66
    v_max3_f32 v221, v67, v68, v69
    v_mfma_f32_16x16x32_bf16 v[132:135], a[96:99], a[48:51], 0
    ds_read_b128 a[120:123], v3 offset:8192
    v_max3_f32 v220, v220, v70, v71
    v_mfma_f32_16x16x32_bf16 v[132:135], a[100:103], a[52:55], v[132:135]
    v_max_f32_e64 v220, v220, v221
    v_max3_f32 v224, v96, v97, v98
    v_mfma_f32_16x16x32_bf16 v[132:135], a[104:107], a[56:59], v[132:135]
    ds_read_b128 a[124:127], v4 offset:8192
    v_max3_f32 v225, v99, v100, v101
    v_mfma_f32_16x16x32_bf16 v[132:135], a[108:111], a[60:63], v[132:135]
    v_max3_f32 v224, v224, v102, v103
    v_max_f32_e64 v224, v224, v225
    s_nop 5
    v_max3_f32 v228, v128, v129, v130
    v_max3_f32 v229, v131, v132, v133
    v_max3_f32 v228, v228, v134, v135
    v_max_f32_e64 v228, v228, v229
    v_mov_b32 v217, v216
    v_mov_b32 v221, v220
    v_mov_b32 v225, v224
    v_mov_b32 v229, v228
    s_nop 1
    v_permlane32_swap_b32 v216, v217
    v_permlane32_swap_b32 v220, v221
    v_permlane32_swap_b32 v224, v225
    v_permlane32_swap_b32 v228, v229
    v_max_f32 v216, v216, v217
    v_max_f32 v220, v220, v221
    v_max_f32 v224, v224, v225
    v_max_f32 v228, v228, v229
    v_mov_b32 v217, v216
    v_mov_b32 v221, v220
    v_mov_b32 v225, v224
    v_mov_b32 v229, v228
    s_nop 1
    v_permlane16_swap_b32 v216, v217
    v_permlane16_swap_b32 v220, v221
    v_permlane16_swap_b32 v224, v225
    v_permlane16_swap_b32 v228, v229
    v_max_f32 v216, v216, v217
    v_max_f32 v220, v220, v221
    v_max_f32 v224, v224, v225
    v_max_f32 v228, v228, v229
    v_sub_f32 v219, 0, v216
    v_sub_f32 v218, 0, v216
    v_sub_f32 v217, 0, v216
    v_sub_f32 v216, 0, v216
    v_mov_b32 v236, 0
    v_sub_f32 v223, 0, v220
    v_sub_f32 v222, 0, v220
    v_sub_f32 v221, 0, v220
    v_sub_f32 v220, 0, v220
    v_mov_b32 v237, 0
    v_sub_f32 v227, 0, v224
    v_sub_f32 v226, 0, v224
    v_sub_f32 v225, 0, v224
    v_sub_f32 v224, 0, v224
    v_mov_b32 v238, 0
    v_sub_f32 v231, 0, v228
    v_sub_f32 v230, 0, v228
    v_sub_f32 v229, 0, v228
    v_sub_f32 v228, 0, v228
    v_mov_b32 v239, 0
    s_mov_b32 s59, 0
    v_accvgpr_write_b32 a208, -1
    v_accvgpr_write_b32 a209, -1
    v_accvgpr_write_b32 a210, -1
    v_accvgpr_write_b32 a211, -1
    s_mov_b32 s47, 3
    s_nop 0
    s_mov_b32 s48, s42
    s_cmp_lg_u32 s42, 0
    s_cbranch_scc1 L_nz
    v_lshrrev_b32 v192, 4, v19
    v_lshlrev_b32 v192, 7, v192
    v_add_u32 v193, 8192, v192
    global_store_dword v192, v250, s[94:95] sc1
    global_store_dword v193, v250, s[94:95] sc1
    v_add_u32 v194, 131072, v192
    v_add_u32 v195, 131072, v193
    global_store_dword v194, v250, s[94:95] sc1
    global_store_dword v195, v250, s[94:95] sc1
    s_nop 1
L_nz:
    ds_read_b128 a[128:131], v1 offset:12288
    ds_read_b128 a[132:135], v2 offset:12288
    ds_read_b128 a[136:139], v3 offset:12288
    ds_read_b128 a[140:143], v4 offset:12288
    v_add_f32 v32, v216, v32
    v_exp_f32 v32, v32
    v_add_f32 v33, v216, v33
    v_exp_f32 v33, v33
    v_add_f32 v236, v236, v32
    v_add_f32 v236, v236, v33
    v_add_f32 v34, v216, v34
    v_exp_f32 v34, v34
    v_add_f32 v35, v216, v35
    v_exp_f32 v35, v35
    v_cvt_pk_bf16_f32 v208, v32, v33
    v_add_f32 v236, v236, v34
    v_add_f32 v36, v216, v36
    v_exp_f32 v36, v36
    v_add_f32 v236, v236, v35
    v_cvt_pk_bf16_f32 v209, v34, v35
    v_add_f32 v37, v216, v37
    v_exp_f32 v37, v37
    v_add_f32 v38, v216, v38
    v_exp_f32 v38, v38
    v_add_f32 v236, v236, v36
    v_add_f32 v236, v236, v37
    v_add_f32 v39, v216, v39
    v_exp_f32 v39, v39
    v_cvt_pk_bf16_f32 v210, v36, v37
    v_add_f32 v236, v236, v38
    v_add_f32 v236, v236, v39
    v_cvt_pk_bf16_f32 v211, v38, v39
    s_nop 1
    v_mfma_f32_16x16x32_bf16 v[32:35], a[144:147], v[208:211], 0
    s_add_u32 m0, s45, 49152
    ds_read_b64_tr_b16 a[176:177], v5 offset:8192
    v_add_f32 v64, v220, v64
    v_exp_f32 v64, v64
    v_add_f32 v65, v220, v65
    v_exp_f32 v65, v65
    v_mfma_f32_16x16x32_bf16 v[36:39], a[148:151], v[208:211], 0
    buffer_load_dwordx4 v13, s[28:31], s46 offen offset:0 nt lds
    ds_read_b64_tr_b16 a[178:179], v5 offset:12288
    v_add_f32 v237, v237, v64
    v_add_f32 v237, v237, v65
    v_add_f32 v66, v220, v66
    v_mfma_f32_16x16x32_bf16 v[40:43], a[152:155], v[208:211], 0
    buffer_load_dwordx4 v14, s[28:31], s46 offen offset:1024 nt lds
    ds_read_b64_tr_b16 a[180:181], v6 offset:8192
    v_exp_f32 v66, v66
    v_add_f32 v67, v220, v67
    v_exp_f32 v67, v67
    v_cvt_pk_bf16_f32 v212, v64, v65
    v_mfma_f32_16x16x32_bf16 v[44:47], a[156:159], v[208:211], 0
    buffer_load_dwordx4 v15, s[28:31], s46 offen offset:2048 nt lds
    ds_read_b64_tr_b16 a[182:183], v6 offset:12288
    v_add_f32 v237, v237, v66
    v_add_f32 v68, v220, v68
    v_exp_f32 v68, v68
    v_mfma_f32_16x16x32_bf16 v[48:51], a[160:163], v[208:211], 0
    buffer_load_dwordx4 v16, s[28:31], s46 offen offset:3072 nt lds
    ds_read_b64_tr_b16 a[184:185], v7 offset:8192
    v_add_f32 v237, v237, v67
    v_cvt_pk_bf16_f32 v213, v66, v67
    v_add_f32 v69, v220, v69
    v_exp_f32 v69, v69
    v_mfma_f32_16x16x32_bf16 v[52:55], a[164:167], v[208:211], 0
    ds_read_b64_tr_b16 a[186:187], v7 offset:12288
    v_add_f32 v70, v220, v70
    v_exp_f32 v70, v70
    v_add_f32 v237, v237, v68
    v_mfma_f32_16x16x32_bf16 v[56:59], a[168:171], v[208:211], 0
    ds_read_b64_tr_b16 a[188:189], v8 offset:8192
    v_add_f32 v237, v237, v69
    v_add_f32 v71, v220, v71
    v_exp_f32 v71, v71
    v_cvt_pk_bf16_f32 v214, v68, v69
    v_mfma_f32_16x16x32_bf16 v[60:63], a[172:175], v[208:211], 0
    ds_read_b64_tr_b16 a[190:191], v8 offset:12288
    v_add_f32 v237, v237, v70
    v_add_f32 v237, v237, v71
    v_cvt_pk_bf16_f32 v215, v70, v71
    s_nop 1
    v_mfma_f32_16x16x32_bf16 v[64:67], a[144:147], v[212:215], 0
    s_add_u32 m0, s45, 114688
    ds_read_b64_tr_b16 a[192:193], v9 offset:8192
    ds_read_b64_tr_b16 a[194:195], v9 offset:12288
    v_add_f32 v96, v224, v96
    v_exp_f32 v96, v96
    v_add_f32 v97, v224, v97
    v_exp_f32 v97, v97
    v_mfma_f32_16x16x32_bf16 v[68:71], a[148:151], v[212:215], 0
    buffer_load_dwordx4 v17, s[32:35], s46 offen offset:0 nt lds
    ds_read_b64_tr_b16 a[196:197], v10 offset:8192
    ds_read_b64_tr_b16 a[198:199], v10 offset:12288
    v_add_f32 v238, v238, v96
    v_add_f32 v98, v224, v98
    v_exp_f32 v98, v98
    v_mfma_f32_16x16x32_bf16 v[72:75], a[152:155], v[212:215], 0
    buffer_load_dwordx4 v18, s[32:35], s46 offen offset:1024 nt lds
    ds_read_b64_tr_b16 a[200:201], v11 offset:8192
    v_add_f32 v238, v238, v97
    v_add_f32 v99, v224, v99
    v_exp_f32 v99, v99
    v_cvt_pk_bf16_f32 v208, v96, v97
    v_mfma_f32_16x16x32_bf16 v[76:79], a[156:159], v[212:215], 0
    buffer_load_dwordx4 v17, s[32:35], s46 offen offset:2048 nt lds
    ds_read_b64_tr_b16 a[202:203], v11 offset:12288
    ds_read_b64_tr_b16 a[204:205], v12 offset:8192
    v_add_f32 v100, v224, v100
    v_exp_f32 v100, v100
    v_add_f32 v238, v238, v98
    v_mfma_f32_16x16x32_bf16 v[80:83], a[160:163], v[212:215], 0
    buffer_load_dwordx4 v18, s[32:35], s46 offen offset:3072 nt lds
    ds_read_b64_tr_b16 a[206:207], v12 offset:12288
    v_add_f32 v101, v224, v101
    v_exp_f32 v101, v101
    v_add_f32 v238, v238, v99
    v_cvt_pk_bf16_f32 v209, v98, v99
    v_mfma_f32_16x16x32_bf16 v[84:87], a[164:167], v[212:215], 0
    v_add_f32 v102, v224, v102
    v_exp_f32 v102, v102
    v_add_f32 v238, v238, v100
    v_mfma_f32_16x16x32_bf16 v[88:91], a[168:171], v[212:215], 0
    v_add_f32 v238, v238, v101
    v_add_f32 v103, v224, v103
    v_exp_f32 v103, v103
    v_cvt_pk_bf16_f32 v210, v100, v101
    v_mfma_f32_16x16x32_bf16 v[92:95], a[172:175], v[212:215], 0
    v_add_f32 v238, v238, v102
    v_add_f32 v238, v238, v103
    v_cvt_pk_bf16_f32 v211, v102, v103
    s_waitcnt vmcnt(16) lgkmcnt(0)
    s_barrier
    s_nop 1
    v_mfma_f32_16x16x32_bf16 v[192:195], a[112:115], a[0:3], v[216:219]
    s_add_u32 s46, s46, 16384
    v_add_f32 v128, v228, v128
    v_exp_f32 v128, v128
    v_mfma_f32_16x16x32_bf16 v[192:195], a[116:119], a[4:7], v[192:195]
    s_and_b32 s46, s46, 0x3ffff
    v_add_f32 v129, v228, v129
    v_exp_f32 v129, v129
    v_mfma_f32_16x16x32_bf16 v[192:195], a[120:123], a[8:11], v[192:195]
    s_sub_u32 s82, s46, 12288
    v_add_f32 v239, v239, v128
    v_add_f32 v239, v239, v129
    v_mfma_f32_16x16x32_bf16 v[192:195], a[124:127], a[12:15], v[192:195]
    s_sub_u32 s83, s46, 8192
    v_add_f32 v130, v228, v130
    v_exp_f32 v130, v130
    v_mfma_f32_16x16x32_bf16 v[196:199], a[128:131], a[0:3], v[216:219]
    s_sub_u32 s84, s46, 4096
    v_add_f32 v131, v228, v131
    v_exp_f32 v131, v131
    v_mfma_f32_16x16x32_bf16 v[196:199], a[132:135], a[4:7], v[196:199]
    s_mov_b32 m0, 0
    ds_read_b128 a[80:83], v1 offset:16384
    v_cvt_pk_bf16_f32 v212, v128, v129
    v_mfma_f32_16x16x32_bf16 v[196:199], a[136:139], a[8:11], v[196:199]
    ds_read_b128 a[84:87], v2 offset:16384
    v_add_f32 v239, v239, v130
    v_mfma_f32_16x16x32_bf16 v[196:199], a[140:143], a[12:15], v[196:199]
    buffer_load_dwordx4 v13, s[28:31], s82 offen offset:0 nt lds
    v_add_f32 v132, v228, v132
    v_exp_f32 v132, v132
    v_mfma_f32_16x16x32_bf16 v[96:99], a[144:147], v[208:211], 0
    buffer_load_dwordx4 v14, s[28:31], s82 offen offset:1024 nt lds
    v_add_f32 v239, v239, v131
    v_cvt_pk_bf16_f32 v213, v130, v131
    v_mfma_f32_16x16x32_bf16 v[100:103], a[148:151], v[208:211], 0
    buffer_load_dwordx4 v15, s[28:31], s82 offen offset:2048 nt lds
    v_add_f32 v133, v228, v133
    v_exp_f32 v133, v133
    v_mfma_f32_16x16x32_bf16 v[104:107], a[152:155], v[208:211], 0
    buffer_load_dwordx4 v16, s[28:31], s82 offen offset:3072 nt lds
    v_add_f32 v134, v228, v134
    v_exp_f32 v134, v134
    v_mfma_f32_16x16x32_bf16 v[108:111], a[156:159], v[208:211], 0
    v_add_f32 v239, v239, v132
    v_add_f32 v239, v239, v133
    v_mfma_f32_16x16x32_bf16 v[112:115], a[160:163], v[208:211], 0
    v_add_f32 v135, v228, v135
    v_exp_f32 v135, v135
    v_mfma_f32_16x16x32_bf16 v[116:119], a[164:167], v[208:211], 0
    ds_read_b128 a[88:91], v3 offset:16384
    v_cvt_pk_bf16_f32 v214, v132, v133
    v_mfma_f32_16x16x32_bf16 v[120:123], a[168:171], v[208:211], 0
    ds_read_b128 a[92:95], v4 offset:16384
    v_add_f32 v239, v239, v134
    v_mfma_f32_16x16x32_bf16 v[124:127], a[172:175], v[208:211], 0
    v_add_f32 v239, v239, v135
    v_cvt_pk_bf16_f32 v215, v134, v135
    v_mfma_f32_16x16x32_bf16 v[200:203], a[112:115], a[16:19], v[220:223]
    s_mov_b32 m0, 4096
    v_exp_f32 v192, v192
    v_mfma_f32_16x16x32_bf16 v[200:203], a[116:119], a[20:23], v[200:203]
    buffer_load_dwordx4 v13, s[28:31], s83 offen offset:0 nt lds
    v_exp_f32 v193, v193
    v_mfma_f32_16x16x32_bf16 v[200:203], a[120:123], a[24:27], v[200:203]
    buffer_load_dwordx4 v14, s[28:31], s83 offen offset:1024 nt lds
    v_add_f32 v236, v236, v192
    v_add_f32 v236, v236, v193
    v_mfma_f32_16x16x32_bf16 v[200:203], a[124:127], a[28:31], v[200:203]
    buffer_load_dwordx4 v15, s[28:31], s83 offen offset:2048 nt lds
    v_exp_f32 v194, v194
    v_mfma_f32_16x16x32_bf16 v[204:207], a[128:131], a[16:19], v[220:223]
    buffer_load_dwordx4 v16, s[28:31], s83 offen offset:3072 nt lds
    v_exp_f32 v195, v195
    v_mfma_f32_16x16x32_bf16 v[204:207], a[132:135], a[20:23], v[204:207]
    ds_read_b128 a[96:99], v1 offset:20480
    v_cvt_pk_bf16_f32 v208, v192, v193
    v_mfma_f32_16x16x32_bf16 v[204:207], a[136:139], a[24:27], v[204:207]
    ds_read_b128 a[100:103], v2 offset:20480
    v_add_f32 v236, v236, v194
    v_mfma_f32_16x16x32_bf16 v[204:207], a[140:143], a[28:31], v[204:207]
    v_exp_f32 v196, v196
    v_mfma_f32_16x16x32_bf16 v[128:131], a[144:147], v[212:215], 0
    v_add_f32 v236, v236, v195
    v_cvt_pk_bf16_f32 v209, v194, v195
    v_mfma_f32_16x16x32_bf16 v[132:135], a[148:151], v[212:215], 0
    v_exp_f32 v197, v197
    v_mfma_f32_16x16x32_bf16 v[136:139], a[152:155], v[212:215], 0
    v_exp_f32 v198, v198
    v_mfma_f32_16x16x32_bf16 v[140:143], a[156:159], v[212:215], 0
    v_add_f32 v236, v236, v196
    v_add_f32 v236, v236, v197
    v_mfma_f32_16x16x32_bf16 v[144:147], a[160:163], v[212:215], 0
    v_exp_f32 v199, v199
    v_mfma_f32_16x16x32_bf16 v[148:151], a[164:167], v[212:215], 0
    ds_read_b128 a[104:107], v3 offset:20480
    v_cvt_pk_bf16_f32 v210, v196, v197
    v_mfma_f32_16x16x32_bf16 v[152:155], a[168:171], v[212:215], 0
    ds_read_b128 a[108:111], v4 offset:20480
    v_add_f32 v236, v236, v198
    v_mfma_f32_16x16x32_bf16 v[156:159], a[172:175], v[212:215], 0
    v_add_f32 v236, v236, v199
    v_cvt_pk_bf16_f32 v211, v198, v199
    s_branch L_mid_b
.p2align 6
L_loop_b:
    s_cmp_lg_u32 s48, 0
    s_cbranch_scc1 L_np
    v_mov_b32 v252, s1
    v_mov_b32 v253, 1
    s_mov_b32 s48, 1
    global_store_dword v252, v253, s[80:81] sc1
L_np:
    v_mfma_f32_16x16x32_bf16 v[200:203], a[80:83], a[16:19], v[220:223]
    s_mov_b32 m0, 118784
    v_exp_f32 v192, v192
    v_mfma_f32_16x16x32_bf16 v[200:203], a[84:87], a[20:23], v[200:203]
    buffer_load_dwordx4 v17, s[32:35], s83 offen offset:0 nt lds
    v_exp_f32 v193, v193
    v_mfma_f32_16x16x32_bf16 v[200:203], a[88:91], a[24:27], v[200:203]
    buffer_load_dwordx4 v18, s[32:35], s83 offen offset:1024 nt lds
    v_add_f32 v236, v236, v192
    v_add_f32 v236, v236, v193
    v_mfma_f32_16x16x32_bf16 v[200:203], a[92:95], a[28:31], v[200:203]
    buffer_load_dwordx4 v17, s[32:35], s83 offen offset:2048 nt lds
    v_exp_f32 v194, v194
    v_mfma_f32_16x16x32_bf16 v[204:207], a[96:99], a[16:19], v[220:223]
    buffer_load_dwordx4 v18, s[32:35], s83 offen offset:3072 nt lds
    v_exp_f32 v195, v195
    v_mfma_f32_16x16x32_bf16 v[204:207], a[100:103], a[20:23], v[204:207]
    ds_read_b128 a[128:131], v1 offset:12288
    v_cvt_pk_bf16_f32 v208, v192, v193
    v_mfma_f32_16x16x32_bf16 v[204:207], a[104:107], a[24:27], v[204:207]
    ds_read_b128 a[132:135], v2 offset:12288
    v_add_f32 v236, v236, v194
    v_mfma_f32_16x16x32_bf16 v[204:207], a[108:111], a[28:31], v[204:207]
    v_exp_f32 v196, v196
    v_mfma_f32_16x16x32_bf16 v[128:131], a[176:179], v[212:215], v[128:131]
    v_add_f32 v236, v236, v195
    v_cvt_pk_bf16_f32 v209, v194, v195
    v_mfma_f32_16x16x32_bf16 v[132:135], a[180:183], v[212:215], v[132:135]
    v_exp_f32 v197, v197
    v_mfma_f32_16x16x32_bf16 v[136:139], a[184:187], v[212:215], v[136:139]
    v_exp_f32 v198, v198
    v_mfma_f32_16x16x32_bf16 v[140:143], a[188:191], v[212:215], v[140:143]
    v_add_f32 v236, v236, v196
    v_add_f32 v236, v236, v197
    v_mfma_f32_16x16x32_bf16 v[144:147], a[192:195], v[212:215], v[144:147]
    v_exp_f32 v199, v199
    v_mfma_f32_16x16x32_bf16 v[148:151], a[196:199], v[212:215], v[148:151]
    ds_read_b128 a[136:139], v3 offset:12288
    v_cvt_pk_bf16_f32 v210, v196, v197
    v_mfma_f32_16x16x32_bf16 v[152:155], a[200:203], v[212:215], v[152:155]
    ds_read_b128 a[140:143], v4 offset:12288
    v_add_f32 v236, v236, v198
    v_mfma_f32_16x16x32_bf16 v[156:159], a[204:207], v[212:215], v[156:159]
    v_add_f32 v236, v236, v199
    v_cvt_pk_bf16_f32 v211, v198, v199
    v_mfma_f32_16x16x32_bf16 v[192:195], a[80:83], a[32:35], v[224:227]
    s_mov_b32 m0, 122880
    v_exp_f32 v200, v200
    v_mfma_f32_16x16x32_bf16 v[192:195], a[84:87], a[36:39], v[192:195]
    buffer_load_dwordx4 v17, s[32:35], s84 offen offset:0 nt lds
    v_exp_f32 v201, v201
    v_mfma_f32_16x16x32_bf16 v[192:195], a[88:91], a[40:43], v[192:195]
    ds_read_b64_tr_b16 a[176:177], v5 offset:8192
    v_add_f32 v237, v237, v200
    v_add_f32 v237, v237, v201
    v_mfma_f32_16x16x32_bf16 v[192:195], a[92:95], a[44:47], v[192:195]
    buffer_load_dwordx4 v18, s[32:35], s84 offen offset:1024 nt lds
    v_exp_f32 v202, v202
    v_mfma_f32_16x16x32_bf16 v[196:199], a[96:99], a[32:35], v[224:227]
    buffer_load_dwordx4 v17, s[32:35], s84 offen offset:2048 nt lds
    v_exp_f32 v203, v203
    v_mfma_f32_16x16x32_bf16 v[196:199], a[100:103], a[36:39], v[196:199]
    ds_read_b64_tr_b16 a[178:179], v5 offset:12288
    v_cvt_pk_bf16_f32 v212, v200, v201
    v_mfma_f32_16x16x32_bf16 v[196:199], a[104:107], a[40:43], v[196:199]
    ds_read_b64_tr_b16 a[180:181], v6 offset:8192
    v_add_f32 v237, v237, v202
    v_mfma_f32_16x16x32_bf16 v[196:199], a[108:111], a[44:47], v[196:199]
    buffer_load_dwordx4 v18, s[32:35], s84 offen offset:3072 nt lds
    v_exp_f32 v204, v204
    v_mfma_f32_16x16x32_bf16 v[32:35], a[144:147], v[208:211], v[32:35]
    ds_read_b64_tr_b16 a[182:183], v6 offset:12288
    v_add_f32 v237, v237, v203
    v_cvt_pk_bf16_f32 v213, v202, v203
    v_mfma_f32_16x16x32_bf16 v[36:39], a[148:151], v[208:211], v[36:39]
    global_load_dword v251, v254, s[100:101]
    v_exp_f32 v205, v205
    v_mfma_f32_16x16x32_bf16 v[40:43], a[152:155], v[208:211], v[40:43]
    v_exp_f32 v206, v206
    v_mfma_f32_16x16x32_bf16 v[44:47], a[156:159], v[208:211], v[44:47]
    ds_read_b64_tr_b16 a[184:185], v7 offset:8192
    v_add_f32 v237, v237, v204
    v_add_f32 v237, v237, v205
    v_mfma_f32_16x16x32_bf16 v[48:51], a[160:163], v[208:211], v[48:51]
    v_exp_f32 v207, v207
    v_mfma_f32_16x16x32_bf16 v[52:55], a[164:167], v[208:211], v[52:55]
    ds_read_b64_tr_b16 a[186:187], v7 offset:12288
    v_cvt_pk_bf16_f32 v214, v204, v205
    v_mfma_f32_16x16x32_bf16 v[56:59], a[168:171], v[208:211], v[56:59]
    ds_read_b64_tr_b16 a[188:189], v8 offset:8192
    v_add_f32 v237, v237, v206
    v_mfma_f32_16x16x32_bf16 v[60:63], a[172:175], v[208:211], v[60:63]
    ds_read_b64_tr_b16 a[190:191], v8 offset:12288
    v_add_f32 v237, v237, v207
    v_cvt_pk_bf16_f32 v215, v206, v207
    v_mfma_f32_16x16x32_bf16 v[200:203], a[80:83], a[48:51], v[228:231]
    s_mov_b32 m0, 126976
    v_exp_f32 v192, v192
    v_mfma_f32_16x16x32_bf16 v[200:203], a[84:87], a[52:55], v[200:203]
    buffer_load_dwordx4 v17, s[32:35], s46 offen offset:0 nt lds
    v_exp_f32 v193, v193
    v_mfma_f32_16x16x32_bf16 v[200:203], a[88:91], a[56:59], v[200:203]
    ds_read_b64_tr_b16 a[192:193], v9 offset:8192
    ds_read_b64_tr_b16 a[194:195], v9 offset:12288
    v_add_f32 v238, v238, v192
    v_mfma_f32_16x16x32_bf16 v[200:203], a[92:95], a[60:63], v[200:203]
    buffer_load_dwordx4 v18, s[32:35], s46 offen offset:1024 nt lds
    v_exp_f32 v194, v194
    v_mfma_f32_16x16x32_bf16 v[204:207], a[96:99], a[48:51], v[228:231]
    ds_read_b64_tr_b16 a[196:197], v10 offset:8192
    ds_read_b64_tr_b16 a[198:199], v10 offset:12288
    v_add_f32 v238, v238, v193
    v_mfma_f32_16x16x32_bf16 v[204:207], a[100:103], a[52:55], v[204:207]
    buffer_load_dwordx4 v17, s[32:35], s46 offen offset:2048 nt lds
    v_exp_f32 v195, v195
    v_mfma_f32_16x16x32_bf16 v[204:207], a[104:107], a[56:59], v[204:207]
    ds_read_b64_tr_b16 a[200:201], v11 offset:8192
    ds_read_b64_tr_b16 a[202:203], v11 offset:12288
    v_cvt_pk_bf16_f32 v208, v192, v193
    v_mfma_f32_16x16x32_bf16 v[204:207], a[108:111], a[60:63], v[204:207]
    buffer_load_dwordx4 v18, s[32:35], s46 offen offset:3072 nt lds
    v_exp_f32 v196, v196
    v_mfma_f32_16x16x32_bf16 v[64:67], a[144:147], v[212:215], v[64:67]
    ds_read_b64_tr_b16 a[204:205], v12 offset:8192
    ds_read_b64_tr_b16 a[206:207], v12 offset:12288
    v_add_f32 v238, v238, v194
    v_mfma_f32_16x16x32_bf16 v[68:71], a[148:151], v[212:215], v[68:71]
    v_exp_f32 v197, v197
    v_mfma_f32_16x16x32_bf16 v[72:75], a[152:155], v[212:215], v[72:75]
    v_add_f32 v238, v238, v195
    v_cvt_pk_bf16_f32 v209, v194, v195
    v_mfma_f32_16x16x32_bf16 v[76:79], a[156:159], v[212:215], v[76:79]
    v_exp_f32 v198, v198
    v_mfma_f32_16x16x32_bf16 v[80:83], a[160:163], v[212:215], v[80:83]
    v_add_f32 v238, v238, v196
    v_add_f32 v238, v238, v197
    v_mfma_f32_16x16x32_bf16 v[84:87], a[164:167], v[212:215], v[84:87]
    v_exp_f32 v199, v199
    v_mfma_f32_16x16x32_bf16 v[88:91], a[168:171], v[212:215], v[88:91]
    s_waitcnt vmcnt(63) lgkmcnt(0)
    v_cvt_pk_bf16_f32 v210, v196, v197
    v_add_f32 v238, v238, v198
    v_mfma_f32_16x16x32_bf16 v[92:95], a[172:175], v[212:215], v[92:95]
    s_barrier
    v_add_f32 v238, v238, v199
    v_cvt_pk_bf16_f32 v211, v198, v199
    v_mfma_f32_16x16x32_bf16 v[192:195], a[112:115], a[0:3], v[216:219]
    s_add_u32 s46, s46, 16384
    v_exp_f32 v200, v200
    v_mfma_f32_16x16x32_bf16 v[192:195], a[116:119], a[4:7], v[192:195]
    s_and_b32 s46, s46, 0x3ffff
    v_exp_f32 v201, v201
    v_mfma_f32_16x16x32_bf16 v[192:195], a[120:123], a[8:11], v[192:195]
    s_sub_u32 s82, s46, 12288
    v_add_f32 v239, v239, v200
    v_add_f32 v239, v239, v201
    v_mfma_f32_16x16x32_bf16 v[192:195], a[124:127], a[12:15], v[192:195]
    s_sub_u32 s83, s46, 8192
    v_exp_f32 v202, v202
    v_mfma_f32_16x16x32_bf16 v[196:199], a[128:131], a[0:3], v[216:219]
    s_sub_u32 s84, s46, 4096
    v_exp_f32 v203, v203
    v_mfma_f32_16x16x32_bf16 v[196:199], a[132:135], a[4:7], v[196:199]
    s_mov_b32 m0, 0
    ds_read_b128 a[80:83], v1 offset:16384
    v_cvt_pk_bf16_f32 v212, v200, v201
    v_mfma_f32_16x16x32_bf16 v[196:199], a[136:139], a[8:11], v[196:199]
    ds_read_b128 a[84:87], v2 offset:16384
    v_add_f32 v239, v239, v202
    v_mfma_f32_16x16x32_bf16 v[196:199], a[140:143], a[12:15], v[196:199]
    buffer_load_dwordx4 v13, s[28:31], s82 offen offset:0 nt lds
    v_exp_f32 v204, v204
    v_mfma_f32_16x16x32_bf16 v[96:99], a[144:147], v[208:211], v[96:99]
    buffer_load_dwordx4 v14, s[28:31], s82 offen offset:1024 nt lds
    v_add_f32 v239, v239, v203
    v_cvt_pk_bf16_f32 v213, v202, v203
    v_mfma_f32_16x16x32_bf16 v[100:103], a[148:151], v[208:211], v[100:103]
    buffer_load_dwordx4 v15, s[28:31], s82 offen offset:2048 nt lds
    v_exp_f32 v205, v205
    v_mfma_f32_16x16x32_bf16 v[104:107], a[152:155], v[208:211], v[104:107]
    buffer_load_dwordx4 v16, s[28:31], s82 offen offset:3072 nt lds
    v_exp_f32 v206, v206
    v_mfma_f32_16x16x32_bf16 v[108:111], a[156:159], v[208:211], v[108:111]
    v_add_f32 v239, v239, v204
    v_add_f32 v239, v239, v205
    v_mfma_f32_16x16x32_bf16 v[112:115], a[160:163], v[208:211], v[112:115]
    v_exp_f32 v207, v207
    v_mfma_f32_16x16x32_bf16 v[116:119], a[164:167], v[208:211], v[116:119]
    ds_read_b128 a[88:91], v3 offset:16384
    v_cvt_pk_bf16_f32 v214, v204, v205
    v_mfma_f32_16x16x32_bf16 v[120:123], a[168:171], v[208:211], v[120:123]
    ds_read_b128 a[92:95], v4 offset:16384
    v_add_f32 v239, v239, v206
    v_mfma_f32_16x16x32_bf16 v[124:127], a[172:175], v[208:211], v[124:127]
    v_add_f32 v239, v239, v207
    v_cvt_pk_bf16_f32 v215, v206, v207
    v_mfma_f32_16x16x32_bf16 v[200:203], a[112:115], a[16:19], v[220:223]
    s_mov_b32 m0, 4096
    v_exp_f32 v192, v192
    v_mfma_f32_16x16x32_bf16 v[200:203], a[116:119], a[20:23], v[200:203]
    buffer_load_dwordx4 v13, s[28:31], s83 offen offset:0 nt lds
    v_exp_f32 v193, v193
    v_mfma_f32_16x16x32_bf16 v[200:203], a[120:123], a[24:27], v[200:203]
    buffer_load_dwordx4 v14, s[28:31], s83 offen offset:1024 nt lds
    v_add_f32 v236, v236, v192
    v_add_f32 v236, v236, v193
    v_mfma_f32_16x16x32_bf16 v[200:203], a[124:127], a[28:31], v[200:203]
    buffer_load_dwordx4 v15, s[28:31], s83 offen offset:2048 nt lds
    v_exp_f32 v194, v194
    v_mfma_f32_16x16x32_bf16 v[204:207], a[128:131], a[16:19], v[220:223]
    buffer_load_dwordx4 v16, s[28:31], s83 offen offset:3072 nt lds
    v_exp_f32 v195, v195
    v_mfma_f32_16x16x32_bf16 v[204:207], a[132:135], a[20:23], v[204:207]
    ds_read_b128 a[96:99], v1 offset:20480
    v_cvt_pk_bf16_f32 v208, v192, v193
    v_mfma_f32_16x16x32_bf16 v[204:207], a[136:139], a[24:27], v[204:207]
    ds_read_b128 a[100:103], v2 offset:20480
    v_add_f32 v236, v236, v194
    v_mfma_f32_16x16x32_bf16 v[204:207], a[140:143], a[28:31], v[204:207]
    v_exp_f32 v196, v196
    v_mfma_f32_16x16x32_bf16 v[128:131], a[144:147], v[212:215], v[128:131]
    v_add_f32 v236, v236, v195
    v_cvt_pk_bf16_f32 v209, v194, v195
    v_mfma_f32_16x16x32_bf16 v[132:135], a[148:151], v[212:215], v[132:135]
    v_exp_f32 v197, v197
    v_mfma_f32_16x16x32_bf16 v[136:139], a[152:155], v[212:215], v[136:139]
    v_exp_f32 v198, v198
    v_mfma_f32_16x16x32_bf16 v[140:143], a[156:159], v[212:215], v[140:143]
    v_add_f32 v236, v236, v196
    v_add_f32 v236, v236, v197
    v_mfma_f32_16x16x32_bf16 v[144:147], a[160:163], v[212:215], v[144:147]
    v_exp_f32 v199, v199
    v_mfma_f32_16x16x32_bf16 v[148:151], a[164:167], v[212:215], v[148:151]
    ds_read_b128 a[104:107], v3 offset:20480
    v_cvt_pk_bf16_f32 v210, v196, v197
    v_mfma_f32_16x16x32_bf16 v[152:155], a[168:171], v[212:215], v[152:155]
    ds_read_b128 a[108:111], v4 offset:20480
    v_add_f32 v236, v236, v198
    v_mfma_f32_16x16x32_bf16 v[156:159], a[172:175], v[212:215], v[156:159]
    v_add_f32 v236, v236, v199
    v_cvt_pk_bf16_f32 v211, v198, v199
L_mid_b:
    v_mfma_f32_16x16x32_bf16 v[192:195], a[112:115], a[32:35], v[224:227]
    s_mov_b32 m0, 8192
    v_exp_f32 v200, v200
    v_mfma_f32_16x16x32_bf16 v[192:195], a[116:119], a[36:39], v[192:195]
    buffer_load_dwordx4 v13, s[28:31], s84 offen offset:0 nt lds
    v_exp_f32 v201, v201
    v_mfma_f32_16x16x32_bf16 v[192:195], a[120:123], a[40:43], v[192:195]
    ds_read_b64_tr_b16 a[144:145], v5 offset:16384
    v_add_f32 v237, v237, v200
    v_add_f32 v237, v237, v201
    v_mfma_f32_16x16x32_bf16 v[192:195], a[124:127], a[44:47], v[192:195]
    buffer_load_dwordx4 v14, s[28:31], s84 offen offset:1024 nt lds
    v_exp_f32 v202, v202
    v_mfma_f32_16x16x32_bf16 v[196:199], a[128:131], a[32:35], v[224:227]
    buffer_load_dwordx4 v15, s[28:31], s84 offen offset:2048 nt lds
    v_exp_f32 v203, v203
    v_mfma_f32_16x16x32_bf16 v[196:199], a[132:135], a[36:39], v[196:199]
    ds_read_b64_tr_b16 a[146:147], v5 offset:20480
    v_cvt_pk_bf16_f32 v212, v200, v201
    v_mfma_f32_16x16x32_bf16 v[196:199], a[136:139], a[40:43], v[196:199]
    ds_read_b64_tr_b16 a[148:149], v6 offset:16384
    v_add_f32 v237, v237, v202
    v_mfma_f32_16x16x32_bf16 v[196:199], a[140:143], a[44:47], v[196:199]
    buffer_load_dwordx4 v16, s[28:31], s84 offen offset:3072 nt lds
    v_exp_f32 v204, v204
    v_mfma_f32_16x16x32_bf16 v[32:35], a[176:179], v[208:211], v[32:35]
    ds_read_b64_tr_b16 a[150:151], v6 offset:20480
    v_add_f32 v237, v237, v203
    v_cvt_pk_bf16_f32 v213, v202, v203
    v_mfma_f32_16x16x32_bf16 v[36:39], a[180:183], v[208:211], v[36:39]
    v_exp_f32 v205, v205
    v_mfma_f32_16x16x32_bf16 v[40:43], a[184:187], v[208:211], v[40:43]
    v_exp_f32 v206, v206
    v_mfma_f32_16x16x32_bf16 v[44:47], a[188:191], v[208:211], v[44:47]
    ds_read_b64_tr_b16 a[152:153], v7 offset:16384
    v_add_f32 v237, v237, v204
    v_add_f32 v237, v237, v205
    v_mfma_f32_16x16x32_bf16 v[48:51], a[192:195], v[208:211], v[48:51]
    v_exp_f32 v207, v207
    v_mfma_f32_16x16x32_bf16 v[52:55], a[196:199], v[208:211], v[52:55]
    ds_read_b64_tr_b16 a[154:155], v7 offset:20480
    v_cvt_pk_bf16_f32 v214, v204, v205
    v_mfma_f32_16x16x32_bf16 v[56:59], a[200:203], v[208:211], v[56:59]
    ds_read_b64_tr_b16 a[156:157], v8 offset:16384
    v_add_f32 v237, v237, v206
    v_mfma_f32_16x16x32_bf16 v[60:63], a[204:207], v[208:211], v[60:63]
    ds_read_b64_tr_b16 a[158:159], v8 offset:20480
    v_add_f32 v237, v237, v207
    v_cvt_pk_bf16_f32 v215, v206, v207
    v_mfma_f32_16x16x32_bf16 v[200:203], a[112:115], a[48:51], v[228:231]
    s_mov_b32 m0, 12288
    v_exp_f32 v192, v192
    v_mfma_f32_16x16x32_bf16 v[200:203], a[116:119], a[52:55], v[200:203]
    buffer_load_dwordx4 v13, s[28:31], s46 offen offset:0 nt lds
    v_exp_f32 v193, v193
    v_mfma_f32_16x16x32_bf16 v[200:203], a[120:123], a[56:59], v[200:203]
    ds_read_b64_tr_b16 a[160:161], v9 offset:16384
    ds_read_b64_tr_b16 a[162:163], v9 offset:20480
    v_add_f32 v238, v238, v192
    v_mfma_f32_16x16x32_bf16 v[200:203], a[124:127], a[60:63], v[200:203]
    buffer_load_dwordx4 v14, s[28:31], s46 offen offset:1024 nt lds
    v_exp_f32 v194, v194
    v_mfma_f32_16x16x32_bf16 v[204:207], a[128:131], a[48:51], v[228:231]
    ds_read_b64_tr_b16 a[164:165], v10 offset:16384
    ds_read_b64_tr_b16 a[166:167], v10 offset:20480
    v_add_f32 v238, v238, v193
    v_mfma_f32_16x16x32_bf16 v[204:207], a[132:135], a[52:55], v[204:207]
    buffer_load_dwordx4 v15, s[28:31], s46 offen offset:2048 nt lds
    v_exp_f32 v195, v195
    v_mfma_f32_16x16x32_bf16 v[204:207], a[136:139], a[56:59], v[204:207]
    ds_read_b64_tr_b16 a[168:169], v11 offset:16384
    ds_read_b64_tr_b16 a[170:171], v11 offset:20480
    v_cvt_pk_bf16_f32 v208, v192, v193
    v_mfma_f32_16x16x32_bf16 v[204:207], a[140:143], a[60:63], v[204:207]
    buffer_load_dwordx4 v16, s[28:31], s46 offen offset:3072 nt lds
    v_exp_f32 v196, v196
    v_mfma_f32_16x16x32_bf16 v[64:67], a[176:179], v[212:215], v[64:67]
    ds_read_b64_tr_b16 a[172:173], v12 offset:16384
    ds_read_b64_tr_b16 a[174:175], v12 offset:20480
    v_add_f32 v238, v238, v194
    v_mfma_f32_16x16x32_bf16 v[68:71], a[180:183], v[212:215], v[68:71]
    v_exp_f32 v197, v197
    v_mfma_f32_16x16x32_bf16 v[72:75], a[184:187], v[212:215], v[72:75]
    v_add_f32 v238, v238, v195
    v_cvt_pk_bf16_f32 v209, v194, v195
    v_mfma_f32_16x16x32_bf16 v[76:79], a[188:191], v[212:215], v[76:79]
    v_exp_f32 v198, v198
    v_mfma_f32_16x16x32_bf16 v[80:83], a[192:195], v[212:215], v[80:83]
    v_add_f32 v238, v238, v196
    v_add_f32 v238, v238, v197
    v_mfma_f32_16x16x32_bf16 v[84:87], a[196:199], v[212:215], v[84:87]
    v_exp_f32 v199, v199
    v_mfma_f32_16x16x32_bf16 v[88:91], a[200:203], v[212:215], v[88:91]
    v_cvt_pk_bf16_f32 v210, v196, v197
    v_add_f32 v238, v238, v198
    v_mfma_f32_16x16x32_bf16 v[92:95], a[204:207], v[212:215], v[92:95]
    s_waitcnt lgkmcnt(0)
    v_add_f32 v238, v238, v199
    v_cvt_pk_bf16_f32 v211, v198, v199
    v_mfma_f32_16x16x32_bf16 v[192:195], a[80:83], a[0:3], v[216:219]
    s_mov_b32 m0, 65536
    v_exp_f32 v200, v200
    v_mfma_f32_16x16x32_bf16 v[192:195], a[84:87], a[4:7], v[192:195]
    buffer_load_dwordx4 v17, s[32:35], s82 offen offset:0 nt lds
    v_exp_f32 v201, v201
    v_mfma_f32_16x16x32_bf16 v[192:195], a[88:91], a[8:11], v[192:195]
    buffer_load_dwordx4 v18, s[32:35], s82 offen offset:1024 nt lds
    v_add_f32 v239, v239, v200
    v_add_f32 v239, v239, v201
    v_mfma_f32_16x16x32_bf16 v[192:195], a[92:95], a[12:15], v[192:195]
    buffer_load_dwordx4 v17, s[32:35], s82 offen offset:2048 nt lds
    v_exp_f32 v202, v202
    v_mfma_f32_16x16x32_bf16 v[196:199], a[96:99], a[0:3], v[216:219]
    buffer_load_dwordx4 v18, s[32:35], s82 offen offset:3072 nt lds
    v_exp_f32 v203, v203
    v_mfma_f32_16x16x32_bf16 v[196:199], a[100:103], a[4:7], v[196:199]
    ds_read_b128 a[112:115], v1 offset:24576
    v_cvt_pk_bf16_f32 v212, v200, v201
    v_mfma_f32_16x16x32_bf16 v[196:199], a[104:107], a[8:11], v[196:199]
    ds_read_b128 a[116:119], v2 offset:24576
    v_add_f32 v239, v239, v202
    v_mfma_f32_16x16x32_bf16 v[196:199], a[108:111], a[12:15], v[196:199]
    v_exp_f32 v204, v204
    v_mfma_f32_16x16x32_bf16 v[96:99], a[176:179], v[208:211], v[96:99]
    v_add_f32 v239, v239, v203
    v_cvt_pk_bf16_f32 v213, v202, v203
    v_mfma_f32_16x16x32_bf16 v[100:103], a[180:183], v[208:211], v[100:103]
    v_exp_f32 v205, v205
    v_mfma_f32_16x16x32_bf16 v[104:107], a[184:187], v[208:211], v[104:107]
    v_exp_f32 v206, v206
    v_mfma_f32_16x16x32_bf16 v[108:111], a[188:191], v[208:211], v[108:111]
    v_add_f32 v239, v239, v204
    v_add_f32 v239, v239, v205
    v_mfma_f32_16x16x32_bf16 v[112:115], a[192:195], v[208:211], v[112:115]
    v_exp_f32 v207, v207
    v_mfma_f32_16x16x32_bf16 v[116:119], a[196:199], v[208:211], v[116:119]
    ds_read_b128 a[120:123], v3 offset:24576
    v_cvt_pk_bf16_f32 v214, v204, v205
    v_mfma_f32_16x16x32_bf16 v[120:123], a[200:203], v[208:211], v[120:123]
    ds_read_b128 a[124:127], v4 offset:24576
    v_add_f32 v239, v239, v206
    v_mfma_f32_16x16x32_bf16 v[124:127], a[204:207], v[208:211], v[124:127]
    v_add_f32 v239, v239, v207
    v_cvt_pk_bf16_f32 v215, v206, v207
    v_mfma_f32_16x16x32_bf16 v[200:203], a[80:83], a[16:19], v[220:223]
    s_mov_b32 m0, 69632
    v_exp_f32 v192, v192
    v_mfma_f32_16x16x32_bf16 v[200:203], a[84:87], a[20:23], v[200:203]
    buffer_load_dwordx4 v17, s[32:35], s83 offen offset:0 nt lds
    v_exp_f32 v193, v193
    v_mfma_f32_16x16x32_bf16 v[200:203], a[88:91], a[24:27], v[200:203]
    buffer_load_dwordx4 v18, s[32:35], s83 offen offset:1024 nt lds
    v_add_f32 v236, v236, v192
    v_add_f32 v236, v236, v193
    v_mfma_f32_16x16x32_bf16 v[200:203], a[92:95], a[28:31], v[200:203]
    buffer_load_dwordx4 v17, s[32:35], s83 offen offset:2048 nt lds
    v_exp_f32 v194, v194
    v_mfma_f32_16x16x32_bf16 v[204:207], a[96:99], a[16:19], v[220:223]
    buffer_load_dwordx4 v18, s[32:35], s83 offen offset:3072 nt lds
    v_exp_f32 v195, v195
    v_mfma_f32_16x16x32_bf16 v[204:207], a[100:103], a[20:23], v[204:207]
    ds_read_b128 a[128:131], v1 offset:28672
    v_cvt_pk_bf16_f32 v208, v192, v193
    v_mfma_f32_16x16x32_bf16 v[204:207], a[104:107], a[24:27], v[204:207]
    ds_read_b128 a[132:135], v2 offset:28672
    v_add_f32 v236, v236, v194
    v_mfma_f32_16x16x32_bf16 v[204:207], a[108:111], a[28:31], v[204:207]
    v_exp_f32 v196, v196
    v_mfma_f32_16x16x32_bf16 v[128:131], a[176:179], v[212:215], v[128:131]
    v_add_f32 v236, v236, v195
    v_cvt_pk_bf16_f32 v209, v194, v195
    v_mfma_f32_16x16x32_bf16 v[132:135], a[180:183], v[212:215], v[132:135]
    v_exp_f32 v197, v197
    v_mfma_f32_16x16x32_bf16 v[136:139], a[184:187], v[212:215], v[136:139]
    v_exp_f32 v198, v198
    v_mfma_f32_16x16x32_bf16 v[140:143], a[188:191], v[212:215], v[140:143]
    v_add_f32 v236, v236, v196
    v_add_f32 v236, v236, v197
    v_mfma_f32_16x16x32_bf16 v[144:147], a[192:195], v[212:215], v[144:147]
    v_exp_f32 v199, v199
    v_mfma_f32_16x16x32_bf16 v[148:151], a[196:199], v[212:215], v[148:151]
    ds_read_b128 a[136:139], v3 offset:28672
    v_cvt_pk_bf16_f32 v210, v196, v197
    v_mfma_f32_16x16x32_bf16 v[152:155], a[200:203], v[212:215], v[152:155]
    ds_read_b128 a[140:143], v4 offset:28672
    v_add_f32 v236, v236, v198
    v_mfma_f32_16x16x32_bf16 v[156:159], a[204:207], v[212:215], v[156:159]
    v_add_f32 v236, v236, v199
    v_cvt_pk_bf16_f32 v211, v198, v199
    v_mfma_f32_16x16x32_bf16 v[192:195], a[80:83], a[32:35], v[224:227]
    s_mov_b32 m0, 73728
    v_exp_f32 v200, v200
    v_mfma_f32_16x16x32_bf16 v[192:195], a[84:87], a[36:39], v[192:195]
    buffer_load_dwordx4 v17, s[32:35], s84 offen offset:0 nt lds
    v_exp_f32 v201, v201
    v_mfma_f32_16x16x32_bf16 v[192:195], a[88:91], a[40:43], v[192:195]
    ds_read_b64_tr_b16 a[176:177], v5 offset:24576
    v_add_f32 v237, v237, v200
    v_add_f32 v237, v237, v201
    v_mfma_f32_16x16x32_bf16 v[192:195], a[92:95], a[44:47], v[192:195]
    buffer_load_dwordx4 v18, s[32:35], s84 offen offset:1024 nt lds
    v_exp_f32 v202, v202
    v_mfma_f32_16x16x32_bf16 v[196:199], a[96:99], a[32:35], v[224:227]
    buffer_load_dwordx4 v17, s[32:35], s84 offen offset:2048 nt lds
    v_exp_f32 v203, v203
    v_mfma_f32_16x16x32_bf16 v[196:199], a[100:103], a[36:39], v[196:199]
    ds_read_b64_tr_b16 a[178:179], v5 offset:28672
    v_cvt_pk_bf16_f32 v212, v200, v201
    v_mfma_f32_16x16x32_bf16 v[196:199], a[104:107], a[40:43], v[196:199]
    ds_read_b64_tr_b16 a[180:181], v6 offset:24576
    v_add_f32 v237, v237, v202
    v_mfma_f32_16x16x32_bf16 v[196:199], a[108:111], a[44:47], v[196:199]
    buffer_load_dwordx4 v18, s[32:35], s84 offen offset:3072 nt lds
    v_exp_f32 v204, v204
    v_mfma_f32_16x16x32_bf16 v[32:35], a[144:147], v[208:211], v[32:35]
    ds_read_b64_tr_b16 a[182:183], v6 offset:28672
    v_add_f32 v237, v237, v203
    v_cvt_pk_bf16_f32 v213, v202, v203
    v_mfma_f32_16x16x32_bf16 v[36:39], a[148:151], v[208:211], v[36:39]
    v_exp_f32 v205, v205
    v_mfma_f32_16x16x32_bf16 v[40:43], a[152:155], v[208:211], v[40:43]
    v_exp_f32 v206, v206
    v_mfma_f32_16x16x32_bf16 v[44:47], a[156:159], v[208:211], v[44:47]
    ds_read_b64_tr_b16 a[184:185], v7 offset:24576
    v_add_f32 v237, v237, v204
    v_add_f32 v237, v237, v205
    v_mfma_f32_16x16x32_bf16 v[48:51], a[160:163], v[208:211], v[48:51]
    v_exp_f32 v207, v207
    v_mfma_f32_16x16x32_bf16 v[52:55], a[164:167], v[208:211], v[52:55]
    ds_read_b64_tr_b16 a[186:187], v7 offset:28672
    v_cvt_pk_bf16_f32 v214, v204, v205
    v_mfma_f32_16x16x32_bf16 v[56:59], a[168:171], v[208:211], v[56:59]
    ds_read_b64_tr_b16 a[188:189], v8 offset:24576
    v_add_f32 v237, v237, v206
    v_mfma_f32_16x16x32_bf16 v[60:63], a[172:175], v[208:211], v[60:63]
    ds_read_b64_tr_b16 a[190:191], v8 offset:28672
    v_add_f32 v237, v237, v207
    v_cvt_pk_bf16_f32 v215, v206, v207
    v_mfma_f32_16x16x32_bf16 v[200:203], a[80:83], a[48:51], v[228:231]
    s_mov_b32 m0, 77824
    v_exp_f32 v192, v192
    v_mfma_f32_16x16x32_bf16 v[200:203], a[84:87], a[52:55], v[200:203]
    buffer_load_dwordx4 v17, s[32:35], s46 offen offset:0 nt lds
    v_exp_f32 v193, v193
    v_mfma_f32_16x16x32_bf16 v[200:203], a[88:91], a[56:59], v[200:203]
    ds_read_b64_tr_b16 a[192:193], v9 offset:24576
    ds_read_b64_tr_b16 a[194:195], v9 offset:28672
    v_add_f32 v238, v238, v192
    v_mfma_f32_16x16x32_bf16 v[200:203], a[92:95], a[60:63], v[200:203]
    buffer_load_dwordx4 v18, s[32:35], s46 offen offset:1024 nt lds
    v_exp_f32 v194, v194
    v_mfma_f32_16x16x32_bf16 v[204:207], a[96:99], a[48:51], v[228:231]
    ds_read_b64_tr_b16 a[196:197], v10 offset:24576
    ds_read_b64_tr_b16 a[198:199], v10 offset:28672
    v_add_f32 v238, v238, v193
    v_mfma_f32_16x16x32_bf16 v[204:207], a[100:103], a[52:55], v[204:207]
    buffer_load_dwordx4 v17, s[32:35], s46 offen offset:2048 nt lds
    v_exp_f32 v195, v195
    v_mfma_f32_16x16x32_bf16 v[204:207], a[104:107], a[56:59], v[204:207]
    ds_read_b64_tr_b16 a[200:201], v11 offset:24576
    ds_read_b64_tr_b16 a[202:203], v11 offset:28672
    v_cvt_pk_bf16_f32 v208, v192, v193
    v_mfma_f32_16x16x32_bf16 v[204:207], a[108:111], a[60:63], v[204:207]
    buffer_load_dwordx4 v18, s[32:35], s46 offen offset:3072 nt lds
    v_exp_f32 v196, v196
    v_mfma_f32_16x16x32_bf16 v[64:67], a[144:147], v[212:215], v[64:67]
    ds_read_b64_tr_b16 a[204:205], v12 offset:24576
    ds_read_b64_tr_b16 a[206:207], v12 offset:28672
    v_add_f32 v238, v238, v194
    v_mfma_f32_16x16x32_bf16 v[68:71], a[148:151], v[212:215], v[68:71]
    v_exp_f32 v197, v197
    v_mfma_f32_16x16x32_bf16 v[72:75], a[152:155], v[212:215], v[72:75]
    v_add_f32 v238, v238, v195
    v_cvt_pk_bf16_f32 v209, v194, v195
    v_mfma_f32_16x16x32_bf16 v[76:79], a[156:159], v[212:215], v[76:79]
    v_exp_f32 v198, v198
    v_mfma_f32_16x16x32_bf16 v[80:83], a[160:163], v[212:215], v[80:83]
    v_add_f32 v238, v238, v196
    v_add_f32 v238, v238, v197
    v_mfma_f32_16x16x32_bf16 v[84:87], a[164:167], v[212:215], v[84:87]
    v_exp_f32 v199, v199
    v_mfma_f32_16x16x32_bf16 v[88:91], a[168:171], v[212:215], v[88:91]
    s_waitcnt vmcnt(40) lgkmcnt(0)
    v_cvt_pk_bf16_f32 v210, v196, v197
    v_add_f32 v238, v238, v198
    v_mfma_f32_16x16x32_bf16 v[92:95], a[172:175], v[212:215], v[92:95]
    s_barrier
    v_add_f32 v238, v238, v199
    v_cvt_pk_bf16_f32 v211, v198, v199
    v_mfma_f32_16x16x32_bf16 v[192:195], a[112:115], a[0:3], v[216:219]
    s_add_u32 s46, s46, 16384
    v_exp_f32 v200, v200
    v_mfma_f32_16x16x32_bf16 v[192:195], a[116:119], a[4:7], v[192:195]
    s_and_b32 s46, s46, 0x3ffff
    v_exp_f32 v201, v201
    v_mfma_f32_16x16x32_bf16 v[192:195], a[120:123], a[8:11], v[192:195]
    s_sub_u32 s82, s46, 12288
    v_add_f32 v239, v239, v200
    v_add_f32 v239, v239, v201
    v_mfma_f32_16x16x32_bf16 v[192:195], a[124:127], a[12:15], v[192:195]
    s_sub_u32 s83, s46, 8192
    v_exp_f32 v202, v202
    v_mfma_f32_16x16x32_bf16 v[196:199], a[128:131], a[0:3], v[216:219]
    s_sub_u32 s84, s46, 4096
    v_exp_f32 v203, v203
    v_mfma_f32_16x16x32_bf16 v[196:199], a[132:135], a[4:7], v[196:199]
    s_mov_b32 m0, 16384
    ds_read_b128 a[80:83], v1 offset:32768
    v_cvt_pk_bf16_f32 v212, v200, v201
    v_mfma_f32_16x16x32_bf16 v[196:199], a[136:139], a[8:11], v[196:199]
    ds_read_b128 a[84:87], v2 offset:32768
    v_add_f32 v239, v239, v202
    v_mfma_f32_16x16x32_bf16 v[196:199], a[140:143], a[12:15], v[196:199]
    buffer_load_dwordx4 v13, s[28:31], s82 offen offset:0 nt lds
    v_exp_f32 v204, v204
    v_mfma_f32_16x16x32_bf16 v[96:99], a[144:147], v[208:211], v[96:99]
    buffer_load_dwordx4 v14, s[28:31], s82 offen offset:1024 nt lds
    v_add_f32 v239, v239, v203
    v_cvt_pk_bf16_f32 v213, v202, v203
    v_mfma_f32_16x16x32_bf16 v[100:103], a[148:151], v[208:211], v[100:103]
    buffer_load_dwordx4 v15, s[28:31], s82 offen offset:2048 nt lds
    v_exp_f32 v205, v205
    v_mfma_f32_16x16x32_bf16 v[104:107], a[152:155], v[208:211], v[104:107]
    buffer_load_dwordx4 v16, s[28:31], s82 offen offset:3072 nt lds
    v_exp_f32 v206, v206
    v_mfma_f32_16x16x32_bf16 v[108:111], a[156:159], v[208:211], v[108:111]
    v_add_f32 v239, v239, v204
    v_add_f32 v239, v239, v205
    v_mfma_f32_16x16x32_bf16 v[112:115], a[160:163], v[208:211], v[112:115]
    v_exp_f32 v207, v207
    v_mfma_f32_16x16x32_bf16 v[116:119], a[164:167], v[208:211], v[116:119]
    ds_read_b128 a[88:91], v3 offset:32768
    v_cvt_pk_bf16_f32 v214, v204, v205
    v_mfma_f32_16x16x32_bf16 v[120:123], a[168:171], v[208:211], v[120:123]
    ds_read_b128 a[92:95], v4 offset:32768
    v_add_f32 v239, v239, v206
    v_mfma_f32_16x16x32_bf16 v[124:127], a[172:175], v[208:211], v[124:127]
    v_add_f32 v239, v239, v207
    v_cvt_pk_bf16_f32 v215, v206, v207
    v_mfma_f32_16x16x32_bf16 v[200:203], a[112:115], a[16:19], v[220:223]
    s_mov_b32 m0, 20480
    v_exp_f32 v192, v192
    v_mfma_f32_16x16x32_bf16 v[200:203], a[116:119], a[20:23], v[200:203]
    buffer_load_dwordx4 v13, s[28:31], s83 offen offset:0 nt lds
    v_exp_f32 v193, v193
    v_mfma_f32_16x16x32_bf16 v[200:203], a[120:123], a[24:27], v[200:203]
    buffer_load_dwordx4 v14, s[28:31], s83 offen offset:1024 nt lds
    v_add_f32 v236, v236, v192
    v_add_f32 v236, v236, v193
    v_mfma_f32_16x16x32_bf16 v[200:203], a[124:127], a[28:31], v[200:203]
    buffer_load_dwordx4 v15, s[28:31], s83 offen offset:2048 nt lds
    v_exp_f32 v194, v194
    v_mfma_f32_16x16x32_bf16 v[204:207], a[128:131], a[16:19], v[220:223]
    buffer_load_dwordx4 v16, s[28:31], s83 offen offset:3072 nt lds
    v_exp_f32 v195, v195
    v_mfma_f32_16x16x32_bf16 v[204:207], a[132:135], a[20:23], v[204:207]
    ds_read_b128 a[96:99], v1 offset:36864
    v_cvt_pk_bf16_f32 v208, v192, v193
    v_mfma_f32_16x16x32_bf16 v[204:207], a[136:139], a[24:27], v[204:207]
    ds_read_b128 a[100:103], v2 offset:36864
    v_add_f32 v236, v236, v194
    v_mfma_f32_16x16x32_bf16 v[204:207], a[140:143], a[28:31], v[204:207]
    v_exp_f32 v196, v196
    v_mfma_f32_16x16x32_bf16 v[128:131], a[144:147], v[212:215], v[128:131]
    v_add_f32 v236, v236, v195
    v_cvt_pk_bf16_f32 v209, v194, v195
    v_mfma_f32_16x16x32_bf16 v[132:135], a[148:151], v[212:215], v[132:135]
    v_exp_f32 v197, v197
    v_mfma_f32_16x16x32_bf16 v[136:139], a[152:155], v[212:215], v[136:139]
    v_exp_f32 v198, v198
    v_mfma_f32_16x16x32_bf16 v[140:143], a[156:159], v[212:215], v[140:143]
    v_add_f32 v236, v236, v196
    v_add_f32 v236, v236, v197
    v_mfma_f32_16x16x32_bf16 v[144:147], a[160:163], v[212:215], v[144:147]
    v_exp_f32 v199, v199
    v_mfma_f32_16x16x32_bf16 v[148:151], a[164:167], v[212:215], v[148:151]
    ds_read_b128 a[104:107], v3 offset:36864
    v_cvt_pk_bf16_f32 v210, v196, v197
    v_mfma_f32_16x16x32_bf16 v[152:155], a[168:171], v[212:215], v[152:155]
    ds_read_b128 a[108:111], v4 offset:36864
    v_add_f32 v236, v236, v198
    v_mfma_f32_16x16x32_bf16 v[156:159], a[172:175], v[212:215], v[156:159]
    v_add_f32 v236, v236, v199
    v_cvt_pk_bf16_f32 v211, v198, v199
    v_mfma_f32_16x16x32_bf16 v[192:195], a[112:115], a[32:35], v[224:227]
    s_mov_b32 m0, 24576
    v_exp_f32 v200, v200
    v_mfma_f32_16x16x32_bf16 v[192:195], a[116:119], a[36:39], v[192:195]
    buffer_load_dwordx4 v13, s[28:31], s84 offen offset:0 nt lds
    v_exp_f32 v201, v201
    v_mfma_f32_16x16x32_bf16 v[192:195], a[120:123], a[40:43], v[192:195]
    ds_read_b64_tr_b16 a[144:145], v5 offset:32768
    v_add_f32 v237, v237, v200
    v_add_f32 v237, v237, v201
    v_mfma_f32_16x16x32_bf16 v[192:195], a[124:127], a[44:47], v[192:195]
    buffer_load_dwordx4 v14, s[28:31], s84 offen offset:1024 nt lds
    v_exp_f32 v202, v202
    v_mfma_f32_16x16x32_bf16 v[196:199], a[128:131], a[32:35], v[224:227]
    buffer_load_dwordx4 v15, s[28:31], s84 offen offset:2048 nt lds
    v_exp_f32 v203, v203
    v_mfma_f32_16x16x32_bf16 v[196:199], a[132:135], a[36:39], v[196:199]
    ds_read_b64_tr_b16 a[146:147], v5 offset:36864
    v_cvt_pk_bf16_f32 v212, v200, v201
    v_mfma_f32_16x16x32_bf16 v[196:199], a[136:139], a[40:43], v[196:199]
    ds_read_b64_tr_b16 a[148:149], v6 offset:32768
    v_add_f32 v237, v237, v202
    v_mfma_f32_16x16x32_bf16 v[196:199], a[140:143], a[44:47], v[196:199]
    buffer_load_dwordx4 v16, s[28:31], s84 offen offset:3072 nt lds
    v_exp_f32 v204, v204
    v_mfma_f32_16x16x32_bf16 v[32:35], a[176:179], v[208:211], v[32:35]
    ds_read_b64_tr_b16 a[150:151], v6 offset:36864
    v_add_f32 v237, v237, v203
    v_cvt_pk_bf16_f32 v213, v202, v203
    v_mfma_f32_16x16x32_bf16 v[36:39], a[180:183], v[208:211], v[36:39]
    v_exp_f32 v205, v205
    v_mfma_f32_16x16x32_bf16 v[40:43], a[184:187], v[208:211], v[40:43]
    v_exp_f32 v206, v206
    v_mfma_f32_16x16x32_bf16 v[44:47], a[188:191], v[208:211], v[44:47]
    ds_read_b64_tr_b16 a[152:153], v7 offset:32768
    v_add_f32 v237, v237, v204
    v_add_f32 v237, v237, v205
    v_mfma_f32_16x16x32_bf16 v[48:51], a[192:195], v[208:211], v[48:51]
    v_exp_f32 v207, v207
    v_mfma_f32_16x16x32_bf16 v[52:55], a[196:199], v[208:211], v[52:55]
    ds_read_b64_tr_b16 a[154:155], v7 offset:36864
    v_cvt_pk_bf16_f32 v214, v204, v205
    v_mfma_f32_16x16x32_bf16 v[56:59], a[200:203], v[208:211], v[56:59]
    ds_read_b64_tr_b16 a[156:157], v8 offset:32768
    v_add_f32 v237, v237, v206
    v_mfma_f32_16x16x32_bf16 v[60:63], a[204:207], v[208:211], v[60:63]
    ds_read_b64_tr_b16 a[158:159], v8 offset:36864
    v_add_f32 v237, v237, v207
    v_cvt_pk_bf16_f32 v215, v206, v207
    v_mfma_f32_16x16x32_bf16 v[200:203], a[112:115], a[48:51], v[228:231]
    s_mov_b32 m0, 28672
    v_exp_f32 v192, v192
    v_mfma_f32_16x16x32_bf16 v[200:203], a[116:119], a[52:55], v[200:203]
    buffer_load_dwordx4 v13, s[28:31], s46 offen offset:0 nt lds
    v_exp_f32 v193, v193
    v_mfma_f32_16x16x32_bf16 v[200:203], a[120:123], a[56:59], v[200:203]
    ds_read_b64_tr_b16 a[160:161], v9 offset:32768
    ds_read_b64_tr_b16 a[162:163], v9 offset:36864
    v_add_f32 v238, v238, v192
    v_mfma_f32_16x16x32_bf16 v[200:203], a[124:127], a[60:63], v[200:203]
    buffer_load_dwordx4 v14, s[28:31], s46 offen offset:1024 nt lds
    v_exp_f32 v194, v194
    v_mfma_f32_16x16x32_bf16 v[204:207], a[128:131], a[48:51], v[228:231]
    ds_read_b64_tr_b16 a[164:165], v10 offset:32768
    ds_read_b64_tr_b16 a[166:167], v10 offset:36864
    v_add_f32 v238, v238, v193
    v_mfma_f32_16x16x32_bf16 v[204:207], a[132:135], a[52:55], v[204:207]
    buffer_load_dwordx4 v15, s[28:31], s46 offen offset:2048 nt lds
    v_exp_f32 v195, v195
    v_mfma_f32_16x16x32_bf16 v[204:207], a[136:139], a[56:59], v[204:207]
    ds_read_b64_tr_b16 a[168:169], v11 offset:32768
    ds_read_b64_tr_b16 a[170:171], v11 offset:36864
    v_cvt_pk_bf16_f32 v208, v192, v193
    v_mfma_f32_16x16x32_bf16 v[204:207], a[140:143], a[60:63], v[204:207]
    buffer_load_dwordx4 v16, s[28:31], s46 offen offset:3072 nt lds
    v_exp_f32 v196, v196
    v_mfma_f32_16x16x32_bf16 v[64:67], a[176:179], v[212:215], v[64:67]
    ds_read_b64_tr_b16 a[172:173], v12 offset:32768
    ds_read_b64_tr_b16 a[174:175], v12 offset:36864
    v_add_f32 v238, v238, v194
    v_mfma_f32_16x16x32_bf16 v[68:71], a[180:183], v[212:215], v[68:71]
    v_exp_f32 v197, v197
    v_mfma_f32_16x16x32_bf16 v[72:75], a[184:187], v[212:215], v[72:75]
    v_add_f32 v238, v238, v195
    v_cvt_pk_bf16_f32 v209, v194, v195
    v_mfma_f32_16x16x32_bf16 v[76:79], a[188:191], v[212:215], v[76:79]
    v_exp_f32 v198, v198
    v_mfma_f32_16x16x32_bf16 v[80:83], a[192:195], v[212:215], v[80:83]
    v_add_f32 v238, v238, v196
    v_add_f32 v238, v238, v197
    v_mfma_f32_16x16x32_bf16 v[84:87], a[196:199], v[212:215], v[84:87]
    v_exp_f32 v199, v199
    v_mfma_f32_16x16x32_bf16 v[88:91], a[200:203], v[212:215], v[88:91]
    v_cvt_pk_bf16_f32 v210, v196, v197
    v_add_f32 v238, v238, v198
    v_mfma_f32_16x16x32_bf16 v[92:95], a[204:207], v[212:215], v[92:95]
    s_waitcnt lgkmcnt(0)
    v_add_f32 v238, v238, v199
    v_cvt_pk_bf16_f32 v211, v198, v199
    v_mfma_f32_16x16x32_bf16 v[192:195], a[80:83], a[0:3], v[216:219]
    s_mov_b32 m0, 81920
    v_exp_f32 v200, v200
    v_mfma_f32_16x16x32_bf16 v[192:195], a[84:87], a[4:7], v[192:195]
    buffer_load_dwordx4 v17, s[32:35], s82 offen offset:0 nt lds
    v_exp_f32 v201, v201
    v_mfma_f32_16x16x32_bf16 v[192:195], a[88:91], a[8:11], v[192:195]
    buffer_load_dwordx4 v18, s[32:35], s82 offen offset:1024 nt lds
    v_add_f32 v239, v239, v200
    v_add_f32 v239, v239, v201
    v_mfma_f32_16x16x32_bf16 v[192:195], a[92:95], a[12:15], v[192:195]
    buffer_load_dwordx4 v17, s[32:35], s82 offen offset:2048 nt lds
    v_exp_f32 v202, v202
    v_mfma_f32_16x16x32_bf16 v[196:199], a[96:99], a[0:3], v[216:219]
    buffer_load_dwordx4 v18, s[32:35], s82 offen offset:3072 nt lds
    v_exp_f32 v203, v203
    v_mfma_f32_16x16x32_bf16 v[196:199], a[100:103], a[4:7], v[196:199]
    ds_read_b128 a[112:115], v1 offset:40960
    v_cvt_pk_bf16_f32 v212, v200, v201
    v_mfma_f32_16x16x32_bf16 v[196:199], a[104:107], a[8:11], v[196:199]
    ds_read_b128 a[116:119], v2 offset:40960
    v_add_f32 v239, v239, v202
    v_mfma_f32_16x16x32_bf16 v[196:199], a[108:111], a[12:15], v[196:199]
    v_exp_f32 v204, v204
    v_mfma_f32_16x16x32_bf16 v[96:99], a[176:179], v[208:211], v[96:99]
    v_add_f32 v239, v239, v203
    v_cvt_pk_bf16_f32 v213, v202, v203
    v_mfma_f32_16x16x32_bf16 v[100:103], a[180:183], v[208:211], v[100:103]
    v_exp_f32 v205, v205
    v_mfma_f32_16x16x32_bf16 v[104:107], a[184:187], v[208:211], v[104:107]
    v_exp_f32 v206, v206
    v_mfma_f32_16x16x32_bf16 v[108:111], a[188:191], v[208:211], v[108:111]
    v_add_f32 v239, v239, v204
    v_add_f32 v239, v239, v205
    v_mfma_f32_16x16x32_bf16 v[112:115], a[192:195], v[208:211], v[112:115]
    v_exp_f32 v207, v207
    v_mfma_f32_16x16x32_bf16 v[116:119], a[196:199], v[208:211], v[116:119]
    ds_read_b128 a[120:123], v3 offset:40960
    v_cvt_pk_bf16_f32 v214, v204, v205
    v_mfma_f32_16x16x32_bf16 v[120:123], a[200:203], v[208:211], v[120:123]
    ds_read_b128 a[124:127], v4 offset:40960
    v_add_f32 v239, v239, v206
    v_mfma_f32_16x16x32_bf16 v[124:127], a[204:207], v[208:211], v[124:127]
    v_add_f32 v239, v239, v207
    v_cvt_pk_bf16_f32 v215, v206, v207
    v_mfma_f32_16x16x32_bf16 v[200:203], a[80:83], a[16:19], v[220:223]
    s_mov_b32 m0, 86016
    v_exp_f32 v192, v192
    v_mfma_f32_16x16x32_bf16 v[200:203], a[84:87], a[20:23], v[200:203]
    buffer_load_dwordx4 v17, s[32:35], s83 offen offset:0 nt lds
    v_exp_f32 v193, v193
    v_mfma_f32_16x16x32_bf16 v[200:203], a[88:91], a[24:27], v[200:203]
    buffer_load_dwordx4 v18, s[32:35], s83 offen offset:1024 nt lds
    v_add_f32 v236, v236, v192
    v_add_f32 v236, v236, v193
    v_mfma_f32_16x16x32_bf16 v[200:203], a[92:95], a[28:31], v[200:203]
    buffer_load_dwordx4 v17, s[32:35], s83 offen offset:2048 nt lds
    v_exp_f32 v194, v194
    v_mfma_f32_16x16x32_bf16 v[204:207], a[96:99], a[16:19], v[220:223]
    buffer_load_dwordx4 v18, s[32:35], s83 offen offset:3072 nt lds
    v_exp_f32 v195, v195
    v_mfma_f32_16x16x32_bf16 v[204:207], a[100:103], a[20:23], v[204:207]
    ds_read_b128 a[128:131], v1 offset:45056
    v_cvt_pk_bf16_f32 v208, v192, v193
    v_mfma_f32_16x16x32_bf16 v[204:207], a[104:107], a[24:27], v[204:207]
    ds_read_b128 a[132:135], v2 offset:45056
    v_add_f32 v236, v236, v194
    v_mfma_f32_16x16x32_bf16 v[204:207], a[108:111], a[28:31], v[204:207]
    v_exp_f32 v196, v196
    v_mfma_f32_16x16x32_bf16 v[128:131], a[176:179], v[212:215], v[128:131]
    v_add_f32 v236, v236, v195
    v_cvt_pk_bf16_f32 v209, v194, v195
    v_mfma_f32_16x16x32_bf16 v[132:135], a[180:183], v[212:215], v[132:135]
    v_exp_f32 v197, v197
    v_mfma_f32_16x16x32_bf16 v[136:139], a[184:187], v[212:215], v[136:139]
    v_exp_f32 v198, v198
    v_mfma_f32_16x16x32_bf16 v[140:143], a[188:191], v[212:215], v[140:143]
    v_add_f32 v236, v236, v196
    v_add_f32 v236, v236, v197
    v_mfma_f32_16x16x32_bf16 v[144:147], a[192:195], v[212:215], v[144:147]
    v_exp_f32 v199, v199
    v_mfma_f32_16x16x32_bf16 v[148:151], a[196:199], v[212:215], v[148:151]
    ds_read_b128 a[136:139], v3 offset:45056
    v_cvt_pk_bf16_f32 v210, v196, v197
    v_mfma_f32_16x16x32_bf16 v[152:155], a[200:203], v[212:215], v[152:155]
    ds_read_b128 a[140:143], v4 offset:45056
    v_add_f32 v236, v236, v198
    v_mfma_f32_16x16x32_bf16 v[156:159], a[204:207], v[212:215], v[156:159]
    v_add_f32 v236, v236, v199
    v_cvt_pk_bf16_f32 v211, v198, v199
    v_mfma_f32_16x16x32_bf16 v[192:195], a[80:83], a[32:35], v[224:227]
    s_mov_b32 m0, 90112
    v_exp_f32 v200, v200
    v_mfma_f32_16x16x32_bf16 v[192:195], a[84:87], a[36:39], v[192:195]
    buffer_load_dwordx4 v17, s[32:35], s84 offen offset:0 nt lds
    v_exp_f32 v201, v201
    v_mfma_f32_16x16x32_bf16 v[192:195], a[88:91], a[40:43], v[192:195]
    ds_read_b64_tr_b16 a[176:177], v5 offset:40960
    v_add_f32 v237, v237, v200
    v_add_f32 v237, v237, v201
    v_mfma_f32_16x16x32_bf16 v[192:195], a[92:95], a[44:47], v[192:195]
    buffer_load_dwordx4 v18, s[32:35], s84 offen offset:1024 nt lds
    v_exp_f32 v202, v202
    v_mfma_f32_16x16x32_bf16 v[196:199], a[96:99], a[32:35], v[224:227]
    buffer_load_dwordx4 v17, s[32:35], s84 offen offset:2048 nt lds
    v_exp_f32 v203, v203
    v_mfma_f32_16x16x32_bf16 v[196:199], a[100:103], a[36:39], v[196:199]
    ds_read_b64_tr_b16 a[178:179], v5 offset:45056
    v_cvt_pk_bf16_f32 v212, v200, v201
    v_mfma_f32_16x16x32_bf16 v[196:199], a[104:107], a[40:43], v[196:199]
    ds_read_b64_tr_b16 a[180:181], v6 offset:40960
    v_add_f32 v237, v237, v202
    v_mfma_f32_16x16x32_bf16 v[196:199], a[108:111], a[44:47], v[196:199]
    buffer_load_dwordx4 v18, s[32:35], s84 offen offset:3072 nt lds
    v_exp_f32 v204, v204
    v_mfma_f32_16x16x32_bf16 v[32:35], a[144:147], v[208:211], v[32:35]
    ds_read_b64_tr_b16 a[182:183], v6 offset:45056
    v_add_f32 v237, v237, v203
    v_cvt_pk_bf16_f32 v213, v202, v203
    v_mfma_f32_16x16x32_bf16 v[36:39], a[148:151], v[208:211], v[36:39]
    v_exp_f32 v205, v205
    v_mfma_f32_16x16x32_bf16 v[40:43], a[152:155], v[208:211], v[40:43]
    v_exp_f32 v206, v206
    v_mfma_f32_16x16x32_bf16 v[44:47], a[156:159], v[208:211], v[44:47]
    ds_read_b64_tr_b16 a[184:185], v7 offset:40960
    v_add_f32 v237, v237, v204
    v_add_f32 v237, v237, v205
    v_mfma_f32_16x16x32_bf16 v[48:51], a[160:163], v[208:211], v[48:51]
    v_exp_f32 v207, v207
    v_mfma_f32_16x16x32_bf16 v[52:55], a[164:167], v[208:211], v[52:55]
    ds_read_b64_tr_b16 a[186:187], v7 offset:45056
    v_cvt_pk_bf16_f32 v214, v204, v205
    v_mfma_f32_16x16x32_bf16 v[56:59], a[168:171], v[208:211], v[56:59]
    ds_read_b64_tr_b16 a[188:189], v8 offset:40960
    v_add_f32 v237, v237, v206
    v_mfma_f32_16x16x32_bf16 v[60:63], a[172:175], v[208:211], v[60:63]
    ds_read_b64_tr_b16 a[190:191], v8 offset:45056
    v_add_f32 v237, v237, v207
    v_cvt_pk_bf16_f32 v215, v206, v207
    v_mfma_f32_16x16x32_bf16 v[200:203], a[80:83], a[48:51], v[228:231]
    s_mov_b32 m0, 94208
    v_exp_f32 v192, v192
    v_mfma_f32_16x16x32_bf16 v[200:203], a[84:87], a[52:55], v[200:203]
    buffer_load_dwordx4 v17, s[32:35], s46 offen offset:0 nt lds
    v_exp_f32 v193, v193
    v_mfma_f32_16x16x32_bf16 v[200:203], a[88:91], a[56:59], v[200:203]
    ds_read_b64_tr_b16 a[192:193], v9 offset:40960
    ds_read_b64_tr_b16 a[194:195], v9 offset:45056
    v_add_f32 v238, v238, v192
    v_mfma_f32_16x16x32_bf16 v[200:203], a[92:95], a[60:63], v[200:203]
    buffer_load_dwordx4 v18, s[32:35], s46 offen offset:1024 nt lds
    v_exp_f32 v194, v194
    v_mfma_f32_16x16x32_bf16 v[204:207], a[96:99], a[48:51], v[228:231]
    ds_read_b64_tr_b16 a[196:197], v10 offset:40960
    ds_read_b64_tr_b16 a[198:199], v10 offset:45056
    v_add_f32 v238, v238, v193
    v_mfma_f32_16x16x32_bf16 v[204:207], a[100:103], a[52:55], v[204:207]
    buffer_load_dwordx4 v17, s[32:35], s46 offen offset:2048 nt lds
    v_exp_f32 v195, v195
    v_mfma_f32_16x16x32_bf16 v[204:207], a[104:107], a[56:59], v[204:207]
    ds_read_b64_tr_b16 a[200:201], v11 offset:40960
    ds_read_b64_tr_b16 a[202:203], v11 offset:45056
    v_cvt_pk_bf16_f32 v208, v192, v193
    v_mfma_f32_16x16x32_bf16 v[204:207], a[108:111], a[60:63], v[204:207]
    buffer_load_dwordx4 v18, s[32:35], s46 offen offset:3072 nt lds
    v_exp_f32 v196, v196
    v_mfma_f32_16x16x32_bf16 v[64:67], a[144:147], v[212:215], v[64:67]
    ds_read_b64_tr_b16 a[204:205], v12 offset:40960
    ds_read_b64_tr_b16 a[206:207], v12 offset:45056
    v_add_f32 v238, v238, v194
    v_mfma_f32_16x16x32_bf16 v[68:71], a[148:151], v[212:215], v[68:71]
    v_exp_f32 v197, v197
    v_mfma_f32_16x16x32_bf16 v[72:75], a[152:155], v[212:215], v[72:75]
    v_add_f32 v238, v238, v195
    v_cvt_pk_bf16_f32 v209, v194, v195
    v_mfma_f32_16x16x32_bf16 v[76:79], a[156:159], v[212:215], v[76:79]
    v_exp_f32 v198, v198
    v_mfma_f32_16x16x32_bf16 v[80:83], a[160:163], v[212:215], v[80:83]
    v_add_f32 v238, v238, v196
    v_add_f32 v238, v238, v197
    v_mfma_f32_16x16x32_bf16 v[84:87], a[164:167], v[212:215], v[84:87]
    v_exp_f32 v199, v199
    v_mfma_f32_16x16x32_bf16 v[88:91], a[168:171], v[212:215], v[88:91]
    s_waitcnt vmcnt(63) lgkmcnt(0)
    v_cvt_pk_bf16_f32 v210, v196, v197
    v_add_f32 v238, v238, v198
    v_mfma_f32_16x16x32_bf16 v[92:95], a[172:175], v[212:215], v[92:95]
    s_barrier
    v_add_f32 v238, v238, v199
    v_cvt_pk_bf16_f32 v211, v198, v199
    v_mfma_f32_16x16x32_bf16 v[192:195], a[112:115], a[0:3], v[216:219]
    s_add_u32 s46, s46, 16384
    v_exp_f32 v200, v200
    v_mfma_f32_16x16x32_bf16 v[192:195], a[116:119], a[4:7], v[192:195]
    s_and_b32 s46, s46, 0x3ffff
    v_exp_f32 v201, v201
    v_mfma_f32_16x16x32_bf16 v[192:195], a[120:123], a[8:11], v[192:195]
    s_sub_u32 s82, s46, 12288
    v_add_f32 v239, v239, v200
    v_add_f32 v239, v239, v201
    v_mfma_f32_16x16x32_bf16 v[192:195], a[124:127], a[12:15], v[192:195]
    s_sub_u32 s83, s46, 8192
    v_exp_f32 v202, v202
    v_mfma_f32_16x16x32_bf16 v[196:199], a[128:131], a[0:3], v[216:219]
    s_sub_u32 s84, s46, 4096
    v_exp_f32 v203, v203
    v_mfma_f32_16x16x32_bf16 v[196:199], a[132:135], a[4:7], v[196:199]
    s_mov_b32 m0, 32768
    ds_read_b128 a[80:83], v1 offset:49152
    v_cvt_pk_bf16_f32 v212, v200, v201
    v_mfma_f32_16x16x32_bf16 v[196:199], a[136:139], a[8:11], v[196:199]
    ds_read_b128 a[84:87], v2 offset:49152
    v_add_f32 v239, v239, v202
    v_mfma_f32_16x16x32_bf16 v[196:199], a[140:143], a[12:15], v[196:199]
    buffer_load_dwordx4 v13, s[28:31], s82 offen offset:0 nt lds
    v_exp_f32 v204, v204
    v_mfma_f32_16x16x32_bf16 v[96:99], a[144:147], v[208:211], v[96:99]
    buffer_load_dwordx4 v14, s[28:31], s82 offen offset:1024 nt lds
    v_add_f32 v239, v239, v203
    v_cvt_pk_bf16_f32 v213, v202, v203
    v_mfma_f32_16x16x32_bf16 v[100:103], a[148:151], v[208:211], v[100:103]
    buffer_load_dwordx4 v15, s[28:31], s82 offen offset:2048 nt lds
    v_exp_f32 v205, v205
    v_mfma_f32_16x16x32_bf16 v[104:107], a[152:155], v[208:211], v[104:107]
    buffer_load_dwordx4 v16, s[28:31], s82 offen offset:3072 nt lds
    v_exp_f32 v206, v206
    v_mfma_f32_16x16x32_bf16 v[108:111], a[156:159], v[208:211], v[108:111]
    v_add_f32 v239, v239, v204
    v_add_f32 v239, v239, v205
    v_mfma_f32_16x16x32_bf16 v[112:115], a[160:163], v[208:211], v[112:115]
    v_exp_f32 v207, v207
    v_mfma_f32_16x16x32_bf16 v[116:119], a[164:167], v[208:211], v[116:119]
    ds_read_b128 a[88:91], v3 offset:49152
    v_cvt_pk_bf16_f32 v214, v204, v205
    v_mfma_f32_16x16x32_bf16 v[120:123], a[168:171], v[208:211], v[120:123]
    ds_read_b128 a[92:95], v4 offset:49152
    v_add_f32 v239, v239, v206
    v_mfma_f32_16x16x32_bf16 v[124:127], a[172:175], v[208:211], v[124:127]
    v_add_f32 v239, v239, v207
    v_cvt_pk_bf16_f32 v215, v206, v207
    v_mfma_f32_16x16x32_bf16 v[200:203], a[112:115], a[16:19], v[220:223]
    s_mov_b32 m0, 36864
    v_exp_f32 v192, v192
    v_mfma_f32_16x16x32_bf16 v[200:203], a[116:119], a[20:23], v[200:203]
    buffer_load_dwordx4 v13, s[28:31], s83 offen offset:0 nt lds
    v_exp_f32 v193, v193
    v_mfma_f32_16x16x32_bf16 v[200:203], a[120:123], a[24:27], v[200:203]
    buffer_load_dwordx4 v14, s[28:31], s83 offen offset:1024 nt lds
    v_add_f32 v236, v236, v192
    v_add_f32 v236, v236, v193
    v_mfma_f32_16x16x32_bf16 v[200:203], a[124:127], a[28:31], v[200:203]
    buffer_load_dwordx4 v15, s[28:31], s83 offen offset:2048 nt lds
    v_exp_f32 v194, v194
    v_mfma_f32_16x16x32_bf16 v[204:207], a[128:131], a[16:19], v[220:223]
    buffer_load_dwordx4 v16, s[28:31], s83 offen offset:3072 nt lds
    v_exp_f32 v195, v195
    v_mfma_f32_16x16x32_bf16 v[204:207], a[132:135], a[20:23], v[204:207]
    ds_read_b128 a[96:99], v1 offset:53248
    v_cvt_pk_bf16_f32 v208, v192, v193
    v_mfma_f32_16x16x32_bf16 v[204:207], a[136:139], a[24:27], v[204:207]
    ds_read_b128 a[100:103], v2 offset:53248
    v_add_f32 v236, v236, v194
    v_mfma_f32_16x16x32_bf16 v[204:207], a[140:143], a[28:31], v[204:207]
    v_exp_f32 v196, v196
    v_mfma_f32_16x16x32_bf16 v[128:131], a[144:147], v[212:215], v[128:131]
    v_add_f32 v236, v236, v195
    v_cvt_pk_bf16_f32 v209, v194, v195
    v_mfma_f32_16x16x32_bf16 v[132:135], a[148:151], v[212:215], v[132:135]
    v_exp_f32 v197, v197
    v_mfma_f32_16x16x32_bf16 v[136:139], a[152:155], v[212:215], v[136:139]
    v_exp_f32 v198, v198
    v_mfma_f32_16x16x32_bf16 v[140:143], a[156:159], v[212:215], v[140:143]
    v_add_f32 v236, v236, v196
    v_add_f32 v236, v236, v197
    v_mfma_f32_16x16x32_bf16 v[144:147], a[160:163], v[212:215], v[144:147]
    v_exp_f32 v199, v199
    v_mfma_f32_16x16x32_bf16 v[148:151], a[164:167], v[212:215], v[148:151]
    ds_read_b128 a[104:107], v3 offset:53248
    v_cvt_pk_bf16_f32 v210, v196, v197
    v_mfma_f32_16x16x32_bf16 v[152:155], a[168:171], v[212:215], v[152:155]
    ds_read_b128 a[108:111], v4 offset:53248
    v_add_f32 v236, v236, v198
    v_mfma_f32_16x16x32_bf16 v[156:159], a[172:175], v[212:215], v[156:159]
    v_add_f32 v236, v236, v199
    v_cvt_pk_bf16_f32 v211, v198, v199
    v_mfma_f32_16x16x32_bf16 v[192:195], a[112:115], a[32:35], v[224:227]
    s_mov_b32 m0, 40960
    v_exp_f32 v200, v200
    v_mfma_f32_16x16x32_bf16 v[192:195], a[116:119], a[36:39], v[192:195]
    buffer_load_dwordx4 v13, s[28:31], s84 offen offset:0 nt lds
    v_exp_f32 v201, v201
    v_mfma_f32_16x16x32_bf16 v[192:195], a[120:123], a[40:43], v[192:195]
    ds_read_b64_tr_b16 a[144:145], v5 offset:49152
    v_add_f32 v237, v237, v200
    v_add_f32 v237, v237, v201
    v_mfma_f32_16x16x32_bf16 v[192:195], a[124:127], a[44:47], v[192:195]
    buffer_load_dwordx4 v14, s[28:31], s84 offen offset:1024 nt lds
    v_exp_f32 v202, v202
    v_mfma_f32_16x16x32_bf16 v[196:199], a[128:131], a[32:35], v[224:227]
    buffer_load_dwordx4 v15, s[28:31], s84 offen offset:2048 nt lds
    v_exp_f32 v203, v203
    v_mfma_f32_16x16x32_bf16 v[196:199], a[132:135], a[36:39], v[196:199]
    ds_read_b64_tr_b16 a[146:147], v5 offset:53248
    v_cvt_pk_bf16_f32 v212, v200, v201
    v_mfma_f32_16x16x32_bf16 v[196:199], a[136:139], a[40:43], v[196:199]
    ds_read_b64_tr_b16 a[148:149], v6 offset:49152
    v_add_f32 v237, v237, v202
    v_mfma_f32_16x16x32_bf16 v[196:199], a[140:143], a[44:47], v[196:199]
    buffer_load_dwordx4 v16, s[28:31], s84 offen offset:3072 nt lds
    v_exp_f32 v204, v204
    v_mfma_f32_16x16x32_bf16 v[32:35], a[176:179], v[208:211], v[32:35]
    ds_read_b64_tr_b16 a[150:151], v6 offset:53248
    v_add_f32 v237, v237, v203
    v_cvt_pk_bf16_f32 v213, v202, v203
    v_mfma_f32_16x16x32_bf16 v[36:39], a[180:183], v[208:211], v[36:39]
    v_exp_f32 v205, v205
    v_mfma_f32_16x16x32_bf16 v[40:43], a[184:187], v[208:211], v[40:43]
    v_exp_f32 v206, v206
    v_mfma_f32_16x16x32_bf16 v[44:47], a[188:191], v[208:211], v[44:47]
    ds_read_b64_tr_b16 a[152:153], v7 offset:49152
    v_add_f32 v237, v237, v204
    v_add_f32 v237, v237, v205
    v_mfma_f32_16x16x32_bf16 v[48:51], a[192:195], v[208:211], v[48:51]
    v_exp_f32 v207, v207
    v_mfma_f32_16x16x32_bf16 v[52:55], a[196:199], v[208:211], v[52:55]
    ds_read_b64_tr_b16 a[154:155], v7 offset:53248
    v_cvt_pk_bf16_f32 v214, v204, v205
    v_mfma_f32_16x16x32_bf16 v[56:59], a[200:203], v[208:211], v[56:59]
    ds_read_b64_tr_b16 a[156:157], v8 offset:49152
    v_add_f32 v237, v237, v206
    v_mfma_f32_16x16x32_bf16 v[60:63], a[204:207], v[208:211], v[60:63]
    ds_read_b64_tr_b16 a[158:159], v8 offset:53248
    v_add_f32 v237, v237, v207
    v_cvt_pk_bf16_f32 v215, v206, v207
    v_mfma_f32_16x16x32_bf16 v[200:203], a[112:115], a[48:51], v[228:231]
    s_mov_b32 m0, 45056
    v_exp_f32 v192, v192
    v_mfma_f32_16x16x32_bf16 v[200:203], a[116:119], a[52:55], v[200:203]
    buffer_load_dwordx4 v13, s[28:31], s46 offen offset:0 nt lds
    v_exp_f32 v193, v193
    v_mfma_f32_16x16x32_bf16 v[200:203], a[120:123], a[56:59], v[200:203]
    ds_read_b64_tr_b16 a[160:161], v9 offset:49152
    ds_read_b64_tr_b16 a[162:163], v9 offset:53248
    v_add_f32 v238, v238, v192
    v_mfma_f32_16x16x32_bf16 v[200:203], a[124:127], a[60:63], v[200:203]
    buffer_load_dwordx4 v14, s[28:31], s46 offen offset:1024 nt lds
    v_exp_f32 v194, v194
    v_mfma_f32_16x16x32_bf16 v[204:207], a[128:131], a[48:51], v[228:231]
    ds_read_b64_tr_b16 a[164:165], v10 offset:49152
    ds_read_b64_tr_b16 a[166:167], v10 offset:53248
    v_add_f32 v238, v238, v193
    v_mfma_f32_16x16x32_bf16 v[204:207], a[132:135], a[52:55], v[204:207]
    buffer_load_dwordx4 v15, s[28:31], s46 offen offset:2048 nt lds
    v_exp_f32 v195, v195
    v_mfma_f32_16x16x32_bf16 v[204:207], a[136:139], a[56:59], v[204:207]
    ds_read_b64_tr_b16 a[168:169], v11 offset:49152
    ds_read_b64_tr_b16 a[170:171], v11 offset:53248
    v_cvt_pk_bf16_f32 v208, v192, v193
    v_mfma_f32_16x16x32_bf16 v[204:207], a[140:143], a[60:63], v[204:207]
    buffer_load_dwordx4 v16, s[28:31], s46 offen offset:3072 nt lds
    v_exp_f32 v196, v196
    v_mfma_f32_16x16x32_bf16 v[64:67], a[176:179], v[212:215], v[64:67]
    ds_read_b64_tr_b16 a[172:173], v12 offset:49152
    ds_read_b64_tr_b16 a[174:175], v12 offset:53248
    v_add_f32 v238, v238, v194
    v_mfma_f32_16x16x32_bf16 v[68:71], a[180:183], v[212:215], v[68:71]
    v_exp_f32 v197, v197
    v_mfma_f32_16x16x32_bf16 v[72:75], a[184:187], v[212:215], v[72:75]
    v_add_f32 v238, v238, v195
    v_cvt_pk_bf16_f32 v209, v194, v195
    v_mfma_f32_16x16x32_bf16 v[76:79], a[188:191], v[212:215], v[76:79]
    v_exp_f32 v198, v198
    v_mfma_f32_16x16x32_bf16 v[80:83], a[192:195], v[212:215], v[80:83]
    v_add_f32 v238, v238, v196
    v_add_f32 v238, v238, v197
    v_mfma_f32_16x16x32_bf16 v[84:87], a[196:199], v[212:215], v[84:87]
    v_exp_f32 v199, v199
    v_mfma_f32_16x16x32_bf16 v[88:91], a[200:203], v[212:215], v[88:91]
    v_cvt_pk_bf16_f32 v210, v196, v197
    v_add_f32 v238, v238, v198
    v_mfma_f32_16x16x32_bf16 v[92:95], a[204:207], v[212:215], v[92:95]
    s_waitcnt lgkmcnt(0)
    v_add_f32 v238, v238, v199
    v_cvt_pk_bf16_f32 v211, v198, v199
    v_mfma_f32_16x16x32_bf16 v[192:195], a[80:83], a[0:3], v[216:219]
    s_mov_b32 m0, 98304
    v_exp_f32 v200, v200
    v_mfma_f32_16x16x32_bf16 v[192:195], a[84:87], a[4:7], v[192:195]
    buffer_load_dwordx4 v17, s[32:35], s82 offen offset:0 nt lds
    v_exp_f32 v201, v201
    v_mfma_f32_16x16x32_bf16 v[192:195], a[88:91], a[8:11], v[192:195]
    buffer_load_dwordx4 v18, s[32:35], s82 offen offset:1024 nt lds
    v_add_f32 v239, v239, v200
    v_add_f32 v239, v239, v201
    v_mfma_f32_16x16x32_bf16 v[192:195], a[92:95], a[12:15], v[192:195]
    buffer_load_dwordx4 v17, s[32:35], s82 offen offset:2048 nt lds
    v_exp_f32 v202, v202
    v_mfma_f32_16x16x32_bf16 v[196:199], a[96:99], a[0:3], v[216:219]
    buffer_load_dwordx4 v18, s[32:35], s82 offen offset:3072 nt lds
    v_exp_f32 v203, v203
    v_mfma_f32_16x16x32_bf16 v[196:199], a[100:103], a[4:7], v[196:199]
    ds_read_b128 a[112:115], v1 offset:57344
    v_cvt_pk_bf16_f32 v212, v200, v201
    v_mfma_f32_16x16x32_bf16 v[196:199], a[104:107], a[8:11], v[196:199]
    ds_read_b128 a[116:119], v2 offset:57344
    v_add_f32 v239, v239, v202
    v_mfma_f32_16x16x32_bf16 v[196:199], a[108:111], a[12:15], v[196:199]
    v_exp_f32 v204, v204
    v_mfma_f32_16x16x32_bf16 v[96:99], a[176:179], v[208:211], v[96:99]
    v_add_f32 v239, v239, v203
    v_cvt_pk_bf16_f32 v213, v202, v203
    v_mfma_f32_16x16x32_bf16 v[100:103], a[180:183], v[208:211], v[100:103]
    v_exp_f32 v205, v205
    v_mfma_f32_16x16x32_bf16 v[104:107], a[184:187], v[208:211], v[104:107]
    v_exp_f32 v206, v206
    v_mfma_f32_16x16x32_bf16 v[108:111], a[188:191], v[208:211], v[108:111]
    v_add_f32 v239, v239, v204
    v_add_f32 v239, v239, v205
    v_mfma_f32_16x16x32_bf16 v[112:115], a[192:195], v[208:211], v[112:115]
    v_exp_f32 v207, v207
    v_mfma_f32_16x16x32_bf16 v[116:119], a[196:199], v[208:211], v[116:119]
    ds_read_b128 a[120:123], v3 offset:57344
    v_cvt_pk_bf16_f32 v214, v204, v205
    v_mfma_f32_16x16x32_bf16 v[120:123], a[200:203], v[208:211], v[120:123]
    ds_read_b128 a[124:127], v4 offset:57344
    v_add_f32 v239, v239, v206
    v_mfma_f32_16x16x32_bf16 v[124:127], a[204:207], v[208:211], v[124:127]
    v_add_f32 v239, v239, v207
    v_cvt_pk_bf16_f32 v215, v206, v207
    v_mfma_f32_16x16x32_bf16 v[200:203], a[80:83], a[16:19], v[220:223]
    s_mov_b32 m0, 102400
    v_exp_f32 v192, v192
    v_mfma_f32_16x16x32_bf16 v[200:203], a[84:87], a[20:23], v[200:203]
    buffer_load_dwordx4 v17, s[32:35], s83 offen offset:0 nt lds
    v_exp_f32 v193, v193
    v_mfma_f32_16x16x32_bf16 v[200:203], a[88:91], a[24:27], v[200:203]
    buffer_load_dwordx4 v18, s[32:35], s83 offen offset:1024 nt lds
    v_add_f32 v236, v236, v192
    v_add_f32 v236, v236, v193
    v_mfma_f32_16x16x32_bf16 v[200:203], a[92:95], a[28:31], v[200:203]
    buffer_load_dwordx4 v17, s[32:35], s83 offen offset:2048 nt lds
    v_exp_f32 v194, v194
    v_mfma_f32_16x16x32_bf16 v[204:207], a[96:99], a[16:19], v[220:223]
    buffer_load_dwordx4 v18, s[32:35], s83 offen offset:3072 nt lds
    v_exp_f32 v195, v195
    v_mfma_f32_16x16x32_bf16 v[204:207], a[100:103], a[20:23], v[204:207]
    ds_read_b128 a[128:131], v1 offset:61440
    v_cvt_pk_bf16_f32 v208, v192, v193
    v_mfma_f32_16x16x32_bf16 v[204:207], a[104:107], a[24:27], v[204:207]
    ds_read_b128 a[132:135], v2 offset:61440
    v_add_f32 v236, v236, v194
    v_mfma_f32_16x16x32_bf16 v[204:207], a[108:111], a[28:31], v[204:207]
    v_exp_f32 v196, v196
    v_mfma_f32_16x16x32_bf16 v[128:131], a[176:179], v[212:215], v[128:131]
    v_add_f32 v236, v236, v195
    v_cvt_pk_bf16_f32 v209, v194, v195
    v_mfma_f32_16x16x32_bf16 v[132:135], a[180:183], v[212:215], v[132:135]
    v_exp_f32 v197, v197
    v_mfma_f32_16x16x32_bf16 v[136:139], a[184:187], v[212:215], v[136:139]
    v_exp_f32 v198, v198
    v_mfma_f32_16x16x32_bf16 v[140:143], a[188:191], v[212:215], v[140:143]
    v_add_f32 v236, v236, v196
    v_add_f32 v236, v236, v197
    v_mfma_f32_16x16x32_bf16 v[144:147], a[192:195], v[212:215], v[144:147]
    v_exp_f32 v199, v199
    v_mfma_f32_16x16x32_bf16 v[148:151], a[196:199], v[212:215], v[148:151]
    ds_read_b128 a[136:139], v3 offset:61440
    v_cvt_pk_bf16_f32 v210, v196, v197
    v_mfma_f32_16x16x32_bf16 v[152:155], a[200:203], v[212:215], v[152:155]
    ds_read_b128 a[140:143], v4 offset:61440
    v_add_f32 v236, v236, v198
    v_mfma_f32_16x16x32_bf16 v[156:159], a[204:207], v[212:215], v[156:159]
    v_add_f32 v236, v236, v199
    v_cvt_pk_bf16_f32 v211, v198, v199
    v_mfma_f32_16x16x32_bf16 v[192:195], a[80:83], a[32:35], v[224:227]
    s_mov_b32 m0, 106496
    v_exp_f32 v200, v200
    v_mfma_f32_16x16x32_bf16 v[192:195], a[84:87], a[36:39], v[192:195]
    buffer_load_dwordx4 v17, s[32:35], s84 offen offset:0 nt lds
    v_exp_f32 v201, v201
    v_mfma_f32_16x16x32_bf16 v[192:195], a[88:91], a[40:43], v[192:195]
    ds_read_b64_tr_b16 a[176:177], v5 offset:57344
    v_add_f32 v237, v237, v200
    v_add_f32 v237, v237, v201
    v_mfma_f32_16x16x32_bf16 v[192:195], a[92:95], a[44:47], v[192:195]
    buffer_load_dwordx4 v18, s[32:35], s84 offen offset:1024 nt lds
    v_exp_f32 v202, v202
    v_mfma_f32_16x16x32_bf16 v[196:199], a[96:99], a[32:35], v[224:227]
    buffer_load_dwordx4 v17, s[32:35], s84 offen offset:2048 nt lds
    v_exp_f32 v203, v203
    v_mfma_f32_16x16x32_bf16 v[196:199], a[100:103], a[36:39], v[196:199]
    ds_read_b64_tr_b16 a[178:179], v5 offset:61440
    v_cvt_pk_bf16_f32 v212, v200, v201
    v_mfma_f32_16x16x32_bf16 v[196:199], a[104:107], a[40:43], v[196:199]
    ds_read_b64_tr_b16 a[180:181], v6 offset:57344
    v_add_f32 v237, v237, v202
    v_mfma_f32_16x16x32_bf16 v[196:199], a[108:111], a[44:47], v[196:199]
    buffer_load_dwordx4 v18, s[32:35], s84 offen offset:3072 nt lds
    v_exp_f32 v204, v204
    v_mfma_f32_16x16x32_bf16 v[32:35], a[144:147], v[208:211], v[32:35]
    ds_read_b64_tr_b16 a[182:183], v6 offset:61440
    v_add_f32 v237, v237, v203
    v_cvt_pk_bf16_f32 v213, v202, v203
    v_mfma_f32_16x16x32_bf16 v[36:39], a[148:151], v[208:211], v[36:39]
    v_exp_f32 v205, v205
    v_mfma_f32_16x16x32_bf16 v[40:43], a[152:155], v[208:211], v[40:43]
    v_exp_f32 v206, v206
    v_mfma_f32_16x16x32_bf16 v[44:47], a[156:159], v[208:211], v[44:47]
    ds_read_b64_tr_b16 a[184:185], v7 offset:57344
    v_add_f32 v237, v237, v204
    v_add_f32 v237, v237, v205
    v_mfma_f32_16x16x32_bf16 v[48:51], a[160:163], v[208:211], v[48:51]
    v_exp_f32 v207, v207
    v_mfma_f32_16x16x32_bf16 v[52:55], a[164:167], v[208:211], v[52:55]
    ds_read_b64_tr_b16 a[186:187], v7 offset:61440
    v_cvt_pk_bf16_f32 v214, v204, v205
    v_mfma_f32_16x16x32_bf16 v[56:59], a[168:171], v[208:211], v[56:59]
    ds_read_b64_tr_b16 a[188:189], v8 offset:57344
    v_add_f32 v237, v237, v206
    v_mfma_f32_16x16x32_bf16 v[60:63], a[172:175], v[208:211], v[60:63]
    ds_read_b64_tr_b16 a[190:191], v8 offset:61440
    v_add_f32 v237, v237, v207
    v_cvt_pk_bf16_f32 v215, v206, v207
    v_mfma_f32_16x16x32_bf16 v[200:203], a[80:83], a[48:51], v[228:231]
    s_mov_b32 m0, 110592
    v_exp_f32 v192, v192
    v_mfma_f32_16x16x32_bf16 v[200:203], a[84:87], a[52:55], v[200:203]
    buffer_load_dwordx4 v17, s[32:35], s46 offen offset:0 nt lds
    v_exp_f32 v193, v193
    v_mfma_f32_16x16x32_bf16 v[200:203], a[88:91], a[56:59], v[200:203]
    ds_read_b64_tr_b16 a[192:193], v9 offset:57344
    ds_read_b64_tr_b16 a[194:195], v9 offset:61440
    v_add_f32 v238, v238, v192
    v_mfma_f32_16x16x32_bf16 v[200:203], a[92:95], a[60:63], v[200:203]
    buffer_load_dwordx4 v18, s[32:35], s46 offen offset:1024 nt lds
    v_exp_f32 v194, v194
    v_mfma_f32_16x16x32_bf16 v[204:207], a[96:99], a[48:51], v[228:231]
    ds_read_b64_tr_b16 a[196:197], v10 offset:57344
    ds_read_b64_tr_b16 a[198:199], v10 offset:61440
    v_add_f32 v238, v238, v193
    v_mfma_f32_16x16x32_bf16 v[204:207], a[100:103], a[52:55], v[204:207]
    buffer_load_dwordx4 v17, s[32:35], s46 offen offset:2048 nt lds
    v_exp_f32 v195, v195
    v_mfma_f32_16x16x32_bf16 v[204:207], a[104:107], a[56:59], v[204:207]
    ds_read_b64_tr_b16 a[200:201], v11 offset:57344
    ds_read_b64_tr_b16 a[202:203], v11 offset:61440
    v_cvt_pk_bf16_f32 v208, v192, v193
    v_mfma_f32_16x16x32_bf16 v[204:207], a[108:111], a[60:63], v[204:207]
    buffer_load_dwordx4 v18, s[32:35], s46 offen offset:3072 nt lds
    v_exp_f32 v196, v196
    v_mfma_f32_16x16x32_bf16 v[64:67], a[144:147], v[212:215], v[64:67]
    ds_read_b64_tr_b16 a[204:205], v12 offset:57344
    ds_read_b64_tr_b16 a[206:207], v12 offset:61440
    v_add_f32 v238, v238, v194
    v_mfma_f32_16x16x32_bf16 v[68:71], a[148:151], v[212:215], v[68:71]
    v_exp_f32 v197, v197
    v_mfma_f32_16x16x32_bf16 v[72:75], a[152:155], v[212:215], v[72:75]
    v_add_f32 v238, v238, v195
    v_cvt_pk_bf16_f32 v209, v194, v195
    v_mfma_f32_16x16x32_bf16 v[76:79], a[156:159], v[212:215], v[76:79]
    v_exp_f32 v198, v198
    v_mfma_f32_16x16x32_bf16 v[80:83], a[160:163], v[212:215], v[80:83]
    v_add_f32 v238, v238, v196
    v_add_f32 v238, v238, v197
    v_mfma_f32_16x16x32_bf16 v[84:87], a[164:167], v[212:215], v[84:87]
    v_exp_f32 v199, v199
    v_mfma_f32_16x16x32_bf16 v[88:91], a[168:171], v[212:215], v[88:91]
    s_waitcnt vmcnt(63) lgkmcnt(0)
    v_cvt_pk_bf16_f32 v210, v196, v197
    v_add_f32 v238, v238, v198
    v_mfma_f32_16x16x32_bf16 v[92:95], a[172:175], v[212:215], v[92:95]
    s_barrier
    v_add_f32 v238, v238, v199
    v_cvt_pk_bf16_f32 v211, v198, v199
    v_mfma_f32_16x16x32_bf16 v[192:195], a[112:115], a[0:3], v[216:219]
    s_add_u32 s46, s46, 16384
    v_exp_f32 v200, v200
    v_mfma_f32_16x16x32_bf16 v[192:195], a[116:119], a[4:7], v[192:195]
    s_and_b32 s46, s46, 0x3ffff
    v_exp_f32 v201, v201
    v_mfma_f32_16x16x32_bf16 v[192:195], a[120:123], a[8:11], v[192:195]
    s_sub_u32 s82, s46, 12288
    v_add_f32 v239, v239, v200
    v_add_f32 v239, v239, v201
    v_mfma_f32_16x16x32_bf16 v[192:195], a[124:127], a[12:15], v[192:195]
    s_sub_u32 s83, s46, 8192
    v_exp_f32 v202, v202
    v_mfma_f32_16x16x32_bf16 v[196:199], a[128:131], a[0:3], v[216:219]
    s_sub_u32 s84, s46, 4096
    v_exp_f32 v203, v203
    v_mfma_f32_16x16x32_bf16 v[196:199], a[132:135], a[4:7], v[196:199]
    s_mov_b32 m0, 49152
    ds_read_b128 a[80:83], v1 offset:0
    v_cvt_pk_bf16_f32 v212, v200, v201
    v_mfma_f32_16x16x32_bf16 v[196:199], a[136:139], a[8:11], v[196:199]
    ds_read_b128 a[84:87], v2 offset:0
    v_add_f32 v239, v239, v202
    v_mfma_f32_16x16x32_bf16 v[196:199], a[140:143], a[12:15], v[196:199]
    buffer_load_dwordx4 v13, s[28:31], s82 offen offset:0 nt lds
    v_exp_f32 v204, v204
    v_mfma_f32_16x16x32_bf16 v[96:99], a[144:147], v[208:211], v[96:99]
    buffer_load_dwordx4 v14, s[28:31], s82 offen offset:1024 nt lds
    v_add_f32 v239, v239, v203
    v_cvt_pk_bf16_f32 v213, v202, v203
    v_mfma_f32_16x16x32_bf16 v[100:103], a[148:151], v[208:211], v[100:103]
    buffer_load_dwordx4 v15, s[28:31], s82 offen offset:2048 nt lds
    v_exp_f32 v205, v205
    v_mfma_f32_16x16x32_bf16 v[104:107], a[152:155], v[208:211], v[104:107]
    buffer_load_dwordx4 v16, s[28:31], s82 offen offset:3072 nt lds
    v_exp_f32 v206, v206
    v_mfma_f32_16x16x32_bf16 v[108:111], a[156:159], v[208:211], v[108:111]
    v_add_f32 v239, v239, v204
    v_add_f32 v239, v239, v205
    v_mfma_f32_16x16x32_bf16 v[112:115], a[160:163], v[208:211], v[112:115]
    v_exp_f32 v207, v207
    v_mfma_f32_16x16x32_bf16 v[116:119], a[164:167], v[208:211], v[116:119]
    ds_read_b128 a[88:91], v3 offset:0
    v_cvt_pk_bf16_f32 v214, v204, v205
    v_mfma_f32_16x16x32_bf16 v[120:123], a[168:171], v[208:211], v[120:123]
    ds_read_b128 a[92:95], v4 offset:0
    v_add_f32 v239, v239, v206
    v_mfma_f32_16x16x32_bf16 v[124:127], a[172:175], v[208:211], v[124:127]
    v_add_f32 v239, v239, v207
    v_cvt_pk_bf16_f32 v215, v206, v207
    v_mfma_f32_16x16x32_bf16 v[200:203], a[112:115], a[16:19], v[220:223]
    s_mov_b32 m0, 53248
    v_exp_f32 v192, v192
    v_mfma_f32_16x16x32_bf16 v[200:203], a[116:119], a[20:23], v[200:203]
    buffer_load_dwordx4 v13, s[28:31], s83 offen offset:0 nt lds
    v_exp_f32 v193, v193
    v_mfma_f32_16x16x32_bf16 v[200:203], a[120:123], a[24:27], v[200:203]
    buffer_load_dwordx4 v14, s[28:31], s83 offen offset:1024 nt lds
    v_add_f32 v236, v236, v192
    v_add_f32 v236, v236, v193
    v_mfma_f32_16x16x32_bf16 v[200:203], a[124:127], a[28:31], v[200:203]
    buffer_load_dwordx4 v15, s[28:31], s83 offen offset:2048 nt lds
    v_exp_f32 v194, v194
    v_mfma_f32_16x16x32_bf16 v[204:207], a[128:131], a[16:19], v[220:223]
    buffer_load_dwordx4 v16, s[28:31], s83 offen offset:3072 nt lds
    v_exp_f32 v195, v195
    v_mfma_f32_16x16x32_bf16 v[204:207], a[132:135], a[20:23], v[204:207]
    ds_read_b128 a[96:99], v1 offset:4096
    v_cvt_pk_bf16_f32 v208, v192, v193
    v_mfma_f32_16x16x32_bf16 v[204:207], a[136:139], a[24:27], v[204:207]
    ds_read_b128 a[100:103], v2 offset:4096
    v_add_f32 v236, v236, v194
    v_mfma_f32_16x16x32_bf16 v[204:207], a[140:143], a[28:31], v[204:207]
    v_exp_f32 v196, v196
    v_mfma_f32_16x16x32_bf16 v[128:131], a[144:147], v[212:215], v[128:131]
    v_add_f32 v236, v236, v195
    v_cvt_pk_bf16_f32 v209, v194, v195
    v_mfma_f32_16x16x32_bf16 v[132:135], a[148:151], v[212:215], v[132:135]
    v_exp_f32 v197, v197
    v_mfma_f32_16x16x32_bf16 v[136:139], a[152:155], v[212:215], v[136:139]
    v_exp_f32 v198, v198
    v_mfma_f32_16x16x32_bf16 v[140:143], a[156:159], v[212:215], v[140:143]
    v_add_f32 v236, v236, v196
    v_add_f32 v236, v236, v197
    v_mfma_f32_16x16x32_bf16 v[144:147], a[160:163], v[212:215], v[144:147]
    v_exp_f32 v199, v199
    v_mfma_f32_16x16x32_bf16 v[148:151], a[164:167], v[212:215], v[148:151]
    ds_read_b128 a[104:107], v3 offset:4096
    v_cvt_pk_bf16_f32 v210, v196, v197
    v_mfma_f32_16x16x32_bf16 v[152:155], a[168:171], v[212:215], v[152:155]
    ds_read_b128 a[108:111], v4 offset:4096
    v_add_f32 v236, v236, v198
    v_mfma_f32_16x16x32_bf16 v[156:159], a[172:175], v[212:215], v[156:159]
    v_add_f32 v236, v236, v199
    v_cvt_pk_bf16_f32 v211, v198, v199
    v_mfma_f32_16x16x32_bf16 v[192:195], a[112:115], a[32:35], v[224:227]
    s_mov_b32 m0, 57344
    v_exp_f32 v200, v200
    v_mfma_f32_16x16x32_bf16 v[192:195], a[116:119], a[36:39], v[192:195]
    buffer_load_dwordx4 v13, s[28:31], s84 offen offset:0 nt lds
    v_exp_f32 v201, v201
    v_mfma_f32_16x16x32_bf16 v[192:195], a[120:123], a[40:43], v[192:195]
    ds_read_b64_tr_b16 a[144:145], v5 offset:0
    v_add_f32 v237, v237, v200
    v_add_f32 v237, v237, v201
    v_mfma_f32_16x16x32_bf16 v[192:195], a[124:127], a[44:47], v[192:195]
    buffer_load_dwordx4 v14, s[28:31], s84 offen offset:1024 nt lds
    v_exp_f32 v202, v202
    v_mfma_f32_16x16x32_bf16 v[196:199], a[128:131], a[32:35], v[224:227]
    buffer_load_dwordx4 v15, s[28:31], s84 offen offset:2048 nt lds
    v_exp_f32 v203, v203
    v_mfma_f32_16x16x32_bf16 v[196:199], a[132:135], a[36:39], v[196:199]
    ds_read_b64_tr_b16 a[146:147], v5 offset:4096
    v_cvt_pk_bf16_f32 v212, v200, v201
    v_mfma_f32_16x16x32_bf16 v[196:199], a[136:139], a[40:43], v[196:199]
    ds_read_b64_tr_b16 a[148:149], v6 offset:0
    v_add_f32 v237, v237, v202
    v_mfma_f32_16x16x32_bf16 v[196:199], a[140:143], a[44:47], v[196:199]
    buffer_load_dwordx4 v16, s[28:31], s84 offen offset:3072 nt lds
    v_exp_f32 v204, v204
    v_mfma_f32_16x16x32_bf16 v[32:35], a[176:179], v[208:211], v[32:35]
    ds_read_b64_tr_b16 a[150:151], v6 offset:4096
    v_add_f32 v237, v237, v203
    v_cvt_pk_bf16_f32 v213, v202, v203
    v_mfma_f32_16x16x32_bf16 v[36:39], a[180:183], v[208:211], v[36:39]
    v_exp_f32 v205, v205
    v_mfma_f32_16x16x32_bf16 v[40:43], a[184:187], v[208:211], v[40:43]
    v_exp_f32 v206, v206
    v_mfma_f32_16x16x32_bf16 v[44:47], a[188:191], v[208:211], v[44:47]
    ds_read_b64_tr_b16 a[152:153], v7 offset:0
    v_add_f32 v237, v237, v204
    v_add_f32 v237, v237, v205
    v_mfma_f32_16x16x32_bf16 v[48:51], a[192:195], v[208:211], v[48:51]
    v_exp_f32 v207, v207
    v_mfma_f32_16x16x32_bf16 v[52:55], a[196:199], v[208:211], v[52:55]
    ds_read_b64_tr_b16 a[154:155], v7 offset:4096
    v_cvt_pk_bf16_f32 v214, v204, v205
    v_mfma_f32_16x16x32_bf16 v[56:59], a[200:203], v[208:211], v[56:59]
    ds_read_b64_tr_b16 a[156:157], v8 offset:0
    v_add_f32 v237, v237, v206
    v_mfma_f32_16x16x32_bf16 v[60:63], a[204:207], v[208:211], v[60:63]
    ds_read_b64_tr_b16 a[158:159], v8 offset:4096
    v_add_f32 v237, v237, v207
    v_cvt_pk_bf16_f32 v215, v206, v207
    v_mfma_f32_16x16x32_bf16 v[200:203], a[112:115], a[48:51], v[228:231]
    s_mov_b32 m0, 61440
    v_exp_f32 v192, v192
    v_mfma_f32_16x16x32_bf16 v[200:203], a[116:119], a[52:55], v[200:203]
    buffer_load_dwordx4 v13, s[28:31], s46 offen offset:0 nt lds
    v_exp_f32 v193, v193
    v_mfma_f32_16x16x32_bf16 v[200:203], a[120:123], a[56:59], v[200:203]
    ds_read_b64_tr_b16 a[160:161], v9 offset:0
    ds_read_b64_tr_b16 a[162:163], v9 offset:4096
    v_add_f32 v238, v238, v192
    v_mfma_f32_16x16x32_bf16 v[200:203], a[124:127], a[60:63], v[200:203]
    buffer_load_dwordx4 v14, s[28:31], s46 offen offset:1024 nt lds
    v_exp_f32 v194, v194
    v_mfma_f32_16x16x32_bf16 v[204:207], a[128:131], a[48:51], v[228:231]
    ds_read_b64_tr_b16 a[164:165], v10 offset:0
    ds_read_b64_tr_b16 a[166:167], v10 offset:4096
    v_add_f32 v238, v238, v193
    v_mfma_f32_16x16x32_bf16 v[204:207], a[132:135], a[52:55], v[204:207]
    buffer_load_dwordx4 v15, s[28:31], s46 offen offset:2048 nt lds
    v_exp_f32 v195, v195
    v_mfma_f32_16x16x32_bf16 v[204:207], a[136:139], a[56:59], v[204:207]
    ds_read_b64_tr_b16 a[168:169], v11 offset:0
    ds_read_b64_tr_b16 a[170:171], v11 offset:4096
    v_cvt_pk_bf16_f32 v208, v192, v193
    v_mfma_f32_16x16x32_bf16 v[204:207], a[140:143], a[60:63], v[204:207]
    buffer_load_dwordx4 v16, s[28:31], s46 offen offset:3072 nt lds
    v_exp_f32 v196, v196
    v_mfma_f32_16x16x32_bf16 v[64:67], a[176:179], v[212:215], v[64:67]
    ds_read_b64_tr_b16 a[172:173], v12 offset:0
    ds_read_b64_tr_b16 a[174:175], v12 offset:4096
    v_add_f32 v238, v238, v194
    v_mfma_f32_16x16x32_bf16 v[68:71], a[180:183], v[212:215], v[68:71]
    v_exp_f32 v197, v197
    v_mfma_f32_16x16x32_bf16 v[72:75], a[184:187], v[212:215], v[72:75]
    v_add_f32 v238, v238, v195
    v_cvt_pk_bf16_f32 v209, v194, v195
    v_mfma_f32_16x16x32_bf16 v[76:79], a[188:191], v[212:215], v[76:79]
    v_exp_f32 v198, v198
    v_mfma_f32_16x16x32_bf16 v[80:83], a[192:195], v[212:215], v[80:83]
    v_add_f32 v238, v238, v196
    v_add_f32 v238, v238, v197
    v_mfma_f32_16x16x32_bf16 v[84:87], a[196:199], v[212:215], v[84:87]
    v_exp_f32 v199, v199
    v_mfma_f32_16x16x32_bf16 v[88:91], a[200:203], v[212:215], v[88:91]
    v_cvt_pk_bf16_f32 v210, v196, v197
    v_add_f32 v238, v238, v198
    v_mfma_f32_16x16x32_bf16 v[92:95], a[204:207], v[212:215], v[92:95]
    s_waitcnt lgkmcnt(0)
    v_add_f32 v238, v238, v199
    v_cvt_pk_bf16_f32 v211, v198, v199
    v_mfma_f32_16x16x32_bf16 v[192:195], a[80:83], a[0:3], v[216:219]
    s_mov_b32 m0, 114688
    v_exp_f32 v200, v200
    v_mfma_f32_16x16x32_bf16 v[192:195], a[84:87], a[4:7], v[192:195]
    buffer_load_dwordx4 v17, s[32:35], s82 offen offset:0 nt lds
    v_exp_f32 v201, v201
    v_mfma_f32_16x16x32_bf16 v[192:195], a[88:91], a[8:11], v[192:195]
    buffer_load_dwordx4 v18, s[32:35], s82 offen offset:1024 nt lds
    v_add_f32 v239, v239, v200
    v_add_f32 v239, v239, v201
    v_mfma_f32_16x16x32_bf16 v[192:195], a[92:95], a[12:15], v[192:195]
    buffer_load_dwordx4 v17, s[32:35], s82 offen offset:2048 nt lds
    v_exp_f32 v202, v202
    v_mfma_f32_16x16x32_bf16 v[196:199], a[96:99], a[0:3], v[216:219]
    buffer_load_dwordx4 v18, s[32:35], s82 offen offset:3072 nt lds
    v_exp_f32 v203, v203
    v_mfma_f32_16x16x32_bf16 v[196:199], a[100:103], a[4:7], v[196:199]
    ds_read_b128 a[112:115], v1 offset:8192
    v_cvt_pk_bf16_f32 v212, v200, v201
    v_mfma_f32_16x16x32_bf16 v[196:199], a[104:107], a[8:11], v[196:199]
    ds_read_b128 a[116:119], v2 offset:8192
    v_add_f32 v239, v239, v202
    v_mfma_f32_16x16x32_bf16 v[196:199], a[108:111], a[12:15], v[196:199]
    v_exp_f32 v204, v204
    v_mfma_f32_16x16x32_bf16 v[96:99], a[176:179], v[208:211], v[96:99]
    v_add_f32 v239, v239, v203
    v_cvt_pk_bf16_f32 v213, v202, v203
    v_mfma_f32_16x16x32_bf16 v[100:103], a[180:183], v[208:211], v[100:103]
    v_exp_f32 v205, v205
    v_mfma_f32_16x16x32_bf16 v[104:107], a[184:187], v[208:211], v[104:107]
    v_exp_f32 v206, v206
    v_mfma_f32_16x16x32_bf16 v[108:111], a[188:191], v[208:211], v[108:111]
    v_add_f32 v239, v239, v204
    v_add_f32 v239, v239, v205
    v_mfma_f32_16x16x32_bf16 v[112:115], a[192:195], v[208:211], v[112:115]
    v_exp_f32 v207, v207
    v_mfma_f32_16x16x32_bf16 v[116:119], a[196:199], v[208:211], v[116:119]
    ds_read_b128 a[120:123], v3 offset:8192
    v_cvt_pk_bf16_f32 v214, v204, v205
    v_mfma_f32_16x16x32_bf16 v[120:123], a[200:203], v[208:211], v[120:123]
    ds_read_b128 a[124:127], v4 offset:8192
    v_add_f32 v239, v239, v206
    v_mfma_f32_16x16x32_bf16 v[124:127], a[204:207], v[208:211], v[124:127]
    v_add_f32 v239, v239, v207
    v_cvt_pk_bf16_f32 v215, v206, v207
    s_sub_u32 s47, s47, 1
    s_cmp_lg_u32 s47, 0
    s_cbranch_scc1 L_loop_b
    s_load_dword s54, s[80:81], s1
    s_mov_b32 s56, 0x40000
    v_mfma_f32_16x16x32_bf16 v[200:203], a[80:83], a[16:19], v[220:223]
    s_mov_b32 m0, 118784
    v_exp_f32 v192, v192
    v_mfma_f32_16x16x32_bf16 v[200:203], a[84:87], a[20:23], v[200:203]
    buffer_load_dwordx4 v17, s[32:35], s83 offen offset:0 nt lds
    v_exp_f32 v193, v193
    v_mfma_f32_16x16x32_bf16 v[200:203], a[88:91], a[24:27], v[200:203]
    buffer_load_dwordx4 v18, s[32:35], s83 offen offset:1024 nt lds
    v_add_f32 v236, v236, v192
    v_add_f32 v236, v236, v193
    v_mfma_f32_16x16x32_bf16 v[200:203], a[92:95], a[28:31], v[200:203]
    buffer_load_dwordx4 v17, s[32:35], s83 offen offset:2048 nt lds
    v_exp_f32 v194, v194
    v_mfma_f32_16x16x32_bf16 v[204:207], a[96:99], a[16:19], v[220:223]
    buffer_load_dwordx4 v18, s[32:35], s83 offen offset:3072 nt lds
    v_exp_f32 v195, v195
    v_mfma_f32_16x16x32_bf16 v[204:207], a[100:103], a[20:23], v[204:207]
    ds_read_b128 a[128:131], v1 offset:12288
    v_cvt_pk_bf16_f32 v208, v192, v193
    v_mfma_f32_16x16x32_bf16 v[204:207], a[104:107], a[24:27], v[204:207]
    ds_read_b128 a[132:135], v2 offset:12288
    v_add_f32 v236, v236, v194
    v_mfma_f32_16x16x32_bf16 v[204:207], a[108:111], a[28:31], v[204:207]
    v_exp_f32 v196, v196
    v_mfma_f32_16x16x32_bf16 v[128:131], a[176:179], v[212:215], v[128:131]
    v_add_f32 v236, v236, v195
    v_cvt_pk_bf16_f32 v209, v194, v195
    v_mfma_f32_16x16x32_bf16 v[132:135], a[180:183], v[212:215], v[132:135]
    v_exp_f32 v197, v197
    v_mfma_f32_16x16x32_bf16 v[136:139], a[184:187], v[212:215], v[136:139]
    v_exp_f32 v198, v198
    v_mfma_f32_16x16x32_bf16 v[140:143], a[188:191], v[212:215], v[140:143]
    v_add_f32 v236, v236, v196
    v_add_f32 v236, v236, v197
    v_mfma_f32_16x16x32_bf16 v[144:147], a[192:195], v[212:215], v[144:147]
    v_exp_f32 v199, v199
    v_mfma_f32_16x16x32_bf16 v[148:151], a[196:199], v[212:215], v[148:151]
    ds_read_b128 a[136:139], v3 offset:12288
    v_cvt_pk_bf16_f32 v210, v196, v197
    v_mfma_f32_16x16x32_bf16 v[152:155], a[200:203], v[212:215], v[152:155]
    ds_read_b128 a[140:143], v4 offset:12288
    v_add_f32 v236, v236, v198
    v_mfma_f32_16x16x32_bf16 v[156:159], a[204:207], v[212:215], v[156:159]
    v_add_f32 v236, v236, v199
    v_cvt_pk_bf16_f32 v211, v198, v199
    s_movk_i32 s50, 20480
    s_lshl_b32 s87, s85, 12
    s_add_u32 s86, s60, s87
    v_lshlrev_b32 v254, 2, v19
    v_add_u32 v254, s86, v254
    v_mfma_f32_16x16x32_bf16 v[192:195], a[80:83], a[32:35], v[224:227]
    s_mov_b32 m0, 122880
    v_exp_f32 v200, v200
    v_mfma_f32_16x16x32_bf16 v[192:195], a[84:87], a[36:39], v[192:195]
    buffer_load_dwordx4 v17, s[32:35], s84 offen offset:0 nt lds
    v_exp_f32 v201, v201
    v_mfma_f32_16x16x32_bf16 v[192:195], a[88:91], a[40:43], v[192:195]
    ds_read_b64_tr_b16 a[176:177], v5 offset:8192
    v_add_f32 v237, v237, v200
    v_add_f32 v237, v237, v201
    v_mfma_f32_16x16x32_bf16 v[192:195], a[92:95], a[44:47], v[192:195]
    buffer_load_dwordx4 v18, s[32:35], s84 offen offset:1024 nt lds
    v_exp_f32 v202, v202
    v_mfma_f32_16x16x32_bf16 v[196:199], a[96:99], a[32:35], v[224:227]
    buffer_load_dwordx4 v17, s[32:35], s84 offen offset:2048 nt lds
    v_exp_f32 v203, v203
    v_mfma_f32_16x16x32_bf16 v[196:199], a[100:103], a[36:39], v[196:199]
    ds_read_b64_tr_b16 a[178:179], v5 offset:12288
    v_cvt_pk_bf16_f32 v212, v200, v201
    v_mfma_f32_16x16x32_bf16 v[196:199], a[104:107], a[40:43], v[196:199]
    ds_read_b64_tr_b16 a[180:181], v6 offset:8192
    v_add_f32 v237, v237, v202
    v_mfma_f32_16x16x32_bf16 v[196:199], a[108:111], a[44:47], v[196:199]
    buffer_load_dwordx4 v18, s[32:35], s84 offen offset:3072 nt lds
    v_exp_f32 v204, v204
    v_mfma_f32_16x16x32_bf16 v[32:35], a[144:147], v[208:211], v[32:35]
    ds_read_b64_tr_b16 a[182:183], v6 offset:12288
    v_add_f32 v237, v237, v203
    v_cvt_pk_bf16_f32 v213, v202, v203
    v_mfma_f32_16x16x32_bf16 v[36:39], a[148:151], v[208:211], v[36:39]
    buffer_store_dwordx4 a[208:211], v19, s[36:39], s50 offen sc1
    v_exp_f32 v205, v205
    v_mfma_f32_16x16x32_bf16 v[40:43], a[152:155], v[208:211], v[40:43]
    global_load_dword v251, v254, s[12:13]
    v_exp_f32 v206, v206
    v_mfma_f32_16x16x32_bf16 v[44:47], a[156:159], v[208:211], v[44:47]
    ds_read_b64_tr_b16 a[184:185], v7 offset:8192
    v_add_f32 v237, v237, v204
    v_add_f32 v237, v237, v205
    v_mfma_f32_16x16x32_bf16 v[48:51], a[160:163], v[208:211], v[48:51]
    v_exp_f32 v207, v207
    v_mfma_f32_16x16x32_bf16 v[52:55], a[164:167], v[208:211], v[52:55]
    ds_read_b64_tr_b16 a[186:187], v7 offset:12288
    v_cvt_pk_bf16_f32 v214, v204, v205
    v_mfma_f32_16x16x32_bf16 v[56:59], a[168:171], v[208:211], v[56:59]
    ds_read_b64_tr_b16 a[188:189], v8 offset:8192
    v_add_f32 v237, v237, v206
    v_mfma_f32_16x16x32_bf16 v[60:63], a[172:175], v[208:211], v[60:63]
    ds_read_b64_tr_b16 a[190:191], v8 offset:12288
    v_add_f32 v237, v237, v207
    v_cvt_pk_bf16_f32 v215, v206, v207
    v_mfma_f32_16x16x32_bf16 v[200:203], a[80:83], a[48:51], v[228:231]
    s_mov_b32 m0, 126976
    v_exp_f32 v192, v192
    v_mfma_f32_16x16x32_bf16 v[200:203], a[84:87], a[52:55], v[200:203]
    buffer_load_dwordx4 v17, s[32:35], s46 offen offset:0 nt lds
    v_exp_f32 v193, v193
    v_mfma_f32_16x16x32_bf16 v[200:203], a[88:91], a[56:59], v[200:203]
    ds_read_b64_tr_b16 a[192:193], v9 offset:8192
    ds_read_b64_tr_b16 a[194:195], v9 offset:12288
    v_add_f32 v238, v238, v192
    v_mfma_f32_16x16x32_bf16 v[200:203], a[92:95], a[60:63], v[200:203]
    buffer_load_dwordx4 v18, s[32:35], s46 offen offset:1024 nt lds
    v_exp_f32 v194, v194
    v_mfma_f32_16x16x32_bf16 v[204:207], a[96:99], a[48:51], v[228:231]
    ds_read_b64_tr_b16 a[196:197], v10 offset:8192
    ds_read_b64_tr_b16 a[198:199], v10 offset:12288
    v_add_f32 v238, v238, v193
    v_mfma_f32_16x16x32_bf16 v[204:207], a[100:103], a[52:55], v[204:207]
    buffer_load_dwordx4 v17, s[32:35], s46 offen offset:2048 nt lds
    v_exp_f32 v195, v195
    v_mfma_f32_16x16x32_bf16 v[204:207], a[104:107], a[56:59], v[204:207]
    ds_read_b64_tr_b16 a[200:201], v11 offset:8192
    ds_read_b64_tr_b16 a[202:203], v11 offset:12288
    v_cvt_pk_bf16_f32 v208, v192, v193
    v_mfma_f32_16x16x32_bf16 v[204:207], a[108:111], a[60:63], v[204:207]
    buffer_load_dwordx4 v18, s[32:35], s46 offen offset:3072 nt lds
    v_exp_f32 v196, v196
    v_mfma_f32_16x16x32_bf16 v[64:67], a[144:147], v[212:215], v[64:67]
    ds_read_b64_tr_b16 a[204:205], v12 offset:8192
    ds_read_b64_tr_b16 a[206:207], v12 offset:12288
    v_add_f32 v238, v238, v194
    v_mfma_f32_16x16x32_bf16 v[68:71], a[148:151], v[212:215], v[68:71]
    v_exp_f32 v197, v197
    v_mfma_f32_16x16x32_bf16 v[72:75], a[152:155], v[212:215], v[72:75]
    v_add_f32 v238, v238, v195
    v_cvt_pk_bf16_f32 v209, v194, v195
    v_mfma_f32_16x16x32_bf16 v[76:79], a[156:159], v[212:215], v[76:79]
    v_exp_f32 v198, v198
    v_mfma_f32_16x16x32_bf16 v[80:83], a[160:163], v[212:215], v[80:83]
    v_add_f32 v238, v238, v196
    v_add_f32 v238, v238, v197
    v_mfma_f32_16x16x32_bf16 v[84:87], a[164:167], v[212:215], v[84:87]
    v_exp_f32 v199, v199
    v_mfma_f32_16x16x32_bf16 v[88:91], a[168:171], v[212:215], v[88:91]
    s_waitcnt vmcnt(63) lgkmcnt(0)
    v_cvt_pk_bf16_f32 v210, v196, v197
    v_add_f32 v238, v238, v198
    v_mfma_f32_16x16x32_bf16 v[92:95], a[172:175], v[212:215], v[92:95]
    s_barrier
    v_add_f32 v238, v238, v199
    v_cvt_pk_bf16_f32 v211, v198, v199
    s_movk_i32 s51, 21504
    v_mfma_f32_16x16x32_bf16 v[192:195], a[112:115], a[0:3], v[216:219]
    buffer_store_dwordx4 a[208:211], v19, s[36:39], s51 offen sc1
    v_exp_f32 v200, v200
    v_mfma_f32_16x16x32_bf16 v[192:195], a[116:119], a[4:7], v[192:195]
    v_exp_f32 v201, v201
    v_mfma_f32_16x16x32_bf16 v[192:195], a[120:123], a[8:11], v[192:195]
    v_add_f32 v239, v239, v200
    v_add_f32 v239, v239, v201
    v_mfma_f32_16x16x32_bf16 v[192:195], a[124:127], a[12:15], v[192:195]
    v_exp_f32 v202, v202
    v_mfma_f32_16x16x32_bf16 v[196:199], a[128:131], a[0:3], v[216:219]
    v_exp_f32 v203, v203
    v_mfma_f32_16x16x32_bf16 v[196:199], a[132:135], a[4:7], v[196:199]
    ds_read_b128 a[80:83], v1 offset:16384
    v_cvt_pk_bf16_f32 v212, v200, v201
    v_mfma_f32_16x16x32_bf16 v[196:199], a[136:139], a[8:11], v[196:199]
    ds_read_b128 a[84:87], v2 offset:16384
    v_add_f32 v239, v239, v202
    v_mfma_f32_16x16x32_bf16 v[196:199], a[140:143], a[12:15], v[196:199]
    v_exp_f32 v204, v204
    v_mfma_f32_16x16x32_bf16 v[96:99], a[144:147], v[208:211], v[96:99]
    v_add_f32 v239, v239, v203
    v_cvt_pk_bf16_f32 v213, v202, v203
    v_mfma_f32_16x16x32_bf16 v[100:103], a[148:151], v[208:211], v[100:103]
    v_exp_f32 v205, v205
    v_mfma_f32_16x16x32_bf16 v[104:107], a[152:155], v[208:211], v[104:107]
    v_exp_f32 v206, v206
    v_mfma_f32_16x16x32_bf16 v[108:111], a[156:159], v[208:211], v[108:111]
    v_add_f32 v239, v239, v204
    v_add_f32 v239, v239, v205
    v_mfma_f32_16x16x32_bf16 v[112:115], a[160:163], v[208:211], v[112:115]
    v_exp_f32 v207, v207
    v_mfma_f32_16x16x32_bf16 v[116:119], a[164:167], v[208:211], v[116:119]
    ds_read_b128 a[88:91], v3 offset:16384
    v_cvt_pk_bf16_f32 v214, v204, v205
    v_mfma_f32_16x16x32_bf16 v[120:123], a[168:171], v[208:211], v[120:123]
    ds_read_b128 a[92:95], v4 offset:16384
    v_add_f32 v239, v239, v206
    v_mfma_f32_16x16x32_bf16 v[124:127], a[172:175], v[208:211], v[124:127]
    v_add_f32 v239, v239, v207
    v_cvt_pk_bf16_f32 v215, v206, v207
    v_mfma_f32_16x16x32_bf16 v[200:203], a[112:115], a[16:19], v[220:223]
    v_exp_f32 v192, v192
    v_mfma_f32_16x16x32_bf16 v[200:203], a[116:119], a[20:23], v[200:203]
    v_exp_f32 v193, v193
    v_mfma_f32_16x16x32_bf16 v[200:203], a[120:123], a[24:27], v[200:203]
    v_add_f32 v236, v236, v192
    v_add_f32 v236, v236, v193
    v_mfma_f32_16x16x32_bf16 v[200:203], a[124:127], a[28:31], v[200:203]
    v_exp_f32 v194, v194
    v_mfma_f32_16x16x32_bf16 v[204:207], a[128:131], a[16:19], v[220:223]
    v_exp_f32 v195, v195
    v_mfma_f32_16x16x32_bf16 v[204:207], a[132:135], a[20:23], v[204:207]
    ds_read_b128 a[96:99], v1 offset:20480
    v_cvt_pk_bf16_f32 v208, v192, v193
    v_mfma_f32_16x16x32_bf16 v[204:207], a[136:139], a[24:27], v[204:207]
    ds_read_b128 a[100:103], v2 offset:20480
    v_add_f32 v236, v236, v194
    v_mfma_f32_16x16x32_bf16 v[204:207], a[140:143], a[28:31], v[204:207]
    v_exp_f32 v196, v196
    v_mfma_f32_16x16x32_bf16 v[128:131], a[144:147], v[212:215], v[128:131]
    v_add_f32 v236, v236, v195
    v_cvt_pk_bf16_f32 v209, v194, v195
    v_mfma_f32_16x16x32_bf16 v[132:135], a[148:151], v[212:215], v[132:135]
    v_exp_f32 v197, v197
    v_mfma_f32_16x16x32_bf16 v[136:139], a[152:155], v[212:215], v[136:139]
    v_exp_f32 v198, v198
    v_mfma_f32_16x16x32_bf16 v[140:143], a[156:159], v[212:215], v[140:143]
    v_add_f32 v236, v236, v196
    v_add_f32 v236, v236, v197
    v_mfma_f32_16x16x32_bf16 v[144:147], a[160:163], v[212:215], v[144:147]
    v_exp_f32 v199, v199
    v_mfma_f32_16x16x32_bf16 v[148:151], a[164:167], v[212:215], v[148:151]
    ds_read_b128 a[104:107], v3 offset:20480
    v_cvt_pk_bf16_f32 v210, v196, v197
    v_mfma_f32_16x16x32_bf16 v[152:155], a[168:171], v[212:215], v[152:155]
    ds_read_b128 a[108:111], v4 offset:20480
    v_add_f32 v236, v236, v198
    v_mfma_f32_16x16x32_bf16 v[156:159], a[172:175], v[212:215], v[156:159]
    v_add_f32 v236, v236, v199
    v_cvt_pk_bf16_f32 v211, v198, v199
    s_movk_i32 s50, 22528
    v_mfma_f32_16x16x32_bf16 v[192:195], a[112:115], a[32:35], v[224:227]
    buffer_store_dwordx4 a[208:211], v19, s[36:39], s50 offen sc1
    v_exp_f32 v200, v200
    v_mfma_f32_16x16x32_bf16 v[192:195], a[116:119], a[36:39], v[192:195]
    v_exp_f32 v201, v201
    v_mfma_f32_16x16x32_bf16 v[192:195], a[120:123], a[40:43], v[192:195]
    ds_read_b64_tr_b16 a[144:145], v5 offset:16384
    v_add_f32 v237, v237, v200
    v_add_f32 v237, v237, v201
    v_mfma_f32_16x16x32_bf16 v[192:195], a[124:127], a[44:47], v[192:195]
    v_exp_f32 v202, v202
    v_mfma_f32_16x16x32_bf16 v[196:199], a[128:131], a[32:35], v[224:227]
    v_exp_f32 v203, v203
    v_mfma_f32_16x16x32_bf16 v[196:199], a[132:135], a[36:39], v[196:199]
    ds_read_b64_tr_b16 a[146:147], v5 offset:20480
    v_cvt_pk_bf16_f32 v212, v200, v201
    v_mfma_f32_16x16x32_bf16 v[196:199], a[136:139], a[40:43], v[196:199]
    ds_read_b64_tr_b16 a[148:149], v6 offset:16384
    v_add_f32 v237, v237, v202
    v_mfma_f32_16x16x32_bf16 v[196:199], a[140:143], a[44:47], v[196:199]
    v_exp_f32 v204, v204
    v_mfma_f32_16x16x32_bf16 v[32:35], a[176:179], v[208:211], v[32:35]
    ds_read_b64_tr_b16 a[150:151], v6 offset:20480
    v_add_f32 v237, v237, v203
    v_cvt_pk_bf16_f32 v213, v202, v203
    v_mfma_f32_16x16x32_bf16 v[36:39], a[180:183], v[208:211], v[36:39]
    v_exp_f32 v205, v205
    v_mfma_f32_16x16x32_bf16 v[40:43], a[184:187], v[208:211], v[40:43]
    v_exp_f32 v206, v206
    v_mfma_f32_16x16x32_bf16 v[44:47], a[188:191], v[208:211], v[44:47]
    ds_read_b64_tr_b16 a[152:153], v7 offset:16384
    v_add_f32 v237, v237, v204
    v_add_f32 v237, v237, v205
    v_mfma_f32_16x16x32_bf16 v[48:51], a[192:195], v[208:211], v[48:51]
    v_exp_f32 v207, v207
    v_mfma_f32_16x16x32_bf16 v[52:55], a[196:199], v[208:211], v[52:55]
    ds_read_b64_tr_b16 a[154:155], v7 offset:20480
    v_cvt_pk_bf16_f32 v214, v204, v205
    v_mfma_f32_16x16x32_bf16 v[56:59], a[200:203], v[208:211], v[56:59]
    ds_read_b64_tr_b16 a[156:157], v8 offset:16384
    v_add_f32 v237, v237, v206
    v_mfma_f32_16x16x32_bf16 v[60:63], a[204:207], v[208:211], v[60:63]
    ds_read_b64_tr_b16 a[158:159], v8 offset:20480
    v_add_f32 v237, v237, v207
    v_cvt_pk_bf16_f32 v215, v206, v207
    v_mfma_f32_16x16x32_bf16 v[200:203], a[112:115], a[48:51], v[228:231]
    v_exp_f32 v192, v192
    v_mfma_f32_16x16x32_bf16 v[200:203], a[116:119], a[52:55], v[200:203]
    v_exp_f32 v193, v193
    v_mfma_f32_16x16x32_bf16 v[200:203], a[120:123], a[56:59], v[200:203]
    ds_read_b64_tr_b16 a[160:161], v9 offset:16384
    ds_read_b64_tr_b16 a[162:163], v9 offset:20480
    v_add_f32 v238, v238, v192
    v_mfma_f32_16x16x32_bf16 v[200:203], a[124:127], a[60:63], v[200:203]
    v_exp_f32 v194, v194
    v_mfma_f32_16x16x32_bf16 v[204:207], a[128:131], a[48:51], v[228:231]
    ds_read_b64_tr_b16 a[164:165], v10 offset:16384
    ds_read_b64_tr_b16 a[166:167], v10 offset:20480
    v_add_f32 v238, v238, v193
    v_mfma_f32_16x16x32_bf16 v[204:207], a[132:135], a[52:55], v[204:207]
    v_exp_f32 v195, v195
    v_mfma_f32_16x16x32_bf16 v[204:207], a[136:139], a[56:59], v[204:207]
    ds_read_b64_tr_b16 a[168:169], v11 offset:16384
    ds_read_b64_tr_b16 a[170:171], v11 offset:20480
    v_cvt_pk_bf16_f32 v208, v192, v193
    v_mfma_f32_16x16x32_bf16 v[204:207], a[140:143], a[60:63], v[204:207]
    v_exp_f32 v196, v196
    v_mfma_f32_16x16x32_bf16 v[64:67], a[176:179], v[212:215], v[64:67]
    ds_read_b64_tr_b16 a[172:173], v12 offset:16384
    ds_read_b64_tr_b16 a[174:175], v12 offset:20480
    v_add_f32 v238, v238, v194
    v_mfma_f32_16x16x32_bf16 v[68:71], a[180:183], v[212:215], v[68:71]
    v_exp_f32 v197, v197
    v_mfma_f32_16x16x32_bf16 v[72:75], a[184:187], v[212:215], v[72:75]
    v_add_f32 v238, v238, v195
    v_cvt_pk_bf16_f32 v209, v194, v195
    v_mfma_f32_16x16x32_bf16 v[76:79], a[188:191], v[212:215], v[76:79]
    v_exp_f32 v198, v198
    v_mfma_f32_16x16x32_bf16 v[80:83], a[192:195], v[212:215], v[80:83]
    v_add_f32 v238, v238, v196
    v_add_f32 v238, v238, v197
    v_mfma_f32_16x16x32_bf16 v[84:87], a[196:199], v[212:215], v[84:87]
    v_exp_f32 v199, v199
    v_mfma_f32_16x16x32_bf16 v[88:91], a[200:203], v[212:215], v[88:91]
    v_cvt_pk_bf16_f32 v210, v196, v197
    v_add_f32 v238, v238, v198
    v_mfma_f32_16x16x32_bf16 v[92:95], a[204:207], v[212:215], v[92:95]
    s_waitcnt lgkmcnt(0)
    v_add_f32 v238, v238, v199
    v_cvt_pk_bf16_f32 v211, v198, v199
    s_movk_i32 s51, 23552
    v_add_u32 v254, 0x20000, v254
    v_mfma_f32_16x16x32_bf16 v[192:195], a[80:83], a[0:3], v[216:219]
    s_add_u32 m0, s63, 0
    v_exp_f32 v200, v200
    v_mfma_f32_16x16x32_bf16 v[192:195], a[84:87], a[4:7], v[192:195]
    s_xor_b32 s61, s3, 0
    v_exp_f32 v201, v201
    v_mfma_f32_16x16x32_bf16 v[192:195], a[88:91], a[8:11], v[192:195]
    buffer_load_dwordx4 v241, s[64:67], s61 offen offset:0 lds
    v_add_f32 v239, v239, v200
    v_add_f32 v239, v239, v201
    v_mfma_f32_16x16x32_bf16 v[192:195], a[92:95], a[12:15], v[192:195]
    buffer_load_dwordx4 v242, s[64:67], s61 offen offset:1024 lds
    v_exp_f32 v202, v202
    v_mfma_f32_16x16x32_bf16 v[196:199], a[96:99], a[0:3], v[216:219]
    buffer_load_dwordx4 v243, s[64:67], s61 offen offset:2048 lds
    v_exp_f32 v203, v203
    v_mfma_f32_16x16x32_bf16 v[196:199], a[100:103], a[4:7], v[196:199]
    ds_read_b128 a[112:115], v1 offset:24576
    v_cvt_pk_bf16_f32 v212, v200, v201
    v_mfma_f32_16x16x32_bf16 v[196:199], a[104:107], a[8:11], v[196:199]
    ds_read_b128 a[116:119], v2 offset:24576
    v_add_f32 v239, v239, v202
    v_mfma_f32_16x16x32_bf16 v[196:199], a[108:111], a[12:15], v[196:199]
    buffer_store_dwordx4 a[208:211], v19, s[36:39], s51 offen sc1
    v_exp_f32 v204, v204
    v_mfma_f32_16x16x32_bf16 v[96:99], a[176:179], v[208:211], v[96:99]
    global_load_dword v251, v254, s[12:13]
    v_add_f32 v239, v239, v203
    v_cvt_pk_bf16_f32 v213, v202, v203
    v_mfma_f32_16x16x32_bf16 v[100:103], a[180:183], v[208:211], v[100:103]
    v_exp_f32 v205, v205
    v_mfma_f32_16x16x32_bf16 v[104:107], a[184:187], v[208:211], v[104:107]
    v_exp_f32 v206, v206
    v_mfma_f32_16x16x32_bf16 v[108:111], a[188:191], v[208:211], v[108:111]
    v_add_f32 v239, v239, v204
    v_add_f32 v239, v239, v205
    v_mfma_f32_16x16x32_bf16 v[112:115], a[192:195], v[208:211], v[112:115]
    v_exp_f32 v207, v207
    v_mfma_f32_16x16x32_bf16 v[116:119], a[196:199], v[208:211], v[116:119]
    ds_read_b128 a[120:123], v3 offset:24576
    v_cvt_pk_bf16_f32 v214, v204, v205
    v_mfma_f32_16x16x32_bf16 v[120:123], a[200:203], v[208:211], v[120:123]
    ds_read_b128 a[124:127], v4 offset:24576
    v_add_f32 v239, v239, v206
    v_mfma_f32_16x16x32_bf16 v[124:127], a[204:207], v[208:211], v[124:127]
    v_add_f32 v239, v239, v207
    v_cvt_pk_bf16_f32 v215, v206, v207
    v_mfma_f32_16x16x32_bf16 v[200:203], a[80:83], a[16:19], v[220:223]
    buffer_load_dwordx4 v244, s[64:67], s61 offen offset:3072 lds
    v_exp_f32 v192, v192
    v_mfma_f32_16x16x32_bf16 v[200:203], a[84:87], a[20:23], v[200:203]
    s_add_u32 m0, s63, 4096
    v_exp_f32 v193, v193
    v_mfma_f32_16x16x32_bf16 v[200:203], a[88:91], a[24:27], v[200:203]
    s_xor_b32 s61, s3, 128
    v_add_f32 v236, v236, v192
    v_add_f32 v236, v236, v193
    v_mfma_f32_16x16x32_bf16 v[200:203], a[92:95], a[28:31], v[200:203]
    buffer_load_dwordx4 v241, s[64:67], s61 offen offset:0 lds
    v_exp_f32 v194, v194
    v_mfma_f32_16x16x32_bf16 v[204:207], a[96:99], a[16:19], v[220:223]
    buffer_load_dwordx4 v242, s[64:67], s61 offen offset:1024 lds
    v_exp_f32 v195, v195
    v_mfma_f32_16x16x32_bf16 v[204:207], a[100:103], a[20:23], v[204:207]
    ds_read_b128 a[128:131], v1 offset:28672
    v_cvt_pk_bf16_f32 v208, v192, v193
    v_mfma_f32_16x16x32_bf16 v[204:207], a[104:107], a[24:27], v[204:207]
    ds_read_b128 a[132:135], v2 offset:28672
    v_add_f32 v236, v236, v194
    v_mfma_f32_16x16x32_bf16 v[204:207], a[108:111], a[28:31], v[204:207]
    v_exp_f32 v196, v196
    v_mfma_f32_16x16x32_bf16 v[128:131], a[176:179], v[212:215], v[128:131]
    v_add_f32 v236, v236, v195
    v_cvt_pk_bf16_f32 v209, v194, v195
    v_mfma_f32_16x16x32_bf16 v[132:135], a[180:183], v[212:215], v[132:135]
    v_exp_f32 v197, v197
    v_mfma_f32_16x16x32_bf16 v[136:139], a[184:187], v[212:215], v[136:139]
    v_exp_f32 v198, v198
    v_mfma_f32_16x16x32_bf16 v[140:143], a[188:191], v[212:215], v[140:143]
    v_add_f32 v236, v236, v196
    v_add_f32 v236, v236, v197
    v_mfma_f32_16x16x32_bf16 v[144:147], a[192:195], v[212:215], v[144:147]
    v_exp_f32 v199, v199
    v_mfma_f32_16x16x32_bf16 v[148:151], a[196:199], v[212:215], v[148:151]
    ds_read_b128 a[136:139], v3 offset:28672
    v_cvt_pk_bf16_f32 v210, v196, v197
    v_mfma_f32_16x16x32_bf16 v[152:155], a[200:203], v[212:215], v[152:155]
    ds_read_b128 a[140:143], v4 offset:28672
    v_add_f32 v236, v236, v198
    v_mfma_f32_16x16x32_bf16 v[156:159], a[204:207], v[212:215], v[156:159]
    v_add_f32 v236, v236, v199
    v_cvt_pk_bf16_f32 v211, v198, v199
    s_movk_i32 s50, 24576
    v_mfma_f32_16x16x32_bf16 v[192:195], a[80:83], a[32:35], v[224:227]
    buffer_load_dwordx4 v243, s[64:67], s61 offen offset:2048 lds
    v_exp_f32 v200, v200
    v_mfma_f32_16x16x32_bf16 v[192:195], a[84:87], a[36:39], v[192:195]
    buffer_load_dwordx4 v244, s[64:67], s61 offen offset:3072 lds
    v_exp_f32 v201, v201
    v_mfma_f32_16x16x32_bf16 v[192:195], a[88:91], a[40:43], v[192:195]
    s_add_u32 m0, s45, 0
    ds_read_b64_tr_b16 a[176:177], v5 offset:24576
    v_add_f32 v237, v237, v200
    v_add_f32 v237, v237, v201
    v_mfma_f32_16x16x32_bf16 v[192:195], a[92:95], a[44:47], v[192:195]
    s_xor_b32 s61, s3, 32768
    v_exp_f32 v202, v202
    v_mfma_f32_16x16x32_bf16 v[196:199], a[96:99], a[32:35], v[224:227]
    buffer_load_dwordx4 v241, s[64:67], s61 offen offset:0 lds
    v_exp_f32 v203, v203
    v_mfma_f32_16x16x32_bf16 v[196:199], a[100:103], a[36:39], v[196:199]
    ds_read_b64_tr_b16 a[178:179], v5 offset:28672
    v_cvt_pk_bf16_f32 v212, v200, v201
    v_mfma_f32_16x16x32_bf16 v[196:199], a[104:107], a[40:43], v[196:199]
    ds_read_b64_tr_b16 a[180:181], v6 offset:24576
    v_add_f32 v237, v237, v202
    v_mfma_f32_16x16x32_bf16 v[196:199], a[108:111], a[44:47], v[196:199]
    buffer_store_dwordx4 a[208:211], v19, s[36:39], s50 offen sc1
    v_exp_f32 v204, v204
    v_mfma_f32_16x16x32_bf16 v[32:35], a[144:147], v[208:211], v[32:35]
    ds_read_b64_tr_b16 a[182:183], v6 offset:28672
    v_add_f32 v237, v237, v203
    v_cvt_pk_bf16_f32 v213, v202, v203
    v_mfma_f32_16x16x32_bf16 v[36:39], a[148:151], v[208:211], v[36:39]
    v_exp_f32 v205, v205
    v_mfma_f32_16x16x32_bf16 v[40:43], a[152:155], v[208:211], v[40:43]
    v_exp_f32 v206, v206
    v_mfma_f32_16x16x32_bf16 v[44:47], a[156:159], v[208:211], v[44:47]
    ds_read_b64_tr_b16 a[184:185], v7 offset:24576
    v_add_f32 v237, v237, v204
    v_add_f32 v237, v237, v205
    v_mfma_f32_16x16x32_bf16 v[48:51], a[160:163], v[208:211], v[48:51]
    v_exp_f32 v207, v207
    v_mfma_f32_16x16x32_bf16 v[52:55], a[164:167], v[208:211], v[52:55]
    ds_read_b64_tr_b16 a[186:187], v7 offset:28672
    v_cvt_pk_bf16_f32 v214, v204, v205
    v_mfma_f32_16x16x32_bf16 v[56:59], a[168:171], v[208:211], v[56:59]
    ds_read_b64_tr_b16 a[188:189], v8 offset:24576
    v_add_f32 v237, v237, v206
    v_mfma_f32_16x16x32_bf16 v[60:63], a[172:175], v[208:211], v[60:63]
    ds_read_b64_tr_b16 a[190:191], v8 offset:28672
    v_add_f32 v237, v237, v207
    v_cvt_pk_bf16_f32 v215, v206, v207
    s_waitcnt vmcnt(6)
    v_mfma_f32_16x16x32_bf16 v[200:203], a[80:83], a[48:51], v[228:231]
    ds_read_b64_tr_b16 a[192:193], v9 offset:24576
    ds_read_b64_tr_b16 a[194:195], v9 offset:28672
    v_exp_f32 v192, v192
    v_mfma_f32_16x16x32_bf16 v[200:203], a[84:87], a[52:55], v[200:203]
    ds_read_b64_tr_b16 a[196:197], v10 offset:24576
    v_exp_f32 v193, v193
    v_mfma_f32_16x16x32_bf16 v[200:203], a[88:91], a[56:59], v[200:203]
    ds_read_b64_tr_b16 a[198:199], v10 offset:28672
    ds_read_b64_tr_b16 a[200:201], v11 offset:24576
    v_add_f32 v238, v238, v192
    v_mfma_f32_16x16x32_bf16 v[200:203], a[92:95], a[60:63], v[200:203]
    ds_read_b64_tr_b16 a[202:203], v11 offset:28672
    v_exp_f32 v194, v194
    v_mfma_f32_16x16x32_bf16 v[204:207], a[96:99], a[48:51], v[228:231]
    ds_read_b64_tr_b16 a[204:205], v12 offset:24576
    ds_read_b64_tr_b16 a[206:207], v12 offset:28672
    v_add_f32 v238, v238, v193
    v_mfma_f32_16x16x32_bf16 v[204:207], a[100:103], a[52:55], v[204:207]
    ds_read_b64_tr_b16 a[208:209], v28 offset:0
    v_exp_f32 v195, v195
    v_mfma_f32_16x16x32_bf16 v[204:207], a[104:107], a[56:59], v[204:207]
    ds_read_b64_tr_b16 a[210:211], v28 offset:2048
    ds_read_b64_tr_b16 a[212:213], v29 offset:0
    v_cvt_pk_bf16_f32 v208, v192, v193
    v_mfma_f32_16x16x32_bf16 v[204:207], a[108:111], a[60:63], v[204:207]
    ds_read_b64_tr_b16 a[214:215], v29 offset:2048
    v_exp_f32 v196, v196
    v_mfma_f32_16x16x32_bf16 v[64:67], a[144:147], v[212:215], v[64:67]
    ds_read_b64_tr_b16 a[216:217], v30 offset:0
    ds_read_b64_tr_b16 a[218:219], v30 offset:2048
    v_add_f32 v238, v238, v194
    v_mfma_f32_16x16x32_bf16 v[68:71], a[148:151], v[212:215], v[68:71]
    buffer_load_dwordx4 v242, s[64:67], s61 offen offset:1024 lds
    v_exp_f32 v197, v197
    v_mfma_f32_16x16x32_bf16 v[72:75], a[152:155], v[212:215], v[72:75]
    buffer_load_dwordx4 v243, s[64:67], s61 offen offset:2048 lds
    v_add_f32 v238, v238, v195
    v_cvt_pk_bf16_f32 v209, v194, v195
    v_mfma_f32_16x16x32_bf16 v[76:79], a[156:159], v[212:215], v[76:79]
    buffer_load_dwordx4 v244, s[64:67], s61 offen offset:3072 lds
    v_exp_f32 v198, v198
    v_mfma_f32_16x16x32_bf16 v[80:83], a[160:163], v[212:215], v[80:83]
    v_add_f32 v238, v238, v196
    v_add_f32 v238, v238, v197
    v_mfma_f32_16x16x32_bf16 v[84:87], a[164:167], v[212:215], v[84:87]
    v_exp_f32 v199, v199
    v_mfma_f32_16x16x32_bf16 v[88:91], a[168:171], v[212:215], v[88:91]
    s_waitcnt vmcnt(51) lgkmcnt(0)
    v_cvt_pk_bf16_f32 v210, v196, v197
    v_add_f32 v238, v238, v198
    v_mfma_f32_16x16x32_bf16 v[92:95], a[172:175], v[212:215], v[92:95]
    s_barrier
    v_add_f32 v238, v238, v199
    v_cvt_pk_bf16_f32 v211, v198, v199
    s_waitcnt vmcnt(5)
    v_mfma_f32_16x16x32_bf16 v[192:195], a[112:115], a[0:3], v[216:219]
    s_add_u32 m0, s45, 65536
    v_exp_f32 v200, v200
    v_mfma_f32_16x16x32_bf16 v[192:195], a[116:119], a[4:7], v[192:195]
    s_xor_b32 s61, s3, 32896
    v_exp_f32 v201, v201
    v_mfma_f32_16x16x32_bf16 v[192:195], a[120:123], a[8:11], v[192:195]
    ds_read_b128 a[80:83], v1 offset:32768
    v_add_f32 v239, v239, v200
    v_add_f32 v239, v239, v201
    v_mfma_f32_16x16x32_bf16 v[192:195], a[124:127], a[12:15], v[192:195]
    buffer_load_dwordx4 v241, s[64:67], s61 offen offset:0 lds
    v_exp_f32 v202, v202
    v_mfma_f32_16x16x32_bf16 v[196:199], a[128:131], a[0:3], v[216:219]
    buffer_load_dwordx4 v242, s[64:67], s61 offen offset:1024 lds
    v_exp_f32 v203, v203
    v_mfma_f32_16x16x32_bf16 v[196:199], a[132:135], a[4:7], v[196:199]
    ds_read_b128 a[84:87], v2 offset:32768
    ds_read_b128 a[88:91], v3 offset:32768
    v_cvt_pk_bf16_f32 v212, v200, v201
    v_mfma_f32_16x16x32_bf16 v[196:199], a[136:139], a[8:11], v[196:199]
    ds_read_b128 a[92:95], v4 offset:32768
    ds_read_b64_tr_b16 a[220:221], v31 offset:0
    v_add_f32 v239, v239, v202
    v_mfma_f32_16x16x32_bf16 v[196:199], a[140:143], a[12:15], v[196:199]
    buffer_load_dwordx4 v243, s[64:67], s61 offen offset:2048 lds
    v_exp_f32 v204, v204
    v_mfma_f32_16x16x32_bf16 v[96:99], a[144:147], v[208:211], v[96:99]
    ds_read_b64_tr_b16 a[222:223], v31 offset:2048
    v_add_f32 v239, v239, v203
    v_cvt_pk_bf16_f32 v213, v202, v203
    v_mfma_f32_16x16x32_bf16 v[100:103], a[148:151], v[208:211], v[100:103]
    v_exp_f32 v205, v205
    v_mfma_f32_16x16x32_bf16 v[104:107], a[152:155], v[208:211], v[104:107]
    v_exp_f32 v206, v206
    v_mfma_f32_16x16x32_bf16 v[108:111], a[156:159], v[208:211], v[108:111]
    ds_read_b64_tr_b16 a[224:225], v28 offset:4096
    v_add_f32 v239, v239, v204
    v_add_f32 v239, v239, v205
    v_mfma_f32_16x16x32_bf16 v[112:115], a[160:163], v[208:211], v[112:115]
    v_exp_f32 v207, v207
    v_mfma_f32_16x16x32_bf16 v[116:119], a[164:167], v[208:211], v[116:119]
    ds_read_b64_tr_b16 a[226:227], v28 offset:6144
    v_cvt_pk_bf16_f32 v214, v204, v205
    v_mfma_f32_16x16x32_bf16 v[120:123], a[168:171], v[208:211], v[120:123]
    ds_read_b64_tr_b16 a[228:229], v29 offset:4096
    v_add_f32 v239, v239, v206
    v_mfma_f32_16x16x32_bf16 v[124:127], a[172:175], v[208:211], v[124:127]
    ds_read_b64_tr_b16 a[230:231], v29 offset:6144
    v_add_f32 v239, v239, v207
    v_cvt_pk_bf16_f32 v215, v206, v207
    s_waitcnt vmcnt(3)
    v_add_u32 v254, 0x20000, v254
    v_mfma_f32_16x16x32_bf16 v[200:203], a[112:115], a[16:19], v[220:223]
    buffer_load_dwordx4 v244, s[64:67], s61 offen offset:3072 lds
    v_exp_f32 v192, v192
    v_mfma_f32_16x16x32_bf16 v[200:203], a[116:119], a[20:23], v[200:203]
    s_add_u32 m0, s45, 16384
    v_exp_f32 v193, v193
    v_mfma_f32_16x16x32_bf16 v[200:203], a[120:123], a[24:27], v[200:203]
    s_xor_b32 s61, s3, 65536
    ds_read_b128 a[96:99], v1 offset:36864
    v_add_f32 v236, v236, v192
    v_add_f32 v236, v236, v193
    v_mfma_f32_16x16x32_bf16 v[200:203], a[124:127], a[28:31], v[200:203]
    buffer_load_dwordx4 v241, s[64:67], s61 offen offset:0 lds
    v_exp_f32 v194, v194
    v_mfma_f32_16x16x32_bf16 v[204:207], a[128:131], a[16:19], v[220:223]
    buffer_load_dwordx4 v242, s[64:67], s61 offen offset:1024 lds
    v_exp_f32 v195, v195
    v_mfma_f32_16x16x32_bf16 v[204:207], a[132:135], a[20:23], v[204:207]
    ds_read_b128 a[100:103], v2 offset:36864
    ds_read_b128 a[104:107], v3 offset:36864
    v_cvt_pk_bf16_f32 v208, v192, v193
    v_mfma_f32_16x16x32_bf16 v[204:207], a[136:139], a[24:27], v[204:207]
    ds_read_b128 a[108:111], v4 offset:36864
    ds_read_b64_tr_b16 a[232:233], v30 offset:4096
    v_add_f32 v236, v236, v194
    v_mfma_f32_16x16x32_bf16 v[204:207], a[140:143], a[28:31], v[204:207]
    global_load_dword v251, v254, s[12:13]
    v_exp_f32 v196, v196
    v_mfma_f32_16x16x32_bf16 v[128:131], a[144:147], v[212:215], v[128:131]
    ds_read_b64_tr_b16 a[234:235], v30 offset:6144
    v_add_f32 v236, v236, v195
    v_cvt_pk_bf16_f32 v209, v194, v195
    v_mfma_f32_16x16x32_bf16 v[132:135], a[148:151], v[212:215], v[132:135]
    v_exp_f32 v197, v197
    v_mfma_f32_16x16x32_bf16 v[136:139], a[152:155], v[212:215], v[136:139]
    v_exp_f32 v198, v198
    v_mfma_f32_16x16x32_bf16 v[140:143], a[156:159], v[212:215], v[140:143]
    ds_read_b64_tr_b16 a[236:237], v31 offset:4096
    v_add_f32 v236, v236, v196
    v_add_f32 v236, v236, v197
    v_mfma_f32_16x16x32_bf16 v[144:147], a[160:163], v[212:215], v[144:147]
    v_exp_f32 v199, v199
    v_mfma_f32_16x16x32_bf16 v[148:151], a[164:167], v[212:215], v[148:151]
    ds_read_b64_tr_b16 a[238:239], v31 offset:6144
    v_cvt_pk_bf16_f32 v210, v196, v197
    v_mfma_f32_16x16x32_bf16 v[152:155], a[168:171], v[212:215], v[152:155]
    ds_read_b64_tr_b16 a[240:241], v20 offset:0
    v_add_f32 v236, v236, v198
    v_mfma_f32_16x16x32_bf16 v[156:159], a[172:175], v[212:215], v[156:159]
    ds_read_b64_tr_b16 a[242:243], v20 offset:2048
    v_add_f32 v236, v236, v199
    v_cvt_pk_bf16_f32 v211, v198, v199
    v_mfma_f32_16x16x32_bf16 v[192:195], a[112:115], a[32:35], v[224:227]
    buffer_load_dwordx4 v243, s[64:67], s61 offen offset:2048 lds
    v_exp_f32 v200, v200
    v_mfma_f32_16x16x32_bf16 v[192:195], a[116:119], a[36:39], v[192:195]
    buffer_load_dwordx4 v244, s[64:67], s61 offen offset:3072 lds
    v_exp_f32 v201, v201
    v_mfma_f32_16x16x32_bf16 v[192:195], a[120:123], a[40:43], v[192:195]
    s_add_u32 m0, s45, 81920
    ds_read_b64_tr_b16 a[144:145], v5 offset:32768
    ds_read_b64_tr_b16 a[146:147], v5 offset:36864
    v_add_f32 v237, v237, v200
    v_add_f32 v237, v237, v201
    v_mfma_f32_16x16x32_bf16 v[192:195], a[124:127], a[44:47], v[192:195]
    s_xor_b32 s61, s3, 65664
    v_exp_f32 v202, v202
    v_mfma_f32_16x16x32_bf16 v[196:199], a[128:131], a[32:35], v[224:227]
    buffer_load_dwordx4 v241, s[64:67], s61 offen offset:0 lds
    v_exp_f32 v203, v203
    v_mfma_f32_16x16x32_bf16 v[196:199], a[132:135], a[36:39], v[196:199]
    ds_read_b64_tr_b16 a[148:149], v6 offset:32768
    ds_read_b64_tr_b16 a[150:151], v6 offset:36864
    v_cvt_pk_bf16_f32 v212, v200, v201
    v_mfma_f32_16x16x32_bf16 v[196:199], a[136:139], a[40:43], v[196:199]
    ds_read_b64_tr_b16 a[152:153], v7 offset:32768
    ds_read_b64_tr_b16 a[154:155], v7 offset:36864
    v_add_f32 v237, v237, v202
    v_mfma_f32_16x16x32_bf16 v[196:199], a[140:143], a[44:47], v[196:199]
    v_exp_f32 v204, v204
    v_mfma_f32_16x16x32_bf16 v[32:35], a[176:179], v[208:211], v[32:35]
    ds_read_b64_tr_b16 a[156:157], v8 offset:32768
    ds_read_b64_tr_b16 a[158:159], v8 offset:36864
    v_add_f32 v237, v237, v203
    v_cvt_pk_bf16_f32 v213, v202, v203
    v_mfma_f32_16x16x32_bf16 v[36:39], a[180:183], v[208:211], v[36:39]
    v_exp_f32 v205, v205
    v_mfma_f32_16x16x32_bf16 v[40:43], a[184:187], v[208:211], v[40:43]
    v_exp_f32 v206, v206
    v_mfma_f32_16x16x32_bf16 v[44:47], a[188:191], v[208:211], v[44:47]
    ds_read_b64_tr_b16 a[244:245], v21 offset:0
    v_add_f32 v237, v237, v204
    v_add_f32 v237, v237, v205
    v_mfma_f32_16x16x32_bf16 v[48:51], a[192:195], v[208:211], v[48:51]
    v_exp_f32 v207, v207
    v_mfma_f32_16x16x32_bf16 v[52:55], a[196:199], v[208:211], v[52:55]
    ds_read_b64_tr_b16 a[246:247], v21 offset:2048
    ds_read_b64_tr_b16 a[248:249], v22 offset:0
    v_cvt_pk_bf16_f32 v214, v204, v205
    v_mfma_f32_16x16x32_bf16 v[56:59], a[200:203], v[208:211], v[56:59]
    ds_read_b64_tr_b16 a[250:251], v22 offset:2048
    ds_read_b64_tr_b16 a[252:253], v23 offset:0
    v_add_f32 v237, v237, v206
    v_mfma_f32_16x16x32_bf16 v[60:63], a[204:207], v[208:211], v[60:63]
    ds_read_b64_tr_b16 a[254:255], v23 offset:2048
    v_add_f32 v237, v237, v207
    v_cvt_pk_bf16_f32 v215, v206, v207
    v_mfma_f32_16x16x32_bf16 v[200:203], a[112:115], a[48:51], v[228:231]
    buffer_load_dwordx4 v242, s[64:67], s61 offen offset:1024 lds
    v_exp_f32 v192, v192
    v_mfma_f32_16x16x32_bf16 v[200:203], a[116:119], a[52:55], v[200:203]
    buffer_load_dwordx4 v243, s[64:67], s61 offen offset:2048 lds
    v_exp_f32 v193, v193
    v_mfma_f32_16x16x32_bf16 v[200:203], a[120:123], a[56:59], v[200:203]
    ds_read_b64_tr_b16 a[160:161], v9 offset:32768
    ds_read_b64_tr_b16 a[162:163], v9 offset:36864
    v_add_f32 v238, v238, v192
    v_mfma_f32_16x16x32_bf16 v[200:203], a[124:127], a[60:63], v[200:203]
    buffer_load_dwordx4 v244, s[64:67], s61 offen offset:3072 lds
    v_exp_f32 v194, v194
    v_mfma_f32_16x16x32_bf16 v[204:207], a[128:131], a[48:51], v[228:231]
    ds_read_b64_tr_b16 a[164:165], v10 offset:32768
    ds_read_b64_tr_b16 a[166:167], v10 offset:36864
    v_add_f32 v238, v238, v193
    v_mfma_f32_16x16x32_bf16 v[204:207], a[132:135], a[52:55], v[204:207]
    v_exp_f32 v195, v195
    v_mfma_f32_16x16x32_bf16 v[204:207], a[136:139], a[56:59], v[204:207]
    ds_read_b64_tr_b16 a[168:169], v11 offset:32768
    ds_read_b64_tr_b16 a[170:171], v11 offset:36864
    v_cvt_pk_bf16_f32 v208, v192, v193
    v_mfma_f32_16x16x32_bf16 v[204:207], a[140:143], a[60:63], v[204:207]
    v_exp_f32 v196, v196
    v_mfma_f32_16x16x32_bf16 v[64:67], a[176:179], v[212:215], v[64:67]
    ds_read_b64_tr_b16 a[172:173], v12 offset:32768
    ds_read_b64_tr_b16 a[174:175], v12 offset:36864
    v_add_f32 v238, v238, v194
    v_mfma_f32_16x16x32_bf16 v[68:71], a[180:183], v[212:215], v[68:71]
    v_exp_f32 v197, v197
    v_mfma_f32_16x16x32_bf16 v[72:75], a[184:187], v[212:215], v[72:75]
    v_add_f32 v238, v238, v195
    v_cvt_pk_bf16_f32 v209, v194, v195
    v_mfma_f32_16x16x32_bf16 v[76:79], a[188:191], v[212:215], v[76:79]
    v_exp_f32 v198, v198
    v_mfma_f32_16x16x32_bf16 v[80:83], a[192:195], v[212:215], v[80:83]
    v_add_f32 v238, v238, v196
    v_add_f32 v238, v238, v197
    v_mfma_f32_16x16x32_bf16 v[84:87], a[196:199], v[212:215], v[84:87]
    v_exp_f32 v199, v199
    v_mfma_f32_16x16x32_bf16 v[88:91], a[200:203], v[212:215], v[88:91]
    v_cvt_pk_bf16_f32 v210, v196, v197
    v_add_f32 v238, v238, v198
    v_mfma_f32_16x16x32_bf16 v[92:95], a[204:207], v[212:215], v[92:95]
    s_waitcnt lgkmcnt(0)
    v_add_f32 v238, v238, v199
    v_cvt_pk_bf16_f32 v211, v198, v199
    s_cmp_eq_u32 s54, 0
    s_cbranch_scc1 L_regw_b
L_rdy_b:
    v_mov_b32 v252, s58
    s_waitcnt vmcnt(16)
    global_store_dword v250, v252, s[78:79] sc1
    v_mfma_f32_16x16x32_bf16 v[192:195], a[80:83], a[0:3], v[216:219]
    s_add_u32 m0, s63, 0
    v_exp_f32 v200, v200
    v_mfma_f32_16x16x32_bf16 v[192:195], a[84:87], a[4:7], v[192:195]
    s_xor_b32 s61, s3, 98304
    v_exp_f32 v201, v201
    v_mfma_f32_16x16x32_bf16 v[192:195], a[88:91], a[8:11], v[192:195]
    buffer_load_dwordx4 v241, s[64:67], s61 offen offset:0 lds
    v_add_f32 v239, v239, v200
    v_add_f32 v239, v239, v201
    v_mfma_f32_16x16x32_bf16 v[192:195], a[92:95], a[12:15], v[192:195]
    buffer_load_dwordx4 v242, s[64:67], s61 offen offset:1024 lds
    v_exp_f32 v202, v202
    v_mfma_f32_16x16x32_bf16 v[196:199], a[96:99], a[0:3], v[216:219]
    buffer_load_dwordx4 v243, s[64:67], s61 offen offset:2048 lds
    v_exp_f32 v203, v203
    v_mfma_f32_16x16x32_bf16 v[196:199], a[100:103], a[4:7], v[196:199]
    ds_read_b128 a[112:115], v1 offset:40960
    v_cvt_pk_bf16_f32 v212, v200, v201
    v_mfma_f32_16x16x32_bf16 v[196:199], a[104:107], a[8:11], v[196:199]
    ds_read_b128 a[116:119], v2 offset:40960
    v_add_f32 v239, v239, v202
    v_mfma_f32_16x16x32_bf16 v[196:199], a[108:111], a[12:15], v[196:199]
    v_exp_f32 v204, v204
    v_mfma_f32_16x16x32_bf16 v[96:99], a[176:179], v[208:211], v[96:99]
    v_add_f32 v239, v239, v203
    v_cvt_pk_bf16_f32 v213, v202, v203
    v_mfma_f32_16x16x32_bf16 v[100:103], a[180:183], v[208:211], v[100:103]
    v_exp_f32 v205, v205
    v_mfma_f32_16x16x32_bf16 v[104:107], a[184:187], v[208:211], v[104:107]
    v_exp_f32 v206, v206
    v_mfma_f32_16x16x32_bf16 v[108:111], a[188:191], v[208:211], v[108:111]
    v_add_f32 v239, v239, v204
    v_add_f32 v239, v239, v205
    v_mfma_f32_16x16x32_bf16 v[112:115], a[192:195], v[208:211], v[112:115]
    v_exp_f32 v207, v207
    v_mfma_f32_16x16x32_bf16 v[116:119], a[196:199], v[208:211], v[116:119]
    ds_read_b128 a[120:123], v3 offset:40960
    v_cvt_pk_bf16_f32 v214, v204, v205
    v_mfma_f32_16x16x32_bf16 v[120:123], a[200:203], v[208:211], v[120:123]
    ds_read_b128 a[124:127], v4 offset:40960
    v_add_f32 v239, v239, v206
    v_mfma_f32_16x16x32_bf16 v[124:127], a[204:207], v[208:211], v[124:127]
    v_add_f32 v239, v239, v207
    v_cvt_pk_bf16_f32 v215, v206, v207
    v_mfma_f32_16x16x32_bf16 v[200:203], a[80:83], a[16:19], v[220:223]
    buffer_load_dwordx4 v244, s[64:67], s61 offen offset:3072 lds
    v_exp_f32 v192, v192
    v_mfma_f32_16x16x32_bf16 v[200:203], a[84:87], a[20:23], v[200:203]
    s_add_u32 m0, s63, 4096
    v_exp_f32 v193, v193
    v_mfma_f32_16x16x32_bf16 v[200:203], a[88:91], a[24:27], v[200:203]
    s_xor_b32 s61, s3, 98432
    v_add_f32 v236, v236, v192
    v_add_f32 v236, v236, v193
    v_mfma_f32_16x16x32_bf16 v[200:203], a[92:95], a[28:31], v[200:203]
    buffer_load_dwordx4 v241, s[64:67], s61 offen offset:0 lds
    v_exp_f32 v194, v194
    v_mfma_f32_16x16x32_bf16 v[204:207], a[96:99], a[16:19], v[220:223]
    buffer_load_dwordx4 v242, s[64:67], s61 offen offset:1024 lds
    v_exp_f32 v195, v195
    v_mfma_f32_16x16x32_bf16 v[204:207], a[100:103], a[20:23], v[204:207]
    ds_read_b128 a[128:131], v1 offset:45056
    v_cvt_pk_bf16_f32 v208, v192, v193
    v_mfma_f32_16x16x32_bf16 v[204:207], a[104:107], a[24:27], v[204:207]
    ds_read_b128 a[132:135], v2 offset:45056
    v_add_f32 v236, v236, v194
    v_mfma_f32_16x16x32_bf16 v[204:207], a[108:111], a[28:31], v[204:207]
    v_exp_f32 v196, v196
    v_mfma_f32_16x16x32_bf16 v[128:131], a[176:179], v[212:215], v[128:131]
    v_add_f32 v236, v236, v195
    v_cvt_pk_bf16_f32 v209, v194, v195
    v_mfma_f32_16x16x32_bf16 v[132:135], a[180:183], v[212:215], v[132:135]
    v_exp_f32 v197, v197
    v_mfma_f32_16x16x32_bf16 v[136:139], a[184:187], v[212:215], v[136:139]
    v_exp_f32 v198, v198
    v_mfma_f32_16x16x32_bf16 v[140:143], a[188:191], v[212:215], v[140:143]
    v_add_f32 v236, v236, v196
    v_add_f32 v236, v236, v197
    v_mfma_f32_16x16x32_bf16 v[144:147], a[192:195], v[212:215], v[144:147]
    v_exp_f32 v199, v199
    v_mfma_f32_16x16x32_bf16 v[148:151], a[196:199], v[212:215], v[148:151]
    ds_read_b128 a[136:139], v3 offset:45056
    v_cvt_pk_bf16_f32 v210, v196, v197
    v_mfma_f32_16x16x32_bf16 v[152:155], a[200:203], v[212:215], v[152:155]
    ds_read_b128 a[140:143], v4 offset:45056
    v_add_f32 v236, v236, v198
    v_mfma_f32_16x16x32_bf16 v[156:159], a[204:207], v[212:215], v[156:159]
    v_add_f32 v236, v236, v199
    v_cvt_pk_bf16_f32 v211, v198, v199
    v_mfma_f32_16x16x32_bf16 v[192:195], a[80:83], a[32:35], v[224:227]
    buffer_load_dwordx4 v243, s[64:67], s61 offen offset:2048 lds
    v_exp_f32 v200, v200
    v_mfma_f32_16x16x32_bf16 v[192:195], a[84:87], a[36:39], v[192:195]
    buffer_load_dwordx4 v244, s[64:67], s61 offen offset:3072 lds
    v_exp_f32 v201, v201
    v_mfma_f32_16x16x32_bf16 v[192:195], a[88:91], a[40:43], v[192:195]
    s_add_u32 m0, s45, 0
    ds_read_b64_tr_b16 a[176:177], v5 offset:40960
    v_add_f32 v237, v237, v200
    v_add_f32 v237, v237, v201
    v_mfma_f32_16x16x32_bf16 v[192:195], a[92:95], a[44:47], v[192:195]
    s_xor_b32 s61, s3, 131072
    v_exp_f32 v202, v202
    v_mfma_f32_16x16x32_bf16 v[196:199], a[96:99], a[32:35], v[224:227]
    buffer_load_dwordx4 v241, s[64:67], s61 offen offset:0 lds
    v_exp_f32 v203, v203
    v_mfma_f32_16x16x32_bf16 v[196:199], a[100:103], a[36:39], v[196:199]
    ds_read_b64_tr_b16 a[178:179], v5 offset:45056
    v_cvt_pk_bf16_f32 v212, v200, v201
    v_mfma_f32_16x16x32_bf16 v[196:199], a[104:107], a[40:43], v[196:199]
    ds_read_b64_tr_b16 a[180:181], v6 offset:40960
    v_add_f32 v237, v237, v202
    v_mfma_f32_16x16x32_bf16 v[196:199], a[108:111], a[44:47], v[196:199]
    v_exp_f32 v204, v204
    v_mfma_f32_16x16x32_bf16 v[32:35], a[144:147], v[208:211], v[32:35]
    ds_read_b64_tr_b16 a[182:183], v6 offset:45056
    v_add_f32 v237, v237, v203
    v_cvt_pk_bf16_f32 v213, v202, v203
    v_mfma_f32_16x16x32_bf16 v[36:39], a[148:151], v[208:211], v[36:39]
    v_exp_f32 v205, v205
    v_mfma_f32_16x16x32_bf16 v[40:43], a[152:155], v[208:211], v[40:43]
    v_exp_f32 v206, v206
    v_mfma_f32_16x16x32_bf16 v[44:47], a[156:159], v[208:211], v[44:47]
    ds_read_b64_tr_b16 a[184:185], v7 offset:40960
    v_add_f32 v237, v237, v204
    v_add_f32 v237, v237, v205
    v_mfma_f32_16x16x32_bf16 v[48:51], a[160:163], v[208:211], v[48:51]
    v_exp_f32 v207, v207
    v_mfma_f32_16x16x32_bf16 v[52:55], a[164:167], v[208:211], v[52:55]
    ds_read_b64_tr_b16 a[186:187], v7 offset:45056
    v_cvt_pk_bf16_f32 v214, v204, v205
    v_mfma_f32_16x16x32_bf16 v[56:59], a[168:171], v[208:211], v[56:59]
    ds_read_b64_tr_b16 a[188:189], v8 offset:40960
    v_add_f32 v237, v237, v206
    v_mfma_f32_16x16x32_bf16 v[60:63], a[172:175], v[208:211], v[60:63]
    ds_read_b64_tr_b16 a[190:191], v8 offset:45056
    v_add_f32 v237, v237, v207
    v_cvt_pk_bf16_f32 v215, v206, v207
    v_add_u32 v254, 0x20000, v254
    v_mfma_f32_16x16x32_bf16 v[200:203], a[80:83], a[48:51], v[228:231]
    buffer_load_dwordx4 v242, s[64:67], s61 offen offset:1024 lds
    v_exp_f32 v192, v192
    v_mfma_f32_16x16x32_bf16 v[200:203], a[84:87], a[52:55], v[200:203]
    buffer_load_dwordx4 v243, s[64:67], s61 offen offset:2048 lds
    v_exp_f32 v193, v193
    v_mfma_f32_16x16x32_bf16 v[200:203], a[88:91], a[56:59], v[200:203]
    ds_read_b64_tr_b16 a[192:193], v9 offset:40960
    ds_read_b64_tr_b16 a[194:195], v9 offset:45056
    v_add_f32 v238, v238, v192
    v_mfma_f32_16x16x32_bf16 v[200:203], a[92:95], a[60:63], v[200:203]
    buffer_load_dwordx4 v244, s[64:67], s61 offen offset:3072 lds
    v_exp_f32 v194, v194
    v_mfma_f32_16x16x32_bf16 v[204:207], a[96:99], a[48:51], v[228:231]
    ds_read_b64_tr_b16 a[196:197], v10 offset:40960
    ds_read_b64_tr_b16 a[198:199], v10 offset:45056
    v_add_f32 v238, v238, v193
    v_mfma_f32_16x16x32_bf16 v[204:207], a[100:103], a[52:55], v[204:207]
    global_load_dword v251, v254, s[12:13]
    v_exp_f32 v195, v195
    v_mfma_f32_16x16x32_bf16 v[204:207], a[104:107], a[56:59], v[204:207]
    ds_read_b64_tr_b16 a[200:201], v11 offset:40960
    ds_read_b64_tr_b16 a[202:203], v11 offset:45056
    v_cvt_pk_bf16_f32 v208, v192, v193
    v_mfma_f32_16x16x32_bf16 v[204:207], a[108:111], a[60:63], v[204:207]
    v_exp_f32 v196, v196
    v_mfma_f32_16x16x32_bf16 v[64:67], a[144:147], v[212:215], v[64:67]
    ds_read_b64_tr_b16 a[204:205], v12 offset:40960
    ds_read_b64_tr_b16 a[206:207], v12 offset:45056
    v_add_f32 v238, v238, v194
    v_mfma_f32_16x16x32_bf16 v[68:71], a[148:151], v[212:215], v[68:71]
    v_exp_f32 v197, v197
    v_mfma_f32_16x16x32_bf16 v[72:75], a[152:155], v[212:215], v[72:75]
    v_add_f32 v238, v238, v195
    v_cvt_pk_bf16_f32 v209, v194, v195
    v_mfma_f32_16x16x32_bf16 v[76:79], a[156:159], v[212:215], v[76:79]
    v_exp_f32 v198, v198
    v_mfma_f32_16x16x32_bf16 v[80:83], a[160:163], v[212:215], v[80:83]
    v_add_f32 v238, v238, v196
    v_add_f32 v238, v238, v197
    v_mfma_f32_16x16x32_bf16 v[84:87], a[164:167], v[212:215], v[84:87]
    v_exp_f32 v199, v199
    v_mfma_f32_16x16x32_bf16 v[88:91], a[168:171], v[212:215], v[88:91]
    s_waitcnt vmcnt(44) lgkmcnt(0)
    v_cvt_pk_bf16_f32 v210, v196, v197
    v_add_f32 v238, v238, v198
    v_mfma_f32_16x16x32_bf16 v[92:95], a[172:175], v[212:215], v[92:95]
    s_barrier
    v_add_f32 v238, v238, v199
    v_cvt_pk_bf16_f32 v211, v198, v199
    v_mfma_f32_16x16x32_bf16 v[192:195], a[112:115], a[0:3], v[216:219]
    s_add_u32 m0, s45, 32768
    v_exp_f32 v200, v200
    v_mfma_f32_16x16x32_bf16 v[192:195], a[116:119], a[4:7], v[192:195]
    s_xor_b32 s61, s3, 131200
    v_exp_f32 v201, v201
    v_mfma_f32_16x16x32_bf16 v[192:195], a[120:123], a[8:11], v[192:195]
    buffer_load_dwordx4 v241, s[64:67], s61 offen offset:0 lds
    v_add_f32 v239, v239, v200
    v_add_f32 v239, v239, v201
    v_mfma_f32_16x16x32_bf16 v[192:195], a[124:127], a[12:15], v[192:195]
    buffer_load_dwordx4 v242, s[64:67], s61 offen offset:1024 lds
    v_exp_f32 v202, v202
    v_mfma_f32_16x16x32_bf16 v[196:199], a[128:131], a[0:3], v[216:219]
    buffer_load_dwordx4 v243, s[64:67], s61 offen offset:2048 lds
    v_exp_f32 v203, v203
    v_mfma_f32_16x16x32_bf16 v[196:199], a[132:135], a[4:7], v[196:199]
    ds_read_b128 a[80:83], v1 offset:49152
    v_cvt_pk_bf16_f32 v212, v200, v201
    v_mfma_f32_16x16x32_bf16 v[196:199], a[136:139], a[8:11], v[196:199]
    ds_read_b128 a[84:87], v2 offset:49152
    v_add_f32 v239, v239, v202
    v_mfma_f32_16x16x32_bf16 v[196:199], a[140:143], a[12:15], v[196:199]
    v_exp_f32 v204, v204
    v_mfma_f32_16x16x32_bf16 v[96:99], a[144:147], v[208:211], v[96:99]
    v_add_f32 v239, v239, v203
    v_cvt_pk_bf16_f32 v213, v202, v203
    v_mfma_f32_16x16x32_bf16 v[100:103], a[148:151], v[208:211], v[100:103]
    v_exp_f32 v205, v205
    v_mfma_f32_16x16x32_bf16 v[104:107], a[152:155], v[208:211], v[104:107]
    v_exp_f32 v206, v206
    v_mfma_f32_16x16x32_bf16 v[108:111], a[156:159], v[208:211], v[108:111]
    v_add_f32 v239, v239, v204
    v_add_f32 v239, v239, v205
    v_mfma_f32_16x16x32_bf16 v[112:115], a[160:163], v[208:211], v[112:115]
    v_exp_f32 v207, v207
    v_mfma_f32_16x16x32_bf16 v[116:119], a[164:167], v[208:211], v[116:119]
    ds_read_b128 a[88:91], v3 offset:49152
    v_cvt_pk_bf16_f32 v214, v204, v205
    v_mfma_f32_16x16x32_bf16 v[120:123], a[168:171], v[208:211], v[120:123]
    ds_read_b128 a[92:95], v4 offset:49152
    v_add_f32 v239, v239, v206
    v_mfma_f32_16x16x32_bf16 v[124:127], a[172:175], v[208:211], v[124:127]
    v_add_f32 v239, v239, v207
    v_cvt_pk_bf16_f32 v215, v206, v207
    v_mfma_f32_16x16x32_bf16 v[200:203], a[112:115], a[16:19], v[220:223]
    buffer_load_dwordx4 v244, s[64:67], s61 offen offset:3072 lds
    v_exp_f32 v192, v192
    v_mfma_f32_16x16x32_bf16 v[200:203], a[116:119], a[20:23], v[200:203]
    s_add_u32 m0, s45, 98304
    v_exp_f32 v193, v193
    v_mfma_f32_16x16x32_bf16 v[200:203], a[120:123], a[24:27], v[200:203]
    s_xor_b32 s61, s3, 163840
    v_add_f32 v236, v236, v192
    v_add_f32 v236, v236, v193
    v_mfma_f32_16x16x32_bf16 v[200:203], a[124:127], a[28:31], v[200:203]
    buffer_load_dwordx4 v241, s[64:67], s61 offen offset:0 lds
    v_exp_f32 v194, v194
    v_mfma_f32_16x16x32_bf16 v[204:207], a[128:131], a[16:19], v[220:223]
    buffer_load_dwordx4 v242, s[64:67], s61 offen offset:1024 lds
    v_exp_f32 v195, v195
    v_mfma_f32_16x16x32_bf16 v[204:207], a[132:135], a[20:23], v[204:207]
    ds_read_b128 a[96:99], v1 offset:53248
    v_cvt_pk_bf16_f32 v208, v192, v193
    v_mfma_f32_16x16x32_bf16 v[204:207], a[136:139], a[24:27], v[204:207]
    ds_read_b128 a[100:103], v2 offset:53248
    v_add_f32 v236, v236, v194
    v_mfma_f32_16x16x32_bf16 v[204:207], a[140:143], a[28:31], v[204:207]
    v_exp_f32 v196, v196
    v_mfma_f32_16x16x32_bf16 v[128:131], a[144:147], v[212:215], v[128:131]
    v_add_f32 v236, v236, v195
    v_cvt_pk_bf16_f32 v209, v194, v195
    v_mfma_f32_16x16x32_bf16 v[132:135], a[148:151], v[212:215], v[132:135]
    v_exp_f32 v197, v197
    v_mfma_f32_16x16x32_bf16 v[136:139], a[152:155], v[212:215], v[136:139]
    v_exp_f32 v198, v198
    v_mfma_f32_16x16x32_bf16 v[140:143], a[156:159], v[212:215], v[140:143]
    v_add_f32 v236, v236, v196
    v_add_f32 v236, v236, v197
    v_mfma_f32_16x16x32_bf16 v[144:147], a[160:163], v[212:215], v[144:147]
    v_exp_f32 v199, v199
    v_mfma_f32_16x16x32_bf16 v[148:151], a[164:167], v[212:215], v[148:151]
    ds_read_b128 a[104:107], v3 offset:53248
    v_cvt_pk_bf16_f32 v210, v196, v197
    v_mfma_f32_16x16x32_bf16 v[152:155], a[168:171], v[212:215], v[152:155]
    ds_read_b128 a[108:111], v4 offset:53248
    v_add_f32 v236, v236, v198
    v_mfma_f32_16x16x32_bf16 v[156:159], a[172:175], v[212:215], v[156:159]
    v_add_f32 v236, v236, v199
    v_cvt_pk_bf16_f32 v211, v198, v199
    v_mfma_f32_16x16x32_bf16 v[192:195], a[112:115], a[32:35], v[224:227]
    buffer_load_dwordx4 v243, s[64:67], s61 offen offset:2048 lds
    v_exp_f32 v200, v200
    v_mfma_f32_16x16x32_bf16 v[192:195], a[116:119], a[36:39], v[192:195]
    buffer_load_dwordx4 v244, s[64:67], s61 offen offset:3072 lds
    v_exp_f32 v201, v201
    v_mfma_f32_16x16x32_bf16 v[192:195], a[120:123], a[40:43], v[192:195]
    ds_read_b64_tr_b16 a[144:145], v5 offset:49152
    v_add_f32 v237, v237, v200
    v_add_f32 v237, v237, v201
    v_mfma_f32_16x16x32_bf16 v[192:195], a[124:127], a[44:47], v[192:195]
    v_exp_f32 v202, v202
    v_mfma_f32_16x16x32_bf16 v[196:199], a[128:131], a[32:35], v[224:227]
    v_exp_f32 v203, v203
    v_mfma_f32_16x16x32_bf16 v[196:199], a[132:135], a[36:39], v[196:199]
    ds_read_b64_tr_b16 a[146:147], v5 offset:53248
    v_cvt_pk_bf16_f32 v212, v200, v201
    v_mfma_f32_16x16x32_bf16 v[196:199], a[136:139], a[40:43], v[196:199]
    ds_read_b64_tr_b16 a[148:149], v6 offset:49152
    v_add_f32 v237, v237, v202
    v_mfma_f32_16x16x32_bf16 v[196:199], a[140:143], a[44:47], v[196:199]
    v_exp_f32 v204, v204
    v_mfma_f32_16x16x32_bf16 v[32:35], a[176:179], v[208:211], v[32:35]
    ds_read_b64_tr_b16 a[150:151], v6 offset:53248
    v_add_f32 v237, v237, v203
    v_cvt_pk_bf16_f32 v213, v202, v203
    v_mfma_f32_16x16x32_bf16 v[36:39], a[180:183], v[208:211], v[36:39]
    v_exp_f32 v205, v205
    v_mfma_f32_16x16x32_bf16 v[40:43], a[184:187], v[208:211], v[40:43]
    v_exp_f32 v206, v206
    v_mfma_f32_16x16x32_bf16 v[44:47], a[188:191], v[208:211], v[44:47]
    ds_read_b64_tr_b16 a[152:153], v7 offset:49152
    v_add_f32 v237, v237, v204
    v_add_f32 v237, v237, v205
    v_mfma_f32_16x16x32_bf16 v[48:51], a[192:195], v[208:211], v[48:51]
    v_exp_f32 v207, v207
    v_mfma_f32_16x16x32_bf16 v[52:55], a[196:199], v[208:211], v[52:55]
    ds_read_b64_tr_b16 a[154:155], v7 offset:53248
    v_cvt_pk_bf16_f32 v214, v204, v205
    v_mfma_f32_16x16x32_bf16 v[56:59], a[200:203], v[208:211], v[56:59]
    ds_read_b64_tr_b16 a[156:157], v8 offset:49152
    v_add_f32 v237, v237, v206
    v_mfma_f32_16x16x32_bf16 v[60:63], a[204:207], v[208:211], v[60:63]
    ds_read_b64_tr_b16 a[158:159], v8 offset:53248
    v_add_f32 v237, v237, v207
    v_cvt_pk_bf16_f32 v215, v206, v207
    v_and_b32 v254, 0x30, v19
    v_lshlrev_b32 v254, 5, v254
    v_add_u32 v254, s55, v254
    s_mov_b32 exec_lo, 0
    v_mov_b32 v254, s0
    s_mov_b32 exec_lo, -1
    v_mfma_f32_16x16x32_bf16 v[200:203], a[112:115], a[48:51], v[228:231]
    global_load_dword v253, v254, s[18:19] sc1
    v_exp_f32 v192, v192
    v_mfma_f32_16x16x32_bf16 v[200:203], a[116:119], a[52:55], v[200:203]
    v_exp_f32 v193, v193
    v_mfma_f32_16x16x32_bf16 v[200:203], a[120:123], a[56:59], v[200:203]
    ds_read_b64_tr_b16 a[160:161], v9 offset:49152
    ds_read_b64_tr_b16 a[162:163], v9 offset:53248
    v_add_f32 v238, v238, v192
    v_mfma_f32_16x16x32_bf16 v[200:203], a[124:127], a[60:63], v[200:203]
    v_exp_f32 v194, v194
    v_mfma_f32_16x16x32_bf16 v[204:207], a[128:131], a[48:51], v[228:231]
    ds_read_b64_tr_b16 a[164:165], v10 offset:49152
    ds_read_b64_tr_b16 a[166:167], v10 offset:53248
    v_add_f32 v238, v238, v193
    v_mfma_f32_16x16x32_bf16 v[204:207], a[132:135], a[52:55], v[204:207]
    v_exp_f32 v195, v195
    v_mfma_f32_16x16x32_bf16 v[204:207], a[136:139], a[56:59], v[204:207]
    ds_read_b64_tr_b16 a[168:169], v11 offset:49152
    ds_read_b64_tr_b16 a[170:171], v11 offset:53248
    v_cvt_pk_bf16_f32 v208, v192, v193
    v_mfma_f32_16x16x32_bf16 v[204:207], a[140:143], a[60:63], v[204:207]
    v_exp_f32 v196, v196
    v_mfma_f32_16x16x32_bf16 v[64:67], a[176:179], v[212:215], v[64:67]
    ds_read_b64_tr_b16 a[172:173], v12 offset:49152
    ds_read_b64_tr_b16 a[174:175], v12 offset:53248
    v_add_f32 v238, v238, v194
    v_mfma_f32_16x16x32_bf16 v[68:71], a[180:183], v[212:215], v[68:71]
    v_exp_f32 v197, v197
    v_mfma_f32_16x16x32_bf16 v[72:75], a[184:187], v[212:215], v[72:75]
    v_add_f32 v238, v238, v195
    v_cvt_pk_bf16_f32 v209, v194, v195
    v_mfma_f32_16x16x32_bf16 v[76:79], a[188:191], v[212:215], v[76:79]
    v_exp_f32 v198, v198
    v_mfma_f32_16x16x32_bf16 v[80:83], a[192:195], v[212:215], v[80:83]
    v_add_f32 v238, v238, v196
    v_add_f32 v238, v238, v197
    v_mfma_f32_16x16x32_bf16 v[84:87], a[196:199], v[212:215], v[84:87]
    v_exp_f32 v199, v199
    v_mfma_f32_16x16x32_bf16 v[88:91], a[200:203], v[212:215], v[88:91]
    v_cvt_pk_bf16_f32 v210, v196, v197
    v_add_f32 v238, v238, v198
    v_mfma_f32_16x16x32_bf16 v[92:95], a[204:207], v[212:215], v[92:95]
    s_waitcnt lgkmcnt(0)
    v_add_f32 v238, v238, v199
    v_cvt_pk_bf16_f32 v211, v198, v199
    v_mfma_f32_16x16x32_bf16 v[192:195], a[80:83], a[0:3], v[216:219]
    v_exp_f32 v200, v200
    v_mfma_f32_16x16x32_bf16 v[192:195], a[84:87], a[4:7], v[192:195]
    v_exp_f32 v201, v201
    v_mfma_f32_16x16x32_bf16 v[192:195], a[88:91], a[8:11], v[192:195]
    ds_read_b128 a[112:115], v1 offset:57344
    ds_read_b128 a[116:119], v2 offset:57344
    v_add_f32 v239, v239, v200
    v_mfma_f32_16x16x32_bf16 v[192:195], a[92:95], a[12:15], v[192:195]
    v_exp_f32 v202, v202
    v_mfma_f32_16x16x32_bf16 v[196:199], a[96:99], a[0:3], v[216:219]
    ds_read_b128 a[120:123], v3 offset:57344
    ds_read_b128 a[124:127], v4 offset:57344
    v_add_f32 v239, v239, v201
    v_mfma_f32_16x16x32_bf16 v[196:199], a[100:103], a[4:7], v[196:199]
    v_exp_f32 v203, v203
    v_mfma_f32_16x16x32_bf16 v[196:199], a[104:107], a[8:11], v[196:199]
    ds_read_b128 a[128:131], v1 offset:61440
    ds_read_b128 a[132:135], v2 offset:61440
    v_cvt_pk_bf16_f32 v212, v200, v201
    v_mfma_f32_16x16x32_bf16 v[196:199], a[108:111], a[12:15], v[196:199]
    v_exp_f32 v204, v204
    v_mfma_f32_16x16x32_bf16 v[96:99], a[176:179], v[208:211], v[96:99]
    ds_read_b128 a[136:139], v3 offset:61440
    ds_read_b128 a[140:143], v4 offset:61440
    v_add_f32 v239, v239, v202
    v_mfma_f32_16x16x32_bf16 v[100:103], a[180:183], v[208:211], v[100:103]
    v_exp_f32 v205, v205
    v_mfma_f32_16x16x32_bf16 v[104:107], a[184:187], v[208:211], v[104:107]
    v_add_f32 v239, v239, v203
    v_cvt_pk_bf16_f32 v213, v202, v203
    v_mfma_f32_16x16x32_bf16 v[108:111], a[188:191], v[208:211], v[108:111]
    v_exp_f32 v206, v206
    v_mfma_f32_16x16x32_bf16 v[112:115], a[192:195], v[208:211], v[112:115]
    v_add_f32 v239, v239, v204
    v_add_f32 v239, v239, v205
    v_mfma_f32_16x16x32_bf16 v[116:119], a[196:199], v[208:211], v[116:119]
    v_exp_f32 v207, v207
    v_mfma_f32_16x16x32_bf16 v[120:123], a[200:203], v[208:211], v[120:123]
    v_cvt_pk_bf16_f32 v214, v204, v205
    v_add_f32 v239, v239, v206
    v_mfma_f32_16x16x32_bf16 v[124:127], a[204:207], v[208:211], v[124:127]
    s_waitcnt lgkmcnt(0)
    v_add_f32 v239, v239, v207
    v_cvt_pk_bf16_f32 v215, v206, v207
    v_mfma_f32_16x16x32_bf16 v[200:203], a[112:115], a[0:3], v[216:219]
    v_exp_f32 v192, v192
    v_mfma_f32_16x16x32_bf16 v[200:203], a[116:119], a[4:7], v[200:203]
    v_exp_f32 v193, v193
    v_mfma_f32_16x16x32_bf16 v[200:203], a[120:123], a[8:11], v[200:203]
    v_add_f32 v236, v236, v192
    v_add_f32 v236, v236, v193
    v_mfma_f32_16x16x32_bf16 v[200:203], a[124:127], a[12:15], v[200:203]
    v_exp_f32 v194, v194
    v_mfma_f32_16x16x32_bf16 v[204:207], a[128:131], a[0:3], v[216:219]
    v_exp_f32 v195, v195
    v_mfma_f32_16x16x32_bf16 v[204:207], a[132:135], a[4:7], v[204:207]
    v_cvt_pk_bf16_f32 v208, v192, v193
    v_mfma_f32_16x16x32_bf16 v[204:207], a[136:139], a[8:11], v[204:207]
    v_add_f32 v236, v236, v194
    v_mfma_f32_16x16x32_bf16 v[204:207], a[140:143], a[12:15], v[204:207]
    v_exp_f32 v196, v196
    v_mfma_f32_16x16x32_bf16 v[128:131], a[176:179], v[212:215], v[128:131]
    v_add_f32 v236, v236, v195
    v_cvt_pk_bf16_f32 v209, v194, v195
    v_mfma_f32_16x16x32_bf16 v[132:135], a[180:183], v[212:215], v[132:135]
    v_exp_f32 v197, v197
    v_mfma_f32_16x16x32_bf16 v[136:139], a[184:187], v[212:215], v[136:139]
    v_exp_f32 v198, v198
    v_mfma_f32_16x16x32_bf16 v[140:143], a[188:191], v[212:215], v[140:143]
    v_add_f32 v236, v236, v196
    v_add_f32 v236, v236, v197
    v_mfma_f32_16x16x32_bf16 v[144:147], a[192:195], v[212:215], v[144:147]
    v_exp_f32 v199, v199
    v_mfma_f32_16x16x32_bf16 v[148:151], a[196:199], v[212:215], v[148:151]
    v_cvt_pk_bf16_f32 v210, v196, v197
    v_mfma_f32_16x16x32_bf16 v[152:155], a[200:203], v[212:215], v[152:155]
    v_add_f32 v236, v236, v198
    v_mfma_f32_16x16x32_bf16 v[156:159], a[204:207], v[212:215], v[156:159]
    v_add_f32 v236, v236, v199
    v_cvt_pk_bf16_f32 v211, v198, v199
    v_mfma_f32_16x16x32_bf16 v[192:195], a[80:83], a[16:19], v[220:223]
    v_exp_f32 v200, v200
    v_mfma_f32_16x16x32_bf16 v[192:195], a[84:87], a[20:23], v[192:195]
    v_exp_f32 v201, v201
    v_mfma_f32_16x16x32_bf16 v[192:195], a[88:91], a[24:27], v[192:195]
    ds_read_b64_tr_b16 a[176:177], v5 offset:57344
    v_add_f32 v236, v236, v200
    v_add_f32 v236, v236, v201
    v_mfma_f32_16x16x32_bf16 v[192:195], a[92:95], a[28:31], v[192:195]
    v_exp_f32 v202, v202
    v_mfma_f32_16x16x32_bf16 v[196:199], a[96:99], a[16:19], v[220:223]
    v_exp_f32 v203, v203
    v_mfma_f32_16x16x32_bf16 v[196:199], a[100:103], a[20:23], v[196:199]
    ds_read_b64_tr_b16 a[178:179], v5 offset:61440
    ds_read_b64_tr_b16 a[180:181], v6 offset:57344
    v_cvt_pk_bf16_f32 v212, v200, v201
    v_mfma_f32_16x16x32_bf16 v[196:199], a[104:107], a[24:27], v[196:199]
    ds_read_b64_tr_b16 a[182:183], v6 offset:61440
    ds_read_b64_tr_b16 a[184:185], v7 offset:57344
    v_add_f32 v236, v236, v202
    v_mfma_f32_16x16x32_bf16 v[196:199], a[108:111], a[28:31], v[196:199]
    v_exp_f32 v204, v204
    v_mfma_f32_16x16x32_bf16 v[32:35], a[144:147], v[208:211], v[32:35]
    ds_read_b64_tr_b16 a[186:187], v7 offset:61440
    v_add_f32 v236, v236, v203
    v_cvt_pk_bf16_f32 v213, v202, v203
    v_mfma_f32_16x16x32_bf16 v[36:39], a[148:151], v[208:211], v[36:39]
    v_exp_f32 v205, v205
    v_mfma_f32_16x16x32_bf16 v[40:43], a[152:155], v[208:211], v[40:43]
    v_exp_f32 v206, v206
    v_mfma_f32_16x16x32_bf16 v[44:47], a[156:159], v[208:211], v[44:47]
    ds_read_b64_tr_b16 a[188:189], v8 offset:57344
    v_add_f32 v236, v236, v204
    v_add_f32 v236, v236, v205
    v_mfma_f32_16x16x32_bf16 v[48:51], a[160:163], v[208:211], v[48:51]
    v_exp_f32 v207, v207
    v_mfma_f32_16x16x32_bf16 v[52:55], a[164:167], v[208:211], v[52:55]
    ds_read_b64_tr_b16 a[190:191], v8 offset:61440
    ds_read_b64_tr_b16 a[192:193], v9 offset:57344
    v_cvt_pk_bf16_f32 v214, v204, v205
    v_mfma_f32_16x16x32_bf16 v[56:59], a[168:171], v[208:211], v[56:59]
    ds_read_b64_tr_b16 a[194:195], v9 offset:61440
    ds_read_b64_tr_b16 a[196:197], v10 offset:57344
    v_add_f32 v236, v236, v206
    v_mfma_f32_16x16x32_bf16 v[60:63], a[172:175], v[208:211], v[60:63]
    ds_read_b64_tr_b16 a[198:199], v10 offset:61440
    v_add_f32 v236, v236, v207
    v_cvt_pk_bf16_f32 v215, v206, v207
    v_mfma_f32_16x16x32_bf16 v[200:203], a[112:115], a[16:19], v[220:223]
    ds_read_b64_tr_b16 a[200:201], v11 offset:57344
    v_exp_f32 v192, v192
    v_mov_b32 v216, v236
    v_mfma_f32_16x16x32_bf16 v[200:203], a[116:119], a[20:23], v[200:203]
    ds_read_b64_tr_b16 a[202:203], v11 offset:61440
    v_exp_f32 v193, v193
    s_nop 1
    v_permlane32_swap_b32 v236, v216
    v_mfma_f32_16x16x32_bf16 v[200:203], a[120:123], a[24:27], v[200:203]
    ds_read_b64_tr_b16 a[204:205], v12 offset:57344
    ds_read_b64_tr_b16 a[206:207], v12 offset:61440
    v_add_f32 v237, v237, v192
    v_add_f32 v237, v237, v193
    v_mfma_f32_16x16x32_bf16 v[200:203], a[124:127], a[28:31], v[200:203]
    v_exp_f32 v194, v194
    v_add_f32 v236, v236, v216
    v_mfma_f32_16x16x32_bf16 v[204:207], a[128:131], a[16:19], v[220:223]
    v_exp_f32 v195, v195
    v_mfma_f32_16x16x32_bf16 v[204:207], a[132:135], a[20:23], v[204:207]
    v_cvt_pk_bf16_f32 v208, v192, v193
    v_mov_b32 v216, v236
    v_mfma_f32_16x16x32_bf16 v[204:207], a[136:139], a[24:27], v[204:207]
    v_add_f32 v237, v237, v194
    v_mfma_f32_16x16x32_bf16 v[204:207], a[140:143], a[28:31], v[204:207]
    v_exp_f32 v196, v196
    s_waitcnt lgkmcnt(0)
    s_barrier
    s_nop 1
    v_permlane16_swap_b32 v236, v216
    v_mfma_f32_16x16x32_bf16 v[32:35], a[176:179], v[212:215], v[32:35]
    v_add_f32 v237, v237, v195
    v_cvt_pk_bf16_f32 v209, v194, v195
    v_add_f32 v236, v236, v216
    v_mfma_f32_16x16x32_bf16 v[36:39], a[180:183], v[212:215], v[36:39]
    v_exp_f32 v197, v197
    v_mfma_f32_16x16x32_bf16 v[40:43], a[184:187], v[212:215], v[40:43]
    v_exp_f32 v198, v198
    v_cmp_nge_f32 vcc, 0x53800000, v236
    v_mfma_f32_16x16x32_bf16 v[44:47], a[188:191], v[212:215], v[44:47]
    v_add_f32 v237, v237, v196
    v_add_f32 v237, v237, v197
    v_mfma_f32_16x16x32_bf16 v[48:51], a[192:195], v[212:215], v[48:51]
    v_exp_f32 v199, v199
    v_rcp_f32 v216, v236
    v_mfma_f32_16x16x32_bf16 v[52:55], a[196:199], v[212:215], v[52:55]
    v_cvt_pk_bf16_f32 v210, v196, v197
    v_mfma_f32_16x16x32_bf16 v[56:59], a[200:203], v[212:215], v[56:59]
    v_add_f32 v237, v237, v198
    s_cmp_lg_u64 vcc, 0
    s_cselect_b32 s88, 1, 0
    s_or_b32 s59, s59, s88
    v_mfma_f32_16x16x32_bf16 v[60:63], a[204:207], v[212:215], v[60:63]
    v_add_f32 v237, v237, v199
    v_cvt_pk_bf16_f32 v211, v198, v199
    v_mov_b32 v217, v216
.p2align 3
    v_pk_mul_f32 v[32:33], v[32:33], v[216:217]
    v_pk_mul_f32 v[34:35], v[34:35], v[216:217]
    v_pk_mul_f32 v[36:37], v[36:37], v[216:217]
    v_pk_mul_f32 v[38:39], v[38:39], v[216:217]
    v_cvt_pk_bf16_f32 v32, v32, v33
    v_cvt_pk_bf16_f32 v33, v34, v35
    v_cvt_pk_bf16_f32 v34, v36, v37
    v_cvt_pk_bf16_f32 v35, v38, v39
    buffer_store_dwordx4 v[32:35], v245, s[36:39], 0 offen offset:0 sc1
    v_pk_mul_f32 v[40:41], v[40:41], v[216:217]
    v_pk_mul_f32 v[42:43], v[42:43], v[216:217]
    v_pk_mul_f32 v[44:45], v[44:45], v[216:217]
    v_pk_mul_f32 v[46:47], v[46:47], v[216:217]
    v_cvt_pk_bf16_f32 v40, v40, v41
    v_cvt_pk_bf16_f32 v41, v42, v43
    v_cvt_pk_bf16_f32 v42, v44, v45
    v_cvt_pk_bf16_f32 v43, v46, v47
    buffer_store_dwordx4 v[40:43], v245, s[36:39], 0 offen offset:1024 sc1
    v_pk_mul_f32 v[48:49], v[48:49], v[216:217]
    v_pk_mul_f32 v[50:51], v[50:51], v[216:217]
    v_pk_mul_f32 v[52:53], v[52:53], v[216:217]
    v_pk_mul_f32 v[54:55], v[54:55], v[216:217]
    v_cvt_pk_bf16_f32 v48, v48, v49
    v_cvt_pk_bf16_f32 v49, v50, v51
    v_cvt_pk_bf16_f32 v50, v52, v53
    v_cvt_pk_bf16_f32 v51, v54, v55
    buffer_store_dwordx4 v[48:51], v245, s[36:39], 0 offen offset:2048 sc1
    v_pk_mul_f32 v[56:57], v[56:57], v[216:217]
    v_pk_mul_f32 v[58:59], v[58:59], v[216:217]
    v_pk_mul_f32 v[60:61], v[60:61], v[216:217]
    v_pk_mul_f32 v[62:63], v[62:63], v[216:217]
    v_cvt_pk_bf16_f32 v56, v56, v57
    v_cvt_pk_bf16_f32 v57, v58, v59
    v_cvt_pk_bf16_f32 v58, v60, v61
    v_cvt_pk_bf16_f32 v59, v62, v63
    buffer_store_dwordx4 v[56:59], v245, s[36:39], 0 offen offset:3072 sc1
    s_waitcnt vmcnt(36)
    v_mfma_f32_16x16x32_bf16 v[192:195], a[80:83], a[32:35], v[224:227]
    s_add_u32 m0, s45, 49152
    v_exp_f32 v200, v200
    v_mfma_f32_16x16x32_bf16 v[192:195], a[84:87], a[36:39], v[192:195]
    s_xor_b32 s61, s3, 163968
    v_exp_f32 v201, v201
    v_mfma_f32_16x16x32_bf16 v[192:195], a[88:91], a[40:43], v[192:195]
    ds_read_b64_tr_b16 v[32:33], v24 offset:0
    v_add_f32 v237, v237, v200
    v_add_f32 v237, v237, v201
    v_mfma_f32_16x16x32_bf16 v[192:195], a[92:95], a[44:47], v[192:195]
    buffer_load_dwordx4 v241, s[64:67], s61 offen offset:0 lds
    v_exp_f32 v202, v202
    v_mfma_f32_16x16x32_bf16 v[196:199], a[96:99], a[32:35], v[224:227]
    buffer_load_dwordx4 v242, s[64:67], s61 offen offset:1024 lds
    v_exp_f32 v203, v203
    v_mfma_f32_16x16x32_bf16 v[196:199], a[100:103], a[36:39], v[196:199]
    ds_read_b64_tr_b16 v[34:35], v24 offset:2048
    v_cvt_pk_bf16_f32 v212, v200, v201
    v_mfma_f32_16x16x32_bf16 v[196:199], a[104:107], a[40:43], v[196:199]
    ds_read_b64_tr_b16 v[36:37], v25 offset:0
    v_add_f32 v237, v237, v202
    v_mfma_f32_16x16x32_bf16 v[196:199], a[108:111], a[44:47], v[196:199]
    buffer_load_dwordx4 v243, s[64:67], s61 offen offset:2048 lds
    v_exp_f32 v204, v204
    v_mfma_f32_16x16x32_bf16 v[64:67], a[144:147], v[208:211], v[64:67]
    ds_read_b64_tr_b16 v[38:39], v25 offset:2048
    v_add_f32 v237, v237, v203
    v_cvt_pk_bf16_f32 v213, v202, v203
    v_mfma_f32_16x16x32_bf16 v[68:71], a[148:151], v[208:211], v[68:71]
    buffer_load_dwordx4 v244, s[64:67], s61 offen offset:3072 lds
    v_exp_f32 v205, v205
    v_mfma_f32_16x16x32_bf16 v[72:75], a[152:155], v[208:211], v[72:75]
    v_exp_f32 v206, v206
    v_mfma_f32_16x16x32_bf16 v[76:79], a[156:159], v[208:211], v[76:79]
    ds_read_b64_tr_b16 v[40:41], v26 offset:0
    v_add_f32 v237, v237, v204
    v_add_f32 v237, v237, v205
    v_mfma_f32_16x16x32_bf16 v[80:83], a[160:163], v[208:211], v[80:83]
    v_exp_f32 v207, v207
    v_mfma_f32_16x16x32_bf16 v[84:87], a[164:167], v[208:211], v[84:87]
    ds_read_b64_tr_b16 v[42:43], v26 offset:2048
    v_cvt_pk_bf16_f32 v214, v204, v205
    v_mfma_f32_16x16x32_bf16 v[88:91], a[168:171], v[208:211], v[88:91]
    ds_read_b64_tr_b16 v[44:45], v27 offset:0
    v_add_f32 v237, v237, v206
    v_mfma_f32_16x16x32_bf16 v[92:95], a[172:175], v[208:211], v[92:95]
    ds_read_b64_tr_b16 v[46:47], v27 offset:2048
    v_add_f32 v237, v237, v207
    v_cvt_pk_bf16_f32 v215, v206, v207
    s_waitcnt vmcnt(35)
    v_mfma_f32_16x16x32_bf16 v[200:203], a[112:115], a[32:35], v[224:227]
    s_add_u32 m0, s45, 114688
    v_exp_f32 v192, v192
    v_mov_b32 v220, v237
    v_mfma_f32_16x16x32_bf16 v[200:203], a[116:119], a[36:39], v[200:203]
    s_xor_b32 s61, s3, 196608
    v_exp_f32 v193, v193
    s_nop 1
    v_permlane32_swap_b32 v237, v220
    v_mfma_f32_16x16x32_bf16 v[200:203], a[120:123], a[40:43], v[200:203]
    ds_read_b64_tr_b16 v[48:49], v20 offset:16384
    v_add_f32 v238, v238, v192
    v_add_f32 v238, v238, v193
    v_mfma_f32_16x16x32_bf16 v[200:203], a[124:127], a[44:47], v[200:203]
    buffer_load_dwordx4 v241, s[64:67], s61 offen offset:0 lds
    v_exp_f32 v194, v194
    v_add_f32 v237, v237, v220
    v_mfma_f32_16x16x32_bf16 v[204:207], a[128:131], a[32:35], v[224:227]
    buffer_load_dwordx4 v242, s[64:67], s61 offen offset:1024 lds
    v_exp_f32 v195, v195
    v_mfma_f32_16x16x32_bf16 v[204:207], a[132:135], a[36:39], v[204:207]
    ds_read_b64_tr_b16 v[50:51], v20 offset:18432
    v_cvt_pk_bf16_f32 v208, v192, v193
    v_mov_b32 v220, v237
    v_mfma_f32_16x16x32_bf16 v[204:207], a[136:139], a[40:43], v[204:207]
    ds_read_b64_tr_b16 v[52:53], v21 offset:16384
    v_add_f32 v238, v238, v194
    v_mfma_f32_16x16x32_bf16 v[204:207], a[140:143], a[44:47], v[204:207]
    buffer_load_dwordx4 v243, s[64:67], s61 offen offset:2048 lds
    v_exp_f32 v196, v196
    s_nop 1
    v_permlane16_swap_b32 v237, v220
    v_mfma_f32_16x16x32_bf16 v[64:67], a[176:179], v[212:215], v[64:67]
    ds_read_b64_tr_b16 v[54:55], v21 offset:18432
    v_add_f32 v238, v238, v195
    v_cvt_pk_bf16_f32 v209, v194, v195
    v_add_f32 v237, v237, v220
    v_mfma_f32_16x16x32_bf16 v[68:71], a[180:183], v[212:215], v[68:71]
    buffer_load_dwordx4 v244, s[64:67], s61 offen offset:3072 lds
    v_exp_f32 v197, v197
    v_mfma_f32_16x16x32_bf16 v[72:75], a[184:187], v[212:215], v[72:75]
    v_exp_f32 v198, v198
    v_cmp_nge_f32 vcc, 0x53800000, v237
    v_mfma_f32_16x16x32_bf16 v[76:79], a[188:191], v[212:215], v[76:79]
    ds_read_b64_tr_b16 v[56:57], v22 offset:16384
    v_add_f32 v238, v238, v196
    v_add_f32 v238, v238, v197
    v_mfma_f32_16x16x32_bf16 v[80:83], a[192:195], v[212:215], v[80:83]
    v_exp_f32 v199, v199
    v_rcp_f32 v220, v237
    v_mfma_f32_16x16x32_bf16 v[84:87], a[196:199], v[212:215], v[84:87]
    ds_read_b64_tr_b16 v[58:59], v22 offset:18432
    v_cvt_pk_bf16_f32 v210, v196, v197
    v_mfma_f32_16x16x32_bf16 v[88:91], a[200:203], v[212:215], v[88:91]
    ds_read_b64_tr_b16 v[60:61], v23 offset:16384
    v_add_f32 v238, v238, v198
    s_cmp_lg_u64 vcc, 0
    s_cselect_b32 s88, 2, 0
    s_or_b32 s59, s59, s88
    v_mfma_f32_16x16x32_bf16 v[92:95], a[204:207], v[212:215], v[92:95]
    ds_read_b64_tr_b16 v[62:63], v23 offset:18432
    v_add_f32 v238, v238, v199
    v_cvt_pk_bf16_f32 v211, v198, v199
    s_waitcnt lgkmcnt(0)
    v_mov_b32 v221, v220
.p2align 3
    v_pk_mul_f32 v[64:65], v[64:65], v[220:221]
    v_pk_mul_f32 v[66:67], v[66:67], v[220:221]
    v_pk_mul_f32 v[68:69], v[68:69], v[220:221]
    v_pk_mul_f32 v[70:71], v[70:71], v[220:221]
    v_cvt_pk_bf16_f32 v64, v64, v65
    v_cvt_pk_bf16_f32 v65, v66, v67
    v_cvt_pk_bf16_f32 v66, v68, v69
    v_cvt_pk_bf16_f32 v67, v70, v71
    buffer_store_dwordx4 v[64:67], v246, s[36:39], 0 offen offset:0 sc1
    v_pk_mul_f32 v[72:73], v[72:73], v[220:221]
    v_pk_mul_f32 v[74:75], v[74:75], v[220:221]
    v_pk_mul_f32 v[76:77], v[76:77], v[220:221]
    v_pk_mul_f32 v[78:79], v[78:79], v[220:221]
    v_cvt_pk_bf16_f32 v72, v72, v73
    v_cvt_pk_bf16_f32 v73, v74, v75
    v_cvt_pk_bf16_f32 v74, v76, v77
    v_cvt_pk_bf16_f32 v75, v78, v79
    buffer_store_dwordx4 v[72:75], v246, s[36:39], 0 offen offset:1024 sc1
    v_pk_mul_f32 v[80:81], v[80:81], v[220:221]
    v_pk_mul_f32 v[82:83], v[82:83], v[220:221]
    v_pk_mul_f32 v[84:85], v[84:85], v[220:221]
    v_pk_mul_f32 v[86:87], v[86:87], v[220:221]
    v_cvt_pk_bf16_f32 v80, v80, v81
    v_cvt_pk_bf16_f32 v81, v82, v83
    v_cvt_pk_bf16_f32 v82, v84, v85
    v_cvt_pk_bf16_f32 v83, v86, v87
    buffer_store_dwordx4 v[80:83], v246, s[36:39], 0 offen offset:2048 sc1
    v_pk_mul_f32 v[88:89], v[88:89], v[220:221]
    v_pk_mul_f32 v[90:91], v[90:91], v[220:221]
    v_pk_mul_f32 v[92:93], v[92:93], v[220:221]
    v_pk_mul_f32 v[94:95], v[94:95], v[220:221]
    v_cvt_pk_bf16_f32 v88, v88, v89
    v_cvt_pk_bf16_f32 v89, v90, v91
    v_cvt_pk_bf16_f32 v90, v92, v93
    v_cvt_pk_bf16_f32 v91, v94, v95
    buffer_store_dwordx4 v[88:91], v246, s[36:39], 0 offen offset:3072 sc1
    s_waitcnt vmcnt(39)
    v_mfma_f32_16x16x32_bf16 v[192:195], a[80:83], a[48:51], v[228:231]
    s_add_u32 m0, s45, 65536
    v_exp_f32 v200, v200
    v_mfma_f32_16x16x32_bf16 v[192:195], a[84:87], a[52:55], v[192:195]
    s_xor_b32 s61, s3, 196736
    v_exp_f32 v201, v201
    v_mfma_f32_16x16x32_bf16 v[192:195], a[88:91], a[56:59], v[192:195]
    ds_read_b64_tr_b16 v[64:65], v24 offset:16384
    v_add_f32 v238, v238, v200
    v_add_f32 v238, v238, v201
    v_mfma_f32_16x16x32_bf16 v[192:195], a[92:95], a[60:63], v[192:195]
    buffer_load_dwordx4 v241, s[64:67], s61 offen offset:0 lds
    v_exp_f32 v202, v202
    v_mfma_f32_16x16x32_bf16 v[196:199], a[96:99], a[48:51], v[228:231]
    buffer_load_dwordx4 v242, s[64:67], s61 offen offset:1024 lds
    v_exp_f32 v203, v203
    v_mfma_f32_16x16x32_bf16 v[196:199], a[100:103], a[52:55], v[196:199]
    ds_read_b64_tr_b16 v[66:67], v24 offset:18432
    v_cvt_pk_bf16_f32 v212, v200, v201
    v_mfma_f32_16x16x32_bf16 v[196:199], a[104:107], a[56:59], v[196:199]
    ds_read_b64_tr_b16 v[68:69], v25 offset:16384
    v_add_f32 v238, v238, v202
    v_mfma_f32_16x16x32_bf16 v[196:199], a[108:111], a[60:63], v[196:199]
    buffer_load_dwordx4 v243, s[64:67], s61 offen offset:2048 lds
    v_exp_f32 v204, v204
    v_mfma_f32_16x16x32_bf16 v[96:99], a[144:147], v[208:211], v[96:99]
    ds_read_b64_tr_b16 v[70:71], v25 offset:18432
    v_add_f32 v238, v238, v203
    v_cvt_pk_bf16_f32 v213, v202, v203
    v_mfma_f32_16x16x32_bf16 v[100:103], a[148:151], v[208:211], v[100:103]
    buffer_load_dwordx4 v244, s[64:67], s61 offen offset:3072 lds
    v_exp_f32 v205, v205
    v_mfma_f32_16x16x32_bf16 v[104:107], a[152:155], v[208:211], v[104:107]
    v_exp_f32 v206, v206
    v_mfma_f32_16x16x32_bf16 v[108:111], a[156:159], v[208:211], v[108:111]
    ds_read_b64_tr_b16 v[72:73], v26 offset:16384
    v_add_f32 v238, v238, v204
    v_add_f32 v238, v238, v205
    v_mfma_f32_16x16x32_bf16 v[112:115], a[160:163], v[208:211], v[112:115]
    v_exp_f32 v207, v207
    v_mfma_f32_16x16x32_bf16 v[116:119], a[164:167], v[208:211], v[116:119]
    ds_read_b64_tr_b16 v[74:75], v26 offset:18432
    v_cvt_pk_bf16_f32 v214, v204, v205
    v_mfma_f32_16x16x32_bf16 v[120:123], a[168:171], v[208:211], v[120:123]
    ds_read_b64_tr_b16 v[76:77], v27 offset:16384
    v_add_f32 v238, v238, v206
    v_mfma_f32_16x16x32_bf16 v[124:127], a[172:175], v[208:211], v[124:127]
    ds_read_b64_tr_b16 v[78:79], v27 offset:18432
    v_add_f32 v238, v238, v207
    v_cvt_pk_bf16_f32 v215, v206, v207
    s_waitcnt vmcnt(38)
    v_mfma_f32_16x16x32_bf16 v[200:203], a[112:115], a[48:51], v[228:231]
    s_add_u32 m0, s45, 16384
    v_exp_f32 v192, v192
    v_mov_b32 v224, v238
    v_mfma_f32_16x16x32_bf16 v[200:203], a[116:119], a[52:55], v[200:203]
    s_xor_b32 s61, s3, 229376
    v_exp_f32 v193, v193
    s_nop 1
    v_permlane32_swap_b32 v238, v224
    v_mfma_f32_16x16x32_bf16 v[200:203], a[120:123], a[56:59], v[200:203]
    ds_read_b64_tr_b16 v[80:81], v28 offset:0
    v_add_f32 v239, v239, v192
    v_add_f32 v239, v239, v193
    v_mfma_f32_16x16x32_bf16 v[200:203], a[124:127], a[60:63], v[200:203]
    buffer_load_dwordx4 v241, s[64:67], s61 offen offset:0 lds
    v_exp_f32 v194, v194
    v_add_f32 v238, v238, v224
    v_mfma_f32_16x16x32_bf16 v[204:207], a[128:131], a[48:51], v[228:231]
    buffer_load_dwordx4 v242, s[64:67], s61 offen offset:1024 lds
    v_exp_f32 v195, v195
    v_mfma_f32_16x16x32_bf16 v[204:207], a[132:135], a[52:55], v[204:207]
    ds_read_b64_tr_b16 v[82:83], v28 offset:2048
    v_cvt_pk_bf16_f32 v208, v192, v193
    v_mov_b32 v224, v238
    v_mfma_f32_16x16x32_bf16 v[204:207], a[136:139], a[56:59], v[204:207]
    ds_read_b64_tr_b16 v[84:85], v29 offset:0
    v_add_f32 v239, v239, v194
    v_mfma_f32_16x16x32_bf16 v[204:207], a[140:143], a[60:63], v[204:207]
    buffer_load_dwordx4 v243, s[64:67], s61 offen offset:2048 lds
    v_exp_f32 v196, v196
    s_nop 1
    v_permlane16_swap_b32 v238, v224
    v_mfma_f32_16x16x32_bf16 v[96:99], a[176:179], v[212:215], v[96:99]
    ds_read_b64_tr_b16 v[86:87], v29 offset:2048
    v_add_f32 v239, v239, v195
    v_cvt_pk_bf16_f32 v209, v194, v195
    v_add_f32 v238, v238, v224
    v_mfma_f32_16x16x32_bf16 v[100:103], a[180:183], v[212:215], v[100:103]
    buffer_load_dwordx4 v244, s[64:67], s61 offen offset:3072 lds
    v_exp_f32 v197, v197
    v_mfma_f32_16x16x32_bf16 v[104:107], a[184:187], v[212:215], v[104:107]
    v_exp_f32 v198, v198
    v_cmp_nge_f32 vcc, 0x53800000, v238
    v_mfma_f32_16x16x32_bf16 v[108:111], a[188:191], v[212:215], v[108:111]
    ds_read_b64_tr_b16 v[88:89], v30 offset:0
    v_add_f32 v239, v239, v196
    v_add_f32 v239, v239, v197
    v_mfma_f32_16x16x32_bf16 v[112:115], a[192:195], v[212:215], v[112:115]
    v_exp_f32 v199, v199
    v_rcp_f32 v224, v238
    v_mfma_f32_16x16x32_bf16 v[116:119], a[196:199], v[212:215], v[116:119]
    ds_read_b64_tr_b16 v[90:91], v30 offset:2048
    v_cvt_pk_bf16_f32 v210, v196, v197
    v_mfma_f32_16x16x32_bf16 v[120:123], a[200:203], v[212:215], v[120:123]
    ds_read_b64_tr_b16 v[92:93], v31 offset:0
    v_add_f32 v239, v239, v198
    s_cmp_lg_u64 vcc, 0
    s_cselect_b32 s88, 4, 0
    s_or_b32 s59, s59, s88
    v_mfma_f32_16x16x32_bf16 v[124:127], a[204:207], v[212:215], v[124:127]
    ds_read_b64_tr_b16 v[94:95], v31 offset:2048
    v_add_f32 v239, v239, v199
    v_cvt_pk_bf16_f32 v211, v198, v199
    v_mov_b32 v225, v224
.p2align 3
    v_pk_mul_f32 v[96:97], v[96:97], v[224:225]
    v_pk_mul_f32 v[98:99], v[98:99], v[224:225]
    v_pk_mul_f32 v[100:101], v[100:101], v[224:225]
    v_pk_mul_f32 v[102:103], v[102:103], v[224:225]
    v_cvt_pk_bf16_f32 v96, v96, v97
    v_cvt_pk_bf16_f32 v97, v98, v99
    v_cvt_pk_bf16_f32 v98, v100, v101
    v_cvt_pk_bf16_f32 v99, v102, v103
    buffer_store_dwordx4 v[96:99], v247, s[36:39], 0 offen offset:0 sc1
    v_pk_mul_f32 v[104:105], v[104:105], v[224:225]
    v_pk_mul_f32 v[106:107], v[106:107], v[224:225]
    v_pk_mul_f32 v[108:109], v[108:109], v[224:225]
    v_pk_mul_f32 v[110:111], v[110:111], v[224:225]
    v_cvt_pk_bf16_f32 v104, v104, v105
    v_cvt_pk_bf16_f32 v105, v106, v107
    v_cvt_pk_bf16_f32 v106, v108, v109
    v_cvt_pk_bf16_f32 v107, v110, v111
    buffer_store_dwordx4 v[104:107], v247, s[36:39], 0 offen offset:1024 sc1
    v_pk_mul_f32 v[112:113], v[112:113], v[224:225]
    v_pk_mul_f32 v[114:115], v[114:115], v[224:225]
    v_pk_mul_f32 v[116:117], v[116:117], v[224:225]
    v_pk_mul_f32 v[118:119], v[118:119], v[224:225]
    v_cvt_pk_bf16_f32 v112, v112, v113
    v_cvt_pk_bf16_f32 v113, v114, v115
    v_cvt_pk_bf16_f32 v114, v116, v117
    v_cvt_pk_bf16_f32 v115, v118, v119
    buffer_store_dwordx4 v[112:115], v247, s[36:39], 0 offen offset:2048 sc1
    v_pk_mul_f32 v[120:121], v[120:121], v[224:225]
    v_pk_mul_f32 v[122:123], v[122:123], v[224:225]
    v_pk_mul_f32 v[124:125], v[124:125], v[224:225]
    v_pk_mul_f32 v[126:127], v[126:127], v[224:225]
    v_cvt_pk_bf16_f32 v120, v120, v121
    v_cvt_pk_bf16_f32 v121, v122, v123
    v_cvt_pk_bf16_f32 v122, v124, v125
    v_cvt_pk_bf16_f32 v123, v126, v127
    buffer_store_dwordx4 v[120:123], v247, s[36:39], 0 offen offset:3072 sc1
    s_waitcnt vmcnt(42)
    s_nop 1
    v_mfma_f32_16x16x32_bf16 v[128:131], a[144:147], v[208:211], v[128:131]
    ds_read_b64_tr_b16 v[96:97], v28 offset:4096
    v_exp_f32 v200, v200
    v_exp_f32 v201, v201
    v_add_f32 v239, v239, v200
    v_mfma_f32_16x16x32_bf16 v[132:135], a[148:151], v[208:211], v[132:135]
    ds_read_b64_tr_b16 v[98:99], v28 offset:6144
    v_add_f32 v239, v239, v201
    v_exp_f32 v202, v202
    v_mfma_f32_16x16x32_bf16 v[136:139], a[152:155], v[208:211], v[136:139]
    ds_read_b64_tr_b16 v[100:101], v29 offset:4096
    v_exp_f32 v203, v203
    v_cvt_pk_bf16_f32 v212, v200, v201
    v_add_f32 v239, v239, v202
    v_mfma_f32_16x16x32_bf16 v[140:143], a[156:159], v[208:211], v[140:143]
    ds_read_b64_tr_b16 v[102:103], v29 offset:6144
    v_exp_f32 v204, v204
    v_add_f32 v239, v239, v203
    v_mfma_f32_16x16x32_bf16 v[144:147], a[160:163], v[208:211], v[144:147]
    ds_read_b64_tr_b16 v[104:105], v30 offset:4096
    v_cvt_pk_bf16_f32 v213, v202, v203
    v_exp_f32 v205, v205
    v_exp_f32 v206, v206
    v_mfma_f32_16x16x32_bf16 v[148:151], a[164:167], v[208:211], v[148:151]
    ds_read_b64_tr_b16 v[106:107], v30 offset:6144
    v_add_f32 v239, v239, v204
    v_add_f32 v239, v239, v205
    v_mfma_f32_16x16x32_bf16 v[152:155], a[168:171], v[208:211], v[152:155]
    ds_read_b64_tr_b16 v[108:109], v31 offset:4096
    v_exp_f32 v207, v207
    v_cvt_pk_bf16_f32 v214, v204, v205
    v_add_f32 v239, v239, v206
    v_mfma_f32_16x16x32_bf16 v[156:159], a[172:175], v[208:211], v[156:159]
    ds_read_b64_tr_b16 v[110:111], v31 offset:6144
    v_add_f32 v239, v239, v207
    v_cvt_pk_bf16_f32 v215, v206, v207
    s_waitcnt vmcnt(38)
    s_nop 1
    v_mfma_f32_16x16x32_bf16 v[128:131], a[176:179], v[212:215], v[128:131]
    ds_read_b64_tr_b16 v[112:113], v20 offset:0
    v_mov_b32 v228, v239
    s_nop 1
    v_permlane32_swap_b32 v239, v228
    v_mfma_f32_16x16x32_bf16 v[132:135], a[180:183], v[212:215], v[132:135]
    ds_read_b64_tr_b16 v[114:115], v20 offset:2048
    v_add_f32 v239, v239, v228
    v_mfma_f32_16x16x32_bf16 v[136:139], a[184:187], v[212:215], v[136:139]
    ds_read_b64_tr_b16 v[116:117], v21 offset:0
    v_mov_b32 v228, v239
    v_mfma_f32_16x16x32_bf16 v[140:143], a[188:191], v[212:215], v[140:143]
    ds_read_b64_tr_b16 v[118:119], v21 offset:2048
    s_nop 1
    v_permlane16_swap_b32 v239, v228
    v_mfma_f32_16x16x32_bf16 v[144:147], a[192:195], v[212:215], v[144:147]
    ds_read_b64_tr_b16 v[120:121], v22 offset:0
    v_add_f32 v239, v239, v228
    v_mfma_f32_16x16x32_bf16 v[148:151], a[196:199], v[212:215], v[148:151]
    ds_read_b64_tr_b16 v[122:123], v22 offset:2048
    v_cmp_nge_f32 vcc, 0x53800000, v239
    v_mfma_f32_16x16x32_bf16 v[152:155], a[200:203], v[212:215], v[152:155]
    ds_read_b64_tr_b16 v[124:125], v23 offset:0
    v_rcp_f32 v228, v239
    v_mfma_f32_16x16x32_bf16 v[156:159], a[204:207], v[212:215], v[156:159]
    ds_read_b64_tr_b16 v[126:127], v23 offset:2048
    s_cmp_lg_u64 vcc, 0
    s_cselect_b32 s88, 8, 0
    s_or_b32 s59, s59, s88
    v_mov_b32 v229, v228
.p2align 3
    v_pk_mul_f32 v[128:129], v[128:129], v[228:229]
    v_pk_mul_f32 v[130:131], v[130:131], v[228:229]
    v_pk_mul_f32 v[132:133], v[132:133], v[228:229]
    v_pk_mul_f32 v[134:135], v[134:135], v[228:229]
    v_cvt_pk_bf16_f32 v128, v128, v129
    v_cvt_pk_bf16_f32 v129, v130, v131
    v_cvt_pk_bf16_f32 v130, v132, v133
    v_cvt_pk_bf16_f32 v131, v134, v135
    buffer_store_dwordx4 v[128:131], v248, s[36:39], 0 offen offset:0 sc1
    v_pk_mul_f32 v[136:137], v[136:137], v[228:229]
    v_pk_mul_f32 v[138:139], v[138:139], v[228:229]
    v_pk_mul_f32 v[140:141], v[140:141], v[228:229]
    v_pk_mul_f32 v[142:143], v[142:143], v[228:229]
    v_cvt_pk_bf16_f32 v136, v136, v137
    v_cvt_pk_bf16_f32 v137, v138, v139
    v_cvt_pk_bf16_f32 v138, v140, v141
    v_cvt_pk_bf16_f32 v139, v142, v143
    buffer_store_dwordx4 v[136:139], v248, s[36:39], 0 offen offset:1024 sc1
    v_pk_mul_f32 v[144:145], v[144:145], v[228:229]
    v_pk_mul_f32 v[146:147], v[146:147], v[228:229]
    v_pk_mul_f32 v[148:149], v[148:149], v[228:229]
    v_pk_mul_f32 v[150:151], v[150:151], v[228:229]
    v_cvt_pk_bf16_f32 v144, v144, v145
    v_cvt_pk_bf16_f32 v145, v146, v147
    v_cvt_pk_bf16_f32 v146, v148, v149
    v_cvt_pk_bf16_f32 v147, v150, v151
    buffer_store_dwordx4 v[144:147], v248, s[36:39], 0 offen offset:2048 sc1
    v_pk_mul_f32 v[152:153], v[152:153], v[228:229]
    v_pk_mul_f32 v[154:155], v[154:155], v[228:229]
    v_pk_mul_f32 v[156:157], v[156:157], v[228:229]
    v_pk_mul_f32 v[158:159], v[158:159], v[228:229]
    v_cvt_pk_bf16_f32 v152, v152, v153
    v_cvt_pk_bf16_f32 v153, v154, v155
    v_cvt_pk_bf16_f32 v154, v156, v157
    v_cvt_pk_bf16_f32 v155, v158, v159
    buffer_store_dwordx4 v[152:155], v248, s[36:39], 0 offen offset:3072 sc1
    s_branch L_fin
L_regw_b:
    s_sub_u32 s56, s56, 1
    s_cbranch_scc1 L_end
    s_sleep 8
    v_mov_b32 v252, s1
    global_load_dword v252, v252, s[80:81] sc1
    s_waitcnt vmcnt(0)
    v_readfirstlane_b32 s54, v252
    s_cmp_eq_u32 s54, 0
    s_cbranch_scc1 L_regw_b
    s_branch L_rdy_b
L_slow:
    s_waitcnt vmcnt(0) lgkmcnt(0)
    v_add_u32 v1, s45, v1
    v_add_u32 v2, s45, v2
    v_add_u32 v3, s45, v3
    v_add_u32 v4, s45, v4
    v_add_u32 v5, s45, v5
    v_add_u32 v6, s45, v6
    v_add_u32 v7, s45, v7
    v_add_u32 v8, s45, v8
    v_add_u32 v9, s45, v9
    v_add_u32 v10, s45, v10
    v_add_u32 v11, s45, v11
    v_add_u32 v12, s45, v12
L_slq0:
    s_bitcmp1_b32 s59, 0
    s_cbranch_scc0 L_slq1
    s_bitset0_b32 s59, 0
    v_accvgpr_mov_b32 a80, a0
    v_accvgpr_mov_b32 a81, a1
    v_accvgpr_mov_b32 a82, a2
    v_accvgpr_mov_b32 a83, a3
    v_accvgpr_mov_b32 a84, a4
    v_accvgpr_mov_b32 a85, a5
    v_accvgpr_mov_b32 a86, a6
    v_accvgpr_mov_b32 a87, a7
    v_accvgpr_mov_b32 a88, a8
    v_accvgpr_mov_b32 a89, a9
    v_accvgpr_mov_b32 a90, a10
    v_accvgpr_mov_b32 a91, a11
    v_accvgpr_mov_b32 a92, a12
    v_accvgpr_mov_b32 a93, a13
    v_accvgpr_mov_b32 a94, a14
    v_accvgpr_mov_b32 a95, a15
    v_mov_b32 v251, v245
    s_branch L_slt
L_slq1:
    s_bitcmp1_b32 s59, 1
    s_cbranch_scc0 L_slq2
    s_bitset0_b32 s59, 1
    v_accvgpr_mov_b32 a80, a16
    v_accvgpr_mov_b32 a81, a17
    v_accvgpr_mov_b32 a82, a18
    v_accvgpr_mov_b32 a83, a19
    v_accvgpr_mov_b32 a84, a20
    v_accvgpr_mov_b32 a85, a21
    v_accvgpr_mov_b32 a86, a22
    v_accvgpr_mov_b32 a87, a23
    v_accvgpr_mov_b32 a88, a24
    v_accvgpr_mov_b32 a89, a25
    v_accvgpr_mov_b32 a90, a26
    v_accvgpr_mov_b32 a91, a27
    v_accvgpr_mov_b32 a92, a28
    v_accvgpr_mov_b32 a93, a29
    v_accvgpr_mov_b32 a94, a30
    v_accvgpr_mov_b32 a95, a31
    v_mov_b32 v251, v246
    s_branch L_slt
L_slq2:
    s_bitcmp1_b32 s59, 2
    s_cbranch_scc0 L_slq3
    s_bitset0_b32 s59, 2
    v_accvgpr_mov_b32 a80, a32
    v_accvgpr_mov_b32 a81, a33
    v_accvgpr_mov_b32 a82, a34
    v_accvgpr_mov_b32 a83, a35
    v_accvgpr_mov_b32 a84, a36
    v_accvgpr_mov_b32 a85, a37
    v_accvgpr_mov_b32 a86, a38
    v_accvgpr_mov_b32 a87, a39
    v_accvgpr_mov_b32 a88, a40
    v_accvgpr_mov_b32 a89, a41
    v_accvgpr_mov_b32 a90, a42
    v_accvgpr_mov_b32 a91, a43
    v_accvgpr_mov_b32 a92, a44
    v_accvgpr_mov_b32 a93, a45
    v_accvgpr_mov_b32 a94, a46
    v_accvgpr_mov_b32 a95, a47
    v_mov_b32 v251, v247
    s_branch L_slt
L_slq3:
    s_bitcmp1_b32 s59, 3
    s_cbranch_scc0 L_slq4
    s_bitset0_b32 s59, 3
    v_accvgpr_mov_b32 a80, a48
    v_accvgpr_mov_b32 a81, a49
    v_accvgpr_mov_b32 a82, a50
    v_accvgpr_mov_b32 a83, a51
    v_accvgpr_mov_b32 a84, a52
    v_accvgpr_mov_b32 a85, a53
    v_accvgpr_mov_b32 a86, a54
    v_accvgpr_mov_b32 a87, a55
    v_accvgpr_mov_b32 a88, a56
    v_accvgpr_mov_b32 a89, a57
    v_accvgpr_mov_b32 a90, a58
    v_accvgpr_mov_b32 a91, a59
    v_accvgpr_mov_b32 a92, a60
    v_accvgpr_mov_b32 a93, a61
    v_accvgpr_mov_b32 a94, a62
    v_accvgpr_mov_b32 a95, a63
    v_mov_b32 v251, v248
    s_branch L_slt
L_slq4:
    s_bitcmp1_b32 s59, 4
    s_cbranch_scc0 L_slq5
    s_bitset0_b32 s59, 4
    v_accvgpr_mov_b32 a80, a64
    v_accvgpr_mov_b32 a81, a65
    v_accvgpr_mov_b32 a82, a66
    v_accvgpr_mov_b32 a83, a67
    v_accvgpr_mov_b32 a84, a68
    v_accvgpr_mov_b32 a85, a69
    v_accvgpr_mov_b32 a86, a70
    v_accvgpr_mov_b32 a87, a71
    v_accvgpr_mov_b32 a88, a72
    v_accvgpr_mov_b32 a89, a73
    v_accvgpr_mov_b32 a90, a74
    v_accvgpr_mov_b32 a91, a75
    v_accvgpr_mov_b32 a92, a76
    v_accvgpr_mov_b32 a93, a77
    v_accvgpr_mov_b32 a94, a78
    v_accvgpr_mov_b32 a95, a79
    v_mov_b32 v251, v249
    s_branch L_slt
L_slq5:
    s_add_u32 m0, s45, 16384
    s_xor_b32 s61, s3, 229376
    buffer_load_dwordx4 v241, s[64:67], s61 offen offset:0 lds
    buffer_load_dwordx4 v242, s[64:67], s61 offen offset:1024 lds
    buffer_load_dwordx4 v243, s[64:67], s61 offen offset:2048 lds
    buffer_load_dwordx4 v244, s[64:67], s61 offen offset:3072 lds
    s_add_u32 m0, s45, 65536
    s_xor_b32 s61, s3, 196736
    buffer_load_dwordx4 v241, s[64:67], s61 offen offset:0 lds
    buffer_load_dwordx4 v242, s[64:67], s61 offen offset:1024 lds
    buffer_load_dwordx4 v243, s[64:67], s61 offen offset:2048 lds
    buffer_load_dwordx4 v244, s[64:67], s61 offen offset:3072 lds
    s_waitcnt vmcnt(0)
    s_branch L_p2
L_slt:
    v_mov_b32 v216, 0xff61b1e6
    v_mov_b32 v236, 0
    v_mov_b32 v160, 0
    v_mov_b32 v161, 0
    v_mov_b32 v162, 0
    v_mov_b32 v163, 0
    v_mov_b32 v164, 0
    v_mov_b32 v165, 0
    v_mov_b32 v166, 0
    v_mov_b32 v167, 0
    v_mov_b32 v168, 0
    v_mov_b32 v169, 0
    v_mov_b32 v170, 0
    v_mov_b32 v171, 0
    v_mov_b32 v172, 0
    v_mov_b32 v173, 0
    v_mov_b32 v174, 0
    v_mov_b32 v175, 0
    v_mov_b32 v176, 0
    v_mov_b32 v177, 0
    v_mov_b32 v178, 0
    v_mov_b32 v179, 0
    v_mov_b32 v180, 0
    v_mov_b32 v181, 0
    v_mov_b32 v182, 0
    v_mov_b32 v183, 0
    v_mov_b32 v184, 0
    v_mov_b32 v185, 0
    v_mov_b32 v186, 0
    v_mov_b32 v187, 0
    v_mov_b32 v188, 0
    v_mov_b32 v189, 0
    v_mov_b32 v190, 0
    v_mov_b32 v191, 0
    s_mov_b32 s52, 0
L_sll:
    s_add_u32 s53, s52, 4096
    s_add_u32 m0, s45, 0
    s_nop 0
    buffer_load_dwordx4 v13, s[28:31], s52 offen offset:0 nt lds
    buffer_load_dwordx4 v14, s[28:31], s52 offen offset:1024 nt lds
    buffer_load_dwordx4 v15, s[28:31], s52 offen offset:2048 nt lds
    buffer_load_dwordx4 v16, s[28:31], s52 offen offset:3072 nt lds
    s_add_u32 m0, s45, 16384
    s_nop 0
    buffer_load_dwordx4 v13, s[28:31], s53 offen offset:0 nt lds
    buffer_load_dwordx4 v14, s[28:31], s53 offen offset:1024 nt lds
    buffer_load_dwordx4 v15, s[28:31], s53 offen offset:2048 nt lds
    buffer_load_dwordx4 v16, s[28:31], s53 offen offset:3072 nt lds
    s_add_u32 m0, s45, 65536
    s_nop 0
    buffer_load_dwordx4 v17, s[32:35], s52 offen offset:0 nt lds
    buffer_load_dwordx4 v18, s[32:35], s52 offen offset:1024 nt lds
    buffer_load_dwordx4 v17, s[32:35], s52 offen offset:2048 nt lds
    buffer_load_dwordx4 v18, s[32:35], s52 offen offset:3072 nt lds
    s_add_u32 m0, s45, 81920
    s_nop 0
    buffer_load_dwordx4 v17, s[32:35], s53 offen offset:0 nt lds
    buffer_load_dwordx4 v18, s[32:35], s53 offen offset:1024 nt lds
    buffer_load_dwordx4 v17, s[32:35], s53 offen offset:2048 nt lds
    buffer_load_dwordx4 v18, s[32:35], s53 offen offset:3072 nt lds
    s_waitcnt vmcnt(0)
    ds_read_b128 a[112:115], v1 offset:0
    ds_read_b128 a[116:119], v2 offset:0
    ds_read_b128 a[120:123], v3 offset:0
    ds_read_b128 a[124:127], v4 offset:0
    ds_read_b128 a[128:131], v1 offset:16384
    ds_read_b128 a[132:135], v2 offset:16384
    ds_read_b128 a[136:139], v3 offset:16384
    ds_read_b128 a[140:143], v4 offset:16384
    s_waitcnt lgkmcnt(0)
    ds_read_b64_tr_b16 a[176:177], v5 offset:0
    ds_read_b64_tr_b16 a[178:179], v5 offset:16384
    ds_read_b64_tr_b16 a[180:181], v6 offset:0
    ds_read_b64_tr_b16 a[182:183], v6 offset:16384
    ds_read_b64_tr_b16 a[184:185], v7 offset:0
    ds_read_b64_tr_b16 a[186:187], v7 offset:16384
    ds_read_b64_tr_b16 a[188:189], v8 offset:0
    ds_read_b64_tr_b16 a[190:191], v8 offset:16384
    ds_read_b64_tr_b16 a[192:193], v9 offset:0
    ds_read_b64_tr_b16 a[194:195], v9 offset:16384
    ds_read_b64_tr_b16 a[196:197], v10 offset:0
    ds_read_b64_tr_b16 a[198:199], v10 offset:16384
    ds_read_b64_tr_b16 a[200:201], v11 offset:0
    ds_read_b64_tr_b16 a[202:203], v11 offset:16384
    ds_read_b64_tr_b16 a[204:205], v12 offset:0
    ds_read_b64_tr_b16 a[206:207], v12 offset:16384
    s_waitcnt lgkmcnt(0)
    v_mfma_f32_16x16x32_bf16 v[192:195], a[112:115], a[80:83], 0
    v_mfma_f32_16x16x32_bf16 v[192:195], a[116:119], a[84:87], v[192:195]
    v_mfma_f32_16x16x32_bf16 v[192:195], a[120:123], a[88:91], v[192:195]
    v_mfma_f32_16x16x32_bf16 v[192:195], a[124:127], a[92:95], v[192:195]
    v_mfma_f32_16x16x32_bf16 v[196:199], a[128:131], a[80:83], 0
    v_mfma_f32_16x16x32_bf16 v[196:199], a[132:135], a[84:87], v[196:199]
    v_mfma_f32_16x16x32_bf16 v[196:199], a[136:139], a[88:91], v[196:199]
    v_mfma_f32_16x16x32_bf16 v[196:199], a[140:143], a[92:95], v[196:199]
    s_nop 7
    v_max3_f32 v217, v192, v193, v194
    v_max3_f32 v217, v217, v195, v196
    v_max3_f32 v217, v217, v197, v198
    v_max3_f32 v217, v217, v199, v216
    v_mov_b32 v218, v217
    s_nop 1
    v_permlane32_swap_b32 v217, v218
    v_max_f32 v217, v217, v218
    v_mov_b32 v218, v217
    s_nop 1
    v_permlane16_swap_b32 v217, v218
    v_max_f32 v217, v217, v218
    v_sub_f32 v218, v216, v217
    v_exp_f32 v218, v218
    v_mov_b32 v216, v217
    v_sub_f32 v192, v192, v216
    v_sub_f32 v193, v193, v216
    v_sub_f32 v194, v194, v216
    v_sub_f32 v195, v195, v216
    v_sub_f32 v196, v196, v216
    v_sub_f32 v197, v197, v216
    v_sub_f32 v198, v198, v216
    v_sub_f32 v199, v199, v216
    v_exp_f32 v192, v192
    v_exp_f32 v193, v193
    v_exp_f32 v194, v194
    v_exp_f32 v195, v195
    v_exp_f32 v196, v196
    v_exp_f32 v197, v197
    v_exp_f32 v198, v198
    v_exp_f32 v199, v199
    v_mul_f32 v236, v236, v218
    v_add_f32 v236, v236, v192
    v_add_f32 v236, v236, v193
    v_add_f32 v236, v236, v194
    v_add_f32 v236, v236, v195
    v_add_f32 v236, v236, v196
    v_add_f32 v236, v236, v197
    v_add_f32 v236, v236, v198
    v_add_f32 v236, v236, v199
    v_cvt_pk_bf16_f32 v208, v192, v193
    v_cvt_pk_bf16_f32 v209, v194, v195
    v_cvt_pk_bf16_f32 v210, v196, v197
    v_cvt_pk_bf16_f32 v211, v198, v199
    v_mul_f32 v160, v160, v218
    v_mul_f32 v161, v161, v218
    v_mul_f32 v162, v162, v218
    v_mul_f32 v163, v163, v218
    v_mul_f32 v164, v164, v218
    v_mul_f32 v165, v165, v218
    v_mul_f32 v166, v166, v218
    v_mul_f32 v167, v167, v218
    v_mul_f32 v168, v168, v218
    v_mul_f32 v169, v169, v218
    v_mul_f32 v170, v170, v218
    v_mul_f32 v171, v171, v218
    v_mul_f32 v172, v172, v218
    v_mul_f32 v173, v173, v218
    v_mul_f32 v174, v174, v218
    v_mul_f32 v175, v175, v218
    v_mul_f32 v176, v176, v218
    v_mul_f32 v177, v177, v218
    v_mul_f32 v178, v178, v218
    v_mul_f32 v179, v179, v218
    v_mul_f32 v180, v180, v218
    v_mul_f32 v181, v181, v218
    v_mul_f32 v182, v182, v218
    v_mul_f32 v183, v183, v218
    v_mul_f32 v184, v184, v218
    v_mul_f32 v185, v185, v218
    v_mul_f32 v186, v186, v218
    v_mul_f32 v187, v187, v218
    v_mul_f32 v188, v188, v218
    v_mul_f32 v189, v189, v218
    v_mul_f32 v190, v190, v218
    v_mul_f32 v191, v191, v218
    s_nop 1
    v_mfma_f32_16x16x32_bf16 v[160:163], a[176:179], v[208:211], v[160:163]
    v_mfma_f32_16x16x32_bf16 v[164:167], a[180:183], v[208:211], v[164:167]
    v_mfma_f32_16x16x32_bf16 v[168:171], a[184:187], v[208:211], v[168:171]
    v_mfma_f32_16x16x32_bf16 v[172:175], a[188:191], v[208:211], v[172:175]
    v_mfma_f32_16x16x32_bf16 v[176:179], a[192:195], v[208:211], v[176:179]
    v_mfma_f32_16x16x32_bf16 v[180:183], a[196:199], v[208:211], v[180:183]
    v_mfma_f32_16x16x32_bf16 v[184:187], a[200:203], v[208:211], v[184:187]
    v_mfma_f32_16x16x32_bf16 v[188:191], a[204:207], v[208:211], v[188:191]
    s_nop 7
    s_add_u32 s52, s52, 8192
    s_cmp_lt_u32 s52, 0x40000
    s_cbranch_scc1 L_sll
    v_mov_b32 v218, v236
    s_nop 1
    v_permlane32_swap_b32 v236, v218
    v_add_f32 v236, v236, v218
    v_mov_b32 v218, v236
    s_nop 1
    v_permlane16_swap_b32 v236, v218
    v_add_f32 v236, v236, v218
    v_rcp_f32 v218, v236
    s_nop 0
    v_mul_f32 v160, v218, v160
    v_mul_f32 v161, v218, v161
    v_mul_f32 v162, v218, v162
    v_mul_f32 v163, v218, v163
    v_mul_f32 v164, v218, v164
    v_mul_f32 v165, v218, v165
    v_mul_f32 v166, v218, v166
    v_mul_f32 v167, v218, v167
    v_cvt_pk_bf16_f32 v160, v160, v161
    v_cvt_pk_bf16_f32 v161, v162, v163
    v_cvt_pk_bf16_f32 v162, v164, v165
    v_cvt_pk_bf16_f32 v163, v166, v167
    buffer_store_dwordx4 v[160:163], v251, s[36:39], 0 offen offset:0 sc1
    v_mul_f32 v168, v218, v168
    v_mul_f32 v169, v218, v169
    v_mul_f32 v170, v218, v170
    v_mul_f32 v171, v218, v171
    v_mul_f32 v172, v218, v172
    v_mul_f32 v173, v218, v173
    v_mul_f32 v174, v218, v174
    v_mul_f32 v175, v218, v175
    v_cvt_pk_bf16_f32 v168, v168, v169
    v_cvt_pk_bf16_f32 v169, v170, v171
    v_cvt_pk_bf16_f32 v170, v172, v173
    v_cvt_pk_bf16_f32 v171, v174, v175
    buffer_store_dwordx4 v[168:171], v251, s[36:39], 0 offen offset:1024 sc1
    v_mul_f32 v176, v218, v176
    v_mul_f32 v177, v218, v177
    v_mul_f32 v178, v218, v178
    v_mul_f32 v179, v218, v179
    v_mul_f32 v180, v218, v180
    v_mul_f32 v181, v218, v181
    v_mul_f32 v182, v218, v182
    v_mul_f32 v183, v218, v183
    v_cvt_pk_bf16_f32 v176, v176, v177
    v_cvt_pk_bf16_f32 v177, v178, v179
    v_cvt_pk_bf16_f32 v178, v180, v181
    v_cvt_pk_bf16_f32 v179, v182, v183
    buffer_store_dwordx4 v[176:179], v251, s[36:39], 0 offen offset:2048 sc1
    v_mul_f32 v184, v218, v184
    v_mul_f32 v185, v218, v185
    v_mul_f32 v186, v218, v186
    v_mul_f32 v187, v218, v187
    v_mul_f32 v188, v218, v188
    v_mul_f32 v189, v218, v189
    v_mul_f32 v190, v218, v190
    v_mul_f32 v191, v218, v191
    v_cvt_pk_bf16_f32 v184, v184, v185
    v_cvt_pk_bf16_f32 v185, v186, v187
    v_cvt_pk_bf16_f32 v186, v188, v189
    v_cvt_pk_bf16_f32 v187, v190, v191
    buffer_store_dwordx4 v[184:187], v251, s[36:39], 0 offen offset:3072 sc1
    s_waitcnt vmcnt(0)
    s_branch L_slq0
L_fin:
    s_waitcnt vmcnt(32)
    v_cmp_ne_u32 s[52:53], s58, v253
    v_cmp_eq_u32 vcc, 0, v253
    s_cmp_lg_u32 vcc_hi, 0
    s_cbranch_scc1 L_flw
L_fok:
    s_mov_b32 s48, s52
    s_cmp_lg_u32 s59, 0
    s_cbranch_scc1 L_slow
L_p2:
    s_and_b32 s50, s42, 3
    s_cmp_eq_u32 s50, 3
    s_cselect_b32 s50, 0x40000000, 0
    v_add_u32 v249, s50, v249
    v_and_b32 v254, 0x30, v19
    v_lshlrev_b32 v254, 3, v254
    v_add_u32 v254, s76, v254
    v_mov_b32 v252, 1
    v_mov_b32 v251, 131072
    s_waitcnt vmcnt(37)
    ds_read_b64_tr_b16 a[0:1], v20 offset:32768
    ds_read_b64_tr_b16 a[2:3], v20 offset:34816
    ds_read_b64_tr_b16 a[4:5], v21 offset:32768
    ds_read_b64_tr_b16 a[6:7], v21 offset:34816
    ds_read_b64_tr_b16 a[8:9], v22 offset:32768
    ds_read_b64_tr_b16 a[10:11], v22 offset:34816
    ds_read_b64_tr_b16 a[12:13], v23 offset:32768
    ds_read_b64_tr_b16 a[14:15], v23 offset:34816
    s_waitcnt vmcnt(33)
    ds_read_b64_tr_b16 a[16:17], v24 offset:32768
    ds_read_b64_tr_b16 a[18:19], v24 offset:34816
    ds_read_b64_tr_b16 a[20:21], v25 offset:32768
    ds_read_b64_tr_b16 a[22:23], v25 offset:34816
    ds_read_b64_tr_b16 a[24:25], v26 offset:32768
    ds_read_b64_tr_b16 a[26:27], v26 offset:34816
    ds_read_b64_tr_b16 a[28:29], v27 offset:32768
    ds_read_b64_tr_b16 a[30:31], v27 offset:34816
    s_waitcnt lgkmcnt(0)
    s_add_u32 m0, s45, 81920
    s_xor_b32 s61, s3, 229504
    buffer_load_dwordx4 v241, s[64:67], s61 offen offset:0 lds
    buffer_load_dwordx4 v242, s[64:67], s61 offen offset:1024 lds
    buffer_load_dwordx4 v243, s[64:67], s61 offen offset:2048 lds
    buffer_load_dwordx4 v244, s[64:67], s61 offen offset:3072 lds
    s_add_u32 m0, s63, 0
    s_xor_b32 s61, s3, 262144
    buffer_load_dwordx4 v241, s[64:67], s61 offen offset:0 lds
    buffer_load_dwordx4 v242, s[64:67], s61 offen offset:1024 lds
    buffer_load_dwordx4 v243, s[64:67], s61 offen offset:2048 lds
    buffer_load_dwordx4 v244, s[64:67], s61 offen offset:3072 lds
    s_add_u32 m0, s63, 4096
    s_xor_b32 s61, s3, 262272
    buffer_load_dwordx4 v241, s[64:67], s61 offen offset:0 lds
    buffer_load_dwordx4 v242, s[64:67], s61 offen offset:1024 lds
    buffer_load_dwordx4 v243, s[64:67], s61 offen offset:2048 lds
    buffer_load_dwordx4 v244, s[64:67], s61 offen offset:3072 lds
    s_waitcnt vmcnt(12)
    s_cmp_eq_u32 s48, 0
    s_cbranch_scc1 L_flf
    global_store_dword v251, v252, s[78:79] sc1
    s_branch L_fld
L_flf:
    global_store_dword v251, v252, s[78:79]
L_fld:
    s_add_u32 m0, s45, 0
    s_xor_b32 s61, s3, 294912
    buffer_load_dwordx4 v241, s[64:67], s61 offen offset:0 lds
    buffer_load_dwordx4 v242, s[64:67], s61 offen offset:1024 lds
    buffer_load_dwordx4 v243, s[64:67], s61 offen offset:2048 lds
    buffer_load_dwordx4 v244, s[64:67], s61 offen offset:3072 lds
    global_load_dword v253, v254, s[18:19] sc1
    s_add_u32 m0, s45, 32768
    s_xor_b32 s61, s3, 295040
    buffer_load_dwordx4 v241, s[64:67], s61 offen offset:0 lds
    buffer_load_dwordx4 v242, s[64:67], s61 offen offset:1024 lds
    buffer_load_dwordx4 v243, s[64:67], s61 offen offset:2048 lds
    buffer_load_dwordx4 v244, s[64:67], s61 offen offset:3072 lds
    s_add_u32 m0, s45, 98304
    s_xor_b32 s61, s3, 327680
    buffer_load_dwordx4 v241, s[64:67], s61 offen offset:0 lds
    buffer_load_dwordx4 v242, s[64:67], s61 offen offset:1024 lds
    buffer_load_dwordx4 v243, s[64:67], s61 offen offset:2048 lds
    buffer_load_dwordx4 v244, s[64:67], s61 offen offset:3072 lds
    s_waitcnt vmcnt(8)
    v_cmp_ne_u32 vcc, 1, v253
    s_bitcmp1_b32 vcc_lo, 0
    s_cbranch_scc1 L_sp0
L_go0:
    s_mov_b32 s62, 0
    buffer_load_dwordx4 v[128:131], v245, s[68:71], s62 offen offset:0 sc1
    buffer_load_dwordx4 v[132:135], v246, s[68:71], s62 offen offset:0 sc1
    buffer_load_dwordx4 v[136:139], v247, s[68:71], s62 offen offset:0 sc1
    buffer_load_dwordx4 v[140:143], v248, s[68:71], s62 offen offset:0 sc1
    buffer_load_dwordx4 v[144:147], v249, s[68:71], s62 offen offset:0 sc1
    buffer_load_dwordx4 v[148:151], v245, s[68:71], s62 offen offset:1024 sc1
    buffer_load_dwordx4 v[152:155], v246, s[68:71], s62 offen offset:1024 sc1
    buffer_load_dwordx4 v[156:159], v247, s[68:71], s62 offen offset:1024 sc1
    buffer_load_dwordx4 v[160:163], v248, s[68:71], s62 offen offset:1024 sc1
    buffer_load_dwordx4 v[164:167], v249, s[68:71], s62 offen offset:1024 sc1
    s_waitcnt vmcnt(5) lgkmcnt(0)
    v_mfma_f32_16x16x32_bf16 v[192:195], a[208:211], v[128:131], 0
    ds_read_b64_tr_b16 a[32:33], v20 offset:49152
    v_mfma_f32_16x16x32_bf16 a[80:83], a[212:215], v[128:131], 0
    ds_read_b64_tr_b16 a[34:35], v20 offset:51200
    v_mfma_f32_16x16x32_bf16 a[84:87], a[216:219], v[128:131], 0
    ds_read_b64_tr_b16 a[36:37], v21 offset:49152
    v_mfma_f32_16x16x32_bf16 a[88:91], a[220:223], v[128:131], 0
    ds_read_b64_tr_b16 a[38:39], v21 offset:51200
    v_mfma_f32_16x16x32_bf16 v[196:199], a[208:211], v[132:135], 0
    ds_read_b64_tr_b16 a[40:41], v22 offset:49152
    v_mfma_f32_16x16x32_bf16 a[92:95], a[212:215], v[132:135], 0
    ds_read_b64_tr_b16 a[42:43], v22 offset:51200
    v_mfma_f32_16x16x32_bf16 a[96:99], a[216:219], v[132:135], 0
    ds_read_b64_tr_b16 a[44:45], v23 offset:49152
    v_mfma_f32_16x16x32_bf16 a[100:103], a[220:223], v[132:135], 0
    ds_read_b64_tr_b16 a[46:47], v23 offset:51200
    v_mfma_f32_16x16x32_bf16 v[200:203], a[208:211], v[136:139], 0
    buffer_load_dwordx4 v[168:171], v245, s[68:71], s62 offen offset:2048 sc1
    v_mfma_f32_16x16x32_bf16 a[104:107], a[212:215], v[136:139], 0
    buffer_load_dwordx4 v[172:175], v246, s[68:71], s62 offen offset:2048 sc1
    v_mfma_f32_16x16x32_bf16 a[108:111], a[216:219], v[136:139], 0
    buffer_load_dwordx4 v[176:179], v247, s[68:71], s62 offen offset:2048 sc1
    v_mfma_f32_16x16x32_bf16 a[112:115], a[220:223], v[136:139], 0
    buffer_load_dwordx4 v[180:183], v248, s[68:71], s62 offen offset:2048 sc1
    v_mfma_f32_16x16x32_bf16 v[204:207], a[208:211], v[140:143], 0
    buffer_load_dwordx4 v[184:187], v249, s[68:71], s62 offen offset:2048 sc1
    v_mfma_f32_16x16x32_bf16 a[116:119], a[212:215], v[140:143], 0
    v_mfma_f32_16x16x32_bf16 a[120:123], a[216:219], v[140:143], 0
    v_mfma_f32_16x16x32_bf16 a[124:127], a[220:223], v[140:143], 0
    v_mfma_f32_16x16x32_bf16 v[208:211], a[208:211], v[144:147], 0
    v_mfma_f32_16x16x32_bf16 a[128:131], a[212:215], v[144:147], 0
    v_mfma_f32_16x16x32_bf16 a[132:135], a[216:219], v[144:147], 0
    v_mfma_f32_16x16x32_bf16 a[136:139], a[220:223], v[144:147], 0
    s_waitcnt vmcnt(61) lgkmcnt(0)
    v_mfma_f32_16x16x32_bf16 v[212:215], a[224:227], v[128:131], 0
    ds_read_b64_tr_b16 a[48:49], v24 offset:49152
    v_mfma_f32_16x16x32_bf16 a[140:143], a[228:231], v[128:131], 0
    ds_read_b64_tr_b16 a[50:51], v24 offset:51200
    v_mfma_f32_16x16x32_bf16 a[144:147], a[232:235], v[128:131], 0
    ds_read_b64_tr_b16 a[52:53], v25 offset:49152
    v_mfma_f32_16x16x32_bf16 a[148:151], a[236:239], v[128:131], 0
    ds_read_b64_tr_b16 a[54:55], v25 offset:51200
    v_mfma_f32_16x16x32_bf16 v[216:219], a[224:227], v[132:135], 0
    ds_read_b64_tr_b16 a[56:57], v26 offset:49152
    v_mfma_f32_16x16x32_bf16 a[152:155], a[228:231], v[132:135], 0
    ds_read_b64_tr_b16 a[58:59], v26 offset:51200
    v_mfma_f32_16x16x32_bf16 a[156:159], a[232:235], v[132:135], 0
    ds_read_b64_tr_b16 a[60:61], v27 offset:49152
    v_mfma_f32_16x16x32_bf16 a[160:163], a[236:239], v[132:135], 0
    ds_read_b64_tr_b16 a[62:63], v27 offset:51200
    v_mfma_f32_16x16x32_bf16 v[220:223], a[224:227], v[136:139], 0
    global_load_dword v253, v254, s[18:19] sc1
    v_mfma_f32_16x16x32_bf16 a[164:167], a[228:231], v[136:139], 0
    s_add_u32 m0, s45, 49152
    v_mfma_f32_16x16x32_bf16 a[168:171], a[232:235], v[136:139], 0
    s_xor_b32 s61, s3, 327808
    v_mfma_f32_16x16x32_bf16 a[172:175], a[236:239], v[136:139], 0
    buffer_load_dwordx4 v241, s[64:67], s61 offen offset:0 lds
    v_mfma_f32_16x16x32_bf16 v[224:227], a[224:227], v[140:143], 0
    buffer_load_dwordx4 v242, s[64:67], s61 offen offset:1024 lds
    v_mfma_f32_16x16x32_bf16 a[176:179], a[228:231], v[140:143], 0
    buffer_load_dwordx4 v243, s[64:67], s61 offen offset:2048 lds
    v_mfma_f32_16x16x32_bf16 a[180:183], a[232:235], v[140:143], 0
    buffer_load_dwordx4 v244, s[64:67], s61 offen offset:3072 lds
    v_mfma_f32_16x16x32_bf16 a[184:187], a[236:239], v[140:143], 0
    v_mfma_f32_16x16x32_bf16 v[228:231], a[224:227], v[144:147], 0
    v_mfma_f32_16x16x32_bf16 a[188:191], a[228:231], v[144:147], 0
    v_mfma_f32_16x16x32_bf16 a[192:195], a[232:235], v[144:147], 0
    v_mfma_f32_16x16x32_bf16 a[196:199], a[236:239], v[144:147], 0
    s_waitcnt vmcnt(10) lgkmcnt(0)
    v_mfma_f32_16x16x32_bf16 v[192:195], a[240:243], v[148:151], v[192:195]
    ds_read_b64_tr_b16 a[64:65], v24 offset:0
    v_mfma_f32_16x16x32_bf16 a[80:83], a[244:247], v[148:151], a[80:83]
    ds_read_b64_tr_b16 a[66:67], v24 offset:2048
    v_mfma_f32_16x16x32_bf16 a[84:87], a[248:251], v[148:151], a[84:87]
    ds_read_b64_tr_b16 a[68:69], v25 offset:0
    v_mfma_f32_16x16x32_bf16 a[88:91], a[252:255], v[148:151], a[88:91]
    ds_read_b64_tr_b16 a[70:71], v25 offset:2048
    v_mfma_f32_16x16x32_bf16 v[196:199], a[240:243], v[152:155], v[196:199]
    ds_read_b64_tr_b16 a[72:73], v26 offset:0
    v_mfma_f32_16x16x32_bf16 a[92:95], a[244:247], v[152:155], a[92:95]
    ds_read_b64_tr_b16 a[74:75], v26 offset:2048
    v_mfma_f32_16x16x32_bf16 a[96:99], a[248:251], v[152:155], a[96:99]
    ds_read_b64_tr_b16 a[76:77], v27 offset:0
    v_mfma_f32_16x16x32_bf16 a[100:103], a[252:255], v[152:155], a[100:103]
    ds_read_b64_tr_b16 a[78:79], v27 offset:2048
    v_mfma_f32_16x16x32_bf16 v[200:203], a[240:243], v[156:159], v[200:203]
    buffer_load_dwordx4 v[128:131], v245, s[68:71], s62 offen offset:3072 sc1
    v_mfma_f32_16x16x32_bf16 a[104:107], a[244:247], v[156:159], a[104:107]
    buffer_load_dwordx4 v[132:135], v246, s[68:71], s62 offen offset:3072 sc1
    v_mfma_f32_16x16x32_bf16 a[108:111], a[248:251], v[156:159], a[108:111]
    buffer_load_dwordx4 v[136:139], v247, s[68:71], s62 offen offset:3072 sc1
    v_mfma_f32_16x16x32_bf16 a[112:115], a[252:255], v[156:159], a[112:115]
    buffer_load_dwordx4 v[140:143], v248, s[68:71], s62 offen offset:3072 sc1
    v_mfma_f32_16x16x32_bf16 v[204:207], a[240:243], v[160:163], v[204:207]
    buffer_load_dwordx4 v[144:147], v249, s[68:71], s62 offen offset:3072 sc1
    v_mfma_f32_16x16x32_bf16 a[116:119], a[244:247], v[160:163], a[116:119]
    v_mfma_f32_16x16x32_bf16 a[120:123], a[248:251], v[160:163], a[120:123]
    v_mfma_f32_16x16x32_bf16 a[124:127], a[252:255], v[160:163], a[124:127]
    v_mfma_f32_16x16x32_bf16 v[208:211], a[240:243], v[164:167], v[208:211]
    v_mfma_f32_16x16x32_bf16 a[128:131], a[244:247], v[164:167], a[128:131]
    v_mfma_f32_16x16x32_bf16 a[132:135], a[248:251], v[164:167], a[132:135]
    v_mfma_f32_16x16x32_bf16 a[136:139], a[252:255], v[164:167], a[136:139]
    s_waitcnt vmcnt(59) lgkmcnt(0)
    v_mfma_f32_16x16x32_bf16 v[212:215], v[32:35], v[148:151], v[212:215]
    ds_read_b64_tr_b16 v[2:3], v20 offset:16384
    v_mfma_f32_16x16x32_bf16 a[140:143], v[36:39], v[148:151], a[140:143]
    ds_read_b64_tr_b16 v[4:5], v20 offset:18432
    v_mfma_f32_16x16x32_bf16 a[144:147], v[40:43], v[148:151], a[144:147]
    ds_read_b64_tr_b16 v[6:7], v21 offset:16384
    v_mfma_f32_16x16x32_bf16 a[148:151], v[44:47], v[148:151], a[148:151]
    ds_read_b64_tr_b16 v[8:9], v21 offset:18432
    v_mfma_f32_16x16x32_bf16 v[216:219], v[32:35], v[152:155], v[216:219]
    ds_read_b64_tr_b16 v[10:11], v22 offset:16384
    v_mfma_f32_16x16x32_bf16 a[152:155], v[36:39], v[152:155], a[152:155]
    ds_read_b64_tr_b16 v[12:13], v22 offset:18432
    v_mfma_f32_16x16x32_bf16 a[156:159], v[40:43], v[152:155], a[156:159]
    ds_read_b64_tr_b16 v[14:15], v23 offset:16384
    v_mfma_f32_16x16x32_bf16 a[160:163], v[44:47], v[152:155], a[160:163]
    ds_read_b64_tr_b16 v[16:17], v23 offset:18432
    v_mfma_f32_16x16x32_bf16 v[220:223], v[32:35], v[156:159], v[220:223]
    s_add_u32 m0, s45, 114688
    v_mfma_f32_16x16x32_bf16 a[164:167], v[36:39], v[156:159], a[164:167]
    s_xor_b32 s61, s3, 360448
    v_mfma_f32_16x16x32_bf16 a[168:171], v[40:43], v[156:159], a[168:171]
    buffer_load_dwordx4 v241, s[64:67], s61 offen offset:0 lds
    v_mfma_f32_16x16x32_bf16 a[172:175], v[44:47], v[156:159], a[172:175]
    buffer_load_dwordx4 v242, s[64:67], s61 offen offset:1024 lds
    v_mfma_f32_16x16x32_bf16 v[224:227], v[32:35], v[160:163], v[224:227]
    buffer_load_dwordx4 v243, s[64:67], s61 offen offset:2048 lds
    v_mfma_f32_16x16x32_bf16 a[176:179], v[36:39], v[160:163], a[176:179]
    buffer_load_dwordx4 v244, s[64:67], s61 offen offset:3072 lds
    v_mfma_f32_16x16x32_bf16 a[180:183], v[40:43], v[160:163], a[180:183]
    v_mfma_f32_16x16x32_bf16 a[184:187], v[44:47], v[160:163], a[184:187]
    v_mfma_f32_16x16x32_bf16 v[228:231], v[32:35], v[164:167], v[228:231]
    v_mfma_f32_16x16x32_bf16 a[188:191], v[36:39], v[164:167], a[188:191]
    v_mfma_f32_16x16x32_bf16 a[192:195], v[40:43], v[164:167], a[192:195]
    v_mfma_f32_16x16x32_bf16 a[196:199], v[44:47], v[164:167], a[196:199]
    s_waitcnt vmcnt(13) lgkmcnt(0)
    v_mfma_f32_16x16x32_bf16 v[192:195], v[48:51], v[168:171], v[192:195]
    ds_read_b64_tr_b16 a[208:209], v24 offset:16384
    v_mfma_f32_16x16x32_bf16 a[80:83], v[52:55], v[168:171], a[80:83]
    ds_read_b64_tr_b16 a[210:211], v24 offset:18432
    v_mfma_f32_16x16x32_bf16 a[84:87], v[56:59], v[168:171], a[84:87]
    ds_read_b64_tr_b16 a[212:213], v25 offset:16384
    v_mfma_f32_16x16x32_bf16 a[88:91], v[60:63], v[168:171], a[88:91]
    ds_read_b64_tr_b16 a[214:215], v25 offset:18432
    v_mfma_f32_16x16x32_bf16 v[196:199], v[48:51], v[172:175], v[196:199]
    ds_read_b64_tr_b16 a[216:217], v26 offset:16384
    v_mfma_f32_16x16x32_bf16 a[92:95], v[52:55], v[172:175], a[92:95]
    ds_read_b64_tr_b16 a[218:219], v26 offset:18432
    v_mfma_f32_16x16x32_bf16 a[96:99], v[56:59], v[172:175], a[96:99]
    ds_read_b64_tr_b16 a[220:221], v27 offset:16384
    v_mfma_f32_16x16x32_bf16 a[100:103], v[60:63], v[172:175], a[100:103]
    ds_read_b64_tr_b16 a[222:223], v27 offset:18432
    v_mfma_f32_16x16x32_bf16 v[200:203], v[48:51], v[176:179], v[200:203]
    v_cmp_ne_u32 vcc, 1, v253
    v_mfma_f32_16x16x32_bf16 a[104:107], v[52:55], v[176:179], a[104:107]
    s_bitcmp1_b32 vcc_lo, 1
    s_cbranch_scc1 L_sp1
L_go1:
    v_mfma_f32_16x16x32_bf16 a[108:111], v[56:59], v[176:179], a[108:111]
    s_mov_b32 s62, 32768
    v_mfma_f32_16x16x32_bf16 a[112:115], v[60:63], v[176:179], a[112:115]
    buffer_load_dwordx4 v[148:151], v245, s[68:71], s62 offen offset:0 sc1
    v_mfma_f32_16x16x32_bf16 v[204:207], v[48:51], v[180:183], v[204:207]
    buffer_load_dwordx4 v[152:155], v246, s[68:71], s62 offen offset:0 sc1
    v_mfma_f32_16x16x32_bf16 a[116:119], v[52:55], v[180:183], a[116:119]
    buffer_load_dwordx4 v[156:159], v247, s[68:71], s62 offen offset:0 sc1
    v_mfma_f32_16x16x32_bf16 a[120:123], v[56:59], v[180:183], a[120:123]
    buffer_load_dwordx4 v[160:163], v248, s[68:71], s62 offen offset:0 sc1
    v_mfma_f32_16x16x32_bf16 a[124:127], v[60:63], v[180:183], a[124:127]
    buffer_load_dwordx4 v[164:167], v249, s[68:71], s62 offen offset:0 sc1
    v_mfma_f32_16x16x32_bf16 v[208:211], v[48:51], v[184:187], v[208:211]
    v_mfma_f32_16x16x32_bf16 a[128:131], v[52:55], v[184:187], a[128:131]
    v_mfma_f32_16x16x32_bf16 a[132:135], v[56:59], v[184:187], a[132:135]
    v_mfma_f32_16x16x32_bf16 a[136:139], v[60:63], v[184:187], a[136:139]
    s_waitcnt vmcnt(52) lgkmcnt(0)
    v_mfma_f32_16x16x32_bf16 v[212:215], v[64:67], v[168:171], v[212:215]
    ds_read_b64_tr_b16 a[224:225], v28 offset:0
    v_mfma_f32_16x16x32_bf16 a[140:143], v[68:71], v[168:171], a[140:143]
    ds_read_b64_tr_b16 a[226:227], v28 offset:2048
    v_mfma_f32_16x16x32_bf16 a[144:147], v[72:75], v[168:171], a[144:147]
    ds_read_b64_tr_b16 a[228:229], v29 offset:0
    v_mfma_f32_16x16x32_bf16 a[148:151], v[76:79], v[168:171], a[148:151]
    ds_read_b64_tr_b16 a[230:231], v29 offset:2048
    v_mfma_f32_16x16x32_bf16 v[216:219], v[64:67], v[172:175], v[216:219]
    ds_read_b64_tr_b16 a[232:233], v30 offset:0
    v_mfma_f32_16x16x32_bf16 a[152:155], v[68:71], v[172:175], a[152:155]
    ds_read_b64_tr_b16 a[234:235], v30 offset:2048
    v_mfma_f32_16x16x32_bf16 a[156:159], v[72:75], v[172:175], a[156:159]
    ds_read_b64_tr_b16 a[236:237], v31 offset:0
    v_mfma_f32_16x16x32_bf16 a[160:163], v[76:79], v[172:175], a[160:163]
    ds_read_b64_tr_b16 a[238:239], v31 offset:2048
    v_mfma_f32_16x16x32_bf16 v[220:223], v[64:67], v[176:179], v[220:223]
    s_add_u32 m0, s45, 65536
    v_mfma_f32_16x16x32_bf16 a[164:167], v[68:71], v[176:179], a[164:167]
    s_xor_b32 s61, s3, 360576
    v_mfma_f32_16x16x32_bf16 a[168:171], v[72:75], v[176:179], a[168:171]
    buffer_load_dwordx4 v241, s[64:67], s61 offen offset:0 lds
    v_mfma_f32_16x16x32_bf16 a[172:175], v[76:79], v[176:179], a[172:175]
    buffer_load_dwordx4 v242, s[64:67], s61 offen offset:1024 lds
    v_mfma_f32_16x16x32_bf16 v[224:227], v[64:67], v[180:183], v[224:227]
    buffer_load_dwordx4 v243, s[64:67], s61 offen offset:2048 lds
    v_mfma_f32_16x16x32_bf16 a[176:179], v[68:71], v[180:183], a[176:179]
    buffer_load_dwordx4 v244, s[64:67], s61 offen offset:3072 lds
    v_mfma_f32_16x16x32_bf16 a[180:183], v[72:75], v[180:183], a[180:183]
    v_mfma_f32_16x16x32_bf16 a[184:187], v[76:79], v[180:183], a[184:187]
    v_mfma_f32_16x16x32_bf16 v[228:231], v[64:67], v[184:187], v[228:231]
    v_mfma_f32_16x16x32_bf16 a[188:191], v[68:71], v[184:187], a[188:191]
    v_mfma_f32_16x16x32_bf16 a[192:195], v[72:75], v[184:187], a[192:195]
    v_mfma_f32_16x16x32_bf16 a[196:199], v[76:79], v[184:187], a[196:199]
    s_waitcnt vmcnt(13) lgkmcnt(0)
    v_mfma_f32_16x16x32_bf16 v[192:195], v[80:83], v[128:131], v[192:195]
    ds_read_b64_tr_b16 a[240:241], v28 offset:4096
    v_mfma_f32_16x16x32_bf16 a[80:83], v[84:87], v[128:131], a[80:83]
    ds_read_b64_tr_b16 a[242:243], v28 offset:6144
    v_mfma_f32_16x16x32_bf16 a[84:87], v[88:91], v[128:131], a[84:87]
    ds_read_b64_tr_b16 a[244:245], v29 offset:4096
    v_mfma_f32_16x16x32_bf16 a[88:91], v[92:95], v[128:131], a[88:91]
    ds_read_b64_tr_b16 a[246:247], v29 offset:6144
    v_mfma_f32_16x16x32_bf16 v[196:199], v[80:83], v[132:135], v[196:199]
    ds_read_b64_tr_b16 a[248:249], v30 offset:4096
    v_mfma_f32_16x16x32_bf16 a[92:95], v[84:87], v[132:135], a[92:95]
    ds_read_b64_tr_b16 a[250:251], v30 offset:6144
    v_mfma_f32_16x16x32_bf16 a[96:99], v[88:91], v[132:135], a[96:99]
    ds_read_b64_tr_b16 a[252:253], v31 offset:4096
    v_mfma_f32_16x16x32_bf16 a[100:103], v[92:95], v[132:135], a[100:103]
    ds_read_b64_tr_b16 a[254:255], v31 offset:6144
    v_mfma_f32_16x16x32_bf16 v[200:203], v[80:83], v[136:139], v[200:203]
    buffer_load_dwordx4 v[168:171], v245, s[68:71], s62 offen offset:1024 sc1
    v_mfma_f32_16x16x32_bf16 a[104:107], v[84:87], v[136:139], a[104:107]
    buffer_load_dwordx4 v[172:175], v246, s[68:71], s62 offen offset:1024 sc1
    v_mfma_f32_16x16x32_bf16 a[108:111], v[88:91], v[136:139], a[108:111]
    buffer_load_dwordx4 v[176:179], v247, s[68:71], s62 offen offset:1024 sc1
    v_mfma_f32_16x16x32_bf16 a[112:115], v[92:95], v[136:139], a[112:115]
    buffer_load_dwordx4 v[180:183], v248, s[68:71], s62 offen offset:1024 sc1
    v_mfma_f32_16x16x32_bf16 v[204:207], v[80:83], v[140:143], v[204:207]
    buffer_load_dwordx4 v[184:187], v249, s[68:71], s62 offen offset:1024 sc1
    v_mfma_f32_16x16x32_bf16 a[116:119], v[84:87], v[140:143], a[116:119]
    v_mfma_f32_16x16x32_bf16 a[120:123], v[88:91], v[140:143], a[120:123]
    v_mfma_f32_16x16x32_bf16 a[124:127], v[92:95], v[140:143], a[124:127]
    v_mfma_f32_16x16x32_bf16 v[208:211], v[80:83], v[144:147], v[208:211]
    v_mfma_f32_16x16x32_bf16 a[128:131], v[84:87], v[144:147], a[128:131]
    v_mfma_f32_16x16x32_bf16 a[132:135], v[88:91], v[144:147], a[132:135]
    v_mfma_f32_16x16x32_bf16 a[136:139], v[92:95], v[144:147], a[136:139]
    s_waitcnt lgkmcnt(0)
    v_mfma_f32_16x16x32_bf16 v[212:215], v[96:99], v[128:131], v[212:215]
    s_add_u32 m0, s45, 16384
    v_mfma_f32_16x16x32_bf16 a[140:143], v[100:103], v[128:131], a[140:143]
    s_xor_b32 s61, s3, 393216
    v_mfma_f32_16x16x32_bf16 a[144:147], v[104:107], v[128:131], a[144:147]
    buffer_load_dwordx4 v241, s[64:67], s61 offen offset:0 lds
    v_mfma_f32_16x16x32_bf16 a[148:151], v[108:111], v[128:131], a[148:151]
    buffer_load_dwordx4 v242, s[64:67], s61 offen offset:1024 lds
    v_mfma_f32_16x16x32_bf16 v[216:219], v[96:99], v[132:135], v[216:219]
    buffer_load_dwordx4 v243, s[64:67], s61 offen offset:2048 lds
    v_mfma_f32_16x16x32_bf16 a[152:155], v[100:103], v[132:135], a[152:155]
    buffer_load_dwordx4 v244, s[64:67], s61 offen offset:3072 lds
    v_mfma_f32_16x16x32_bf16 a[156:159], v[104:107], v[132:135], a[156:159]
    v_mfma_f32_16x16x32_bf16 a[160:163], v[108:111], v[132:135], a[160:163]
    v_mfma_f32_16x16x32_bf16 v[220:223], v[96:99], v[136:139], v[220:223]
    v_mfma_f32_16x16x32_bf16 a[164:167], v[100:103], v[136:139], a[164:167]
    v_mfma_f32_16x16x32_bf16 a[168:171], v[104:107], v[136:139], a[168:171]
    v_mfma_f32_16x16x32_bf16 a[172:175], v[108:111], v[136:139], a[172:175]
    v_mfma_f32_16x16x32_bf16 v[224:227], v[96:99], v[140:143], v[224:227]
    v_mfma_f32_16x16x32_bf16 a[176:179], v[100:103], v[140:143], a[176:179]
    v_mfma_f32_16x16x32_bf16 a[180:183], v[104:107], v[140:143], a[180:183]
    v_mfma_f32_16x16x32_bf16 a[184:187], v[108:111], v[140:143], a[184:187]
    v_mfma_f32_16x16x32_bf16 v[228:231], v[96:99], v[144:147], v[228:231]
    v_mfma_f32_16x16x32_bf16 a[188:191], v[100:103], v[144:147], a[188:191]
    v_mfma_f32_16x16x32_bf16 a[192:195], v[104:107], v[144:147], a[192:195]
    v_mfma_f32_16x16x32_bf16 a[196:199], v[108:111], v[144:147], a[196:199]
    s_waitcnt vmcnt(13) lgkmcnt(0)
    v_mfma_f32_16x16x32_bf16 v[192:195], v[112:115], v[148:151], v[192:195]
    buffer_load_dwordx4 v[128:131], v245, s[68:71], s62 offen offset:2048 sc1
    v_mfma_f32_16x16x32_bf16 a[80:83], v[116:119], v[148:151], a[80:83]
    buffer_load_dwordx4 v[132:135], v246, s[68:71], s62 offen offset:2048 sc1
    v_mfma_f32_16x16x32_bf16 a[84:87], v[120:123], v[148:151], a[84:87]
    buffer_load_dwordx4 v[136:139], v247, s[68:71], s62 offen offset:2048 sc1
    v_mfma_f32_16x16x32_bf16 a[88:91], v[124:127], v[148:151], a[88:91]
    buffer_load_dwordx4 v[140:143], v248, s[68:71], s62 offen offset:2048 sc1
    v_mfma_f32_16x16x32_bf16 v[196:199], v[112:115], v[152:155], v[196:199]
    buffer_load_dwordx4 v[144:147], v249, s[68:71], s62 offen offset:2048 sc1
    v_mfma_f32_16x16x32_bf16 a[92:95], v[116:119], v[152:155], a[92:95]
    v_mfma_f32_16x16x32_bf16 a[96:99], v[120:123], v[152:155], a[96:99]
    v_mfma_f32_16x16x32_bf16 a[100:103], v[124:127], v[152:155], a[100:103]
    v_mfma_f32_16x16x32_bf16 v[200:203], v[112:115], v[156:159], v[200:203]
    v_mfma_f32_16x16x32_bf16 a[104:107], v[116:119], v[156:159], a[104:107]
    v_mfma_f32_16x16x32_bf16 a[108:111], v[120:123], v[156:159], a[108:111]
    v_mfma_f32_16x16x32_bf16 a[112:115], v[124:127], v[156:159], a[112:115]
    v_mfma_f32_16x16x32_bf16 v[204:207], v[112:115], v[160:163], v[204:207]
    v_mfma_f32_16x16x32_bf16 a[116:119], v[116:119], v[160:163], a[116:119]
    v_mfma_f32_16x16x32_bf16 a[120:123], v[120:123], v[160:163], a[120:123]
    v_mfma_f32_16x16x32_bf16 a[124:127], v[124:127], v[160:163], a[124:127]
    v_mfma_f32_16x16x32_bf16 v[208:211], v[112:115], v[164:167], v[208:211]
    v_mfma_f32_16x16x32_bf16 a[128:131], v[116:119], v[164:167], a[128:131]
    v_mfma_f32_16x16x32_bf16 a[132:135], v[120:123], v[164:167], a[132:135]
    v_mfma_f32_16x16x32_bf16 a[136:139], v[124:127], v[164:167], a[136:139]
    s_waitcnt vmcnt(61) lgkmcnt(0)
    v_mfma_f32_16x16x32_bf16 v[212:215], a[0:3], v[148:151], v[212:215]
    ds_read_b64_tr_b16 v[112:113], v20 offset:0
    v_mfma_f32_16x16x32_bf16 a[140:143], a[4:7], v[148:151], a[140:143]
    ds_read_b64_tr_b16 v[114:115], v20 offset:2048
    v_mfma_f32_16x16x32_bf16 a[144:147], a[8:11], v[148:151], a[144:147]
    ds_read_b64_tr_b16 v[116:117], v21 offset:0
    v_mfma_f32_16x16x32_bf16 a[148:151], a[12:15], v[148:151], a[148:151]
    ds_read_b64_tr_b16 v[118:119], v21 offset:2048
    v_mfma_f32_16x16x32_bf16 v[216:219], a[0:3], v[152:155], v[216:219]
    ds_read_b64_tr_b16 v[120:121], v22 offset:0
    v_mfma_f32_16x16x32_bf16 a[152:155], a[4:7], v[152:155], a[152:155]
    ds_read_b64_tr_b16 v[122:123], v22 offset:2048
    v_mfma_f32_16x16x32_bf16 a[156:159], a[8:11], v[152:155], a[156:159]
    ds_read_b64_tr_b16 v[124:125], v23 offset:0
    v_mfma_f32_16x16x32_bf16 a[160:163], a[12:15], v[152:155], a[160:163]
    ds_read_b64_tr_b16 v[126:127], v23 offset:2048
    v_mfma_f32_16x16x32_bf16 v[220:223], a[0:3], v[156:159], v[220:223]
    global_load_dword v253, v254, s[18:19] sc1
    v_mfma_f32_16x16x32_bf16 a[164:167], a[4:7], v[156:159], a[164:167]
    s_add_u32 m0, s45, 81920
    v_mfma_f32_16x16x32_bf16 a[168:171], a[8:11], v[156:159], a[168:171]
    s_xor_b32 s61, s3, 425984
    v_mfma_f32_16x16x32_bf16 a[172:175], a[12:15], v[156:159], a[172:175]
    buffer_load_dwordx4 v241, s[64:67], s61 offen offset:0 lds
    v_mfma_f32_16x16x32_bf16 v[224:227], a[0:3], v[160:163], v[224:227]
    buffer_load_dwordx4 v242, s[64:67], s61 offen offset:1024 lds
    v_mfma_f32_16x16x32_bf16 a[176:179], a[4:7], v[160:163], a[176:179]
    buffer_load_dwordx4 v243, s[64:67], s61 offen offset:2048 lds
    v_mfma_f32_16x16x32_bf16 a[180:183], a[8:11], v[160:163], a[180:183]
    buffer_load_dwordx4 v244, s[64:67], s61 offen offset:3072 lds
    v_mfma_f32_16x16x32_bf16 a[184:187], a[12:15], v[160:163], a[184:187]
    v_mfma_f32_16x16x32_bf16 v[228:231], a[0:3], v[164:167], v[228:231]
    v_mfma_f32_16x16x32_bf16 a[188:191], a[4:7], v[164:167], a[188:191]
    v_mfma_f32_16x16x32_bf16 a[192:195], a[8:11], v[164:167], a[192:195]
    v_mfma_f32_16x16x32_bf16 a[196:199], a[12:15], v[164:167], a[196:199]
    s_waitcnt vmcnt(14) lgkmcnt(0)
    v_mfma_f32_16x16x32_bf16 v[192:195], a[16:19], v[168:171], v[192:195]
    ds_read_b64_tr_b16 a[0:1], v20 offset:32768
    v_mfma_f32_16x16x32_bf16 a[80:83], a[20:23], v[168:171], a[80:83]
    ds_read_b64_tr_b16 a[2:3], v20 offset:34816
    v_mfma_f32_16x16x32_bf16 a[84:87], a[24:27], v[168:171], a[84:87]
    ds_read_b64_tr_b16 a[4:5], v21 offset:32768
    v_mfma_f32_16x16x32_bf16 a[88:91], a[28:31], v[168:171], a[88:91]
    ds_read_b64_tr_b16 a[6:7], v21 offset:34816
    v_mfma_f32_16x16x32_bf16 v[196:199], a[16:19], v[172:175], v[196:199]
    ds_read_b64_tr_b16 a[8:9], v22 offset:32768
    v_mfma_f32_16x16x32_bf16 a[92:95], a[20:23], v[172:175], a[92:95]
    ds_read_b64_tr_b16 a[10:11], v22 offset:34816
    v_mfma_f32_16x16x32_bf16 a[96:99], a[24:27], v[172:175], a[96:99]
    ds_read_b64_tr_b16 a[12:13], v23 offset:32768
    v_mfma_f32_16x16x32_bf16 a[100:103], a[28:31], v[172:175], a[100:103]
    ds_read_b64_tr_b16 a[14:15], v23 offset:34816
    v_mfma_f32_16x16x32_bf16 v[200:203], a[16:19], v[176:179], v[200:203]
    buffer_load_dwordx4 v[148:151], v245, s[68:71], s62 offen offset:3072 sc1
    v_mfma_f32_16x16x32_bf16 a[104:107], a[20:23], v[176:179], a[104:107]
    buffer_load_dwordx4 v[152:155], v246, s[68:71], s62 offen offset:3072 sc1
    v_mfma_f32_16x16x32_bf16 a[108:111], a[24:27], v[176:179], a[108:111]
    buffer_load_dwordx4 v[156:159], v247, s[68:71], s62 offen offset:3072 sc1
    v_mfma_f32_16x16x32_bf16 a[112:115], a[28:31], v[176:179], a[112:115]
    buffer_load_dwordx4 v[160:163], v248, s[68:71], s62 offen offset:3072 sc1
    v_mfma_f32_16x16x32_bf16 v[204:207], a[16:19], v[180:183], v[204:207]
    buffer_load_dwordx4 v[164:167], v249, s[68:71], s62 offen offset:3072 sc1
    v_mfma_f32_16x16x32_bf16 a[116:119], a[20:23], v[180:183], a[116:119]
    v_mfma_f32_16x16x32_bf16 a[120:123], a[24:27], v[180:183], a[120:123]
    v_mfma_f32_16x16x32_bf16 a[124:127], a[28:31], v[180:183], a[124:127]
    v_mfma_f32_16x16x32_bf16 v[208:211], a[16:19], v[184:187], v[208:211]
    v_mfma_f32_16x16x32_bf16 a[128:131], a[20:23], v[184:187], a[128:131]
    v_mfma_f32_16x16x32_bf16 a[132:135], a[24:27], v[184:187], a[132:135]
    v_mfma_f32_16x16x32_bf16 a[136:139], a[28:31], v[184:187], a[136:139]
    s_waitcnt vmcnt(62) lgkmcnt(0)
    v_mfma_f32_16x16x32_bf16 v[212:215], a[32:35], v[168:171], v[212:215]
    ds_read_b64_tr_b16 a[16:17], v24 offset:32768
    v_mfma_f32_16x16x32_bf16 a[140:143], a[36:39], v[168:171], a[140:143]
    ds_read_b64_tr_b16 a[18:19], v24 offset:34816
    v_mfma_f32_16x16x32_bf16 a[144:147], a[40:43], v[168:171], a[144:147]
    ds_read_b64_tr_b16 a[20:21], v25 offset:32768
    v_mfma_f32_16x16x32_bf16 a[148:151], a[44:47], v[168:171], a[148:151]
    ds_read_b64_tr_b16 a[22:23], v25 offset:34816
    v_mfma_f32_16x16x32_bf16 v[216:219], a[32:35], v[172:175], v[216:219]
    ds_read_b64_tr_b16 a[24:25], v26 offset:32768
    v_mfma_f32_16x16x32_bf16 a[152:155], a[36:39], v[172:175], a[152:155]
    ds_read_b64_tr_b16 a[26:27], v26 offset:34816
    v_mfma_f32_16x16x32_bf16 a[156:159], a[40:43], v[172:175], a[156:159]
    ds_read_b64_tr_b16 a[28:29], v27 offset:32768
    v_mfma_f32_16x16x32_bf16 a[160:163], a[44:47], v[172:175], a[160:163]
    ds_read_b64_tr_b16 a[30:31], v27 offset:34816
    v_mfma_f32_16x16x32_bf16 v[220:223], a[32:35], v[176:179], v[220:223]
    s_add_u32 m0, s63, 0
    v_mfma_f32_16x16x32_bf16 a[164:167], a[36:39], v[176:179], a[164:167]
    s_xor_b32 s61, s3, 458752
    v_mfma_f32_16x16x32_bf16 a[168:171], a[40:43], v[176:179], a[168:171]
    buffer_load_dwordx4 v241, s[64:67], s61 offen offset:0 lds
    v_mfma_f32_16x16x32_bf16 a[172:175], a[44:47], v[176:179], a[172:175]
    buffer_load_dwordx4 v242, s[64:67], s61 offen offset:1024 lds
    v_mfma_f32_16x16x32_bf16 v[224:227], a[32:35], v[180:183], v[224:227]
    buffer_load_dwordx4 v243, s[64:67], s61 offen offset:2048 lds
    v_mfma_f32_16x16x32_bf16 a[176:179], a[36:39], v[180:183], a[176:179]
    buffer_load_dwordx4 v244, s[64:67], s61 offen offset:3072 lds
    v_mfma_f32_16x16x32_bf16 a[180:183], a[40:43], v[180:183], a[180:183]
    v_mfma_f32_16x16x32_bf16 a[184:187], a[44:47], v[180:183], a[184:187]
    v_mfma_f32_16x16x32_bf16 v[228:231], a[32:35], v[184:187], v[228:231]
    v_mfma_f32_16x16x32_bf16 a[188:191], a[36:39], v[184:187], a[188:191]
    v_mfma_f32_16x16x32_bf16 a[192:195], a[40:43], v[184:187], a[192:195]
    v_mfma_f32_16x16x32_bf16 a[196:199], a[44:47], v[184:187], a[196:199]
    s_waitcnt vmcnt(13) lgkmcnt(0)
    v_mfma_f32_16x16x32_bf16 v[192:195], a[48:51], v[128:131], v[192:195]
    ds_read_b64_tr_b16 a[32:33], v20 offset:49152
    v_mfma_f32_16x16x32_bf16 a[80:83], a[52:55], v[128:131], a[80:83]
    ds_read_b64_tr_b16 a[34:35], v20 offset:51200
    v_mfma_f32_16x16x32_bf16 a[84:87], a[56:59], v[128:131], a[84:87]
    ds_read_b64_tr_b16 a[36:37], v21 offset:49152
    v_mfma_f32_16x16x32_bf16 a[88:91], a[60:63], v[128:131], a[88:91]
    ds_read_b64_tr_b16 a[38:39], v21 offset:51200
    v_mfma_f32_16x16x32_bf16 v[196:199], a[48:51], v[132:135], v[196:199]
    ds_read_b64_tr_b16 a[40:41], v22 offset:49152
    v_mfma_f32_16x16x32_bf16 a[92:95], a[52:55], v[132:135], a[92:95]
    ds_read_b64_tr_b16 a[42:43], v22 offset:51200
    v_mfma_f32_16x16x32_bf16 a[96:99], a[56:59], v[132:135], a[96:99]
    ds_read_b64_tr_b16 a[44:45], v23 offset:49152
    v_mfma_f32_16x16x32_bf16 a[100:103], a[60:63], v[132:135], a[100:103]
    ds_read_b64_tr_b16 a[46:47], v23 offset:51200
    v_mfma_f32_16x16x32_bf16 v[200:203], a[48:51], v[136:139], v[200:203]
    v_cmp_ne_u32 vcc, 1, v253
    v_mfma_f32_16x16x32_bf16 a[104:107], a[52:55], v[136:139], a[104:107]
    s_bitcmp1_b32 vcc_lo, 2
    s_cbranch_scc1 L_sp2
L_go2:
    v_mfma_f32_16x16x32_bf16 a[108:111], a[56:59], v[136:139], a[108:111]
    global_load_dword v253, v254, s[18:19] sc1
    v_mfma_f32_16x16x32_bf16 a[112:115], a[60:63], v[136:139], a[112:115]
    s_mov_b32 s62, 65536
    v_mfma_f32_16x16x32_bf16 v[204:207], a[48:51], v[140:143], v[204:207]
    buffer_load_dwordx4 v[168:171], v245, s[68:71], s62 offen offset:0 sc1
    v_mfma_f32_16x16x32_bf16 a[116:119], a[52:55], v[140:143], a[116:119]
    buffer_load_dwordx4 v[172:175], v246, s[68:71], s62 offen offset:0 sc1
    v_mfma_f32_16x16x32_bf16 a[120:123], a[56:59], v[140:143], a[120:123]
    buffer_load_dwordx4 v[176:179], v247, s[68:71], s62 offen offset:0 sc1
    v_mfma_f32_16x16x32_bf16 a[124:127], a[60:63], v[140:143], a[124:127]
    buffer_load_dwordx4 v[180:183], v248, s[68:71], s62 offen offset:0 sc1
    v_mfma_f32_16x16x32_bf16 v[208:211], a[48:51], v[144:147], v[208:211]
    buffer_load_dwordx4 v[184:187], v249, s[68:71], s62 offen offset:0 sc1
    v_mfma_f32_16x16x32_bf16 a[128:131], a[52:55], v[144:147], a[128:131]
    v_mfma_f32_16x16x32_bf16 a[132:135], a[56:59], v[144:147], a[132:135]
    v_mfma_f32_16x16x32_bf16 a[136:139], a[60:63], v[144:147], a[136:139]
    s_waitcnt vmcnt(43) lgkmcnt(0)
    v_mfma_f32_16x16x32_bf16 v[212:215], a[64:67], v[128:131], v[212:215]
    ds_read_b64_tr_b16 a[48:49], v24 offset:49152
    v_mfma_f32_16x16x32_bf16 a[140:143], a[68:71], v[128:131], a[140:143]
    ds_read_b64_tr_b16 a[50:51], v24 offset:51200
    v_mfma_f32_16x16x32_bf16 a[144:147], a[72:75], v[128:131], a[144:147]
    ds_read_b64_tr_b16 a[52:53], v25 offset:49152
    v_mfma_f32_16x16x32_bf16 a[148:151], a[76:79], v[128:131], a[148:151]
    ds_read_b64_tr_b16 a[54:55], v25 offset:51200
    v_mfma_f32_16x16x32_bf16 v[216:219], a[64:67], v[132:135], v[216:219]
    ds_read_b64_tr_b16 a[56:57], v26 offset:49152
    v_mfma_f32_16x16x32_bf16 a[152:155], a[68:71], v[132:135], a[152:155]
    ds_read_b64_tr_b16 a[58:59], v26 offset:51200
    v_mfma_f32_16x16x32_bf16 a[156:159], a[72:75], v[132:135], a[156:159]
    ds_read_b64_tr_b16 a[60:61], v27 offset:49152
    v_mfma_f32_16x16x32_bf16 a[160:163], a[76:79], v[132:135], a[160:163]
    ds_read_b64_tr_b16 a[62:63], v27 offset:51200
    v_mfma_f32_16x16x32_bf16 v[220:223], a[64:67], v[136:139], v[220:223]
    s_add_u32 m0, s63, 4096
    v_mfma_f32_16x16x32_bf16 a[164:167], a[68:71], v[136:139], a[164:167]
    s_xor_b32 s61, s3, 491520
    v_mfma_f32_16x16x32_bf16 a[168:171], a[72:75], v[136:139], a[168:171]
    buffer_load_dwordx4 v241, s[64:67], s61 offen offset:0 lds
    v_mfma_f32_16x16x32_bf16 a[172:175], a[76:79], v[136:139], a[172:175]
    buffer_load_dwordx4 v242, s[64:67], s61 offen offset:1024 lds
    v_mfma_f32_16x16x32_bf16 v[224:227], a[64:67], v[140:143], v[224:227]
    buffer_load_dwordx4 v243, s[64:67], s61 offen offset:2048 lds
    v_mfma_f32_16x16x32_bf16 a[176:179], a[68:71], v[140:143], a[176:179]
    buffer_load_dwordx4 v244, s[64:67], s61 offen offset:3072 lds
    v_mfma_f32_16x16x32_bf16 a[180:183], a[72:75], v[140:143], a[180:183]
    v_mfma_f32_16x16x32_bf16 a[184:187], a[76:79], v[140:143], a[184:187]
    v_mfma_f32_16x16x32_bf16 v[228:231], a[64:67], v[144:147], v[228:231]
    v_mfma_f32_16x16x32_bf16 a[188:191], a[68:71], v[144:147], a[188:191]
    v_mfma_f32_16x16x32_bf16 a[192:195], a[72:75], v[144:147], a[192:195]
    v_mfma_f32_16x16x32_bf16 a[196:199], a[76:79], v[144:147], a[196:199]
    s_waitcnt vmcnt(14) lgkmcnt(0)
    v_mfma_f32_16x16x32_bf16 v[192:195], v[2:5], v[148:151], v[192:195]
    ds_read_b64_tr_b16 a[64:65], v24 offset:0
    v_mfma_f32_16x16x32_bf16 a[80:83], v[6:9], v[148:151], a[80:83]
    ds_read_b64_tr_b16 a[66:67], v24 offset:2048
    v_mfma_f32_16x16x32_bf16 a[84:87], v[10:13], v[148:151], a[84:87]
    ds_read_b64_tr_b16 a[68:69], v25 offset:0
    v_mfma_f32_16x16x32_bf16 a[88:91], v[14:17], v[148:151], a[88:91]
    ds_read_b64_tr_b16 a[70:71], v25 offset:2048
    v_mfma_f32_16x16x32_bf16 v[196:199], v[2:5], v[152:155], v[196:199]
    ds_read_b64_tr_b16 a[72:73], v26 offset:0
    v_mfma_f32_16x16x32_bf16 a[92:95], v[6:9], v[152:155], a[92:95]
    ds_read_b64_tr_b16 a[74:75], v26 offset:2048
    v_mfma_f32_16x16x32_bf16 a[96:99], v[10:13], v[152:155], a[96:99]
    ds_read_b64_tr_b16 a[76:77], v27 offset:0
    v_mfma_f32_16x16x32_bf16 a[100:103], v[14:17], v[152:155], a[100:103]
    ds_read_b64_tr_b16 a[78:79], v27 offset:2048
    v_mfma_f32_16x16x32_bf16 v[200:203], v[2:5], v[156:159], v[200:203]
    buffer_load_dwordx4 v[128:131], v245, s[68:71], s62 offen offset:1024 sc1
    v_mfma_f32_16x16x32_bf16 a[104:107], v[6:9], v[156:159], a[104:107]
    buffer_load_dwordx4 v[132:135], v246, s[68:71], s62 offen offset:1024 sc1
    v_mfma_f32_16x16x32_bf16 a[108:111], v[10:13], v[156:159], a[108:111]
    buffer_load_dwordx4 v[136:139], v247, s[68:71], s62 offen offset:1024 sc1
    v_mfma_f32_16x16x32_bf16 a[112:115], v[14:17], v[156:159], a[112:115]
    buffer_load_dwordx4 v[140:143], v248, s[68:71], s62 offen offset:1024 sc1
    v_mfma_f32_16x16x32_bf16 v[204:207], v[2:5], v[160:163], v[204:207]
    buffer_load_dwordx4 v[144:147], v249, s[68:71], s62 offen offset:1024 sc1
    v_mfma_f32_16x16x32_bf16 a[116:119], v[6:9], v[160:163], a[116:119]
    v_mfma_f32_16x16x32_bf16 a[120:123], v[10:13], v[160:163], a[120:123]
    v_mfma_f32_16x16x32_bf16 a[124:127], v[14:17], v[160:163], a[124:127]
    v_mfma_f32_16x16x32_bf16 v[208:211], v[2:5], v[164:167], v[208:211]
    v_mfma_f32_16x16x32_bf16 a[128:131], v[6:9], v[164:167], a[128:131]
    v_mfma_f32_16x16x32_bf16 a[132:135], v[10:13], v[164:167], a[132:135]
    v_mfma_f32_16x16x32_bf16 a[136:139], v[14:17], v[164:167], a[136:139]
    s_waitcnt vmcnt(14) lgkmcnt(0)
    v_mfma_f32_16x16x32_bf16 v[212:215], a[208:211], v[148:151], v[212:215]
    ds_read_b64_tr_b16 v[2:3], v20 offset:16384
    v_mfma_f32_16x16x32_bf16 a[140:143], a[212:215], v[148:151], a[140:143]
    ds_read_b64_tr_b16 v[4:5], v20 offset:18432
    v_mfma_f32_16x16x32_bf16 a[144:147], a[216:219], v[148:151], a[144:147]
    ds_read_b64_tr_b16 v[6:7], v21 offset:16384
    v_mfma_f32_16x16x32_bf16 a[148:151], a[220:223], v[148:151], a[148:151]
    ds_read_b64_tr_b16 v[8:9], v21 offset:18432
    v_mfma_f32_16x16x32_bf16 v[216:219], a[208:211], v[152:155], v[216:219]
    ds_read_b64_tr_b16 v[10:11], v22 offset:16384
    v_mfma_f32_16x16x32_bf16 a[152:155], a[212:215], v[152:155], a[152:155]
    ds_read_b64_tr_b16 v[12:13], v22 offset:18432
    v_mfma_f32_16x16x32_bf16 a[156:159], a[216:219], v[152:155], a[156:159]
    ds_read_b64_tr_b16 v[14:15], v23 offset:16384
    v_mfma_f32_16x16x32_bf16 a[160:163], a[220:223], v[152:155], a[160:163]
    ds_read_b64_tr_b16 v[16:17], v23 offset:18432
    v_mfma_f32_16x16x32_bf16 v[220:223], a[208:211], v[156:159], v[220:223]
    v_cmp_ne_u32 vcc, 1, v253
    v_mfma_f32_16x16x32_bf16 a[164:167], a[212:215], v[156:159], a[164:167]
    s_bitcmp1_b32 vcc_lo, 3
    s_cbranch_scc1 L_sp3
L_go3:
    v_mfma_f32_16x16x32_bf16 a[168:171], a[216:219], v[156:159], a[168:171]
    s_mov_b32 s53, 98304
    v_mfma_f32_16x16x32_bf16 a[172:175], a[220:223], v[156:159], a[172:175]
    buffer_load_dwordx4 v[32:35], v245, s[68:71], s53 offen offset:0 sc1
    v_mfma_f32_16x16x32_bf16 v[224:227], a[208:211], v[160:163], v[224:227]
    buffer_load_dwordx4 v[36:39], v246, s[68:71], s53 offen offset:0 sc1
    v_mfma_f32_16x16x32_bf16 a[176:179], a[212:215], v[160:163], a[176:179]
    buffer_load_dwordx4 v[40:43], v247, s[68:71], s53 offen offset:0 sc1
    v_mfma_f32_16x16x32_bf16 a[180:183], a[216:219], v[160:163], a[180:183]
    buffer_load_dwordx4 v[44:47], v248, s[68:71], s53 offen offset:0 sc1
    v_mfma_f32_16x16x32_bf16 a[184:187], a[220:223], v[160:163], a[184:187]
    buffer_load_dwordx4 v[48:51], v249, s[68:71], s53 offen offset:0 sc1
    v_mfma_f32_16x16x32_bf16 v[228:231], a[208:211], v[164:167], v[228:231]
    v_mfma_f32_16x16x32_bf16 a[188:191], a[212:215], v[164:167], a[188:191]
    v_mfma_f32_16x16x32_bf16 a[192:195], a[216:219], v[164:167], a[192:195]
    v_mfma_f32_16x16x32_bf16 a[196:199], a[220:223], v[164:167], a[196:199]
    s_waitcnt vmcnt(14) lgkmcnt(0)
    v_mfma_f32_16x16x32_bf16 v[192:195], a[224:227], v[168:171], v[192:195]
    ds_read_b64_tr_b16 a[208:209], v24 offset:16384
    v_mfma_f32_16x16x32_bf16 a[80:83], a[228:231], v[168:171], a[80:83]
    ds_read_b64_tr_b16 a[210:211], v24 offset:18432
    v_mfma_f32_16x16x32_bf16 a[84:87], a[232:235], v[168:171], a[84:87]
    ds_read_b64_tr_b16 a[212:213], v25 offset:16384
    v_mfma_f32_16x16x32_bf16 a[88:91], a[236:239], v[168:171], a[88:91]
    ds_read_b64_tr_b16 a[214:215], v25 offset:18432
    v_mfma_f32_16x16x32_bf16 v[196:199], a[224:227], v[172:175], v[196:199]
    ds_read_b64_tr_b16 a[216:217], v26 offset:16384
    v_mfma_f32_16x16x32_bf16 a[92:95], a[228:231], v[172:175], a[92:95]
    ds_read_b64_tr_b16 a[218:219], v26 offset:18432
    v_mfma_f32_16x16x32_bf16 a[96:99], a[232:235], v[172:175], a[96:99]
    ds_read_b64_tr_b16 a[220:221], v27 offset:16384
    v_mfma_f32_16x16x32_bf16 a[100:103], a[236:239], v[172:175], a[100:103]
    ds_read_b64_tr_b16 a[222:223], v27 offset:18432
    v_mfma_f32_16x16x32_bf16 v[200:203], a[224:227], v[176:179], v[200:203]
    buffer_load_dwordx4 v[148:151], v245, s[68:71], s62 offen offset:2048 sc1
    v_mfma_f32_16x16x32_bf16 a[104:107], a[228:231], v[176:179], a[104:107]
    buffer_load_dwordx4 v[152:155], v246, s[68:71], s62 offen offset:2048 sc1
    v_mfma_f32_16x16x32_bf16 a[108:111], a[232:235], v[176:179], a[108:111]
    buffer_load_dwordx4 v[156:159], v247, s[68:71], s62 offen offset:2048 sc1
    v_mfma_f32_16x16x32_bf16 a[112:115], a[236:239], v[176:179], a[112:115]
    buffer_load_dwordx4 v[160:163], v248, s[68:71], s62 offen offset:2048 sc1
    v_mfma_f32_16x16x32_bf16 v[204:207], a[224:227], v[180:183], v[204:207]
    buffer_load_dwordx4 v[164:167], v249, s[68:71], s62 offen offset:2048 sc1
    v_mfma_f32_16x16x32_bf16 a[116:119], a[228:231], v[180:183], a[116:119]
    v_mfma_f32_16x16x32_bf16 a[120:123], a[232:235], v[180:183], a[120:123]
    v_mfma_f32_16x16x32_bf16 a[124:127], a[236:239], v[180:183], a[124:127]
    v_mfma_f32_16x16x32_bf16 v[208:211], a[224:227], v[184:187], v[208:211]
    v_mfma_f32_16x16x32_bf16 a[128:131], a[228:231], v[184:187], a[128:131]
    v_mfma_f32_16x16x32_bf16 a[132:135], a[232:235], v[184:187], a[132:135]
    v_mfma_f32_16x16x32_bf16 a[136:139], a[236:239], v[184:187], a[136:139]
    s_waitcnt vmcnt(25) lgkmcnt(0)
    v_mfma_f32_16x16x32_bf16 v[212:215], a[240:243], v[168:171], v[212:215]
    ds_read_b64_tr_b16 a[224:225], v28 offset:0
    v_mfma_f32_16x16x32_bf16 a[140:143], a[244:247], v[168:171], a[140:143]
    ds_read_b64_tr_b16 a[226:227], v28 offset:2048
    v_mfma_f32_16x16x32_bf16 a[144:147], a[248:251], v[168:171], a[144:147]
    ds_read_b64_tr_b16 a[228:229], v29 offset:0
    v_mfma_f32_16x16x32_bf16 a[148:151], a[252:255], v[168:171], a[148:151]
    ds_read_b64_tr_b16 a[230:231], v29 offset:2048
    v_mfma_f32_16x16x32_bf16 v[216:219], a[240:243], v[172:175], v[216:219]
    ds_read_b64_tr_b16 a[232:233], v30 offset:0
    v_mfma_f32_16x16x32_bf16 a[152:155], a[244:247], v[172:175], a[152:155]
    ds_read_b64_tr_b16 a[234:235], v30 offset:2048
    v_mfma_f32_16x16x32_bf16 a[156:159], a[248:251], v[172:175], a[156:159]
    ds_read_b64_tr_b16 a[236:237], v31 offset:0
    v_mfma_f32_16x16x32_bf16 a[160:163], a[252:255], v[172:175], a[160:163]
    ds_read_b64_tr_b16 a[238:239], v31 offset:2048
    v_mfma_f32_16x16x32_bf16 v[220:223], a[240:243], v[176:179], v[220:223]
    s_mov_b32 s53, 98304
    v_mfma_f32_16x16x32_bf16 a[164:167], a[244:247], v[176:179], a[164:167]
    buffer_load_dwordx4 v[52:55], v245, s[68:71], s53 offen offset:1024 sc1
    v_mfma_f32_16x16x32_bf16 a[168:171], a[248:251], v[176:179], a[168:171]
    buffer_load_dwordx4 v[56:59], v246, s[68:71], s53 offen offset:1024 sc1
    v_mfma_f32_16x16x32_bf16 a[172:175], a[252:255], v[176:179], a[172:175]
    buffer_load_dwordx4 v[60:63], v247, s[68:71], s53 offen offset:1024 sc1
    v_mfma_f32_16x16x32_bf16 v[224:227], a[240:243], v[180:183], v[224:227]
    buffer_load_dwordx4 v[64:67], v248, s[68:71], s53 offen offset:1024 sc1
    v_mfma_f32_16x16x32_bf16 a[176:179], a[244:247], v[180:183], a[176:179]
    buffer_load_dwordx4 v[68:71], v249, s[68:71], s53 offen offset:1024 sc1
    v_mfma_f32_16x16x32_bf16 a[180:183], a[248:251], v[180:183], a[180:183]
    v_mfma_f32_16x16x32_bf16 a[184:187], a[252:255], v[180:183], a[184:187]
    v_mfma_f32_16x16x32_bf16 v[228:231], a[240:243], v[184:187], v[228:231]
    v_mfma_f32_16x16x32_bf16 a[188:191], a[244:247], v[184:187], a[188:191]
    v_mfma_f32_16x16x32_bf16 a[192:195], a[248:251], v[184:187], a[192:195]
    v_mfma_f32_16x16x32_bf16 a[196:199], a[252:255], v[184:187], a[196:199]
    s_waitcnt vmcnt(15) lgkmcnt(0)
    v_mfma_f32_16x16x32_bf16 v[192:195], v[112:115], v[128:131], v[192:195]
    ds_read_b64_tr_b16 a[240:241], v28 offset:4096
    v_mfma_f32_16x16x32_bf16 a[80:83], v[116:119], v[128:131], a[80:83]
    ds_read_b64_tr_b16 a[242:243], v28 offset:6144
    v_mfma_f32_16x16x32_bf16 a[84:87], v[120:123], v[128:131], a[84:87]
    ds_read_b64_tr_b16 a[244:245], v29 offset:4096
    v_mfma_f32_16x16x32_bf16 a[88:91], v[124:127], v[128:131], a[88:91]
    ds_read_b64_tr_b16 a[246:247], v29 offset:6144
    v_mfma_f32_16x16x32_bf16 v[196:199], v[112:115], v[132:135], v[196:199]
    ds_read_b64_tr_b16 a[248:249], v30 offset:4096
    v_mfma_f32_16x16x32_bf16 a[92:95], v[116:119], v[132:135], a[92:95]
    ds_read_b64_tr_b16 a[250:251], v30 offset:6144
    v_mfma_f32_16x16x32_bf16 a[96:99], v[120:123], v[132:135], a[96:99]
    ds_read_b64_tr_b16 a[252:253], v31 offset:4096
    v_mfma_f32_16x16x32_bf16 a[100:103], v[124:127], v[132:135], a[100:103]
    ds_read_b64_tr_b16 a[254:255], v31 offset:6144
    v_mfma_f32_16x16x32_bf16 v[200:203], v[112:115], v[136:139], v[200:203]
    buffer_load_dwordx4 v[168:171], v245, s[68:71], s62 offen offset:3072 sc1
    v_mfma_f32_16x16x32_bf16 a[104:107], v[116:119], v[136:139], a[104:107]
    buffer_load_dwordx4 v[172:175], v246, s[68:71], s62 offen offset:3072 sc1
    v_mfma_f32_16x16x32_bf16 a[108:111], v[120:123], v[136:139], a[108:111]
    buffer_load_dwordx4 v[176:179], v247, s[68:71], s62 offen offset:3072 sc1
    v_mfma_f32_16x16x32_bf16 a[112:115], v[124:127], v[136:139], a[112:115]
    buffer_load_dwordx4 v[180:183], v248, s[68:71], s62 offen offset:3072 sc1
    v_mfma_f32_16x16x32_bf16 v[204:207], v[112:115], v[140:143], v[204:207]
    buffer_load_dwordx4 v[184:187], v249, s[68:71], s62 offen offset:3072 sc1
    v_mfma_f32_16x16x32_bf16 a[116:119], v[116:119], v[140:143], a[116:119]
    v_mfma_f32_16x16x32_bf16 a[120:123], v[120:123], v[140:143], a[120:123]
    v_mfma_f32_16x16x32_bf16 a[124:127], v[124:127], v[140:143], a[124:127]
    v_mfma_f32_16x16x32_bf16 v[208:211], v[112:115], v[144:147], v[208:211]
    v_mfma_f32_16x16x32_bf16 a[128:131], v[116:119], v[144:147], a[128:131]
    v_mfma_f32_16x16x32_bf16 a[132:135], v[120:123], v[144:147], a[132:135]
    v_mfma_f32_16x16x32_bf16 a[136:139], v[124:127], v[144:147], a[136:139]
    s_waitcnt lgkmcnt(0)
    v_mfma_f32_16x16x32_bf16 v[212:215], a[0:3], v[128:131], v[212:215]
    s_mov_b32 s53, 98304
    v_mfma_f32_16x16x32_bf16 a[140:143], a[4:7], v[128:131], a[140:143]
    buffer_load_dwordx4 v[72:75], v245, s[68:71], s53 offen offset:2048 sc1
    v_mfma_f32_16x16x32_bf16 a[144:147], a[8:11], v[128:131], a[144:147]
    buffer_load_dwordx4 v[76:79], v246, s[68:71], s53 offen offset:2048 sc1
    v_mfma_f32_16x16x32_bf16 a[148:151], a[12:15], v[128:131], a[148:151]
    buffer_load_dwordx4 v[80:83], v247, s[68:71], s53 offen offset:2048 sc1
    v_mfma_f32_16x16x32_bf16 v[216:219], a[0:3], v[132:135], v[216:219]
    buffer_load_dwordx4 v[84:87], v248, s[68:71], s53 offen offset:2048 sc1
    v_mfma_f32_16x16x32_bf16 a[152:155], a[4:7], v[132:135], a[152:155]
    buffer_load_dwordx4 v[88:91], v249, s[68:71], s53 offen offset:2048 sc1
    v_mfma_f32_16x16x32_bf16 a[156:159], a[8:11], v[132:135], a[156:159]
    v_mfma_f32_16x16x32_bf16 a[160:163], a[12:15], v[132:135], a[160:163]
    v_mfma_f32_16x16x32_bf16 v[220:223], a[0:3], v[136:139], v[220:223]
    v_mfma_f32_16x16x32_bf16 a[164:167], a[4:7], v[136:139], a[164:167]
    v_mfma_f32_16x16x32_bf16 a[168:171], a[8:11], v[136:139], a[168:171]
    v_mfma_f32_16x16x32_bf16 a[172:175], a[12:15], v[136:139], a[172:175]
    v_mfma_f32_16x16x32_bf16 v[224:227], a[0:3], v[140:143], v[224:227]
    v_mfma_f32_16x16x32_bf16 a[176:179], a[4:7], v[140:143], a[176:179]
    v_mfma_f32_16x16x32_bf16 a[180:183], a[8:11], v[140:143], a[180:183]
    v_mfma_f32_16x16x32_bf16 a[184:187], a[12:15], v[140:143], a[184:187]
    v_mfma_f32_16x16x32_bf16 v[228:231], a[0:3], v[144:147], v[228:231]
    v_mfma_f32_16x16x32_bf16 a[188:191], a[4:7], v[144:147], a[188:191]
    v_mfma_f32_16x16x32_bf16 a[192:195], a[8:11], v[144:147], a[192:195]
    v_mfma_f32_16x16x32_bf16 a[196:199], a[12:15], v[144:147], a[196:199]
    s_waitcnt vmcnt(15) lgkmcnt(0)
    v_mfma_f32_16x16x32_bf16 v[192:195], a[16:19], v[148:151], v[192:195]
    v_mfma_f32_16x16x32_bf16 a[80:83], a[20:23], v[148:151], a[80:83]
    v_mfma_f32_16x16x32_bf16 a[84:87], a[24:27], v[148:151], a[84:87]
    v_mfma_f32_16x16x32_bf16 a[88:91], a[28:31], v[148:151], a[88:91]
    v_mfma_f32_16x16x32_bf16 v[196:199], a[16:19], v[152:155], v[196:199]
    v_mfma_f32_16x16x32_bf16 a[92:95], a[20:23], v[152:155], a[92:95]
    v_mfma_f32_16x16x32_bf16 a[96:99], a[24:27], v[152:155], a[96:99]
    v_mfma_f32_16x16x32_bf16 a[100:103], a[28:31], v[152:155], a[100:103]
    v_mfma_f32_16x16x32_bf16 v[200:203], a[16:19], v[156:159], v[200:203]
    v_mfma_f32_16x16x32_bf16 a[104:107], a[20:23], v[156:159], a[104:107]
    v_mfma_f32_16x16x32_bf16 a[108:111], a[24:27], v[156:159], a[108:111]
    v_mfma_f32_16x16x32_bf16 a[112:115], a[28:31], v[156:159], a[112:115]
    v_mfma_f32_16x16x32_bf16 v[204:207], a[16:19], v[160:163], v[204:207]
    v_mfma_f32_16x16x32_bf16 a[116:119], a[20:23], v[160:163], a[116:119]
    v_mfma_f32_16x16x32_bf16 a[120:123], a[24:27], v[160:163], a[120:123]
    v_mfma_f32_16x16x32_bf16 a[124:127], a[28:31], v[160:163], a[124:127]
    v_mfma_f32_16x16x32_bf16 v[208:211], a[16:19], v[164:167], v[208:211]
    v_mfma_f32_16x16x32_bf16 a[128:131], a[20:23], v[164:167], a[128:131]
    v_mfma_f32_16x16x32_bf16 a[132:135], a[24:27], v[164:167], a[132:135]
    v_mfma_f32_16x16x32_bf16 a[136:139], a[28:31], v[164:167], a[136:139]
    s_waitcnt lgkmcnt(0)
    v_mfma_f32_16x16x32_bf16 v[212:215], a[32:35], v[148:151], v[212:215]
    s_mov_b32 s53, 98304
    v_mfma_f32_16x16x32_bf16 a[140:143], a[36:39], v[148:151], a[140:143]
    buffer_load_dwordx4 v[92:95], v245, s[68:71], s53 offen offset:3072 sc1
    v_mfma_f32_16x16x32_bf16 a[144:147], a[40:43], v[148:151], a[144:147]
    buffer_load_dwordx4 v[96:99], v246, s[68:71], s53 offen offset:3072 sc1
    v_mfma_f32_16x16x32_bf16 a[148:151], a[44:47], v[148:151], a[148:151]
    buffer_load_dwordx4 v[100:103], v247, s[68:71], s53 offen offset:3072 sc1
    v_mfma_f32_16x16x32_bf16 v[216:219], a[32:35], v[152:155], v[216:219]
    buffer_load_dwordx4 v[104:107], v248, s[68:71], s53 offen offset:3072 sc1
    v_mfma_f32_16x16x32_bf16 a[152:155], a[36:39], v[152:155], a[152:155]
    buffer_load_dwordx4 v[108:111], v249, s[68:71], s53 offen offset:3072 sc1
    v_mfma_f32_16x16x32_bf16 a[156:159], a[40:43], v[152:155], a[156:159]
    s_add_u32 m0, s45, 98304
    v_mfma_f32_16x16x32_bf16 a[160:163], a[44:47], v[152:155], a[160:163]
    s_xor_b32 s61, s3, 393344
    v_mfma_f32_16x16x32_bf16 v[220:223], a[32:35], v[156:159], v[220:223]
    buffer_load_dwordx4 v241, s[64:67], s61 offen offset:0 lds
    v_mfma_f32_16x16x32_bf16 a[164:167], a[36:39], v[156:159], a[164:167]
    buffer_load_dwordx4 v242, s[64:67], s61 offen offset:1024 lds
    v_mfma_f32_16x16x32_bf16 a[168:171], a[40:43], v[156:159], a[168:171]
    buffer_load_dwordx4 v243, s[64:67], s61 offen offset:2048 lds
    v_mfma_f32_16x16x32_bf16 a[172:175], a[44:47], v[156:159], a[172:175]
    buffer_load_dwordx4 v244, s[64:67], s61 offen offset:3072 lds
    v_mfma_f32_16x16x32_bf16 v[224:227], a[32:35], v[160:163], v[224:227]
    v_mfma_f32_16x16x32_bf16 a[176:179], a[36:39], v[160:163], a[176:179]
    v_mfma_f32_16x16x32_bf16 a[180:183], a[40:43], v[160:163], a[180:183]
    v_mfma_f32_16x16x32_bf16 a[184:187], a[44:47], v[160:163], a[184:187]
    v_mfma_f32_16x16x32_bf16 v[228:231], a[32:35], v[164:167], v[228:231]
    v_mfma_f32_16x16x32_bf16 a[188:191], a[36:39], v[164:167], a[188:191]
    v_mfma_f32_16x16x32_bf16 a[192:195], a[40:43], v[164:167], a[192:195]
    v_mfma_f32_16x16x32_bf16 a[196:199], a[44:47], v[164:167], a[196:199]
    s_waitcnt vmcnt(14) lgkmcnt(0)
    v_mfma_f32_16x16x32_bf16 v[192:195], a[48:51], v[168:171], v[192:195]
    s_add_u32 m0, s45, 114688
    v_mfma_f32_16x16x32_bf16 a[80:83], a[52:55], v[168:171], a[80:83]
    s_xor_b32 s61, s3, 426112
    v_mfma_f32_16x16x32_bf16 a[84:87], a[56:59], v[168:171], a[84:87]
    buffer_load_dwordx4 v241, s[64:67], s61 offen offset:0 lds
    v_mfma_f32_16x16x32_bf16 a[88:91], a[60:63], v[168:171], a[88:91]
    buffer_load_dwordx4 v242, s[64:67], s61 offen offset:1024 lds
    v_mfma_f32_16x16x32_bf16 v[196:199], a[48:51], v[172:175], v[196:199]
    buffer_load_dwordx4 v243, s[64:67], s61 offen offset:2048 lds
    v_mfma_f32_16x16x32_bf16 a[92:95], a[52:55], v[172:175], a[92:95]
    buffer_load_dwordx4 v244, s[64:67], s61 offen offset:3072 lds
    v_mfma_f32_16x16x32_bf16 a[96:99], a[56:59], v[172:175], a[96:99]
    v_mfma_f32_16x16x32_bf16 a[100:103], a[60:63], v[172:175], a[100:103]
    v_mfma_f32_16x16x32_bf16 v[200:203], a[48:51], v[176:179], v[200:203]
    v_mfma_f32_16x16x32_bf16 a[104:107], a[52:55], v[176:179], a[104:107]
    v_mfma_f32_16x16x32_bf16 a[108:111], a[56:59], v[176:179], a[108:111]
    v_mfma_f32_16x16x32_bf16 a[112:115], a[60:63], v[176:179], a[112:115]
    v_mfma_f32_16x16x32_bf16 v[204:207], a[48:51], v[180:183], v[204:207]
    v_mfma_f32_16x16x32_bf16 a[116:119], a[52:55], v[180:183], a[116:119]
    v_mfma_f32_16x16x32_bf16 a[120:123], a[56:59], v[180:183], a[120:123]
    v_mfma_f32_16x16x32_bf16 a[124:127], a[60:63], v[180:183], a[124:127]
    v_mfma_f32_16x16x32_bf16 v[208:211], a[48:51], v[184:187], v[208:211]
    v_mfma_f32_16x16x32_bf16 a[128:131], a[52:55], v[184:187], a[128:131]
    v_mfma_f32_16x16x32_bf16 a[132:135], a[56:59], v[184:187], a[132:135]
    v_mfma_f32_16x16x32_bf16 a[136:139], a[60:63], v[184:187], a[136:139]
    s_waitcnt lgkmcnt(0)
    v_mfma_f32_16x16x32_bf16 v[212:215], a[64:67], v[168:171], v[212:215]
    s_add_u32 m0, s45, 65536
    v_mfma_f32_16x16x32_bf16 a[140:143], a[68:71], v[168:171], a[140:143]
    s_xor_b32 s61, s3, 458880
    v_mfma_f32_16x16x32_bf16 a[144:147], a[72:75], v[168:171], a[144:147]
    buffer_load_dwordx4 v241, s[64:67], s61 offen offset:0 lds
    v_mfma_f32_16x16x32_bf16 a[148:151], a[76:79], v[168:171], a[148:151]
    buffer_load_dwordx4 v242, s[64:67], s61 offen offset:1024 lds
    v_mfma_f32_16x16x32_bf16 v[216:219], a[64:67], v[172:175], v[216:219]
    buffer_load_dwordx4 v243, s[64:67], s61 offen offset:2048 lds
    v_mfma_f32_16x16x32_bf16 a[152:155], a[68:71], v[172:175], a[152:155]
    buffer_load_dwordx4 v244, s[64:67], s61 offen offset:3072 lds
    v_mfma_f32_16x16x32_bf16 a[156:159], a[72:75], v[172:175], a[156:159]
    v_mfma_f32_16x16x32_bf16 a[160:163], a[76:79], v[172:175], a[160:163]
    v_mfma_f32_16x16x32_bf16 v[220:223], a[64:67], v[176:179], v[220:223]
    v_mfma_f32_16x16x32_bf16 a[164:167], a[68:71], v[176:179], a[164:167]
    v_mfma_f32_16x16x32_bf16 a[168:171], a[72:75], v[176:179], a[168:171]
    v_mfma_f32_16x16x32_bf16 a[172:175], a[76:79], v[176:179], a[172:175]
    v_mfma_f32_16x16x32_bf16 v[224:227], a[64:67], v[180:183], v[224:227]
    v_mfma_f32_16x16x32_bf16 a[176:179], a[68:71], v[180:183], a[176:179]
    v_mfma_f32_16x16x32_bf16 a[180:183], a[72:75], v[180:183], a[180:183]
    v_mfma_f32_16x16x32_bf16 a[184:187], a[76:79], v[180:183], a[184:187]
    v_mfma_f32_16x16x32_bf16 v[228:231], a[64:67], v[184:187], v[228:231]
    v_mfma_f32_16x16x32_bf16 a[188:191], a[68:71], v[184:187], a[188:191]
    v_mfma_f32_16x16x32_bf16 a[192:195], a[72:75], v[184:187], a[192:195]
    v_mfma_f32_16x16x32_bf16 a[196:199], a[76:79], v[184:187], a[196:199]
    s_waitcnt vmcnt(12) lgkmcnt(0)
    v_mfma_f32_16x16x32_bf16 a[80:83], v[6:9], v[32:35], a[80:83]
    v_add_u32 v20, s45, v19
    v_add_u32 v21, 65536, v20
    v_mfma_f32_16x16x32_bf16 a[80:83], a[212:215], v[52:55], a[80:83]
    s_add_u32 m0, s45, 81920
    v_mfma_f32_16x16x32_bf16 a[80:83], a[228:231], v[72:75], a[80:83]
    s_xor_b32 s61, s3, 491648
    v_mfma_f32_16x16x32_bf16 a[80:83], a[244:247], v[92:95], a[80:83]
    buffer_load_dwordx4 v241, s[64:67], s61 offen offset:0 lds
    v_mfma_f32_16x16x32_bf16 a[84:87], v[10:13], v[32:35], a[84:87]
    buffer_load_dwordx4 v242, s[64:67], s61 offen offset:1024 lds
    v_mfma_f32_16x16x32_bf16 a[84:87], a[216:219], v[52:55], a[84:87]
    buffer_load_dwordx4 v243, s[64:67], s61 offen offset:2048 lds
    v_mfma_f32_16x16x32_bf16 a[84:87], a[232:235], v[72:75], a[84:87]
    buffer_load_dwordx4 v244, s[64:67], s61 offen offset:3072 lds
    v_mfma_f32_16x16x32_bf16 a[84:87], a[248:251], v[92:95], a[84:87]
    s_xor_b32 s50, s77, 0x80000
    v_mfma_f32_16x16x32_bf16 a[88:91], v[14:17], v[32:35], a[88:91]
    s_add_u32 s28, s18, s50
    s_addc_u32 s29, s19, 0
    v_mfma_f32_16x16x32_bf16 a[88:91], a[220:223], v[52:55], a[88:91]
    s_mov_b32 s30, 0x8000
    v_mfma_f32_16x16x32_bf16 a[88:91], a[236:239], v[72:75], a[88:91]
    s_mov_b32 s31, 0x20000
    v_mfma_f32_16x16x32_bf16 a[88:91], a[252:255], v[92:95], a[88:91]
    s_sub_u32 s55, s45, 4096
    ds_write_b128 v20, a[80:83] offset:0
    v_mfma_f32_16x16x32_bf16 a[92:95], v[6:9], v[36:39], a[92:95]
    s_and_b32 s55, s55, 0x3000
    v_mfma_f32_16x16x32_bf16 a[92:95], a[212:215], v[56:59], a[92:95]
    v_add_u32 v233, s55, v19
    v_add_u32 v236, 65536, v233
    v_mfma_f32_16x16x32_bf16 a[92:95], a[228:231], v[76:79], a[92:95]
    s_sub_u32 s55, s45, 8192
    v_mfma_f32_16x16x32_bf16 a[92:95], a[244:247], v[96:99], a[92:95]
    s_and_b32 s55, s55, 0x3000
    ds_write_b128 v20, a[84:87] offset:17408
    v_mfma_f32_16x16x32_bf16 a[96:99], v[10:13], v[36:39], a[96:99]
    v_add_u32 v234, s55, v19
    v_add_u32 v237, 65536, v234
    v_mfma_f32_16x16x32_bf16 a[96:99], a[216:219], v[56:59], a[96:99]
    s_sub_u32 s55, s45, 12288
    v_mfma_f32_16x16x32_bf16 a[96:99], a[232:235], v[76:79], a[96:99]
    s_and_b32 s55, s55, 0x3000
    v_mfma_f32_16x16x32_bf16 a[96:99], a[248:251], v[96:99], a[96:99]
    ds_write_b128 v20, a[88:91] offset:34816
    v_add_u32 v235, s55, v19
    v_add_u32 v238, 65536, v235
    v_mfma_f32_16x16x32_bf16 a[100:103], v[14:17], v[36:39], a[100:103]
    v_and_b32 v245, 0xf0, v19
    v_lshlrev_b32 v245, 6, v245
    v_mfma_f32_16x16x32_bf16 a[100:103], a[220:223], v[56:59], a[100:103]
    v_lshrrev_b32 v246, 8, v19
    v_lshl_add_u32 v245, v246, 3, v245
    v_mfma_f32_16x16x32_bf16 a[100:103], a[236:239], v[76:79], a[100:103]
    v_add_u32 v246, 16384, v245
    v_mfma_f32_16x16x32_bf16 a[100:103], a[252:255], v[96:99], a[100:103]
    ds_write_b128 v20, a[92:95] offset:1024
    v_add_u32 v247, 32768, v245
    v_mfma_f32_16x16x32_bf16 a[104:107], v[6:9], v[40:43], a[104:107]
    v_add_u32 v248, 49152, v245
    v_mfma_f32_16x16x32_bf16 a[104:107], a[212:215], v[60:63], a[104:107]
    v_add_u32 v249, 65536, v245
    v_mfma_f32_16x16x32_bf16 a[104:107], a[228:231], v[80:83], a[104:107]
    v_add_u32 v239, 20480, v19
    v_add_u32 v240, 24576, v19
    v_mfma_f32_16x16x32_bf16 a[104:107], a[244:247], v[100:103], a[104:107]
    ds_write_b128 v20, a[96:99] offset:18432
    v_mfma_f32_16x16x32_bf16 a[108:111], v[10:13], v[40:43], a[108:111]
    v_mfma_f32_16x16x32_bf16 a[108:111], a[216:219], v[60:63], a[108:111]
    v_mfma_f32_16x16x32_bf16 a[108:111], a[232:235], v[80:83], a[108:111]
    v_mfma_f32_16x16x32_bf16 a[108:111], a[248:251], v[100:103], a[108:111]
    ds_write_b128 v20, a[100:103] offset:35840
    v_mfma_f32_16x16x32_bf16 a[112:115], v[14:17], v[40:43], a[112:115]
    v_mfma_f32_16x16x32_bf16 a[112:115], a[220:223], v[60:63], a[112:115]
    v_mfma_f32_16x16x32_bf16 a[112:115], a[236:239], v[80:83], a[112:115]
    v_mfma_f32_16x16x32_bf16 a[112:115], a[252:255], v[100:103], a[112:115]
    ds_write_b128 v20, a[104:107] offset:2048
    v_mfma_f32_16x16x32_bf16 a[116:119], v[6:9], v[44:47], a[116:119]
    v_mfma_f32_16x16x32_bf16 a[116:119], a[212:215], v[64:67], a[116:119]
    v_mfma_f32_16x16x32_bf16 a[116:119], a[228:231], v[84:87], a[116:119]
    v_mfma_f32_16x16x32_bf16 a[116:119], a[244:247], v[104:107], a[116:119]
    ds_write_b128 v20, a[108:111] offset:19456
    v_mfma_f32_16x16x32_bf16 a[120:123], v[10:13], v[44:47], a[120:123]
    v_mfma_f32_16x16x32_bf16 a[120:123], a[216:219], v[64:67], a[120:123]
    v_mfma_f32_16x16x32_bf16 a[120:123], a[232:235], v[84:87], a[120:123]
    v_mfma_f32_16x16x32_bf16 a[120:123], a[248:251], v[104:107], a[120:123]
    ds_write_b128 v20, a[112:115] offset:49152
    v_mfma_f32_16x16x32_bf16 a[124:127], v[14:17], v[44:47], a[124:127]
    v_mfma_f32_16x16x32_bf16 a[124:127], a[220:223], v[64:67], a[124:127]
    v_mfma_f32_16x16x32_bf16 a[124:127], a[236:239], v[84:87], a[124:127]
    v_mfma_f32_16x16x32_bf16 a[124:127], a[252:255], v[104:107], a[124:127]
    ds_write_b128 v20, a[116:119] offset:3072
    v_mfma_f32_16x16x32_bf16 a[128:131], v[6:9], v[48:51], a[128:131]
    s_waitcnt vmcnt(12)
    ds_read_b64_tr_b16 v[112:113], v24 offset:32768
    ds_read_b64_tr_b16 v[114:115], v24 offset:34816
    v_mfma_f32_16x16x32_bf16 a[128:131], a[212:215], v[68:71], a[128:131]
    ds_read_b64_tr_b16 v[116:117], v25 offset:32768
    ds_read_b64_tr_b16 v[118:119], v25 offset:34816
    v_mfma_f32_16x16x32_bf16 a[128:131], a[228:231], v[88:91], a[128:131]
    ds_read_b64_tr_b16 v[120:121], v26 offset:32768
    ds_read_b64_tr_b16 v[122:123], v26 offset:34816
    v_mfma_f32_16x16x32_bf16 a[128:131], a[244:247], v[108:111], a[128:131]
    ds_write_b128 v20, a[120:123] offset:32768
    v_mfma_f32_16x16x32_bf16 a[132:135], v[10:13], v[48:51], a[132:135]
    ds_read_b64_tr_b16 v[124:125], v27 offset:32768
    ds_read_b64_tr_b16 v[126:127], v27 offset:34816
    v_mfma_f32_16x16x32_bf16 a[132:135], a[216:219], v[68:71], a[132:135]
    s_waitcnt vmcnt(8)
    ds_read_b64_tr_b16 a[0:1], v24 offset:49152
    ds_read_b64_tr_b16 a[2:3], v24 offset:51200
    v_mfma_f32_16x16x32_bf16 a[132:135], a[232:235], v[88:91], a[132:135]
    ds_read_b64_tr_b16 a[4:5], v25 offset:49152
    ds_read_b64_tr_b16 a[6:7], v25 offset:51200
    v_mfma_f32_16x16x32_bf16 a[132:135], a[248:251], v[108:111], a[132:135]
    ds_write_b128 v20, a[124:127] offset:50176
    v_mfma_f32_16x16x32_bf16 a[136:139], v[14:17], v[48:51], a[136:139]
    ds_read_b64_tr_b16 a[8:9], v26 offset:49152
    ds_read_b64_tr_b16 a[10:11], v26 offset:51200
    v_mfma_f32_16x16x32_bf16 a[136:139], a[220:223], v[68:71], a[136:139]
    ds_read_b64_tr_b16 a[12:13], v27 offset:49152
    ds_read_b64_tr_b16 a[14:15], v27 offset:51200
    v_mfma_f32_16x16x32_bf16 a[136:139], a[236:239], v[88:91], a[136:139]
    s_waitcnt vmcnt(4)
    ds_read_b64_tr_b16 a[16:17], v24 offset:0
    ds_read_b64_tr_b16 a[18:19], v24 offset:2048
    v_mfma_f32_16x16x32_bf16 a[136:139], a[252:255], v[108:111], a[136:139]
    ds_write_b128 v20, a[128:131] offset:16384
    v_mfma_f32_16x16x32_bf16 v[192:195], v[2:5], v[32:35], v[192:195]
    ds_read_b64_tr_b16 a[20:21], v25 offset:0
    ds_read_b64_tr_b16 a[22:23], v25 offset:2048
    v_mfma_f32_16x16x32_bf16 v[192:195], a[208:211], v[52:55], v[192:195]
    ds_read_b64_tr_b16 a[24:25], v26 offset:0
    ds_read_b64_tr_b16 a[26:27], v26 offset:2048
    v_mfma_f32_16x16x32_bf16 v[192:195], a[224:227], v[72:75], v[192:195]
    ds_read_b64_tr_b16 a[28:29], v27 offset:0
    ds_read_b64_tr_b16 a[30:31], v27 offset:2048
    v_mfma_f32_16x16x32_bf16 v[192:195], a[240:243], v[92:95], v[192:195]
    ds_write_b128 v20, a[132:135] offset:33792
    v_mfma_f32_16x16x32_bf16 v[196:199], v[2:5], v[36:39], v[196:199]
    s_waitcnt vmcnt(0)
    ds_read_b64_tr_b16 a[32:33], v24 offset:16384
    ds_read_b64_tr_b16 a[34:35], v24 offset:18432
    v_mfma_f32_16x16x32_bf16 v[196:199], a[208:211], v[56:59], v[196:199]
    ds_read_b64_tr_b16 a[36:37], v25 offset:16384
    ds_read_b64_tr_b16 a[38:39], v25 offset:18432
    v_mfma_f32_16x16x32_bf16 v[196:199], a[224:227], v[76:79], v[196:199]
    ds_read_b64_tr_b16 a[40:41], v26 offset:16384
    ds_read_b64_tr_b16 a[42:43], v26 offset:18432
    v_mfma_f32_16x16x32_bf16 v[196:199], a[240:243], v[96:99], v[196:199]
    ds_write_b128 v20, a[136:139] offset:51200
    v_mfma_f32_16x16x32_bf16 v[200:203], v[2:5], v[40:43], v[200:203]
    ds_read_b64_tr_b16 a[44:45], v27 offset:16384
    ds_read_b64_tr_b16 a[46:47], v27 offset:18432
    v_mfma_f32_16x16x32_bf16 v[200:203], a[208:211], v[60:63], v[200:203]
    v_mfma_f32_16x16x32_bf16 v[200:203], a[224:227], v[80:83], v[200:203]
    v_mfma_f32_16x16x32_bf16 v[200:203], a[240:243], v[100:103], v[200:203]
    s_waitcnt lgkmcnt(0)
    v_mfma_f32_16x16x32_bf16 v[204:207], v[2:5], v[44:47], v[204:207]
    s_barrier
    v_mfma_f32_16x16x32_bf16 v[204:207], a[208:211], v[64:67], v[204:207]
    ds_read_b128 v[128:131], v233 offset:0
    v_mfma_f32_16x16x32_bf16 v[204:207], a[224:227], v[84:87], v[204:207]
    ds_read_b128 v[132:135], v234 offset:17408
    v_mfma_f32_16x16x32_bf16 v[204:207], a[240:243], v[104:107], v[204:207]
    ds_read_b128 v[136:139], v235 offset:34816
    v_mfma_f32_16x16x32_bf16 v[208:211], v[2:5], v[48:51], v[208:211]
    ds_read_b128 v[140:143], v233 offset:1024
    v_mfma_f32_16x16x32_bf16 v[208:211], a[208:211], v[68:71], v[208:211]
    ds_read_b128 v[144:147], v234 offset:18432
    v_mfma_f32_16x16x32_bf16 v[208:211], a[224:227], v[88:91], v[208:211]
    ds_read_b128 v[148:151], v235 offset:35840
    v_mfma_f32_16x16x32_bf16 v[208:211], a[240:243], v[108:111], v[208:211]
    ds_read_b128 v[152:155], v233 offset:2048
    v_mfma_f32_16x16x32_bf16 a[140:143], v[116:119], v[32:35], a[140:143]
    ds_read_b128 v[156:159], v234 offset:19456
    v_mfma_f32_16x16x32_bf16 a[140:143], a[4:7], v[52:55], a[140:143]
    s_waitcnt lgkmcnt(5)
    ds_read_b128 v[160:163], v235 offset:49152
    v_add_f32 v192, v192, v128
    v_add_f32 v193, v193, v129
    v_mfma_f32_16x16x32_bf16 a[140:143], a[20:23], v[72:75], a[140:143]
    v_add_f32 v194, v194, v130
    v_add_f32 v195, v195, v131
    v_add_f32 v192, v192, v132
    v_mfma_f32_16x16x32_bf16 a[140:143], a[36:39], v[92:95], a[140:143]
    v_add_f32 v193, v193, v133
    v_add_f32 v194, v194, v134
    v_add_f32 v195, v195, v135
    v_mfma_f32_16x16x32_bf16 a[144:147], v[120:123], v[32:35], a[144:147]
    v_add_f32 v192, v192, v136
    v_add_f32 v193, v193, v137
    v_add_f32 v194, v194, v138
    v_mfma_f32_16x16x32_bf16 a[144:147], a[8:11], v[52:55], a[144:147]
    v_add_f32 v195, v195, v139
    v_mfma_f32_16x16x32_bf16 a[144:147], a[24:27], v[72:75], a[144:147]
    buffer_store_dwordx4 v[192:195], v239, s[36:39], 0 offen offset:0 sc1
    v_mfma_f32_16x16x32_bf16 a[144:147], a[40:43], v[92:95], a[144:147]
    s_waitcnt lgkmcnt(3)
    ds_read_b128 v[128:131], v233 offset:3072
    v_add_f32 v196, v196, v140
    v_add_f32 v197, v197, v141
    v_mfma_f32_16x16x32_bf16 a[148:151], v[124:127], v[32:35], a[148:151]
    ds_read_b128 v[132:135], v234 offset:32768
    v_add_f32 v198, v198, v142
    v_add_f32 v199, v199, v143
    v_mfma_f32_16x16x32_bf16 a[148:151], a[12:15], v[52:55], a[148:151]
    ds_read_b128 v[136:139], v235 offset:50176
    v_add_f32 v196, v196, v144
    v_add_f32 v197, v197, v145
    v_mfma_f32_16x16x32_bf16 a[148:151], a[28:31], v[72:75], a[148:151]
    v_add_f32 v198, v198, v146
    v_add_f32 v199, v199, v147
    v_add_f32 v196, v196, v148
    v_mfma_f32_16x16x32_bf16 a[148:151], a[44:47], v[92:95], a[148:151]
    ds_write_b128 v21, a[140:143] offset:0
    v_add_f32 v197, v197, v149
    v_add_f32 v198, v198, v150
    v_mfma_f32_16x16x32_bf16 a[152:155], v[116:119], v[36:39], a[152:155]
    v_add_f32 v199, v199, v151
    v_mfma_f32_16x16x32_bf16 a[152:155], a[4:7], v[56:59], a[152:155]
    buffer_store_dwordx4 v[196:199], v239, s[36:39], 0 offen offset:1024 sc1
    v_mfma_f32_16x16x32_bf16 a[152:155], a[20:23], v[76:79], a[152:155]
    s_waitcnt lgkmcnt(4)
    ds_read_b128 v[140:143], v233 offset:16384
    v_add_f32 v200, v200, v152
    v_add_f32 v201, v201, v153
    v_mfma_f32_16x16x32_bf16 a[152:155], a[36:39], v[96:99], a[152:155]
    ds_write_b128 v21, a[144:147] offset:17408
    v_add_f32 v202, v202, v154
    v_add_f32 v203, v203, v155
    v_mfma_f32_16x16x32_bf16 a[156:159], v[120:123], v[36:39], a[156:159]
    ds_read_b128 v[144:147], v234 offset:33792
    v_add_f32 v200, v200, v156
    v_add_f32 v201, v201, v157
    v_mfma_f32_16x16x32_bf16 a[156:159], a[8:11], v[56:59], a[156:159]
    ds_read_b128 v[148:151], v235 offset:51200
    v_add_f32 v202, v202, v158
    v_add_f32 v203, v203, v159
    v_mfma_f32_16x16x32_bf16 a[156:159], a[24:27], v[76:79], a[156:159]
    v_add_f32 v200, v200, v160
    v_add_f32 v201, v201, v161
    v_add_f32 v202, v202, v162
    v_mfma_f32_16x16x32_bf16 a[156:159], a[40:43], v[96:99], a[156:159]
    ds_write_b128 v21, a[148:151] offset:34816
    v_add_f32 v203, v203, v163
    v_mfma_f32_16x16x32_bf16 a[160:163], v[124:127], v[36:39], a[160:163]
    buffer_store_dwordx4 v[200:203], v239, s[36:39], 0 offen offset:2048 sc1
    v_mfma_f32_16x16x32_bf16 a[160:163], a[12:15], v[56:59], a[160:163]
    s_waitcnt lgkmcnt(6)
    v_add_f32 v204, v204, v128
    v_add_f32 v205, v205, v129
    v_add_f32 v206, v206, v130
    v_mfma_f32_16x16x32_bf16 a[160:163], a[28:31], v[76:79], a[160:163]
    v_add_f32 v207, v207, v131
    v_add_f32 v204, v204, v132
    v_add_f32 v205, v205, v133
    v_mfma_f32_16x16x32_bf16 a[160:163], a[44:47], v[96:99], a[160:163]
    ds_write_b128 v21, a[152:155] offset:1024
    v_add_f32 v206, v206, v134
    v_add_f32 v207, v207, v135
    v_mfma_f32_16x16x32_bf16 a[164:167], v[116:119], v[40:43], a[164:167]
    v_add_f32 v204, v204, v136
    v_add_f32 v205, v205, v137
    v_add_f32 v206, v206, v138
    v_mfma_f32_16x16x32_bf16 a[164:167], a[4:7], v[60:63], a[164:167]
    v_add_f32 v207, v207, v139
    v_mfma_f32_16x16x32_bf16 a[164:167], a[20:23], v[80:83], a[164:167]
    buffer_store_dwordx4 v[204:207], v239, s[36:39], 0 offen offset:3072 sc1
    v_mfma_f32_16x16x32_bf16 a[164:167], a[36:39], v[100:103], a[164:167]
    s_waitcnt lgkmcnt(2)
    ds_write_b128 v21, a[156:159] offset:18432
    v_add_f32 v208, v208, v140
    v_add_f32 v209, v209, v141
    v_mfma_f32_16x16x32_bf16 a[168:171], v[120:123], v[40:43], a[168:171]
    v_add_f32 v210, v210, v142
    v_add_f32 v211, v211, v143
    v_add_f32 v208, v208, v144
    v_mfma_f32_16x16x32_bf16 a[168:171], a[8:11], v[60:63], a[168:171]
    v_add_f32 v209, v209, v145
    v_add_f32 v210, v210, v146
    v_add_f32 v211, v211, v147
    v_mfma_f32_16x16x32_bf16 a[168:171], a[24:27], v[80:83], a[168:171]
    v_add_f32 v208, v208, v148
    v_add_f32 v209, v209, v149
    v_add_f32 v210, v210, v150
    v_mfma_f32_16x16x32_bf16 a[168:171], a[40:43], v[100:103], a[168:171]
    ds_write_b128 v21, a[160:163] offset:35840
    v_add_f32 v211, v211, v151
    v_mfma_f32_16x16x32_bf16 a[172:175], v[124:127], v[40:43], a[172:175]
    buffer_store_dwordx4 v[208:211], v240, s[36:39], 0 offen offset:0 sc1
    v_mfma_f32_16x16x32_bf16 a[172:175], a[12:15], v[60:63], a[172:175]
    v_mfma_f32_16x16x32_bf16 a[172:175], a[28:31], v[80:83], a[172:175]
    v_mfma_f32_16x16x32_bf16 a[172:175], a[44:47], v[100:103], a[172:175]
    ds_write_b128 v21, a[164:167] offset:2048
    v_mfma_f32_16x16x32_bf16 a[176:179], v[116:119], v[44:47], a[176:179]
    v_mfma_f32_16x16x32_bf16 a[176:179], a[4:7], v[64:67], a[176:179]
    v_mfma_f32_16x16x32_bf16 a[176:179], a[20:23], v[84:87], a[176:179]
    v_mfma_f32_16x16x32_bf16 a[176:179], a[36:39], v[104:107], a[176:179]
    ds_write_b128 v21, a[168:171] offset:19456
    v_mfma_f32_16x16x32_bf16 a[180:183], v[120:123], v[44:47], a[180:183]
    v_mfma_f32_16x16x32_bf16 a[180:183], a[8:11], v[64:67], a[180:183]
    v_mfma_f32_16x16x32_bf16 a[180:183], a[24:27], v[84:87], a[180:183]
    v_mfma_f32_16x16x32_bf16 a[180:183], a[40:43], v[104:107], a[180:183]
    ds_write_b128 v21, a[172:175] offset:49152
    v_mfma_f32_16x16x32_bf16 a[184:187], v[124:127], v[44:47], a[184:187]
    v_mfma_f32_16x16x32_bf16 a[184:187], a[12:15], v[64:67], a[184:187]
    v_mfma_f32_16x16x32_bf16 a[184:187], a[28:31], v[84:87], a[184:187]
    v_mfma_f32_16x16x32_bf16 a[184:187], a[44:47], v[104:107], a[184:187]
    ds_write_b128 v21, a[176:179] offset:3072
    v_mfma_f32_16x16x32_bf16 a[188:191], v[116:119], v[48:51], a[188:191]
    v_mfma_f32_16x16x32_bf16 a[188:191], a[4:7], v[68:71], a[188:191]
    v_mfma_f32_16x16x32_bf16 a[188:191], a[20:23], v[88:91], a[188:191]
    v_mfma_f32_16x16x32_bf16 a[188:191], a[36:39], v[108:111], a[188:191]
    ds_write_b128 v21, a[180:183] offset:32768
    v_mfma_f32_16x16x32_bf16 a[192:195], v[120:123], v[48:51], a[192:195]
    v_mfma_f32_16x16x32_bf16 a[192:195], a[8:11], v[68:71], a[192:195]
    v_mfma_f32_16x16x32_bf16 a[192:195], a[24:27], v[88:91], a[192:195]
    v_mfma_f32_16x16x32_bf16 a[192:195], a[40:43], v[108:111], a[192:195]
    ds_write_b128 v21, a[184:187] offset:50176
    v_mfma_f32_16x16x32_bf16 a[196:199], v[124:127], v[48:51], a[196:199]
    buffer_load_dwordx4 v[184:187], v240, s[28:31], 0 offen offset:0 sc1
    v_mfma_f32_16x16x32_bf16 a[196:199], a[12:15], v[68:71], a[196:199]
    buffer_load_dwordx4 v[180:183], v239, s[28:31], 0 offen offset:3072 sc1
    v_mfma_f32_16x16x32_bf16 a[196:199], a[28:31], v[88:91], a[196:199]
    buffer_load_dwordx4 v[176:179], v239, s[28:31], 0 offen offset:2048 sc1
    v_mfma_f32_16x16x32_bf16 a[196:199], a[44:47], v[108:111], a[196:199]
    ds_write_b128 v21, a[188:191] offset:16384
    v_mfma_f32_16x16x32_bf16 v[212:215], v[112:115], v[32:35], v[212:215]
    buffer_load_dwordx4 v[172:175], v239, s[28:31], 0 offen offset:1024 sc1
    v_mfma_f32_16x16x32_bf16 v[212:215], a[0:3], v[52:55], v[212:215]
    buffer_load_dwordx4 v[168:171], v239, s[28:31], 0 offen offset:0 sc1
    v_mfma_f32_16x16x32_bf16 v[212:215], a[16:19], v[72:75], v[212:215]
    v_mfma_f32_16x16x32_bf16 v[212:215], a[32:35], v[92:95], v[212:215]
    ds_write_b128 v21, a[192:195] offset:33792
    v_mfma_f32_16x16x32_bf16 v[216:219], v[112:115], v[36:39], v[216:219]
    v_mfma_f32_16x16x32_bf16 v[216:219], a[0:3], v[56:59], v[216:219]
    v_mfma_f32_16x16x32_bf16 v[216:219], a[16:19], v[76:79], v[216:219]
    v_mfma_f32_16x16x32_bf16 v[216:219], a[32:35], v[96:99], v[216:219]
    ds_write_b128 v21, a[196:199] offset:51200
    v_mfma_f32_16x16x32_bf16 v[220:223], v[112:115], v[40:43], v[220:223]
    v_mfma_f32_16x16x32_bf16 v[220:223], a[0:3], v[60:63], v[220:223]
    v_mfma_f32_16x16x32_bf16 v[220:223], a[16:19], v[80:83], v[220:223]
    v_mfma_f32_16x16x32_bf16 v[220:223], a[32:35], v[100:103], v[220:223]
    s_waitcnt lgkmcnt(0)
    v_mfma_f32_16x16x32_bf16 v[224:227], v[112:115], v[44:47], v[224:227]
    s_barrier
    v_mfma_f32_16x16x32_bf16 v[224:227], a[0:3], v[64:67], v[224:227]
    ds_read_b128 v[128:131], v236 offset:0
    v_mfma_f32_16x16x32_bf16 v[224:227], a[16:19], v[84:87], v[224:227]
    ds_read_b128 v[132:135], v237 offset:17408
    v_mfma_f32_16x16x32_bf16 v[224:227], a[32:35], v[104:107], v[224:227]
    ds_read_b128 v[136:139], v238 offset:34816
    v_mfma_f32_16x16x32_bf16 v[228:231], v[112:115], v[48:51], v[228:231]
    ds_read_b128 v[140:143], v236 offset:1024
    v_mfma_f32_16x16x32_bf16 v[228:231], a[0:3], v[68:71], v[228:231]
    ds_read_b128 v[144:147], v237 offset:18432
    v_mfma_f32_16x16x32_bf16 v[228:231], a[16:19], v[88:91], v[228:231]
    ds_read_b128 v[148:151], v238 offset:35840
    v_mfma_f32_16x16x32_bf16 v[228:231], a[32:35], v[108:111], v[228:231]
    ds_read_b128 v[152:155], v236 offset:2048
    ds_read_b128 v[156:159], v237 offset:19456
    ds_read_b128 v[160:163], v238 offset:49152
    ds_read_b128 v[192:195], v236 offset:3072
    ds_read_b128 v[196:199], v237 offset:32768
    ds_read_b128 v[200:203], v238 offset:50176
    ds_read_b128 v[204:207], v236 offset:16384
    ds_read_b128 v[208:211], v237 offset:33792
    ds_read_b128 v[164:167], v238 offset:51200
.p2align 3
    s_waitcnt lgkmcnt(12)
    s_nop 0
    v_pk_add_f32 v[132:133], v[132:133], v[136:137]
    v_pk_add_f32 v[212:213], v[212:213], v[128:129]
    v_pk_add_f32 v[134:135], v[134:135], v[138:139]
    v_pk_add_f32 v[214:215], v[214:215], v[130:131]
    v_pk_add_f32 v[212:213], v[212:213], v[132:133]
    v_pk_add_f32 v[214:215], v[214:215], v[134:135]
    s_waitcnt lgkmcnt(9)
    s_nop 0
    v_pk_add_f32 v[144:145], v[144:145], v[148:149]
    v_pk_add_f32 v[216:217], v[216:217], v[140:141]
    v_pk_add_f32 v[146:147], v[146:147], v[150:151]
    v_pk_add_f32 v[218:219], v[218:219], v[142:143]
    v_pk_add_f32 v[216:217], v[216:217], v[144:145]
    v_pk_add_f32 v[218:219], v[218:219], v[146:147]
    s_waitcnt lgkmcnt(6)
    s_nop 0
    v_pk_add_f32 v[156:157], v[156:157], v[160:161]
    v_pk_add_f32 v[220:221], v[220:221], v[152:153]
    v_pk_add_f32 v[158:159], v[158:159], v[162:163]
    v_pk_add_f32 v[222:223], v[222:223], v[154:155]
    v_pk_add_f32 v[220:221], v[220:221], v[156:157]
    v_pk_add_f32 v[222:223], v[222:223], v[158:159]
    s_waitcnt lgkmcnt(3)
    s_nop 0
    v_pk_add_f32 v[196:197], v[196:197], v[200:201]
    v_pk_add_f32 v[224:225], v[224:225], v[192:193]
    v_pk_add_f32 v[198:199], v[198:199], v[202:203]
    v_pk_add_f32 v[226:227], v[226:227], v[194:195]
    v_pk_add_f32 v[224:225], v[224:225], v[196:197]
    v_pk_add_f32 v[226:227], v[226:227], v[198:199]
    s_waitcnt lgkmcnt(0)
    s_nop 0
    v_pk_add_f32 v[208:209], v[208:209], v[164:165]
    v_pk_add_f32 v[228:229], v[228:229], v[204:205]
    v_pk_add_f32 v[210:211], v[210:211], v[166:167]
    v_pk_add_f32 v[230:231], v[230:231], v[206:207]
    v_pk_add_f32 v[228:229], v[228:229], v[208:209]
    v_pk_add_f32 v[230:231], v[230:231], v[210:211]
L_xw:
    s_waitcnt vmcnt(0)
    v_max_u32 v232, v168, v169
    v_max3_u32 v232, v232, v170, v171
    v_max3_u32 v232, v232, v172, v173
    v_max3_u32 v232, v232, v174, v175
    v_max3_u32 v232, v232, v176, v177
    v_max3_u32 v232, v232, v178, v179
    v_max3_u32 v232, v232, v180, v181
    v_max3_u32 v232, v232, v182, v183
    v_max3_u32 v232, v232, v184, v185
    v_max3_u32 v232, v232, v186, v187
    v_cmp_eq_u32 vcc, -1, v232
    s_cbranch_vccz L_xg
    s_sub_u32 s56, s56, 1
    s_cbranch_scc1 L_xg
    buffer_load_dwordx4 v[168:171], v239, s[28:31], 0 offen offset:0 sc1
    buffer_load_dwordx4 v[172:175], v239, s[28:31], 0 offen offset:1024 sc1
    buffer_load_dwordx4 v[176:179], v239, s[28:31], 0 offen offset:2048 sc1
    buffer_load_dwordx4 v[180:183], v239, s[28:31], 0 offen offset:3072 sc1
    buffer_load_dwordx4 v[184:187], v240, s[28:31], 0 offen offset:0 sc1
    s_branch L_xw
L_xg:
    v_pk_add_f32 v[212:213], v[212:213], v[168:169]
    v_pk_add_f32 v[214:215], v[214:215], v[170:171]
    v_cvt_pk_bf16_f32 v212, v212, v213
    v_cvt_pk_bf16_f32 v213, v214, v215
    buffer_store_dwordx2 v[212:213], v245, s[72:75], 0 offen
    v_pk_add_f32 v[216:217], v[216:217], v[172:173]
    v_pk_add_f32 v[218:219], v[218:219], v[174:175]
    v_cvt_pk_bf16_f32 v216, v216, v217
    v_cvt_pk_bf16_f32 v217, v218, v219
    buffer_store_dwordx2 v[216:217], v246, s[72:75], 0 offen
    v_pk_add_f32 v[220:221], v[220:221], v[176:177]
    v_pk_add_f32 v[222:223], v[222:223], v[178:179]
    v_cvt_pk_bf16_f32 v220, v220, v221
    v_cvt_pk_bf16_f32 v221, v222, v223
    buffer_store_dwordx2 v[220:221], v247, s[72:75], 0 offen
    v_pk_add_f32 v[224:225], v[224:225], v[180:181]
    v_pk_add_f32 v[226:227], v[226:227], v[182:183]
    v_cvt_pk_bf16_f32 v224, v224, v225
    v_cvt_pk_bf16_f32 v225, v226, v227
    buffer_store_dwordx2 v[224:225], v248, s[72:75], 0 offen
    v_pk_add_f32 v[228:229], v[228:229], v[184:185]
    v_pk_add_f32 v[230:231], v[230:231], v[186:187]
    v_cvt_pk_bf16_f32 v228, v228, v229
    v_cvt_pk_bf16_f32 v229, v230, v231
    buffer_store_dwordx2 v[228:229], v249, s[72:75], 0 offen
    s_endpgm
L_flw:
    s_sub_u32 s56, s56, 1
    s_cbranch_scc1 L_end
    s_sleep 4
    global_load_dword v253, v254, s[18:19] sc1
    s_waitcnt vmcnt(0)
    v_cmp_eq_u32 vcc, 0, v253
    s_cmp_lg_u32 vcc_hi, 0
    s_cbranch_scc1 L_flw
    s_branch L_fok
L_sp0:
    s_sub_u32 s56, s56, 1
    s_cbranch_scc1 L_end
    global_load_dword v252, v254, s[18:19] sc1
    s_waitcnt vmcnt(0)
    v_cmp_ne_u32 vcc, 1, v252
    s_bitcmp1_b32 vcc_lo, 0
    s_cbranch_scc0 L_go0
    s_sleep 1
    s_branch L_sp0
L_sp1:
    s_sub_u32 s56, s56, 1
    s_cbranch_scc1 L_end
    global_load_dword v252, v254, s[18:19] sc1
    s_waitcnt vmcnt(0)
    v_cmp_ne_u32 vcc, 1, v252
    s_bitcmp1_b32 vcc_lo, 1
    s_cbranch_scc0 L_go1
    s_sleep 1
    s_branch L_sp1
L_sp2:
    s_sub_u32 s56, s56, 1
    s_cbranch_scc1 L_end
    global_load_dword v252, v254, s[18:19] sc1
    s_waitcnt vmcnt(0)
    v_cmp_ne_u32 vcc, 1, v252
    s_bitcmp1_b32 vcc_lo, 2
    s_cbranch_scc0 L_go2
    s_sleep 1
    s_branch L_sp2
L_sp3:
    s_sub_u32 s56, s56, 1
    s_cbranch_scc1 L_end
    global_load_dword v252, v254, s[18:19] sc1
    s_waitcnt vmcnt(0)
    v_cmp_ne_u32 vcc, 1, v252
    s_bitcmp1_b32 vcc_lo, 3
    s_cbranch_scc0 L_go3
    s_sleep 1
    s_branch L_sp3
L_end:
    s_endpgm
.section .rodata,"a"
.p2align 6
.amdhsa_kernel standalone__mha_block_cached__near_ridge_kernel
  .amdhsa_next_free_vgpr 512
  .amdhsa_next_free_sgpr 102
  .amdhsa_accum_offset 256
  .amdhsa_group_segment_fixed_size 0
  .amdhsa_kernarg_size 64
  .amdhsa_user_sgpr_count 2
  .amdhsa_user_sgpr_kernarg_segment_ptr 1
  .amdhsa_system_sgpr_workgroup_id_x 1
.end_amdhsa_kernel
```
